```python
import torch

def _softmax(x, axis=-1):
    return torch.softmax(x, dim=axis)

def _gelu(x):
    return torch.nn.functional.gelu(x, approximate='tanh')

def _silu(x):
    return torch.nn.functional.silu(x)

def _sigmoid(x):
    return torch.sigmoid(x)

def _layernorm(x, axis=-1, eps=1e-05):
    m = x.mean(dim=axis, keepdim=True)
    v = x.var(dim=axis, keepdim=True, unbiased=False)
    return (x - m) / torch.sqrt(v + eps)

def _scatter_add(tgt, idx, src, axis=0):
    return tgt.clone().index_add_(axis, idx, src)

def _segment_sum(src, seg, n):
    out = torch.zeros((n,) + src.shape[1:], dtype=src.dtype)
    return out.index_add_(0, seg, src)

def _pad(x, pw):
    flat = tuple((v for pair in reversed(pw) for v in pair))
    return torch.nn.functional.pad(x, flat)
kernel_name = 'parallel_sum__memory_aug_recurrent_mem_tr__swiglu_ffn__prompt'

def setup_inputs():

    _w = lambda a: (lambda t: t.to(torch.bfloat16) if t.is_floating_point() else t)(torch.as_tensor(a))

    def _A_setup():
        B, S, Dm = (1, 2048, 512)
        H, Dh = (32, 128)
        M, seg = (8, 32)
        seg = min(seg, S)
        S = S // seg * seg
        return {'x': _w((lambda *s: torch.randn(*s, dtype=torch.bfloat16) * 0.05)(B, S, Dm)), 'mem0': _w((lambda *s: torch.randn(*s, dtype=torch.bfloat16) * 1.6)(B, M, Dm)), 'Wq': _w((lambda *s: torch.randn(*s, dtype=torch.bfloat16) * 0.8)(Dm, H, Dh) * Dm ** (-0.5)), 'Wk': _w((lambda *s: torch.randn(*s, dtype=torch.bfloat16) * 0.8)(Dm, H, Dh) * Dm ** (-0.5)), 'Wv': _w((lambda *s: torch.randn(*s, dtype=torch.bfloat16) * 1.6)(Dm, H, Dh) * Dm ** (-0.5)), 'Wo': _w((lambda *s: torch.randn(*s, dtype=torch.bfloat16) * 1.6)(H, Dh, Dm) * (H * Dh) ** (-0.5)), 'seg_len': seg}
    _A_in = _A_setup()

    def _B_setup():
        B, S, D, F = (1, 2048, 512, 1792)
        return {'x': _w((lambda *s: torch.randn(*s, dtype=torch.bfloat16) * 0.05)(B, S, D)), 'w_gate': _w((lambda *s: torch.randn(*s, dtype=torch.bfloat16) * 0.05)(D, F)), 'w_up': _w((lambda *s: torch.randn(*s, dtype=torch.bfloat16) * 0.05)(D, F)), 'w_down': _w((lambda *s: torch.randn(*s, dtype=torch.bfloat16) * 0.05)(F, D))}
    _B_in = _B_setup()
    return {'A_x': _A_in['x'], 'A_mem0': _A_in['mem0'], 'A_Wq': _A_in['Wq'], 'A_Wk': _A_in['Wk'], 'A_Wv': _A_in['Wv'], 'A_Wo': _A_in['Wo'], 'A_seg_len': _A_in['seg_len'], 'B_x': _B_in['x'], 'B_w_gate': _B_in['w_gate'], 'B_w_up': _B_in['w_up'], 'B_w_down': _B_in['w_down']}

def reference(A_x, A_mem0, A_Wq, A_Wk, A_Wv, A_Wo, A_seg_len, B_x, B_w_gate, B_w_up, B_w_down):

    def _A_ref(x, mem0, Wq, Wk, Wv, Wo, seg_len):
        B, S, Dm = x.shape
        H, Dh = (Wq.shape[1], Wq.shape[2])
        M = mem0.shape[1]
        scale = Dh ** (-0.5)
        n_seg = S // seg_len
        L = M + seg_len
        idx = torch.arange(L)
        mask = (idx[:, None] < M) | (idx[:, None] >= idx[None, :])
        mem = mem0
        outs = []
        for s in range(n_seg):
            xs = x[:, s * seg_len:(s + 1) * seg_len, :].clone()
            h = torch.concatenate([mem, xs], axis=1)
            q = torch.einsum('btd,dhe->bhte', h, Wq)
            k = torch.einsum('btd,dhe->bhte', h, Wk)
            v = torch.einsum('btd,dhe->bhte', h, Wv)
            scores = torch.einsum('bhqe,bhke->bhqk', q, k) * scale
            scores = torch.where(mask[None, None], scores, -1000000000.0)
            p = _softmax(scores, axis=-1)
            o = torch.einsum('bhqk,bhke->bhqe', p, v)
            o = torch.einsum('bhte,hed->btd', o, Wo)
            mem = o[:, :M, :].clone()
            outs.append(o[:, M:, :])
        return torch.concatenate(outs, axis=1)

    def _B_ref(x, w_gate, w_up, w_down):
        g = _silu(x @ w_gate)
        u = x @ w_up
        return g * u @ w_down
    x = A_x
    xn = _layernorm(x, axis=-1)
    return x + _A_ref(xn, A_mem0, A_Wq, A_Wk, A_Wv, A_Wo, A_seg_len) + _B_ref(xn, B_w_gate, B_w_up, B_w_down)
```

```asm
; @launch grid=(256,1,1) block=(256,1,1) lds=163840
.amdgcn_target "amdgcn-amd-amdhsa--gfx950"
.text
.globl parallel_sum__memory_aug_recurrent_mem_tr__swiglu_ffn__prompt_kernel
.p2align 8
.type parallel_sum__memory_aug_recurrent_mem_tr__swiglu_ffn__prompt_kernel,@function
parallel_sum__memory_aug_recurrent_mem_tr__swiglu_ffn__prompt_kernel:
  s_cmp_ge_u32 s2, 256
  s_cbranch_scc1 L_end
  s_load_dwordx16 s[16:31], s[0:1], 0
  s_load_dwordx8 s[32:39], s[0:1], 64
  s_load_dwordx4 s[40:43], s[0:1], 96
  s_getreg_b32 s3, hwreg(HW_REG_XCC_ID)
  s_and_b32 s3, s3, 7
  s_lshl_b32 s3, s3, 2
  s_lshr_b32 s3, 0x73625140, s3
  s_and_b32 s3, s3, 7
  v_lshrrev_b32 v1, 6, v0
  s_nop 0
  v_readfirstlane_b32 s4, v1
  v_and_b32 v0, 63, v0
  s_mov_b32 s7, 0x200000
  v_mov_b32 v2, 0
  s_getreg_b32 s8, hwreg(HW_REG_HW_ID, 8, 3)
  s_getreg_b32 s9, hwreg(HW_REG_HW_ID, 13, 2)
  s_lshl3_add_u32 s8, s9, s8
  s_mov_b32 s14, s8
  s_cmp_eq_u32 s3, 6
  s_cselect_b32 s9, 32, 0
  s_add_u32 s8, s8, s9
  s_cmp_eq_u32 s3, 0
  s_cselect_b32 s9, 17, 15
  s_cselect_b32 s10, 10, 8
  s_cmp_eq_u32 s3, 1
  s_cselect_b32 s9, 8, s9
  s_cselect_b32 s10, 13, s10
  s_lshl_b32 s8, s8, s9
  s_lshl_b32 s9, s4, 5
  v_lshrrev_b32 v6, 1, v0
  v_add_u32 v6, s9, v6
  v_lshlrev_b32 v6, s10, v6
  v_and_b32 v7, 1, v0
  v_lshl_add_u32 v6, v7, 7, v6
  v_add_u32 v6, s8, v6
  s_sub_u32 s15, s4, 1
  s_lshl_b32 s15, s15, 5
  s_add_u32 s14, s14, s15
  s_mov_b32 s15, 0
  s_cmp_eq_u32 s3, 0
  s_cselect_b32 s15, (L_send_R-L_role_R)/128+1, s15
  s_cselect_b32 s44, L_role_R-L_e_pc, s44
  s_cmp_lt_u32 s14, s15
  s_cbranch_scc0 L_e_wr
  s_lshl_b32 s14, s14, 7
  s_add_u32 s14, s14, s44
  s_getpc_b64 s[46:47]
L_e_pc:
  s_add_u32 s46, s46, s14
  s_addc_u32 s47, s47, 0
  s_mov_b64 exec, 0
  s_setpc_b64 s[46:47]
L_e_wr:
  s_mov_b64 exec, -1
  s_waitcnt lgkmcnt(0)
  s_cmp_eq_u32 s3, 0
  s_cselect_b64 s[12:13], s[26:27], s[16:17]
  s_cmp_eq_u32 s3, 1
  s_cselect_b64 s[12:13], s[22:23], s[12:13]
  s_lshr_b32 s11, 99, s3
  s_and_b32 s11, s11, 1
  s_cmp_eq_u32 s4, 0
  s_cbranch_scc1 L_tk0
  s_cmp_eq_u32 s11, 0
  s_cbranch_scc1 Lep_1
  global_load_dword v255, v6, s[12:13]
Lep_1:
  s_branch L_tk
L_tk0:
  s_lshl_b32 s8, s3, 5
  v_mov_b32 v3, s8
  v_mov_b32 v4, 1
  s_mov_b64 exec, 1
  global_atomic_add v5, v3, v4, s[40:41] sc0 sc1
  s_cmp_eq_u32 s11, 0
  s_cselect_b64 exec, 1, -1
  global_load_dword v255, v6, s[12:13]
  s_mov_b64 exec, 1
  s_waitcnt vmcnt(1)
  v_readfirstlane_b32 s9, v5
  s_lshl_b32 s5, s3, 5
  s_add_u32 s5, s5, s9
  s_cmp_lt_u32 s9, 32
  s_cbranch_scc1 L_tk1
  global_atomic_add v5, v2, v4, s[40:41] offset:36 sc0 sc1
  s_waitcnt vmcnt(0)
  v_readfirstlane_b32 s9, v5
L_ov:
  global_load_dword v8, v2, s[40:41] offset:0 sc1
  global_load_dword v9, v2, s[40:41] offset:32 sc1
  global_load_dword v10, v2, s[40:41] offset:64 sc1
  global_load_dword v11, v2, s[40:41] offset:96 sc1
  global_load_dword v12, v2, s[40:41] offset:128 sc1
  global_load_dword v13, v2, s[40:41] offset:160 sc1
  global_load_dword v14, v2, s[40:41] offset:192 sc1
  global_load_dword v15, v2, s[40:41] offset:224 sc1
  s_waitcnt vmcnt(0)
  v_add3_u32 v5, v8, v9, v10
  v_add3_u32 v5, v5, v11, v12
  v_add3_u32 v5, v5, v13, v14
  v_add_u32 v5, v5, v15
  v_cmp_gt_u32 vcc, 256, v5
  s_cbranch_vccz L_ov1
  s_sleep 2
  s_sub_u32 s7, s7, 1
  s_cbranch_scc0 L_ov
  s_mov_b32 s7, 0
L_ov1:
  s_mov_b32 s5, 255
  v_readfirstlane_b32 s10, v8
  s_min_u32 s10, s10, 32
  s_sub_u32 s11, 32, s10
  s_add_u32 s12, s10, s9
  s_add_u32 s12, s12, 0
  s_cmp_lt_u32 s9, s11
  s_cselect_b32 s5, s12, s5
  s_cbranch_scc1 L_tk1
  s_sub_u32 s9, s9, s11
  v_readfirstlane_b32 s10, v9
  s_min_u32 s10, s10, 32
  s_sub_u32 s11, 32, s10
  s_add_u32 s12, s10, s9
  s_add_u32 s12, s12, 32
  s_cmp_lt_u32 s9, s11
  s_cselect_b32 s5, s12, s5
  s_cbranch_scc1 L_tk1
  s_sub_u32 s9, s9, s11
  v_readfirstlane_b32 s10, v10
  s_min_u32 s10, s10, 32
  s_sub_u32 s11, 32, s10
  s_add_u32 s12, s10, s9
  s_add_u32 s12, s12, 64
  s_cmp_lt_u32 s9, s11
  s_cselect_b32 s5, s12, s5
  s_cbranch_scc1 L_tk1
  s_sub_u32 s9, s9, s11
  v_readfirstlane_b32 s10, v11
  s_min_u32 s10, s10, 32
  s_sub_u32 s11, 32, s10
  s_add_u32 s12, s10, s9
  s_add_u32 s12, s12, 96
  s_cmp_lt_u32 s9, s11
  s_cselect_b32 s5, s12, s5
  s_cbranch_scc1 L_tk1
  s_sub_u32 s9, s9, s11
  v_readfirstlane_b32 s10, v12
  s_min_u32 s10, s10, 32
  s_sub_u32 s11, 32, s10
  s_add_u32 s12, s10, s9
  s_add_u32 s12, s12, 128
  s_cmp_lt_u32 s9, s11
  s_cselect_b32 s5, s12, s5
  s_cbranch_scc1 L_tk1
  s_sub_u32 s9, s9, s11
  v_readfirstlane_b32 s10, v13
  s_min_u32 s10, s10, 32
  s_sub_u32 s11, 32, s10
  s_add_u32 s12, s10, s9
  s_add_u32 s12, s12, 160
  s_cmp_lt_u32 s9, s11
  s_cselect_b32 s5, s12, s5
  s_cbranch_scc1 L_tk1
  s_sub_u32 s9, s9, s11
  v_readfirstlane_b32 s10, v14
  s_min_u32 s10, s10, 32
  s_sub_u32 s11, 32, s10
  s_add_u32 s12, s10, s9
  s_add_u32 s12, s12, 192
  s_cmp_lt_u32 s9, s11
  s_cselect_b32 s5, s12, s5
  s_cbranch_scc1 L_tk1
  s_sub_u32 s9, s9, s11
  v_readfirstlane_b32 s10, v15
  s_min_u32 s10, s10, 32
  s_sub_u32 s11, 32, s10
  s_add_u32 s12, s10, s9
  s_add_u32 s12, s12, 224
  s_cmp_lt_u32 s9, s11
  s_cselect_b32 s5, s12, s5
  s_cbranch_scc1 L_tk1
  s_sub_u32 s9, s9, s11
L_tk1:
  v_mov_b32 v5, s5
  ds_write_b32 v2, v5
  s_waitcnt lgkmcnt(0)
  s_mov_b64 exec, -1
L_tk:
  s_barrier
  ds_read_b32 v5, v2
  s_waitcnt lgkmcnt(0)
  v_readfirstlane_b32 s5, v5
  s_barrier
  s_lshr_b32 s8, s5, 5
  s_and_b32 s6, s5, 31
  s_cmp_eq_u32 s8, 0
  s_cbranch_scc1 L_role_R
  s_cmp_eq_u32 s8, 1
  s_cbranch_scc1 L_role_KV
  s_cmp_eq_u32 s8, 2
  s_cbranch_scc1 L_role_QG
  s_cmp_eq_u32 s8, 3
  s_cbranch_scc1 L_role_QG
  s_cmp_eq_u32 s8, 4
  s_cbranch_scc1 L_role_T
  s_cmp_eq_u32 s8, 5
  s_cbranch_scc1 L_role_O
  s_cmp_eq_u32 s8, 6
  s_cbranch_scc1 L_role_O
  s_cmp_eq_u32 s8, 7
  s_cbranch_scc1 L_role_O
  s_branch L_end
L_end:
  s_endpgm
L_role_T:
  v_lshlrev_b32 v1, 4, v0
  v_mov_b32 v2, 0
  v_mov_b32 v3, 1
  s_and_b32 s45, s4, 1
  s_lshr_b32 s44, s4, 1
  v_and_b32 v4, 7, v0
  v_lshlrev_b32 v4, 2, v4
  v_and_b32 v5, 3, v0
  v_lshlrev_b32 v5, 10, v5
  v_lshrrev_b32 v6, 4, v0
  v_lshlrev_b32 v6, 2, v6
  v_and_b32 v7, 15, v0
  s_lshl_b32 s8, s45, 4
  v_add_u32 v7, s8, v7
  v_sub_u32 v7, v7, v6
  v_cmp_le_i32 s[70:71], 0, v7
  v_cmp_le_i32 s[72:73], 1, v7
  v_cmp_le_i32 s[74:75], 2, v7
  v_cmp_le_i32 s[76:77], 3, v7
  v_cmp_le_i32 s[78:79], 16, v7
  v_cmp_le_i32 s[80:81], 17, v7
  v_cmp_le_i32 s[82:83], 18, v7
  v_cmp_le_i32 s[84:85], 19, v7
  v_mov_b32 v8, 0x3f803f80
  v_mov_b32 v9, 0x3f803f80
  v_mov_b32 v10, 0x3f803f80
  v_mov_b32 v11, 0x3f803f80
  v_mov_b32 v12, 0xd028965f
  s_cmp_lg_u32 s4, 0
  s_cbranch_scc1 Lw1_2
Lww_3:
  global_load_dword v6, v2, s[40:41] offset:164 sc1
  s_waitcnt vmcnt(0)
  v_cmp_gt_u32 vcc, 64, v6
  s_cbranch_vccz Lwd_4
  s_sleep 100
  s_sub_u32 s7, s7, 1
  s_cbranch_scc0 Lww_3
  s_mov_b32 s7, 0
Lwd_4:
Lw1_2:
  s_barrier
  v_lshrrev_b32 v6, 4, v0
  v_and_b32 v7, 15, v0
  s_lshl_b32 s8, s4, 11
  v_lshlrev_b32 v13, 7, v6
  v_lshl_add_u32 v13, v7, 2, v13
  v_add_u32 v13, s8, v13
  v_add_u32 v14, 1024, v13
  v_lshrrev_b32 v15, 2, v7
  v_and_b32 v7, 1, v7
  v_lshl_add_u32 v15, v15, 1, v7
  v_lshlrev_b32 v15, 6, v15
  v_lshl_add_u32 v15, v6, 4, v15
  v_add_u32 v15, s8, v15
  s_lshl_b32 s62, s44, 18
  s_lshl_b32 s63, s6, 13
  s_add_u32 s62, s62, s63
  s_lshr_b32 s63, s62, 7
  s_add_u32 s63, s63, 4096
  s_add_u32 s86, s42, s63
  s_addc_u32 s87, s43, 0
  s_add_u32 s63, s62, 16781312
  s_add_u32 s50, s42, s63
  s_addc_u32 s51, s43, 0
  s_add_u32 s52, s50, 16777216
  s_addc_u32 s53, s51, 0
  s_lshl_b32 s64, s45, 10
  s_add_u32 s64, s64, 33554432
  s_add_u32 s48, s50, s64
  s_addc_u32 s49, s51, 0
Lww_5:
  global_load_dword v6, v4, s[86:87] offset:0 sc1
  s_waitcnt vmcnt(0)
  v_cmp_gt_u32 vcc, 1, v6
  s_cbranch_vccz Lwd_6
  s_sleep 2
  s_sub_u32 s7, s7, 1
  s_cbranch_scc0 Lww_5
  s_mov_b32 s7, 0
Lwd_6:
  global_load_dwordx4 v[196:199], v1, s[48:49] offset:-4096 sc1
  global_load_dwordx4 v[200:203], v1, s[48:49] offset:-2048 sc1
  global_load_dwordx4 v[204:207], v1, s[48:49] offset:0 sc1
  global_load_dwordx4 v[208:211], v1, s[48:49] offset:2048 sc1
  global_load_dwordx4 v[32:35], v1, s[50:51] offset:-4096 sc1
  global_load_dwordx4 v[36:39], v1, s[50:51] offset:-3072 sc1
  global_load_dwordx4 v[40:43], v1, s[50:51] offset:-2048 sc1
  global_load_dwordx4 v[44:47], v1, s[50:51] offset:-1024 sc1
  global_load_dwordx4 v[48:51], v1, s[50:51] offset:0 sc1
  global_load_dwordx4 v[52:55], v1, s[50:51] offset:1024 sc1
  global_load_dwordx4 v[56:59], v1, s[50:51] offset:2048 sc1
  global_load_dwordx4 v[60:63], v1, s[50:51] offset:3072 sc1
  global_load_dwordx4 v[64:67], v1, s[52:53] offset:-4096 sc1
  global_load_dwordx4 v[68:71], v1, s[52:53] offset:-3072 sc1
  global_load_dwordx4 v[72:75], v1, s[52:53] offset:-2048 sc1
  global_load_dwordx4 v[76:79], v1, s[52:53] offset:-1024 sc1
  global_load_dwordx4 v[80:83], v1, s[52:53] offset:0 sc1
  global_load_dwordx4 v[84:87], v1, s[52:53] offset:1024 sc1
  global_load_dwordx4 v[88:91], v1, s[52:53] offset:2048 sc1
  global_load_dwordx4 v[92:95], v1, s[52:53] offset:3072 sc1
  s_waitcnt vmcnt(8)
L_T_loop:
  s_add_u32 s54, s50, 50855936
  s_addc_u32 s55, s51, 0
  s_add_u32 s65, s44, 2
  s_min_u32 s65, s65, 63
  s_lshl_b32 s62, s65, 18
  s_lshl_b32 s63, s6, 13
  s_add_u32 s62, s62, s63
  s_lshr_b32 s63, s62, 7
  s_add_u32 s63, s63, 4096
  s_add_u32 s86, s42, s63
  s_addc_u32 s87, s43, 0
  s_add_u32 s63, s62, 16781312
  s_add_u32 s50, s42, s63
  s_addc_u32 s51, s43, 0
  s_add_u32 s52, s50, 16777216
  s_addc_u32 s53, s51, 0
  s_lshl_b32 s64, s45, 10
  s_add_u32 s64, s64, 33554432
  s_add_u32 s48, s50, s64
  s_addc_u32 s49, s51, 0
  global_load_dword v7, v4, s[86:87] sc1
  v_mov_b32 v16, v196
  v_mov_b32 v17, v197
  v_mov_b32 v18, v198
  v_mov_b32 v19, v199
  v_mov_b32 v20, v200
  v_mov_b32 v21, v201
  v_mov_b32 v22, v202
  v_mov_b32 v23, v203
  v_mov_b32 v24, v204
  v_mov_b32 v25, v205
  v_mov_b32 v26, v206
  v_mov_b32 v27, v207
  v_mov_b32 v28, v208
  v_mov_b32 v29, v209
  v_mov_b32 v30, v210
  v_mov_b32 v31, v211
  v_mfma_f32_16x16x32_bf16 v[120:123], v[32:35], v[16:19], 0
  v_mfma_f32_16x16x32_bf16 v[124:127], v[36:39], v[16:19], 0
  v_mfma_f32_16x16x32_bf16 v[120:123], v[40:43], v[20:23], v[120:123]
  v_mfma_f32_16x16x32_bf16 v[124:127], v[44:47], v[20:23], v[124:127]
  v_mfma_f32_16x16x32_bf16 v[120:123], v[48:51], v[24:27], v[120:123]
  v_mfma_f32_16x16x32_bf16 v[124:127], v[52:55], v[24:27], v[124:127]
  v_mfma_f32_16x16x32_bf16 v[120:123], v[56:59], v[28:31], v[120:123]
  v_mfma_f32_16x16x32_bf16 v[124:127], v[60:63], v[28:31], v[124:127]
  s_lshl_b32 s62, s44, 1
  s_add_u32 s62, s62, s45
  s_lshl_b32 s63, s62, 5
  s_add_u32 s63, s63, s6
  s_lshl_b32 s64, s63, 12
  s_add_u32 s64, s64, 84934656
  s_add_u32 s56, s42, s64
  s_addc_u32 s57, s43, 0
  v_cndmask_b32 v120, v12, v120, s[70:71]
  v_cndmask_b32 v121, v12, v121, s[72:73]
  v_cndmask_b32 v122, v12, v122, s[74:75]
  v_cndmask_b32 v123, v12, v123, s[76:77]
  v_cndmask_b32 v124, v12, v124, s[78:79]
  v_cndmask_b32 v125, v12, v125, s[80:81]
  v_cndmask_b32 v126, v12, v126, s[82:83]
  v_cndmask_b32 v127, v12, v127, s[84:85]
  v_max3_f32 v172, v120, v121, v122
  v_max3_f32 v173, v123, v124, v125
  v_max3_f32 v172, v172, v126, v127
  v_max_f32 v172, v172, v173
  s_cmp_ge_u32 s44, 60
  s_cselect_b32 s62, 0x40000, 0
  s_sub_u32 s46, s54, s62
  s_subb_u32 s47, s55, 0
  s_cmp_ge_u32 s44, 63
  s_cbranch_scc1 L_T_l2
  global_load_dword v6, v5, s[46:47] offset:-3076 sc1
  s_sleep 9
  global_load_dword v6, v5, s[46:47] offset:-3076 sc1
  s_sleep 9
L_T_l:
  global_load_dword v6, v5, s[46:47] offset:-3076 sc1
  s_waitcnt vmcnt(2)
  v_cmp_eq_u32 vcc, -1, v6
  s_cbranch_vccz L_T_l2
  s_sub_u32 s7, s7, 1
  s_cbranch_scc0 L_T_l
  s_mov_b32 s7, 0
L_T_l2:
L_T_km:
  global_load_dwordx4 v[96:99], v1, s[54:55] offset:-4096 sc1
  global_load_dwordx4 v[100:103], v1, s[54:55] offset:-3072 sc1
  global_load_dwordx4 v[104:107], v1, s[54:55] offset:-2048 sc1
  global_load_dwordx4 v[108:111], v1, s[54:55] offset:-1024 sc1
  s_waitcnt vmcnt(3)
  v_max3_u32 v3, v96, v97, 0
  v_max3_u32 v3, v98, v99, v3
  ds_write2_b32 v13, v96, v97 offset0:0 offset1:16
  s_waitcnt vmcnt(2)
  v_max3_u32 v3, v100, v101, v3
  v_max3_u32 v3, v102, v103, v3
  ds_write2_b32 v13, v100, v101 offset0:128 offset1:144
  s_waitcnt vmcnt(1)
  v_max3_u32 v3, v104, v105, v3
  v_max3_u32 v3, v106, v107, v3
  ds_write2_b32 v14, v104, v105 offset0:0 offset1:16
  s_waitcnt vmcnt(0)
  v_max3_u32 v3, v108, v109, v3
  v_max3_u32 v3, v110, v111, v3
  ds_write2_b32 v14, v108, v109 offset0:128 offset1:144
  ds_read_b128 v[180:183], v15 offset:0
  ds_read_b128 v[184:187], v15 offset:512
  ds_read_b128 v[188:191], v15 offset:1024
  ds_read_b128 v[192:195], v15 offset:1536
  v_cmp_eq_u32 vcc, -1, v3
  s_cbranch_vccz L_T_ok
  s_waitcnt lgkmcnt(0)
  s_sub_u32 s7, s7, 1
  s_cbranch_scc0 L_T_km
  s_mov_b32 s7, 0
L_T_ok:
  s_waitcnt lgkmcnt(3)
  v_mfma_f32_16x16x32_bf16 v[128:131], v[180:183], v[16:19], 0
  s_waitcnt lgkmcnt(2)
  v_mfma_f32_16x16x32_bf16 v[128:131], v[184:187], v[20:23], v[128:131]
  s_waitcnt lgkmcnt(1)
  v_mfma_f32_16x16x32_bf16 v[128:131], v[188:191], v[24:27], v[128:131]
  s_waitcnt lgkmcnt(0)
  v_mfma_f32_16x16x32_bf16 v[128:131], v[192:195], v[28:31], v[128:131]
  s_cmp_ge_u32 s44, 62
  v_cmp_eq_u32 vcc, 0, v7
  s_nop 2
  s_cbranch_scc1 L_T_b
  s_cbranch_vccnz L_T_b
  global_load_dwordx4 v[196:199], v1, s[48:49] offset:-4096 sc1
  global_load_dwordx4 v[200:203], v1, s[48:49] offset:-2048 sc1
  global_load_dwordx4 v[204:207], v1, s[48:49] offset:0 sc1
  global_load_dwordx4 v[208:211], v1, s[48:49] offset:2048 sc1
  global_load_dwordx4 v[32:35], v1, s[50:51] offset:-4096 sc1
  global_load_dwordx4 v[36:39], v1, s[50:51] offset:-3072 sc1
  global_load_dwordx4 v[40:43], v1, s[50:51] offset:-2048 sc1
  global_load_dwordx4 v[44:47], v1, s[50:51] offset:-1024 sc1
  global_load_dwordx4 v[48:51], v1, s[50:51] offset:0 sc1
  global_load_dwordx4 v[52:55], v1, s[50:51] offset:1024 sc1
  global_load_dwordx4 v[56:59], v1, s[50:51] offset:2048 sc1
  global_load_dwordx4 v[60:63], v1, s[50:51] offset:3072 sc1
L_T_b:
  v_max3_f32 v172, v172, v128, v129
  v_mov_b32 v173, v172
  s_nop 1
  v_permlane32_swap_b32 v172, v173
  v_max_f32 v172, v172, v173
  v_mov_b32 v173, v172
  s_nop 1
  v_permlane16_swap_b32 v172, v173
  v_max_f32 v172, v172, v173
  v_mul_f32 v172, 0xbe0293ee, v172
  s_mov_b32 s62, 0x3e0293ee
  v_fma_f32 v120, v120, s62, v172
  v_fma_f32 v121, v121, s62, v172
  v_fma_f32 v122, v122, s62, v172
  v_fma_f32 v123, v123, s62, v172
  v_fma_f32 v124, v124, s62, v172
  v_fma_f32 v125, v125, s62, v172
  v_fma_f32 v126, v126, s62, v172
  v_fma_f32 v127, v127, s62, v172
  v_fma_f32 v128, v128, s62, v172
  v_fma_f32 v129, v129, s62, v172
  v_exp_f32 v120, v120
  v_exp_f32 v121, v121
  v_exp_f32 v122, v122
  v_exp_f32 v123, v123
  v_exp_f32 v124, v124
  v_exp_f32 v125, v125
  v_exp_f32 v126, v126
  v_exp_f32 v127, v127
  v_exp_f32 v128, v128
  v_exp_f32 v129, v129
  v_cvt_pk_bf16_f32 v120, v120, v121
  v_cvt_pk_bf16_f32 v121, v122, v123
  v_cvt_pk_bf16_f32 v122, v124, v125
  v_cvt_pk_bf16_f32 v123, v126, v127
  v_cvt_pk_bf16_f32 v168, v128, v129
  v_mov_b32 v169, 0
  v_mov_b32 v170, 0
  v_mov_b32 v171, v168
  v_mfma_f32_16x16x32_bf16 v[132:135], v[8:11], v[120:123], 0
  v_mfma_f32_16x16x16_bf16 v[176:179], v[8:9], v[168:169], 0
  v_mfma_f32_16x16x32_bf16 v[136:139], v[64:67], v[120:123], 0
  v_mfma_f32_16x16x32_bf16 v[140:143], v[68:71], v[120:123], 0
  v_mfma_f32_16x16x32_bf16 v[144:147], v[72:75], v[120:123], 0
  v_mfma_f32_16x16x32_bf16 v[148:151], v[76:79], v[120:123], 0
  v_mfma_f32_16x16x32_bf16 v[152:155], v[80:83], v[120:123], 0
  v_mfma_f32_16x16x32_bf16 v[156:159], v[84:87], v[120:123], 0
  v_mfma_f32_16x16x32_bf16 v[160:163], v[88:91], v[120:123], 0
  v_mfma_f32_16x16x32_bf16 v[164:167], v[92:95], v[120:123], 0
  v_add_f32 v172, v132, v176
  v_rcp_f32 v172, v172
  v_mfma_f32_16x16x16_bf16 v[136:139], v[98:99], v[168:169], v[136:139]
  v_mfma_f32_16x16x16_bf16 v[140:143], v[98:99], v[170:171], v[140:143]
  v_mfma_f32_16x16x16_bf16 v[144:147], v[102:103], v[168:169], v[144:147]
  v_mfma_f32_16x16x16_bf16 v[148:151], v[102:103], v[170:171], v[148:151]
  v_mfma_f32_16x16x16_bf16 v[152:155], v[106:107], v[168:169], v[152:155]
  v_mfma_f32_16x16x16_bf16 v[156:159], v[106:107], v[170:171], v[156:159]
  v_mfma_f32_16x16x16_bf16 v[160:163], v[110:111], v[168:169], v[160:163]
  v_mfma_f32_16x16x16_bf16 v[164:167], v[110:111], v[170:171], v[164:167]
  v_mul_f32 v136, v136, v172
  v_mul_f32 v137, v137, v172
  v_mul_f32 v138, v138, v172
  v_mul_f32 v139, v139, v172
  v_mul_f32 v140, v140, v172
  v_mul_f32 v141, v141, v172
  v_mul_f32 v142, v142, v172
  v_mul_f32 v143, v143, v172
  v_cvt_pk_bf16_f32 v136, v136, v137
  v_cvt_pk_bf16_f32 v137, v138, v139
  v_cvt_pk_bf16_f32 v138, v140, v141
  v_cvt_pk_bf16_f32 v139, v142, v143
  global_store_dwordx4 v1, v[136:139], s[56:57] offset:0 sc1
  v_mul_f32 v144, v144, v172
  v_mul_f32 v145, v145, v172
  v_mul_f32 v146, v146, v172
  v_mul_f32 v147, v147, v172
  v_mul_f32 v148, v148, v172
  v_mul_f32 v149, v149, v172
  v_mul_f32 v150, v150, v172
  v_mul_f32 v151, v151, v172
  v_cvt_pk_bf16_f32 v144, v144, v145
  v_cvt_pk_bf16_f32 v145, v146, v147
  v_cvt_pk_bf16_f32 v146, v148, v149
  v_cvt_pk_bf16_f32 v147, v150, v151
  global_store_dwordx4 v1, v[144:147], s[56:57] offset:1024 sc1
  v_mul_f32 v152, v152, v172
  v_mul_f32 v153, v153, v172
  v_mul_f32 v154, v154, v172
  v_mul_f32 v155, v155, v172
  v_mul_f32 v156, v156, v172
  v_mul_f32 v157, v157, v172
  v_mul_f32 v158, v158, v172
  v_mul_f32 v159, v159, v172
  v_cvt_pk_bf16_f32 v152, v152, v153
  v_cvt_pk_bf16_f32 v153, v154, v155
  v_cvt_pk_bf16_f32 v154, v156, v157
  v_cvt_pk_bf16_f32 v155, v158, v159
  global_store_dwordx4 v1, v[152:155], s[56:57] offset:2048 sc1
  v_mul_f32 v160, v160, v172
  v_mul_f32 v161, v161, v172
  v_mul_f32 v162, v162, v172
  v_mul_f32 v163, v163, v172
  v_mul_f32 v164, v164, v172
  v_mul_f32 v165, v165, v172
  v_mul_f32 v166, v166, v172
  v_mul_f32 v167, v167, v172
  v_cvt_pk_bf16_f32 v160, v160, v161
  v_cvt_pk_bf16_f32 v161, v162, v163
  v_cvt_pk_bf16_f32 v162, v164, v165
  v_cvt_pk_bf16_f32 v163, v166, v167
  global_store_dwordx4 v1, v[160:163], s[56:57] offset:3072 sc1
  s_add_u32 s44, s44, 2
  s_cmp_ge_u32 s44, 64
  s_cbranch_scc1 L_T_end
  s_cbranch_vccz L_T_c
Lww_7:
  global_load_dword v6, v4, s[86:87] offset:0 sc1
  s_waitcnt vmcnt(0)
  v_cmp_gt_u32 vcc, 1, v6
  s_cbranch_vccz Lwd_8
  s_sleep 2
  s_sub_u32 s7, s7, 1
  s_cbranch_scc0 Lww_7
  s_mov_b32 s7, 0
Lwd_8:
  global_load_dwordx4 v[196:199], v1, s[48:49] offset:-4096 sc1
  global_load_dwordx4 v[200:203], v1, s[48:49] offset:-2048 sc1
  global_load_dwordx4 v[204:207], v1, s[48:49] offset:0 sc1
  global_load_dwordx4 v[208:211], v1, s[48:49] offset:2048 sc1
  global_load_dwordx4 v[32:35], v1, s[50:51] offset:-4096 sc1
  global_load_dwordx4 v[36:39], v1, s[50:51] offset:-3072 sc1
  global_load_dwordx4 v[40:43], v1, s[50:51] offset:-2048 sc1
  global_load_dwordx4 v[44:47], v1, s[50:51] offset:-1024 sc1
  global_load_dwordx4 v[48:51], v1, s[50:51] offset:0 sc1
  global_load_dwordx4 v[52:55], v1, s[50:51] offset:1024 sc1
  global_load_dwordx4 v[56:59], v1, s[50:51] offset:2048 sc1
  global_load_dwordx4 v[60:63], v1, s[50:51] offset:3072 sc1
  s_waitcnt vmcnt(0)
L_T_c:
  global_load_dwordx4 v[64:67], v1, s[52:53] offset:-4096 sc1
  global_load_dwordx4 v[68:71], v1, s[52:53] offset:-3072 sc1
  global_load_dwordx4 v[72:75], v1, s[52:53] offset:-2048 sc1
  global_load_dwordx4 v[76:79], v1, s[52:53] offset:-1024 sc1
  global_load_dwordx4 v[80:83], v1, s[52:53] offset:0 sc1
  global_load_dwordx4 v[84:87], v1, s[52:53] offset:1024 sc1
  global_load_dwordx4 v[88:91], v1, s[52:53] offset:2048 sc1
  global_load_dwordx4 v[92:95], v1, s[52:53] offset:3072 sc1
  s_waitcnt vmcnt(12)
  s_branch L_T_loop
L_T_end:
  s_endpgm
L_role_O:
  s_sub_u32 s44, s5, 160
  s_cmp_lt_u32 s44, 64
  s_cbranch_scc1 L_ln
  s_branch L_ln_done
L_ln:
  v_mov_b32 v8, 0
  v_mov_b32 v9, 0
  v_mov_b32 v10, 0
  v_mov_b32 v11, 0
  s_lshl_b32 s8, s44, 12
  s_lshl_b32 s9, s4, 10
  s_add_u32 s8, s8, s9
  v_lshl_add_u32 v4, v0, 4, s8
  v_and_b32 v5, 7, v0
  v_lshrrev_b32 v6, 3, v0
  s_lshl_b32 s8, s44, 15
  s_lshl_b32 s9, s4, 13
  s_add_u32 s8, s8, s9
  v_lshlrev_b32 v7, 10, v5
  v_lshl_add_u32 v7, v6, 4, v7
  v_add_u32 v7, s8, v7
  global_load_dwordx4 v[16:19], v7, s[16:17] offset:0
  global_load_dwordx4 v[20:23], v7, s[16:17] offset:128
  global_load_dwordx4 v[24:27], v7, s[16:17] offset:256
  global_load_dwordx4 v[28:31], v7, s[16:17] offset:384
  global_load_dwordx4 v[32:35], v7, s[16:17] offset:512
  global_load_dwordx4 v[36:39], v7, s[16:17] offset:640
  global_load_dwordx4 v[40:43], v7, s[16:17] offset:768
  global_load_dwordx4 v[44:47], v7, s[16:17] offset:896
  s_cmp_lg_u32 s44, 63
  s_cbranch_scc1 L_ln_a
  v_lshrrev_b32 v56, 4, v0
  v_bfe_u32 v57, v0, 1, 3
  v_and_b32 v58, 1, v0
  v_lshlrev_b32 v59, 10, v57
  v_and_b32 v57, 1, v56
  v_lshl_add_u32 v59, v57, 6, v59
  v_lshrrev_b32 v57, 1, v56
  v_lshl_add_u32 v59, v57, 4, v59
  v_lshl_add_u32 v59, v58, 2, v59
  s_lshl_b32 s8, s4, 8
  v_add_u32 v59, s8, v59
  global_load_dword v48, v59, s[18:19] offset:0
  global_load_dword v49, v59, s[18:19] offset:32
  global_load_dword v50, v59, s[18:19] offset:8
  global_load_dword v51, v59, s[18:19] offset:40
  global_load_dword v52, v59, s[18:19] offset:128
  global_load_dword v53, v59, s[18:19] offset:160
  global_load_dword v54, v59, s[18:19] offset:136
  global_load_dword v55, v59, s[18:19] offset:168
L_ln_a:
  global_store_dwordx4 v4, v[8:11], s[42:43] sc1
  v_mov_b32 v60, -1
  v_mov_b32 v61, -1
  v_mov_b32 v62, -1
  v_mov_b32 v63, -1
  s_add_u32 s12, s42, 262144
  s_addc_u32 s13, s43, 0
  global_store_dwordx4 v4, v[60:63], s[12:13] sc1
  s_cmp_lt_u32 s44, 4
  s_cbranch_scc0 L_ln_p
  s_add_u32 s12, s42, 524288
  s_addc_u32 s13, s43, 0
  global_store_dwordx4 v4, v[60:63], s[12:13] sc1
L_ln_p:
  s_add_u32 s12, s42, 655359
  s_addc_u32 s13, s43, 0
  s_and_b32 s12, s12, 0xffff0000
  v_and_b32 v12, 1, v6
  v_lshlrev_b32 v12, 11, v12
  v_lshrrev_b32 v13, 1, v6
  v_lshl_add_u32 v12, v13, 8, v12
  v_lshl_add_u32 v12, v5, 4, v12
  s_lshl_b32 s8, s44, 15
  s_lshr_b32 s9, s4, 1
  s_lshl_b32 s9, s9, 10
  s_add_u32 s8, s8, s9
  s_and_b32 s9, s4, 1
  s_lshl_b32 s9, s9, 7
  s_add_u32 s8, s8, s9
  s_add_u32 s8, s8, 1048576
  v_add_u32 v12, s8, v12
  s_mov_b32 s9, 0xffff0000
  s_waitcnt vmcnt(2)
  s_and_b32 s8, s44, 63
  s_sub_u32 s8, s8, 2
  s_cmp_lt_u32 s8, 6
  s_cbranch_scc0 L_ln_c
  s_lshr_b32 s8, s44, 4
  s_mul_i32 s8, s8, 0
  v_add_u32 v13, s8, v4
  global_store_dwordx4 v13, v[60:63], s[12:13] sc1
L_ln_c:
  v_lshlrev_b32 v64, 16, v16
  v_and_b32 v65, s9, v16
  v_lshlrev_b32 v66, 16, v17
  v_and_b32 v67, s9, v17
  v_lshlrev_b32 v68, 16, v18
  v_and_b32 v69, s9, v18
  v_lshlrev_b32 v70, 16, v19
  v_and_b32 v71, s9, v19
  v_lshlrev_b32 v72, 16, v20
  v_and_b32 v73, s9, v20
  v_lshlrev_b32 v74, 16, v21
  v_and_b32 v75, s9, v21
  v_lshlrev_b32 v76, 16, v22
  v_and_b32 v77, s9, v22
  v_lshlrev_b32 v78, 16, v23
  v_and_b32 v79, s9, v23
  v_lshlrev_b32 v80, 16, v24
  v_and_b32 v81, s9, v24
  v_lshlrev_b32 v82, 16, v25
  v_and_b32 v83, s9, v25
  v_lshlrev_b32 v84, 16, v26
  v_and_b32 v85, s9, v26
  v_lshlrev_b32 v86, 16, v27
  v_and_b32 v87, s9, v27
  v_lshlrev_b32 v88, 16, v28
  v_and_b32 v89, s9, v28
  v_lshlrev_b32 v90, 16, v29
  v_and_b32 v91, s9, v29
  v_lshlrev_b32 v92, 16, v30
  v_and_b32 v93, s9, v30
  v_lshlrev_b32 v94, 16, v31
  v_and_b32 v95, s9, v31
  v_lshlrev_b32 v96, 16, v32
  v_and_b32 v97, s9, v32
  v_lshlrev_b32 v98, 16, v33
  v_and_b32 v99, s9, v33
  v_lshlrev_b32 v100, 16, v34
  v_and_b32 v101, s9, v34
  v_lshlrev_b32 v102, 16, v35
  v_and_b32 v103, s9, v35
  v_lshlrev_b32 v104, 16, v36
  v_and_b32 v105, s9, v36
  v_lshlrev_b32 v106, 16, v37
  v_and_b32 v107, s9, v37
  v_lshlrev_b32 v108, 16, v38
  v_and_b32 v109, s9, v38
  v_lshlrev_b32 v110, 16, v39
  v_and_b32 v111, s9, v39
  v_lshlrev_b32 v112, 16, v40
  v_and_b32 v113, s9, v40
  v_lshlrev_b32 v114, 16, v41
  v_and_b32 v115, s9, v41
  v_lshlrev_b32 v116, 16, v42
  v_and_b32 v117, s9, v42
  v_lshlrev_b32 v118, 16, v43
  v_and_b32 v119, s9, v43
  v_lshlrev_b32 v120, 16, v44
  v_and_b32 v121, s9, v44
  v_lshlrev_b32 v122, 16, v45
  v_and_b32 v123, s9, v45
  v_lshlrev_b32 v124, 16, v46
  v_and_b32 v125, s9, v46
  v_lshlrev_b32 v126, 16, v47
  v_and_b32 v127, s9, v47
  v_add_f32 v14, v64, v65
  v_add_f32 v15, v66, v67
  v_add_f32 v14, v14, v68
  v_add_f32 v15, v15, v69
  v_add_f32 v14, v14, v70
  v_add_f32 v15, v15, v71
  v_add_f32 v14, v14, v72
  v_add_f32 v15, v15, v73
  v_add_f32 v14, v14, v74
  v_add_f32 v15, v15, v75
  v_add_f32 v14, v14, v76
  v_add_f32 v15, v15, v77
  v_add_f32 v14, v14, v78
  v_add_f32 v15, v15, v79
  v_add_f32 v14, v14, v80
  v_add_f32 v15, v15, v81
  v_add_f32 v14, v14, v82
  v_add_f32 v15, v15, v83
  v_add_f32 v14, v14, v84
  v_add_f32 v15, v15, v85
  v_add_f32 v14, v14, v86
  v_add_f32 v15, v15, v87
  v_add_f32 v14, v14, v88
  v_add_f32 v15, v15, v89
  v_add_f32 v14, v14, v90
  v_add_f32 v15, v15, v91
  v_add_f32 v14, v14, v92
  v_add_f32 v15, v15, v93
  v_add_f32 v14, v14, v94
  v_add_f32 v15, v15, v95
  v_add_f32 v14, v14, v96
  v_add_f32 v15, v15, v97
  v_add_f32 v14, v14, v98
  v_add_f32 v15, v15, v99
  v_add_f32 v14, v14, v100
  v_add_f32 v15, v15, v101
  v_add_f32 v14, v14, v102
  v_add_f32 v15, v15, v103
  v_add_f32 v14, v14, v104
  v_add_f32 v15, v15, v105
  v_add_f32 v14, v14, v106
  v_add_f32 v15, v15, v107
  v_add_f32 v14, v14, v108
  v_add_f32 v15, v15, v109
  v_add_f32 v14, v14, v110
  v_add_f32 v15, v15, v111
  v_add_f32 v14, v14, v112
  v_add_f32 v15, v15, v113
  v_add_f32 v14, v14, v114
  v_add_f32 v15, v15, v115
  v_add_f32 v14, v14, v116
  v_add_f32 v15, v15, v117
  v_add_f32 v14, v14, v118
  v_add_f32 v15, v15, v119
  v_add_f32 v14, v14, v120
  v_add_f32 v15, v15, v121
  v_add_f32 v14, v14, v122
  v_add_f32 v15, v15, v123
  v_add_f32 v14, v14, v124
  v_add_f32 v15, v15, v125
  v_add_f32 v14, v14, v126
  v_add_f32 v15, v15, v127
  v_add_f32 v14, v14, v15
  s_nop 1
  v_add_f32_dpp v14, v14, v14 row_ror:8 row_mask:0xf bank_mask:0xf
  v_mov_b32 v13, v14
  s_nop 1
  v_permlane16_swap_b32 v14, v13
  v_add_f32 v14, v14, v13
  v_mov_b32 v13, v14
  s_nop 1
  v_permlane32_swap_b32 v14, v13
  v_add_f32 v14, v14, v13
  v_mul_f32 v14, 0x3b000000, v14
  v_mov_b32 v15, 0
  v_mov_b32 v9, 0
  v_sub_f32 v10, v64, v14
  v_sub_f32 v11, v65, v14
  v_fmac_f32 v15, v10, v10
  v_fmac_f32 v9, v11, v11
  v_sub_f32 v10, v66, v14
  v_sub_f32 v11, v67, v14
  v_fmac_f32 v15, v10, v10
  v_fmac_f32 v9, v11, v11
  v_sub_f32 v10, v68, v14
  v_sub_f32 v11, v69, v14
  v_fmac_f32 v15, v10, v10
  v_fmac_f32 v9, v11, v11
  v_sub_f32 v10, v70, v14
  v_sub_f32 v11, v71, v14
  v_fmac_f32 v15, v10, v10
  v_fmac_f32 v9, v11, v11
  v_sub_f32 v10, v72, v14
  v_sub_f32 v11, v73, v14
  v_fmac_f32 v15, v10, v10
  v_fmac_f32 v9, v11, v11
  v_sub_f32 v10, v74, v14
  v_sub_f32 v11, v75, v14
  v_fmac_f32 v15, v10, v10
  v_fmac_f32 v9, v11, v11
  v_sub_f32 v10, v76, v14
  v_sub_f32 v11, v77, v14
  v_fmac_f32 v15, v10, v10
  v_fmac_f32 v9, v11, v11
  v_sub_f32 v10, v78, v14
  v_sub_f32 v11, v79, v14
  v_fmac_f32 v15, v10, v10
  v_fmac_f32 v9, v11, v11
  v_sub_f32 v10, v80, v14
  v_sub_f32 v11, v81, v14
  v_fmac_f32 v15, v10, v10
  v_fmac_f32 v9, v11, v11
  v_sub_f32 v10, v82, v14
  v_sub_f32 v11, v83, v14
  v_fmac_f32 v15, v10, v10
  v_fmac_f32 v9, v11, v11
  v_sub_f32 v10, v84, v14
  v_sub_f32 v11, v85, v14
  v_fmac_f32 v15, v10, v10
  v_fmac_f32 v9, v11, v11
  v_sub_f32 v10, v86, v14
  v_sub_f32 v11, v87, v14
  v_fmac_f32 v15, v10, v10
  v_fmac_f32 v9, v11, v11
  v_sub_f32 v10, v88, v14
  v_sub_f32 v11, v89, v14
  v_fmac_f32 v15, v10, v10
  v_fmac_f32 v9, v11, v11
  v_sub_f32 v10, v90, v14
  v_sub_f32 v11, v91, v14
  v_fmac_f32 v15, v10, v10
  v_fmac_f32 v9, v11, v11
  v_sub_f32 v10, v92, v14
  v_sub_f32 v11, v93, v14
  v_fmac_f32 v15, v10, v10
  v_fmac_f32 v9, v11, v11
  v_sub_f32 v10, v94, v14
  v_sub_f32 v11, v95, v14
  v_fmac_f32 v15, v10, v10
  v_fmac_f32 v9, v11, v11
  v_sub_f32 v10, v96, v14
  v_sub_f32 v11, v97, v14
  v_fmac_f32 v15, v10, v10
  v_fmac_f32 v9, v11, v11
  v_sub_f32 v10, v98, v14
  v_sub_f32 v11, v99, v14
  v_fmac_f32 v15, v10, v10
  v_fmac_f32 v9, v11, v11
  v_sub_f32 v10, v100, v14
  v_sub_f32 v11, v101, v14
  v_fmac_f32 v15, v10, v10
  v_fmac_f32 v9, v11, v11
  v_sub_f32 v10, v102, v14
  v_sub_f32 v11, v103, v14
  v_fmac_f32 v15, v10, v10
  v_fmac_f32 v9, v11, v11
  v_sub_f32 v10, v104, v14
  v_sub_f32 v11, v105, v14
  v_fmac_f32 v15, v10, v10
  v_fmac_f32 v9, v11, v11
  v_sub_f32 v10, v106, v14
  v_sub_f32 v11, v107, v14
  v_fmac_f32 v15, v10, v10
  v_fmac_f32 v9, v11, v11
  v_sub_f32 v10, v108, v14
  v_sub_f32 v11, v109, v14
  v_fmac_f32 v15, v10, v10
  v_fmac_f32 v9, v11, v11
  v_sub_f32 v10, v110, v14
  v_sub_f32 v11, v111, v14
  v_fmac_f32 v15, v10, v10
  v_fmac_f32 v9, v11, v11
  v_sub_f32 v10, v112, v14
  v_sub_f32 v11, v113, v14
  v_fmac_f32 v15, v10, v10
  v_fmac_f32 v9, v11, v11
  v_sub_f32 v10, v114, v14
  v_sub_f32 v11, v115, v14
  v_fmac_f32 v15, v10, v10
  v_fmac_f32 v9, v11, v11
  v_sub_f32 v10, v116, v14
  v_sub_f32 v11, v117, v14
  v_fmac_f32 v15, v10, v10
  v_fmac_f32 v9, v11, v11
  v_sub_f32 v10, v118, v14
  v_sub_f32 v11, v119, v14
  v_fmac_f32 v15, v10, v10
  v_fmac_f32 v9, v11, v11
  v_sub_f32 v10, v120, v14
  v_sub_f32 v11, v121, v14
  v_fmac_f32 v15, v10, v10
  v_fmac_f32 v9, v11, v11
  v_sub_f32 v10, v122, v14
  v_sub_f32 v11, v123, v14
  v_fmac_f32 v15, v10, v10
  v_fmac_f32 v9, v11, v11
  v_sub_f32 v10, v124, v14
  v_sub_f32 v11, v125, v14
  v_fmac_f32 v15, v10, v10
  v_fmac_f32 v9, v11, v11
  v_sub_f32 v10, v126, v14
  v_sub_f32 v11, v127, v14
  v_fmac_f32 v15, v10, v10
  v_fmac_f32 v9, v11, v11
  v_add_f32 v15, v15, v9
  s_nop 1
  v_add_f32_dpp v15, v15, v15 row_ror:8 row_mask:0xf bank_mask:0xf
  v_mov_b32 v13, v15
  s_nop 1
  v_permlane16_swap_b32 v15, v13
  v_add_f32 v15, v15, v13
  v_mov_b32 v13, v15
  s_nop 1
  v_permlane32_swap_b32 v15, v13
  v_add_f32 v15, v15, v13
  v_mul_f32 v15, 0x3b000000, v15
  v_cvt_pk_bf16_f32 v14, v14, v14
  v_and_b32 v14, s9, v14
  v_cvt_pk_bf16_f32 v15, v15, v15
  v_and_b32 v15, s9, v15
  v_add_f32 v15, 0x3727c5ac, v15
  v_cvt_pk_bf16_f32 v15, v15, v15
  v_and_b32 v15, s9, v15
  v_sqrt_f32 v15, v15
  s_nop 0
  v_cvt_pk_bf16_f32 v15, v15, v15
  v_and_b32 v15, s9, v15
  v_rcp_f32 v9, v15
  s_nop 0
  v_fma_f32 v10, -v15, v9, 2.0
  v_mul_f32 v9, v9, v10
  v_sub_f32 v64, v64, v14
  v_sub_f32 v65, v65, v14
  v_cvt_pk_bf16_f32 v65, v64, v65
  v_lshlrev_b32 v64, 16, v65
  v_and_b32 v65, s9, v65
  v_mul_f32 v64, v64, v9
  v_mul_f32 v65, v65, v9
  v_cvt_pk_bf16_f32 v16, v64, v65
  v_sub_f32 v66, v66, v14
  v_sub_f32 v67, v67, v14
  v_cvt_pk_bf16_f32 v67, v66, v67
  v_lshlrev_b32 v66, 16, v67
  v_and_b32 v67, s9, v67
  v_mul_f32 v66, v66, v9
  v_mul_f32 v67, v67, v9
  v_cvt_pk_bf16_f32 v17, v66, v67
  v_sub_f32 v68, v68, v14
  v_sub_f32 v69, v69, v14
  v_cvt_pk_bf16_f32 v69, v68, v69
  v_lshlrev_b32 v68, 16, v69
  v_and_b32 v69, s9, v69
  v_mul_f32 v68, v68, v9
  v_mul_f32 v69, v69, v9
  v_cvt_pk_bf16_f32 v18, v68, v69
  v_sub_f32 v70, v70, v14
  v_sub_f32 v71, v71, v14
  v_cvt_pk_bf16_f32 v71, v70, v71
  v_lshlrev_b32 v70, 16, v71
  v_and_b32 v71, s9, v71
  v_mul_f32 v70, v70, v9
  v_mul_f32 v71, v71, v9
  v_cvt_pk_bf16_f32 v19, v70, v71
  global_store_dwordx4 v12, v[16:19], s[42:43] sc1
  v_add_u32 v12, 4096, v12
  v_sub_f32 v72, v72, v14
  v_sub_f32 v73, v73, v14
  v_cvt_pk_bf16_f32 v73, v72, v73
  v_lshlrev_b32 v72, 16, v73
  v_and_b32 v73, s9, v73
  v_mul_f32 v72, v72, v9
  v_mul_f32 v73, v73, v9
  v_cvt_pk_bf16_f32 v20, v72, v73
  v_sub_f32 v74, v74, v14
  v_sub_f32 v75, v75, v14
  v_cvt_pk_bf16_f32 v75, v74, v75
  v_lshlrev_b32 v74, 16, v75
  v_and_b32 v75, s9, v75
  v_mul_f32 v74, v74, v9
  v_mul_f32 v75, v75, v9
  v_cvt_pk_bf16_f32 v21, v74, v75
  v_sub_f32 v76, v76, v14
  v_sub_f32 v77, v77, v14
  v_cvt_pk_bf16_f32 v77, v76, v77
  v_lshlrev_b32 v76, 16, v77
  v_and_b32 v77, s9, v77
  v_mul_f32 v76, v76, v9
  v_mul_f32 v77, v77, v9
  v_cvt_pk_bf16_f32 v22, v76, v77
  v_sub_f32 v78, v78, v14
  v_sub_f32 v79, v79, v14
  v_cvt_pk_bf16_f32 v79, v78, v79
  v_lshlrev_b32 v78, 16, v79
  v_and_b32 v79, s9, v79
  v_mul_f32 v78, v78, v9
  v_mul_f32 v79, v79, v9
  v_cvt_pk_bf16_f32 v23, v78, v79
  global_store_dwordx4 v12, v[20:23], s[42:43] sc1
  v_add_u32 v12, 4096, v12
  v_sub_f32 v80, v80, v14
  v_sub_f32 v81, v81, v14
  v_cvt_pk_bf16_f32 v81, v80, v81
  v_lshlrev_b32 v80, 16, v81
  v_and_b32 v81, s9, v81
  v_mul_f32 v80, v80, v9
  v_mul_f32 v81, v81, v9
  v_cvt_pk_bf16_f32 v24, v80, v81
  v_sub_f32 v82, v82, v14
  v_sub_f32 v83, v83, v14
  v_cvt_pk_bf16_f32 v83, v82, v83
  v_lshlrev_b32 v82, 16, v83
  v_and_b32 v83, s9, v83
  v_mul_f32 v82, v82, v9
  v_mul_f32 v83, v83, v9
  v_cvt_pk_bf16_f32 v25, v82, v83
  v_sub_f32 v84, v84, v14
  v_sub_f32 v85, v85, v14
  v_cvt_pk_bf16_f32 v85, v84, v85
  v_lshlrev_b32 v84, 16, v85
  v_and_b32 v85, s9, v85
  v_mul_f32 v84, v84, v9
  v_mul_f32 v85, v85, v9
  v_cvt_pk_bf16_f32 v26, v84, v85
  v_sub_f32 v86, v86, v14
  v_sub_f32 v87, v87, v14
  v_cvt_pk_bf16_f32 v87, v86, v87
  v_lshlrev_b32 v86, 16, v87
  v_and_b32 v87, s9, v87
  v_mul_f32 v86, v86, v9
  v_mul_f32 v87, v87, v9
  v_cvt_pk_bf16_f32 v27, v86, v87
  global_store_dwordx4 v12, v[24:27], s[42:43] sc1
  v_add_u32 v12, 4096, v12
  v_sub_f32 v88, v88, v14
  v_sub_f32 v89, v89, v14
  v_cvt_pk_bf16_f32 v89, v88, v89
  v_lshlrev_b32 v88, 16, v89
  v_and_b32 v89, s9, v89
  v_mul_f32 v88, v88, v9
  v_mul_f32 v89, v89, v9
  v_cvt_pk_bf16_f32 v28, v88, v89
  v_sub_f32 v90, v90, v14
  v_sub_f32 v91, v91, v14
  v_cvt_pk_bf16_f32 v91, v90, v91
  v_lshlrev_b32 v90, 16, v91
  v_and_b32 v91, s9, v91
  v_mul_f32 v90, v90, v9
  v_mul_f32 v91, v91, v9
  v_cvt_pk_bf16_f32 v29, v90, v91
  v_sub_f32 v92, v92, v14
  v_sub_f32 v93, v93, v14
  v_cvt_pk_bf16_f32 v93, v92, v93
  v_lshlrev_b32 v92, 16, v93
  v_and_b32 v93, s9, v93
  v_mul_f32 v92, v92, v9
  v_mul_f32 v93, v93, v9
  v_cvt_pk_bf16_f32 v30, v92, v93
  v_sub_f32 v94, v94, v14
  v_sub_f32 v95, v95, v14
  v_cvt_pk_bf16_f32 v95, v94, v95
  v_lshlrev_b32 v94, 16, v95
  v_and_b32 v95, s9, v95
  v_mul_f32 v94, v94, v9
  v_mul_f32 v95, v95, v9
  v_cvt_pk_bf16_f32 v31, v94, v95
  global_store_dwordx4 v12, v[28:31], s[42:43] sc1
  v_add_u32 v12, 4096, v12
  v_sub_f32 v96, v96, v14
  v_sub_f32 v97, v97, v14
  v_cvt_pk_bf16_f32 v97, v96, v97
  v_lshlrev_b32 v96, 16, v97
  v_and_b32 v97, s9, v97
  v_mul_f32 v96, v96, v9
  v_mul_f32 v97, v97, v9
  v_cvt_pk_bf16_f32 v32, v96, v97
  v_sub_f32 v98, v98, v14
  v_sub_f32 v99, v99, v14
  v_cvt_pk_bf16_f32 v99, v98, v99
  v_lshlrev_b32 v98, 16, v99
  v_and_b32 v99, s9, v99
  v_mul_f32 v98, v98, v9
  v_mul_f32 v99, v99, v9
  v_cvt_pk_bf16_f32 v33, v98, v99
  v_sub_f32 v100, v100, v14
  v_sub_f32 v101, v101, v14
  v_cvt_pk_bf16_f32 v101, v100, v101
  v_lshlrev_b32 v100, 16, v101
  v_and_b32 v101, s9, v101
  v_mul_f32 v100, v100, v9
  v_mul_f32 v101, v101, v9
  v_cvt_pk_bf16_f32 v34, v100, v101
  v_sub_f32 v102, v102, v14
  v_sub_f32 v103, v103, v14
  v_cvt_pk_bf16_f32 v103, v102, v103
  v_lshlrev_b32 v102, 16, v103
  v_and_b32 v103, s9, v103
  v_mul_f32 v102, v102, v9
  v_mul_f32 v103, v103, v9
  v_cvt_pk_bf16_f32 v35, v102, v103
  global_store_dwordx4 v12, v[32:35], s[42:43] sc1
  v_add_u32 v12, 4096, v12
  v_sub_f32 v104, v104, v14
  v_sub_f32 v105, v105, v14
  v_cvt_pk_bf16_f32 v105, v104, v105
  v_lshlrev_b32 v104, 16, v105
  v_and_b32 v105, s9, v105
  v_mul_f32 v104, v104, v9
  v_mul_f32 v105, v105, v9
  v_cvt_pk_bf16_f32 v36, v104, v105
  v_sub_f32 v106, v106, v14
  v_sub_f32 v107, v107, v14
  v_cvt_pk_bf16_f32 v107, v106, v107
  v_lshlrev_b32 v106, 16, v107
  v_and_b32 v107, s9, v107
  v_mul_f32 v106, v106, v9
  v_mul_f32 v107, v107, v9
  v_cvt_pk_bf16_f32 v37, v106, v107
  v_sub_f32 v108, v108, v14
  v_sub_f32 v109, v109, v14
  v_cvt_pk_bf16_f32 v109, v108, v109
  v_lshlrev_b32 v108, 16, v109
  v_and_b32 v109, s9, v109
  v_mul_f32 v108, v108, v9
  v_mul_f32 v109, v109, v9
  v_cvt_pk_bf16_f32 v38, v108, v109
  v_sub_f32 v110, v110, v14
  v_sub_f32 v111, v111, v14
  v_cvt_pk_bf16_f32 v111, v110, v111
  v_lshlrev_b32 v110, 16, v111
  v_and_b32 v111, s9, v111
  v_mul_f32 v110, v110, v9
  v_mul_f32 v111, v111, v9
  v_cvt_pk_bf16_f32 v39, v110, v111
  global_store_dwordx4 v12, v[36:39], s[42:43] sc1
  v_add_u32 v12, 4096, v12
  v_sub_f32 v112, v112, v14
  v_sub_f32 v113, v113, v14
  v_cvt_pk_bf16_f32 v113, v112, v113
  v_lshlrev_b32 v112, 16, v113
  v_and_b32 v113, s9, v113
  v_mul_f32 v112, v112, v9
  v_mul_f32 v113, v113, v9
  v_cvt_pk_bf16_f32 v40, v112, v113
  v_sub_f32 v114, v114, v14
  v_sub_f32 v115, v115, v14
  v_cvt_pk_bf16_f32 v115, v114, v115
  v_lshlrev_b32 v114, 16, v115
  v_and_b32 v115, s9, v115
  v_mul_f32 v114, v114, v9
  v_mul_f32 v115, v115, v9
  v_cvt_pk_bf16_f32 v41, v114, v115
  v_sub_f32 v116, v116, v14
  v_sub_f32 v117, v117, v14
  v_cvt_pk_bf16_f32 v117, v116, v117
  v_lshlrev_b32 v116, 16, v117
  v_and_b32 v117, s9, v117
  v_mul_f32 v116, v116, v9
  v_mul_f32 v117, v117, v9
  v_cvt_pk_bf16_f32 v42, v116, v117
  v_sub_f32 v118, v118, v14
  v_sub_f32 v119, v119, v14
  v_cvt_pk_bf16_f32 v119, v118, v119
  v_lshlrev_b32 v118, 16, v119
  v_and_b32 v119, s9, v119
  v_mul_f32 v118, v118, v9
  v_mul_f32 v119, v119, v9
  v_cvt_pk_bf16_f32 v43, v118, v119
  global_store_dwordx4 v12, v[40:43], s[42:43] sc1
  v_add_u32 v12, 4096, v12
  v_sub_f32 v120, v120, v14
  v_sub_f32 v121, v121, v14
  v_cvt_pk_bf16_f32 v121, v120, v121
  v_lshlrev_b32 v120, 16, v121
  v_and_b32 v121, s9, v121
  v_mul_f32 v120, v120, v9
  v_mul_f32 v121, v121, v9
  v_cvt_pk_bf16_f32 v44, v120, v121
  v_sub_f32 v122, v122, v14
  v_sub_f32 v123, v123, v14
  v_cvt_pk_bf16_f32 v123, v122, v123
  v_lshlrev_b32 v122, 16, v123
  v_and_b32 v123, s9, v123
  v_mul_f32 v122, v122, v9
  v_mul_f32 v123, v123, v9
  v_cvt_pk_bf16_f32 v45, v122, v123
  v_sub_f32 v124, v124, v14
  v_sub_f32 v125, v125, v14
  v_cvt_pk_bf16_f32 v125, v124, v125
  v_lshlrev_b32 v124, 16, v125
  v_and_b32 v125, s9, v125
  v_mul_f32 v124, v124, v9
  v_mul_f32 v125, v125, v9
  v_cvt_pk_bf16_f32 v46, v124, v125
  v_sub_f32 v126, v126, v14
  v_sub_f32 v127, v127, v14
  v_cvt_pk_bf16_f32 v127, v126, v127
  v_lshlrev_b32 v126, 16, v127
  v_and_b32 v127, s9, v127
  v_mul_f32 v126, v126, v9
  v_mul_f32 v127, v127, v9
  v_cvt_pk_bf16_f32 v47, v126, v127
  global_store_dwordx4 v12, v[44:47], s[42:43] sc1
  v_add_u32 v12, 4096, v12
  s_cmp_lg_u32 s44, 63
  s_cbranch_scc1 L_ln_b
  s_mov_b32 s8, 0x05040100
  s_mov_b32 s9, 0x07060302
  v_perm_b32 v64, v49, v48, s8
  v_perm_b32 v65, v51, v50, s8
  v_perm_b32 v66, v49, v48, s9
  v_perm_b32 v67, v51, v50, s9
  v_perm_b32 v68, v53, v52, s8
  v_perm_b32 v69, v55, v54, s8
  v_perm_b32 v70, v53, v52, s9
  v_perm_b32 v71, v55, v54, s9
  v_min_u32 v64, -2, v64
  v_min_u32 v65, -2, v65
  v_min_u32 v66, -2, v66
  v_min_u32 v67, -2, v67
  v_min_u32 v68, -2, v68
  v_min_u32 v69, -2, v69
  v_min_u32 v70, -2, v70
  v_min_u32 v71, -2, v71
  s_lshl_b32 s8, s4, 11
  v_lshl_add_u32 v4, v0, 4, s8
  global_store_dwordx4 v4, v[64:67], s[12:13] sc1
  global_store_dwordx4 v4, v[68:71], s[12:13] offset:1024 sc1
  v_add_u32 v4, 65536, v4
L_ln_b:
  s_waitcnt vmcnt(0)
  s_barrier
  s_cmp_lg_u32 s4, 0
  s_cbranch_scc1 L_ln_done
  v_mov_b32 v4, 0
  v_mov_b32 v5, 1
  s_mov_b64 exec, 1
  global_atomic_add v4, v5, s[40:41] offset:164 sc1
  s_mov_b64 exec, -1
  s_waitcnt vmcnt(0)
L_ln_done:
  v_mov_b32 v2, 0
  s_and_b32 s45, s44, 15
  s_lshr_b32 s46, s44, 4
  s_mov_b32 s47, 0
  s_mov_b32 s70, 126
  s_cmp_lt_u32 s46, 4
  s_cselect_b32 s73, 2, 0
  s_branch L_O_in
L_O_idle:
L_O_help:
  s_barrier
  s_and_b32 s45, s5, 15
  s_bfe_u32 s46, s5, 0x10005
  s_add_u32 s46, s46, 118
  s_mov_b32 s47, 8
  s_mov_b32 s70, 255
  s_lshr_b32 s73, s5, 3
  s_and_b32 s73, s73, 2
  v_mov_b32 v2, 0
L_O_in:
  s_mov_b32 s72, 0
  s_mov_b32 s71, 0
  v_lshlrev_b32 v1, 4, v0
  v_lshrrev_b32 v4, 2, v0
  v_bfe_u32 v5, v0, 4, 1
  v_lshlrev_b32 v5, 1, v5
  v_and_b32 v6, 3, v0
  v_xor_b32 v6, v6, v5
  v_lshlrev_b32 v4, 10, v4
  v_lshl_add_u32 v4, v6, 4, v4
  s_lshl_b32 s8, s45, 6
  v_add_u32 v4, s8, v4
  v_add_u32 v5, 0x4000, v4
  v_lshrrev_b32 v6, 2, v0
  v_lshlrev_b32 v6, 6, v6
  v_bfe_u32 v7, v0, 4, 1
  v_lshl_add_u32 v6, v7, 5, v6
  v_and_b32 v7, 3, v0
  v_lshl_add_u32 v6, v7, 3, v6
  s_lshl_b32 s68, s4, 15
  v_add_u32 v6, s68, v6
  v_xor_b32 v7, 32, v6
  s_mul_i32 s10, s4, 458752
  s_lshl_b32 s11, s4, 20
  s_add_u32 s64, s10, 0
  s_add_u32 s62, s36, s64
  s_addc_u32 s63, s37, 0
  s_add_u32 m0, s68, 0
  s_nop 0
  global_load_lds_dwordx4 v4, s[62:63]
  s_add_u32 m0, s68, 1024
  s_nop 0
  global_load_lds_dwordx4 v5, s[62:63]
  s_waitcnt vmcnt(0)
  ds_read_b64_tr_b16 a[0:1], v6 offset:0
  ds_read_b64_tr_b16 a[2:3], v6 offset:1024
  ds_read_b64_tr_b16 a[4:5], v7 offset:0
  ds_read_b64_tr_b16 a[6:7], v7 offset:1024
  s_waitcnt lgkmcnt(0)
  s_add_u32 s64, s10, 32768
  s_add_u32 s62, s36, s64
  s_addc_u32 s63, s37, 0
  s_add_u32 m0, s68, 2048
  s_nop 0
  global_load_lds_dwordx4 v4, s[62:63]
  s_add_u32 m0, s68, 3072
  s_nop 0
  global_load_lds_dwordx4 v5, s[62:63]
  s_waitcnt vmcnt(0)
  ds_read_b64_tr_b16 a[8:9], v6 offset:2048
  ds_read_b64_tr_b16 a[10:11], v6 offset:3072
  ds_read_b64_tr_b16 a[12:13], v7 offset:2048
  ds_read_b64_tr_b16 a[14:15], v7 offset:3072
  s_waitcnt lgkmcnt(0)
  s_add_u32 s64, s10, 65536
  s_add_u32 s62, s36, s64
  s_addc_u32 s63, s37, 0
  s_add_u32 m0, s68, 4096
  s_nop 0
  global_load_lds_dwordx4 v4, s[62:63]
  s_add_u32 m0, s68, 5120
  s_nop 0
  global_load_lds_dwordx4 v5, s[62:63]
  s_waitcnt vmcnt(0)
  ds_read_b64_tr_b16 a[16:17], v6 offset:4096
  ds_read_b64_tr_b16 a[18:19], v6 offset:5120
  ds_read_b64_tr_b16 a[20:21], v7 offset:4096
  ds_read_b64_tr_b16 a[22:23], v7 offset:5120
  s_waitcnt lgkmcnt(0)
  s_add_u32 s64, s10, 98304
  s_add_u32 s62, s36, s64
  s_addc_u32 s63, s37, 0
  s_add_u32 m0, s68, 6144
  s_nop 0
  global_load_lds_dwordx4 v4, s[62:63]
  s_add_u32 m0, s68, 7168
  s_nop 0
  global_load_lds_dwordx4 v5, s[62:63]
  s_waitcnt vmcnt(0)
  ds_read_b64_tr_b16 a[24:25], v6 offset:6144
  ds_read_b64_tr_b16 a[26:27], v6 offset:7168
  ds_read_b64_tr_b16 a[28:29], v7 offset:6144
  ds_read_b64_tr_b16 a[30:31], v7 offset:7168
  s_waitcnt lgkmcnt(0)
  s_add_u32 s64, s10, 131072
  s_add_u32 s62, s36, s64
  s_addc_u32 s63, s37, 0
  s_add_u32 m0, s68, 8192
  s_nop 0
  global_load_lds_dwordx4 v4, s[62:63]
  s_add_u32 m0, s68, 9216
  s_nop 0
  global_load_lds_dwordx4 v5, s[62:63]
  s_waitcnt vmcnt(0)
  ds_read_b64_tr_b16 a[32:33], v6 offset:8192
  ds_read_b64_tr_b16 a[34:35], v6 offset:9216
  ds_read_b64_tr_b16 a[36:37], v7 offset:8192
  ds_read_b64_tr_b16 a[38:39], v7 offset:9216
  s_waitcnt lgkmcnt(0)
  s_add_u32 s64, s10, 163840
  s_add_u32 s62, s36, s64
  s_addc_u32 s63, s37, 0
  s_add_u32 m0, s68, 10240
  s_nop 0
  global_load_lds_dwordx4 v4, s[62:63]
  s_add_u32 m0, s68, 11264
  s_nop 0
  global_load_lds_dwordx4 v5, s[62:63]
  s_waitcnt vmcnt(0)
  ds_read_b64_tr_b16 a[40:41], v6 offset:10240
  ds_read_b64_tr_b16 a[42:43], v6 offset:11264
  ds_read_b64_tr_b16 a[44:45], v7 offset:10240
  ds_read_b64_tr_b16 a[46:47], v7 offset:11264
  s_waitcnt lgkmcnt(0)
  s_add_u32 s64, s10, 196608
  s_add_u32 s62, s36, s64
  s_addc_u32 s63, s37, 0
  s_add_u32 m0, s68, 12288
  s_nop 0
  global_load_lds_dwordx4 v4, s[62:63]
  s_add_u32 m0, s68, 13312
  s_nop 0
  global_load_lds_dwordx4 v5, s[62:63]
  s_waitcnt vmcnt(0)
  ds_read_b64_tr_b16 a[48:49], v6 offset:12288
  ds_read_b64_tr_b16 a[50:51], v6 offset:13312
  ds_read_b64_tr_b16 a[52:53], v7 offset:12288
  ds_read_b64_tr_b16 a[54:55], v7 offset:13312
  s_waitcnt lgkmcnt(0)
  s_add_u32 s64, s10, 229376
  s_add_u32 s62, s36, s64
  s_addc_u32 s63, s37, 0
  s_add_u32 m0, s68, 14336
  s_nop 0
  global_load_lds_dwordx4 v4, s[62:63]
  s_add_u32 m0, s68, 15360
  s_nop 0
  global_load_lds_dwordx4 v5, s[62:63]
  s_waitcnt vmcnt(0)
  ds_read_b64_tr_b16 a[56:57], v6 offset:14336
  ds_read_b64_tr_b16 a[58:59], v6 offset:15360
  ds_read_b64_tr_b16 a[60:61], v7 offset:14336
  ds_read_b64_tr_b16 a[62:63], v7 offset:15360
  s_waitcnt lgkmcnt(0)
  s_add_u32 s64, s10, 262144
  s_add_u32 s62, s36, s64
  s_addc_u32 s63, s37, 0
  s_add_u32 m0, s68, 16384
  s_nop 0
  global_load_lds_dwordx4 v4, s[62:63]
  s_add_u32 m0, s68, 17408
  s_nop 0
  global_load_lds_dwordx4 v5, s[62:63]
  s_waitcnt vmcnt(0)
  ds_read_b64_tr_b16 a[64:65], v6 offset:16384
  ds_read_b64_tr_b16 a[66:67], v6 offset:17408
  ds_read_b64_tr_b16 a[68:69], v7 offset:16384
  ds_read_b64_tr_b16 a[70:71], v7 offset:17408
  s_waitcnt lgkmcnt(0)
  s_add_u32 s64, s10, 294912
  s_add_u32 s62, s36, s64
  s_addc_u32 s63, s37, 0
  s_add_u32 m0, s68, 18432
  s_nop 0
  global_load_lds_dwordx4 v4, s[62:63]
  s_add_u32 m0, s68, 19456
  s_nop 0
  global_load_lds_dwordx4 v5, s[62:63]
  s_waitcnt vmcnt(0)
  ds_read_b64_tr_b16 a[72:73], v6 offset:18432
  ds_read_b64_tr_b16 a[74:75], v6 offset:19456
  ds_read_b64_tr_b16 a[76:77], v7 offset:18432
  ds_read_b64_tr_b16 a[78:79], v7 offset:19456
  s_waitcnt lgkmcnt(0)
  s_add_u32 s64, s10, 327680
  s_add_u32 s62, s36, s64
  s_addc_u32 s63, s37, 0
  s_add_u32 m0, s68, 20480
  s_nop 0
  global_load_lds_dwordx4 v4, s[62:63]
  s_add_u32 m0, s68, 21504
  s_nop 0
  global_load_lds_dwordx4 v5, s[62:63]
  s_waitcnt vmcnt(0)
  ds_read_b64_tr_b16 a[80:81], v6 offset:20480
  ds_read_b64_tr_b16 a[82:83], v6 offset:21504
  ds_read_b64_tr_b16 a[84:85], v7 offset:20480
  ds_read_b64_tr_b16 a[86:87], v7 offset:21504
  s_waitcnt lgkmcnt(0)
  s_add_u32 s64, s10, 360448
  s_add_u32 s62, s36, s64
  s_addc_u32 s63, s37, 0
  s_add_u32 m0, s68, 22528
  s_nop 0
  global_load_lds_dwordx4 v4, s[62:63]
  s_add_u32 m0, s68, 23552
  s_nop 0
  global_load_lds_dwordx4 v5, s[62:63]
  s_waitcnt vmcnt(0)
  ds_read_b64_tr_b16 a[88:89], v6 offset:22528
  ds_read_b64_tr_b16 a[90:91], v6 offset:23552
  ds_read_b64_tr_b16 a[92:93], v7 offset:22528
  ds_read_b64_tr_b16 a[94:95], v7 offset:23552
  s_waitcnt lgkmcnt(0)
  s_add_u32 s64, s10, 393216
  s_add_u32 s62, s36, s64
  s_addc_u32 s63, s37, 0
  s_add_u32 m0, s68, 24576
  s_nop 0
  global_load_lds_dwordx4 v4, s[62:63]
  s_add_u32 m0, s68, 25600
  s_nop 0
  global_load_lds_dwordx4 v5, s[62:63]
  s_waitcnt vmcnt(0)
  ds_read_b64_tr_b16 a[96:97], v6 offset:24576
  ds_read_b64_tr_b16 a[98:99], v6 offset:25600
  ds_read_b64_tr_b16 a[100:101], v7 offset:24576
  ds_read_b64_tr_b16 a[102:103], v7 offset:25600
  s_waitcnt lgkmcnt(0)
  s_add_u32 s64, s10, 425984
  s_add_u32 s62, s36, s64
  s_addc_u32 s63, s37, 0
  s_add_u32 m0, s68, 26624
  s_nop 0
  global_load_lds_dwordx4 v4, s[62:63]
  s_add_u32 m0, s68, 27648
  s_nop 0
  global_load_lds_dwordx4 v5, s[62:63]
  s_waitcnt vmcnt(0)
  ds_read_b64_tr_b16 a[104:105], v6 offset:26624
  ds_read_b64_tr_b16 a[106:107], v6 offset:27648
  ds_read_b64_tr_b16 a[108:109], v7 offset:26624
  ds_read_b64_tr_b16 a[110:111], v7 offset:27648
  s_waitcnt lgkmcnt(0)
  s_add_u32 s64, s11, 0
  s_add_u32 s62, s26, s64
  s_addc_u32 s63, s27, 0
  s_add_u32 m0, s68, 28672
  s_nop 0
  global_load_lds_dwordx4 v4, s[62:63]
  s_add_u32 m0, s68, 29696
  s_nop 0
  global_load_lds_dwordx4 v5, s[62:63]
  s_waitcnt vmcnt(0)
  ds_read_b64_tr_b16 a[112:113], v6 offset:28672
  ds_read_b64_tr_b16 a[114:115], v6 offset:29696
  ds_read_b64_tr_b16 a[116:117], v7 offset:28672
  ds_read_b64_tr_b16 a[118:119], v7 offset:29696
  s_waitcnt lgkmcnt(0)
  s_add_u32 s64, s11, 32768
  s_add_u32 s62, s26, s64
  s_addc_u32 s63, s27, 0
  s_add_u32 m0, s68, 30720
  s_nop 0
  global_load_lds_dwordx4 v4, s[62:63]
  s_add_u32 m0, s68, 31744
  s_nop 0
  global_load_lds_dwordx4 v5, s[62:63]
  s_waitcnt vmcnt(0)
  ds_read_b64_tr_b16 a[120:121], v6 offset:30720
  ds_read_b64_tr_b16 a[122:123], v6 offset:31744
  ds_read_b64_tr_b16 a[124:125], v7 offset:30720
  ds_read_b64_tr_b16 a[126:127], v7 offset:31744
  s_waitcnt lgkmcnt(0)
  s_add_u32 s64, s11, 65536
  s_add_u32 s62, s26, s64
  s_addc_u32 s63, s27, 0
  s_add_u32 m0, s68, 0
  s_nop 0
  global_load_lds_dwordx4 v4, s[62:63]
  s_add_u32 m0, s68, 1024
  s_nop 0
  global_load_lds_dwordx4 v5, s[62:63]
  s_waitcnt vmcnt(0)
  ds_read_b64_tr_b16 a[128:129], v6 offset:0
  ds_read_b64_tr_b16 a[130:131], v6 offset:1024
  ds_read_b64_tr_b16 a[132:133], v7 offset:0
  ds_read_b64_tr_b16 a[134:135], v7 offset:1024
  s_waitcnt lgkmcnt(0)
  s_add_u32 s64, s11, 98304
  s_add_u32 s62, s26, s64
  s_addc_u32 s63, s27, 0
  s_add_u32 m0, s68, 2048
  s_nop 0
  global_load_lds_dwordx4 v4, s[62:63]
  s_add_u32 m0, s68, 3072
  s_nop 0
  global_load_lds_dwordx4 v5, s[62:63]
  s_waitcnt vmcnt(0)
  ds_read_b64_tr_b16 a[136:137], v6 offset:2048
  ds_read_b64_tr_b16 a[138:139], v6 offset:3072
  ds_read_b64_tr_b16 a[140:141], v7 offset:2048
  ds_read_b64_tr_b16 a[142:143], v7 offset:3072
  s_waitcnt lgkmcnt(0)
  s_add_u32 s64, s11, 131072
  s_add_u32 s62, s26, s64
  s_addc_u32 s63, s27, 0
  s_add_u32 m0, s68, 4096
  s_nop 0
  global_load_lds_dwordx4 v4, s[62:63]
  s_add_u32 m0, s68, 5120
  s_nop 0
  global_load_lds_dwordx4 v5, s[62:63]
  s_waitcnt vmcnt(0)
  ds_read_b64_tr_b16 a[144:145], v6 offset:4096
  ds_read_b64_tr_b16 a[146:147], v6 offset:5120
  ds_read_b64_tr_b16 a[148:149], v7 offset:4096
  ds_read_b64_tr_b16 a[150:151], v7 offset:5120
  s_waitcnt lgkmcnt(0)
  s_add_u32 s64, s11, 163840
  s_add_u32 s62, s26, s64
  s_addc_u32 s63, s27, 0
  s_add_u32 m0, s68, 6144
  s_nop 0
  global_load_lds_dwordx4 v4, s[62:63]
  s_add_u32 m0, s68, 7168
  s_nop 0
  global_load_lds_dwordx4 v5, s[62:63]
  s_waitcnt vmcnt(0)
  ds_read_b64_tr_b16 a[152:153], v6 offset:6144
  ds_read_b64_tr_b16 a[154:155], v6 offset:7168
  ds_read_b64_tr_b16 a[156:157], v7 offset:6144
  ds_read_b64_tr_b16 a[158:159], v7 offset:7168
  s_waitcnt lgkmcnt(0)
  s_add_u32 s64, s11, 196608
  s_add_u32 s62, s26, s64
  s_addc_u32 s63, s27, 0
  s_add_u32 m0, s68, 8192
  s_nop 0
  global_load_lds_dwordx4 v4, s[62:63]
  s_add_u32 m0, s68, 9216
  s_nop 0
  global_load_lds_dwordx4 v5, s[62:63]
  s_waitcnt vmcnt(0)
  ds_read_b64_tr_b16 a[160:161], v6 offset:8192
  ds_read_b64_tr_b16 a[162:163], v6 offset:9216
  ds_read_b64_tr_b16 a[164:165], v7 offset:8192
  ds_read_b64_tr_b16 a[166:167], v7 offset:9216
  s_waitcnt lgkmcnt(0)
  s_add_u32 s64, s11, 229376
  s_add_u32 s62, s26, s64
  s_addc_u32 s63, s27, 0
  s_add_u32 m0, s68, 10240
  s_nop 0
  global_load_lds_dwordx4 v4, s[62:63]
  s_add_u32 m0, s68, 11264
  s_nop 0
  global_load_lds_dwordx4 v5, s[62:63]
  s_waitcnt vmcnt(0)
  ds_read_b64_tr_b16 a[168:169], v6 offset:10240
  ds_read_b64_tr_b16 a[170:171], v6 offset:11264
  ds_read_b64_tr_b16 a[172:173], v7 offset:10240
  ds_read_b64_tr_b16 a[174:175], v7 offset:11264
  s_waitcnt lgkmcnt(0)
  s_add_u32 s64, s11, 262144
  s_add_u32 s62, s26, s64
  s_addc_u32 s63, s27, 0
  s_add_u32 m0, s68, 12288
  s_nop 0
  global_load_lds_dwordx4 v4, s[62:63]
  s_add_u32 m0, s68, 13312
  s_nop 0
  global_load_lds_dwordx4 v5, s[62:63]
  s_waitcnt vmcnt(0)
  ds_read_b64_tr_b16 a[176:177], v6 offset:12288
  ds_read_b64_tr_b16 a[178:179], v6 offset:13312
  ds_read_b64_tr_b16 a[180:181], v7 offset:12288
  ds_read_b64_tr_b16 a[182:183], v7 offset:13312
  s_waitcnt lgkmcnt(0)
  s_add_u32 s64, s11, 294912
  s_add_u32 s62, s26, s64
  s_addc_u32 s63, s27, 0
  s_add_u32 m0, s68, 14336
  s_nop 0
  global_load_lds_dwordx4 v4, s[62:63]
  s_add_u32 m0, s68, 15360
  s_nop 0
  global_load_lds_dwordx4 v5, s[62:63]
  s_waitcnt vmcnt(0)
  ds_read_b64_tr_b16 a[184:185], v6 offset:14336
  ds_read_b64_tr_b16 a[186:187], v6 offset:15360
  ds_read_b64_tr_b16 a[188:189], v7 offset:14336
  ds_read_b64_tr_b16 a[190:191], v7 offset:15360
  s_waitcnt lgkmcnt(0)
  s_add_u32 s64, s11, 327680
  s_add_u32 s62, s26, s64
  s_addc_u32 s63, s27, 0
  s_add_u32 m0, s68, 16384
  s_nop 0
  global_load_lds_dwordx4 v4, s[62:63]
  s_add_u32 m0, s68, 17408
  s_nop 0
  global_load_lds_dwordx4 v5, s[62:63]
  s_waitcnt vmcnt(0)
  ds_read_b64_tr_b16 a[192:193], v6 offset:16384
  ds_read_b64_tr_b16 a[194:195], v6 offset:17408
  ds_read_b64_tr_b16 a[196:197], v7 offset:16384
  ds_read_b64_tr_b16 a[198:199], v7 offset:17408
  s_waitcnt lgkmcnt(0)
  s_add_u32 s64, s11, 360448
  s_add_u32 s62, s26, s64
  s_addc_u32 s63, s27, 0
  s_add_u32 m0, s68, 18432
  s_nop 0
  global_load_lds_dwordx4 v4, s[62:63]
  s_add_u32 m0, s68, 19456
  s_nop 0
  global_load_lds_dwordx4 v5, s[62:63]
  s_waitcnt vmcnt(0)
  ds_read_b64_tr_b16 a[200:201], v6 offset:18432
  ds_read_b64_tr_b16 a[202:203], v6 offset:19456
  ds_read_b64_tr_b16 a[204:205], v7 offset:18432
  ds_read_b64_tr_b16 a[206:207], v7 offset:19456
  s_waitcnt lgkmcnt(0)
  s_add_u32 s64, s11, 393216
  s_add_u32 s62, s26, s64
  s_addc_u32 s63, s27, 0
  s_add_u32 m0, s68, 20480
  s_nop 0
  global_load_lds_dwordx4 v4, s[62:63]
  s_add_u32 m0, s68, 21504
  s_nop 0
  global_load_lds_dwordx4 v5, s[62:63]
  s_waitcnt vmcnt(0)
  ds_read_b64_tr_b16 a[208:209], v6 offset:20480
  ds_read_b64_tr_b16 a[210:211], v6 offset:21504
  ds_read_b64_tr_b16 a[212:213], v7 offset:20480
  ds_read_b64_tr_b16 a[214:215], v7 offset:21504
  s_waitcnt lgkmcnt(0)
  s_add_u32 s64, s11, 425984
  s_add_u32 s62, s26, s64
  s_addc_u32 s63, s27, 0
  s_add_u32 m0, s68, 22528
  s_nop 0
  global_load_lds_dwordx4 v4, s[62:63]
  s_add_u32 m0, s68, 23552
  s_nop 0
  global_load_lds_dwordx4 v5, s[62:63]
  s_waitcnt vmcnt(0)
  ds_read_b64_tr_b16 a[216:217], v6 offset:22528
  ds_read_b64_tr_b16 a[218:219], v6 offset:23552
  ds_read_b64_tr_b16 a[220:221], v7 offset:22528
  ds_read_b64_tr_b16 a[222:223], v7 offset:23552
  s_waitcnt lgkmcnt(0)
  s_add_u32 s64, s11, 458752
  s_add_u32 s62, s26, s64
  s_addc_u32 s63, s27, 0
  s_add_u32 m0, s68, 24576
  s_nop 0
  global_load_lds_dwordx4 v4, s[62:63]
  s_add_u32 m0, s68, 25600
  s_nop 0
  global_load_lds_dwordx4 v5, s[62:63]
  s_waitcnt vmcnt(0)
  ds_read_b64_tr_b16 a[224:225], v6 offset:24576
  ds_read_b64_tr_b16 a[226:227], v6 offset:25600
  ds_read_b64_tr_b16 a[228:229], v7 offset:24576
  ds_read_b64_tr_b16 a[230:231], v7 offset:25600
  s_waitcnt lgkmcnt(0)
  s_add_u32 s64, s11, 491520
  s_add_u32 s62, s26, s64
  s_addc_u32 s63, s27, 0
  s_add_u32 m0, s68, 26624
  s_nop 0
  global_load_lds_dwordx4 v4, s[62:63]
  s_add_u32 m0, s68, 27648
  s_nop 0
  global_load_lds_dwordx4 v5, s[62:63]
  s_waitcnt vmcnt(0)
  ds_read_b64_tr_b16 a[232:233], v6 offset:26624
  ds_read_b64_tr_b16 a[234:235], v6 offset:27648
  ds_read_b64_tr_b16 a[236:237], v7 offset:26624
  ds_read_b64_tr_b16 a[238:239], v7 offset:27648
  s_waitcnt lgkmcnt(0)
  s_add_u32 s64, s11, 524288
  s_add_u32 s62, s26, s64
  s_addc_u32 s63, s27, 0
  s_add_u32 m0, s68, 28672
  s_nop 0
  global_load_lds_dwordx4 v4, s[62:63]
  s_add_u32 m0, s68, 29696
  s_nop 0
  global_load_lds_dwordx4 v5, s[62:63]
  s_waitcnt vmcnt(0)
  ds_read_b64_tr_b16 a[240:241], v6 offset:28672
  ds_read_b64_tr_b16 a[242:243], v6 offset:29696
  ds_read_b64_tr_b16 a[244:245], v7 offset:28672
  ds_read_b64_tr_b16 a[246:247], v7 offset:29696
  s_waitcnt lgkmcnt(0)
  s_add_u32 s64, s11, 557056
  s_add_u32 s62, s26, s64
  s_addc_u32 s63, s27, 0
  s_add_u32 m0, s68, 30720
  s_nop 0
  global_load_lds_dwordx4 v4, s[62:63]
  s_add_u32 m0, s68, 31744
  s_nop 0
  global_load_lds_dwordx4 v5, s[62:63]
  s_waitcnt vmcnt(0)
  ds_read_b64_tr_b16 a[248:249], v6 offset:30720
  ds_read_b64_tr_b16 a[250:251], v6 offset:31744
  ds_read_b64_tr_b16 a[252:253], v7 offset:30720
  ds_read_b64_tr_b16 a[254:255], v7 offset:31744
  s_waitcnt lgkmcnt(0)
  s_add_u32 s64, s11, 589824
  s_add_u32 s62, s26, s64
  s_addc_u32 s63, s27, 0
  s_add_u32 m0, s68, 0
  s_nop 0
  global_load_lds_dwordx4 v4, s[62:63]
  s_add_u32 m0, s68, 1024
  s_nop 0
  global_load_lds_dwordx4 v5, s[62:63]
  s_waitcnt vmcnt(0)
  ds_read_b64_tr_b16 v[144:145], v6 offset:0
  ds_read_b64_tr_b16 v[146:147], v6 offset:1024
  ds_read_b64_tr_b16 v[148:149], v7 offset:0
  ds_read_b64_tr_b16 v[150:151], v7 offset:1024
  s_waitcnt lgkmcnt(0)
  s_add_u32 s64, s11, 622592
  s_add_u32 s62, s26, s64
  s_addc_u32 s63, s27, 0
  s_add_u32 m0, s68, 2048
  s_nop 0
  global_load_lds_dwordx4 v4, s[62:63]
  s_add_u32 m0, s68, 3072
  s_nop 0
  global_load_lds_dwordx4 v5, s[62:63]
  s_waitcnt vmcnt(0)
  ds_read_b64_tr_b16 v[152:153], v6 offset:2048
  ds_read_b64_tr_b16 v[154:155], v6 offset:3072
  ds_read_b64_tr_b16 v[156:157], v7 offset:2048
  ds_read_b64_tr_b16 v[158:159], v7 offset:3072
  s_waitcnt lgkmcnt(0)
  s_add_u32 s64, s11, 655360
  s_add_u32 s62, s26, s64
  s_addc_u32 s63, s27, 0
  s_add_u32 m0, s68, 4096
  s_nop 0
  global_load_lds_dwordx4 v4, s[62:63]
  s_add_u32 m0, s68, 5120
  s_nop 0
  global_load_lds_dwordx4 v5, s[62:63]
  s_waitcnt vmcnt(0)
  ds_read_b64_tr_b16 v[160:161], v6 offset:4096
  ds_read_b64_tr_b16 v[162:163], v6 offset:5120
  ds_read_b64_tr_b16 v[164:165], v7 offset:4096
  ds_read_b64_tr_b16 v[166:167], v7 offset:5120
  s_waitcnt lgkmcnt(0)
  s_add_u32 s64, s11, 688128
  s_add_u32 s62, s26, s64
  s_addc_u32 s63, s27, 0
  s_add_u32 m0, s68, 6144
  s_nop 0
  global_load_lds_dwordx4 v4, s[62:63]
  s_add_u32 m0, s68, 7168
  s_nop 0
  global_load_lds_dwordx4 v5, s[62:63]
  s_waitcnt vmcnt(0)
  ds_read_b64_tr_b16 v[168:169], v6 offset:6144
  ds_read_b64_tr_b16 v[170:171], v6 offset:7168
  ds_read_b64_tr_b16 v[172:173], v7 offset:6144
  ds_read_b64_tr_b16 v[174:175], v7 offset:7168
  s_waitcnt lgkmcnt(0)
  s_add_u32 s64, s11, 720896
  s_add_u32 s62, s26, s64
  s_addc_u32 s63, s27, 0
  s_add_u32 m0, s68, 8192
  s_nop 0
  global_load_lds_dwordx4 v4, s[62:63]
  s_add_u32 m0, s68, 9216
  s_nop 0
  global_load_lds_dwordx4 v5, s[62:63]
  s_waitcnt vmcnt(0)
  ds_read_b64_tr_b16 v[176:177], v6 offset:8192
  ds_read_b64_tr_b16 v[178:179], v6 offset:9216
  ds_read_b64_tr_b16 v[180:181], v7 offset:8192
  ds_read_b64_tr_b16 v[182:183], v7 offset:9216
  s_waitcnt lgkmcnt(0)
  s_add_u32 s64, s11, 753664
  s_add_u32 s62, s26, s64
  s_addc_u32 s63, s27, 0
  s_add_u32 m0, s68, 10240
  s_nop 0
  global_load_lds_dwordx4 v4, s[62:63]
  s_add_u32 m0, s68, 11264
  s_nop 0
  global_load_lds_dwordx4 v5, s[62:63]
  s_waitcnt vmcnt(0)
  ds_read_b64_tr_b16 v[184:185], v6 offset:10240
  ds_read_b64_tr_b16 v[186:187], v6 offset:11264
  ds_read_b64_tr_b16 v[188:189], v7 offset:10240
  ds_read_b64_tr_b16 v[190:191], v7 offset:11264
  s_waitcnt lgkmcnt(0)
  s_add_u32 s64, s11, 786432
  s_add_u32 s62, s26, s64
  s_addc_u32 s63, s27, 0
  s_add_u32 m0, s68, 12288
  s_nop 0
  global_load_lds_dwordx4 v4, s[62:63]
  s_add_u32 m0, s68, 13312
  s_nop 0
  global_load_lds_dwordx4 v5, s[62:63]
  s_waitcnt vmcnt(0)
  ds_read_b64_tr_b16 v[192:193], v6 offset:12288
  ds_read_b64_tr_b16 v[194:195], v6 offset:13312
  ds_read_b64_tr_b16 v[196:197], v7 offset:12288
  ds_read_b64_tr_b16 v[198:199], v7 offset:13312
  s_waitcnt lgkmcnt(0)
  s_add_u32 s64, s11, 819200
  s_add_u32 s62, s26, s64
  s_addc_u32 s63, s27, 0
  s_add_u32 m0, s68, 14336
  s_nop 0
  global_load_lds_dwordx4 v4, s[62:63]
  s_add_u32 m0, s68, 15360
  s_nop 0
  global_load_lds_dwordx4 v5, s[62:63]
  s_waitcnt vmcnt(0)
  ds_read_b64_tr_b16 v[200:201], v6 offset:14336
  ds_read_b64_tr_b16 v[202:203], v6 offset:15360
  ds_read_b64_tr_b16 v[204:205], v7 offset:14336
  ds_read_b64_tr_b16 v[206:207], v7 offset:15360
  s_waitcnt lgkmcnt(0)
  s_add_u32 s64, s11, 851968
  s_add_u32 s62, s26, s64
  s_addc_u32 s63, s27, 0
  s_add_u32 m0, s68, 16384
  s_nop 0
  global_load_lds_dwordx4 v4, s[62:63]
  s_add_u32 m0, s68, 17408
  s_nop 0
  global_load_lds_dwordx4 v5, s[62:63]
  s_waitcnt vmcnt(0)
  ds_read_b64_tr_b16 v[208:209], v6 offset:16384
  ds_read_b64_tr_b16 v[210:211], v6 offset:17408
  ds_read_b64_tr_b16 v[212:213], v7 offset:16384
  ds_read_b64_tr_b16 v[214:215], v7 offset:17408
  s_waitcnt lgkmcnt(0)
  s_add_u32 s64, s11, 884736
  s_add_u32 s62, s26, s64
  s_addc_u32 s63, s27, 0
  s_add_u32 m0, s68, 18432
  s_nop 0
  global_load_lds_dwordx4 v4, s[62:63]
  s_add_u32 m0, s68, 19456
  s_nop 0
  global_load_lds_dwordx4 v5, s[62:63]
  s_waitcnt vmcnt(0)
  ds_read_b64_tr_b16 v[216:217], v6 offset:18432
  ds_read_b64_tr_b16 v[218:219], v6 offset:19456
  ds_read_b64_tr_b16 v[220:221], v7 offset:18432
  ds_read_b64_tr_b16 v[222:223], v7 offset:19456
  s_waitcnt lgkmcnt(0)
  s_add_u32 s64, s11, 917504
  s_add_u32 s62, s26, s64
  s_addc_u32 s63, s27, 0
  s_add_u32 m0, s68, 20480
  s_nop 0
  global_load_lds_dwordx4 v4, s[62:63]
  s_add_u32 m0, s68, 21504
  s_nop 0
  global_load_lds_dwordx4 v5, s[62:63]
  s_waitcnt vmcnt(0)
  ds_read_b64_tr_b16 v[224:225], v6 offset:20480
  ds_read_b64_tr_b16 v[226:227], v6 offset:21504
  ds_read_b64_tr_b16 v[228:229], v7 offset:20480
  ds_read_b64_tr_b16 v[230:231], v7 offset:21504
  s_waitcnt lgkmcnt(0)
  s_add_u32 s64, s11, 950272
  s_add_u32 s62, s26, s64
  s_addc_u32 s63, s27, 0
  s_add_u32 m0, s68, 22528
  s_nop 0
  global_load_lds_dwordx4 v4, s[62:63]
  s_add_u32 m0, s68, 23552
  s_nop 0
  global_load_lds_dwordx4 v5, s[62:63]
  s_waitcnt vmcnt(0)
  ds_read_b64_tr_b16 v[232:233], v6 offset:22528
  ds_read_b64_tr_b16 v[234:235], v6 offset:23552
  ds_read_b64_tr_b16 v[236:237], v7 offset:22528
  ds_read_b64_tr_b16 v[238:239], v7 offset:23552
  s_waitcnt lgkmcnt(0)
  s_add_u32 s64, s11, 983040
  s_add_u32 s62, s26, s64
  s_addc_u32 s63, s27, 0
  s_add_u32 m0, s68, 24576
  s_nop 0
  global_load_lds_dwordx4 v4, s[62:63]
  s_add_u32 m0, s68, 25600
  s_nop 0
  global_load_lds_dwordx4 v5, s[62:63]
  s_waitcnt vmcnt(0)
  ds_read_b64_tr_b16 v[240:241], v6 offset:24576
  ds_read_b64_tr_b16 v[242:243], v6 offset:25600
  ds_read_b64_tr_b16 v[244:245], v7 offset:24576
  ds_read_b64_tr_b16 v[246:247], v7 offset:25600
  s_waitcnt lgkmcnt(0)
  s_add_u32 s64, s11, 1015808
  s_add_u32 s62, s26, s64
  s_addc_u32 s63, s27, 0
  s_add_u32 m0, s68, 26624
  s_nop 0
  global_load_lds_dwordx4 v4, s[62:63]
  s_add_u32 m0, s68, 27648
  s_nop 0
  global_load_lds_dwordx4 v5, s[62:63]
  s_waitcnt vmcnt(0)
  ds_read_b64_tr_b16 v[248:249], v6 offset:26624
  ds_read_b64_tr_b16 v[250:251], v6 offset:27648
  ds_read_b64_tr_b16 v[252:253], v7 offset:26624
  ds_read_b64_tr_b16 v[254:255], v7 offset:27648
  s_waitcnt lgkmcnt(0)
  s_cmp_lg_u32 s4, 0
  s_cbranch_scc1 Lw1_9
Lww_10:
  global_load_dword v4, v2, s[40:41] offset:164 sc1
  s_waitcnt vmcnt(0)
  v_cmp_gt_u32 vcc, 64, v4
  s_cbranch_vccz Lwd_11
  s_sleep 4
  s_sub_u32 s7, s7, 1
  s_cbranch_scc0 Lww_10
  s_mov_b32 s7, 0
Lwd_11:
Lw1_9:
  s_barrier
  v_min_u32 v4, 13, v0
  v_lshlrev_b32 v4, 2, v4
  s_mul_i32 s8, s4, 56
  s_add_u32 s8, s8, 155648
  v_add_u32 v4, s8, v4
  v_bfe_u32 v5, v0, 2, 3
  v_and_b32 v6, 3, v0
  v_lshlrev_b32 v6, 2, v6
  v_lshl_add_u32 v5, v5, 6, v6
  s_lshl_b32 s8, s4, 9
  s_add_u32 s8, s8, 4112
  v_add_u32 v5, s8, v5
  v_cmp_gt_u32 vcc, 32, v0
  s_nop 1
  v_cndmask_b32 v4, v5, v4, vcc
  v_mov_b32 v5, 11
  v_cndmask_b32 v15, v5, 8, vcc
  v_and_b32 v5, 7, v0
  v_lshlrev_b32 v13, 12, v5
  v_mov_b32 v6, 7
  v_lshl_add_u32 v13, v6, 7, v13
  v_lshrrev_b32 v6, 4, v0
  v_mul_u32_u24 v6, 288, v6
  v_and_b32 v7, 15, v0
  v_lshl_add_u32 v6, v7, 4, v6
  s_mul_i32 s8, s4, 4608
  v_add_u32 v6, s8, v6
  v_lshrrev_b32 v8, 1, v7
  v_mul_u32_u24 v8, 288, v8
  v_and_b32 v9, 1, v0
  v_lshl_add_u32 v8, v9, 3, v8
  v_lshrrev_b32 v9, 4, v0
  s_lshl_b32 s8, s4, 2
  v_add_u32 v9, s8, v9
  v_lshl_add_u32 v8, v9, 4, v8
  v_lshlrev_b32 v9, 10, v9
  v_lshl_add_u32 v9, v7, 2, v9
  s_lshl_b32 s8, s45, 6
  v_add_u32 v9, s8, v9
  v_mov_b32 v7, v8
  v_mov_b32 v8, 0
  s_lshl_b32 s8, s73, 6
  v_xor_b32 v2, s8, v1
  v_and_b32 v2, 0x80, v2
  v_mul_u32_u24 v2, 9, v2
  v_xor_b32 v2, v2, v1
  s_xor_b32 s73, s73, s4
  s_bitcmp1_b32 s73, 1
  s_cselect_b32 s73, 124, -1
  s_barrier
L_O_loop:
  s_lshr_b32 s62, s46, 1
  v_lshl_add_u32 v5, s62, v15, v4
  s_lshl_b32 s62, s46, 7
  s_lshl_b32 s63, s4, 5
  s_add_u32 s62, s62, s63
  s_lshl_b32 s63, s62, 10
  s_add_u32 s63, s63, 84938752
  s_add_u32 s52, s42, s63
  s_addc_u32 s53, s43, 0
  s_mul_i32 s62, s46, 57344
  s_mul_i32 s63, s4, 14336
  s_add_u32 s62, s62, s63
  s_add_u32 s62, s62, 4198400
  s_add_u32 s50, s42, s62
  s_addc_u32 s51, s43, 0
  s_lshl_b32 s62, s46, 14
  s_add_u32 s58, s16, s62
  s_addc_u32 s59, s17, 0
  v_cmp_eq_u32 vcc, 0, v8
  s_add_u32 s75, s46, s47
  s_cmp_ge_u32 s75, s70
  s_cselect_b32 s8, 2, 0
  s_sub_u32 s74, s75, s8
  s_lshr_b32 s8, s74, 1
  v_lshl_add_u32 v11, s8, v15, v4
  s_cbranch_vccz L_O_f
Lww_12:
  global_load_dword v3, v5, s[42:43] offset:0 sc1
  s_waitcnt vmcnt(0)
  v_cmp_gt_u32 vcc, 1, v3
  s_cbranch_vccz Lwd_13
  s_sleep 2
  s_sub_u32 s7, s7, 1
  s_cbranch_scc0 Lww_12
  s_mov_b32 s7, 0
Lwd_13:
L_O_f:
  global_load_dword v10, v9, s[58:59]
  global_load_dwordx4 v[32:35], v1, s[50:51] offset:-4096
  global_load_dwordx4 v[36:39], v1, s[50:51] offset:-3072
  global_load_dwordx4 v[40:43], v1, s[50:51] offset:-2048
  global_load_dwordx4 v[44:47], v1, s[50:51] offset:-1024
  global_load_dwordx4 v[48:51], v1, s[50:51] offset:0
  global_load_dwordx4 v[52:55], v1, s[50:51] offset:1024
  global_load_dwordx4 v[56:59], v1, s[50:51] offset:2048
  global_load_dwordx4 v[60:63], v1, s[50:51] offset:3072
  s_add_u32 s50, s50, 8192
  s_addc_u32 s51, s51, 0
  global_load_dwordx4 v[64:67], v1, s[50:51] offset:-4096
  global_load_dwordx4 v[68:71], v1, s[50:51] offset:-3072
  global_load_dwordx4 v[72:75], v1, s[50:51] offset:-2048
  global_load_dwordx4 v[76:79], v1, s[50:51] offset:-1024
  global_load_dwordx4 v[80:83], v1, s[50:51] offset:0
  global_load_dwordx4 v[84:87], v1, s[50:51] offset:1024
  global_load_dword v8, v11, s[42:43] sc1
  s_add_u32 s58, s38, s62
  s_addc_u32 s59, s39, 0
  s_waitcnt vmcnt(14)
  v_mfma_f32_16x16x32_bf16 v[16:19], a[0:3], v[32:35], 0
  v_mfma_f32_16x16x32_bf16 v[20:23], a[4:7], v[32:35], 0
  s_waitcnt vmcnt(13)
  v_mfma_f32_16x16x32_bf16 v[16:19], a[8:11], v[36:39], v[16:19]
  v_mfma_f32_16x16x32_bf16 v[20:23], a[12:15], v[36:39], v[20:23]
  s_waitcnt vmcnt(12)
  v_mfma_f32_16x16x32_bf16 v[16:19], a[16:19], v[40:43], v[16:19]
  v_mfma_f32_16x16x32_bf16 v[20:23], a[20:23], v[40:43], v[20:23]
  s_waitcnt vmcnt(11)
  v_mfma_f32_16x16x32_bf16 v[16:19], a[24:27], v[44:47], v[16:19]
  v_mfma_f32_16x16x32_bf16 v[20:23], a[28:31], v[44:47], v[20:23]
  s_waitcnt vmcnt(10)
  v_mfma_f32_16x16x32_bf16 v[16:19], a[32:35], v[48:51], v[16:19]
  v_mfma_f32_16x16x32_bf16 v[20:23], a[36:39], v[48:51], v[20:23]
  s_waitcnt vmcnt(9)
  v_mfma_f32_16x16x32_bf16 v[16:19], a[40:43], v[52:55], v[16:19]
  v_mfma_f32_16x16x32_bf16 v[20:23], a[44:47], v[52:55], v[20:23]
  s_waitcnt vmcnt(8)
  v_mfma_f32_16x16x32_bf16 v[16:19], a[48:51], v[56:59], v[16:19]
  v_mfma_f32_16x16x32_bf16 v[20:23], a[52:55], v[56:59], v[20:23]
  s_waitcnt vmcnt(7)
  v_mfma_f32_16x16x32_bf16 v[16:19], a[56:59], v[60:63], v[16:19]
  v_mfma_f32_16x16x32_bf16 v[20:23], a[60:63], v[60:63], v[20:23]
  s_waitcnt vmcnt(6)
  v_mfma_f32_16x16x32_bf16 v[16:19], a[64:67], v[64:67], v[16:19]
  v_mfma_f32_16x16x32_bf16 v[20:23], a[68:71], v[64:67], v[20:23]
  s_waitcnt vmcnt(5)
  v_mfma_f32_16x16x32_bf16 v[16:19], a[72:75], v[68:71], v[16:19]
  v_mfma_f32_16x16x32_bf16 v[20:23], a[76:79], v[68:71], v[20:23]
  s_waitcnt vmcnt(4)
  v_mfma_f32_16x16x32_bf16 v[16:19], a[80:83], v[72:75], v[16:19]
  v_mfma_f32_16x16x32_bf16 v[20:23], a[84:87], v[72:75], v[20:23]
  s_waitcnt vmcnt(3)
  v_mfma_f32_16x16x32_bf16 v[16:19], a[88:91], v[76:79], v[16:19]
  v_mfma_f32_16x16x32_bf16 v[20:23], a[92:95], v[76:79], v[20:23]
  s_waitcnt vmcnt(2)
  v_mfma_f32_16x16x32_bf16 v[16:19], a[96:99], v[80:83], v[16:19]
  v_mfma_f32_16x16x32_bf16 v[20:23], a[100:103], v[80:83], v[20:23]
  s_waitcnt vmcnt(1)
  v_mfma_f32_16x16x32_bf16 v[16:19], a[104:107], v[84:87], v[16:19]
  v_mfma_f32_16x16x32_bf16 v[20:23], a[108:111], v[84:87], v[20:23]
  global_load_dword v3, v13, s[52:53] offset:-900 sc1
  s_sleep 6
  global_load_dword v3, v13, s[52:53] offset:-900 sc1
  s_sleep 6
  s_branch L_O_s
L_O_pk:
  s_add_u32 s48, s52, 0
  s_addc_u32 s49, s53, 0
  global_load_dwordx4 v[32:35], v2, s[48:49] offset:-4096
  global_load_dwordx4 v[36:39], v2, s[48:49] offset:-2048
  global_load_dwordx4 v[40:43], v2, s[48:49] offset:0
  global_load_dwordx4 v[44:47], v2, s[48:49] offset:2048
  s_add_u32 s48, s52, 8192
  s_addc_u32 s49, s53, 0
  global_load_dwordx4 v[48:51], v2, s[48:49] offset:-4096
  global_load_dwordx4 v[52:55], v2, s[48:49] offset:-2048
  global_load_dwordx4 v[56:59], v2, s[48:49] offset:0
  global_load_dwordx4 v[60:63], v2, s[48:49] offset:2048
  s_add_u32 s48, s52, 16384
  s_addc_u32 s49, s53, 0
  global_load_dwordx4 v[64:67], v2, s[48:49] offset:-4096
  global_load_dwordx4 v[68:71], v2, s[48:49] offset:-2048
  global_load_dwordx4 v[72:75], v2, s[48:49] offset:0
  global_load_dwordx4 v[76:79], v2, s[48:49] offset:2048
  s_add_u32 s48, s52, 24576
  s_addc_u32 s49, s53, 0
  global_load_dwordx4 v[80:83], v2, s[48:49] offset:-4096
  global_load_dwordx4 v[84:87], v2, s[48:49] offset:-2048
  global_load_dwordx4 v[88:91], v2, s[48:49] offset:0
  global_load_dwordx4 v[92:95], v2, s[48:49] offset:2048
  s_waitcnt vmcnt(15)
  v_mfma_f32_16x16x32_bf16 v[24:27], a[112:115], v[32:35], 0
  v_mfma_f32_16x16x32_bf16 v[28:31], a[116:119], v[32:35], 0
  v_mfma_f32_16x16x32_bf16 v[112:115], a[120:123], v[32:35], 0
  v_mfma_f32_16x16x32_bf16 v[116:119], a[124:127], v[32:35], 0
  v_max3_u32 v14, v32, v33, 0
  v_max3_u32 v14, v34, v35, v14
  s_waitcnt vmcnt(14)
  v_mfma_f32_16x16x32_bf16 v[24:27], a[128:131], v[36:39], v[24:27]
  v_mfma_f32_16x16x32_bf16 v[28:31], a[132:135], v[36:39], v[28:31]
  v_mfma_f32_16x16x32_bf16 v[112:115], a[136:139], v[36:39], v[112:115]
  v_mfma_f32_16x16x32_bf16 v[116:119], a[140:143], v[36:39], v[116:119]
  v_max3_u32 v14, v36, v37, v14
  v_max3_u32 v14, v38, v39, v14
  s_waitcnt vmcnt(13)
  v_mfma_f32_16x16x32_bf16 v[24:27], a[144:147], v[40:43], v[24:27]
  v_mfma_f32_16x16x32_bf16 v[28:31], a[148:151], v[40:43], v[28:31]
  v_mfma_f32_16x16x32_bf16 v[112:115], a[152:155], v[40:43], v[112:115]
  v_mfma_f32_16x16x32_bf16 v[116:119], a[156:159], v[40:43], v[116:119]
  v_max3_u32 v14, v40, v41, v14
  v_max3_u32 v14, v42, v43, v14
  s_waitcnt vmcnt(12)
  v_mfma_f32_16x16x32_bf16 v[24:27], a[160:163], v[44:47], v[24:27]
  v_mfma_f32_16x16x32_bf16 v[28:31], a[164:167], v[44:47], v[28:31]
  v_mfma_f32_16x16x32_bf16 v[112:115], a[168:171], v[44:47], v[112:115]
  v_mfma_f32_16x16x32_bf16 v[116:119], a[172:175], v[44:47], v[116:119]
  v_max3_u32 v14, v44, v45, v14
  v_max3_u32 v14, v46, v47, v14
  s_waitcnt vmcnt(11)
  v_mfma_f32_16x16x32_bf16 v[24:27], a[176:179], v[48:51], v[24:27]
  v_mfma_f32_16x16x32_bf16 v[28:31], a[180:183], v[48:51], v[28:31]
  v_mfma_f32_16x16x32_bf16 v[112:115], a[184:187], v[48:51], v[112:115]
  v_mfma_f32_16x16x32_bf16 v[116:119], a[188:191], v[48:51], v[116:119]
  v_max3_u32 v14, v48, v49, v14
  v_max3_u32 v14, v50, v51, v14
  s_waitcnt vmcnt(10)
  v_mfma_f32_16x16x32_bf16 v[24:27], a[192:195], v[52:55], v[24:27]
  v_mfma_f32_16x16x32_bf16 v[28:31], a[196:199], v[52:55], v[28:31]
  v_mfma_f32_16x16x32_bf16 v[112:115], a[200:203], v[52:55], v[112:115]
  v_mfma_f32_16x16x32_bf16 v[116:119], a[204:207], v[52:55], v[116:119]
  v_max3_u32 v14, v52, v53, v14
  v_max3_u32 v14, v54, v55, v14
  s_waitcnt vmcnt(9)
  v_mfma_f32_16x16x32_bf16 v[24:27], a[208:211], v[56:59], v[24:27]
  v_mfma_f32_16x16x32_bf16 v[28:31], a[212:215], v[56:59], v[28:31]
  v_mfma_f32_16x16x32_bf16 v[112:115], a[216:219], v[56:59], v[112:115]
  v_mfma_f32_16x16x32_bf16 v[116:119], a[220:223], v[56:59], v[116:119]
  v_max3_u32 v14, v56, v57, v14
  v_max3_u32 v14, v58, v59, v14
  s_waitcnt vmcnt(8)
  v_mfma_f32_16x16x32_bf16 v[24:27], a[224:227], v[60:63], v[24:27]
  v_mfma_f32_16x16x32_bf16 v[28:31], a[228:231], v[60:63], v[28:31]
  v_mfma_f32_16x16x32_bf16 v[112:115], a[232:235], v[60:63], v[112:115]
  v_mfma_f32_16x16x32_bf16 v[116:119], a[236:239], v[60:63], v[116:119]
  v_max3_u32 v14, v60, v61, v14
  v_max3_u32 v14, v62, v63, v14
  s_waitcnt vmcnt(7)
  v_mfma_f32_16x16x32_bf16 v[24:27], a[240:243], v[64:67], v[24:27]
  v_mfma_f32_16x16x32_bf16 v[28:31], a[244:247], v[64:67], v[28:31]
  v_mfma_f32_16x16x32_bf16 v[112:115], a[248:251], v[64:67], v[112:115]
  v_mfma_f32_16x16x32_bf16 v[116:119], a[252:255], v[64:67], v[116:119]
  v_max3_u32 v14, v64, v65, v14
  v_max3_u32 v14, v66, v67, v14
  s_waitcnt vmcnt(6)
  v_mfma_f32_16x16x32_bf16 v[24:27], v[144:147], v[68:71], v[24:27]
  v_mfma_f32_16x16x32_bf16 v[28:31], v[148:151], v[68:71], v[28:31]
  v_mfma_f32_16x16x32_bf16 v[112:115], v[152:155], v[68:71], v[112:115]
  v_mfma_f32_16x16x32_bf16 v[116:119], v[156:159], v[68:71], v[116:119]
  v_max3_u32 v14, v68, v69, v14
  v_max3_u32 v14, v70, v71, v14
  s_waitcnt vmcnt(5)
  v_mfma_f32_16x16x32_bf16 v[24:27], v[160:163], v[72:75], v[24:27]
  v_mfma_f32_16x16x32_bf16 v[28:31], v[164:167], v[72:75], v[28:31]
  v_mfma_f32_16x16x32_bf16 v[112:115], v[168:171], v[72:75], v[112:115]
  v_mfma_f32_16x16x32_bf16 v[116:119], v[172:175], v[72:75], v[116:119]
  v_max3_u32 v14, v72, v73, v14
  v_max3_u32 v14, v74, v75, v14
  s_waitcnt vmcnt(4)
  v_mfma_f32_16x16x32_bf16 v[24:27], v[176:179], v[76:79], v[24:27]
  v_mfma_f32_16x16x32_bf16 v[28:31], v[180:183], v[76:79], v[28:31]
  v_mfma_f32_16x16x32_bf16 v[112:115], v[184:187], v[76:79], v[112:115]
  v_mfma_f32_16x16x32_bf16 v[116:119], v[188:191], v[76:79], v[116:119]
  v_max3_u32 v14, v76, v77, v14
  v_max3_u32 v14, v78, v79, v14
  s_waitcnt vmcnt(3)
  v_mfma_f32_16x16x32_bf16 v[24:27], v[192:195], v[80:83], v[24:27]
  v_mfma_f32_16x16x32_bf16 v[28:31], v[196:199], v[80:83], v[28:31]
  v_mfma_f32_16x16x32_bf16 v[112:115], v[200:203], v[80:83], v[112:115]
  v_mfma_f32_16x16x32_bf16 v[116:119], v[204:207], v[80:83], v[116:119]
  v_max3_u32 v14, v80, v81, v14
  v_max3_u32 v14, v82, v83, v14
  s_waitcnt vmcnt(2)
  v_mfma_f32_16x16x32_bf16 v[24:27], v[208:211], v[84:87], v[24:27]
  v_mfma_f32_16x16x32_bf16 v[28:31], v[212:215], v[84:87], v[28:31]
  v_mfma_f32_16x16x32_bf16 v[112:115], v[216:219], v[84:87], v[112:115]
  v_mfma_f32_16x16x32_bf16 v[116:119], v[220:223], v[84:87], v[116:119]
  v_max3_u32 v14, v84, v85, v14
  v_max3_u32 v14, v86, v87, v14
  s_waitcnt vmcnt(1)
  v_mfma_f32_16x16x32_bf16 v[24:27], v[224:227], v[88:91], v[24:27]
  v_mfma_f32_16x16x32_bf16 v[28:31], v[228:231], v[88:91], v[28:31]
  v_mfma_f32_16x16x32_bf16 v[112:115], v[232:235], v[88:91], v[112:115]
  v_mfma_f32_16x16x32_bf16 v[116:119], v[236:239], v[88:91], v[116:119]
  v_max3_u32 v14, v88, v89, v14
  v_max3_u32 v14, v90, v91, v14
  s_waitcnt vmcnt(0)
  v_mfma_f32_16x16x32_bf16 v[24:27], v[240:243], v[92:95], v[24:27]
  v_mfma_f32_16x16x32_bf16 v[28:31], v[244:247], v[92:95], v[28:31]
  v_mfma_f32_16x16x32_bf16 v[112:115], v[248:251], v[92:95], v[112:115]
  v_mfma_f32_16x16x32_bf16 v[116:119], v[252:255], v[92:95], v[116:119]
  v_max3_u32 v14, v92, v93, v14
  v_max3_u32 v14, v94, v95, v14
  v_cmp_eq_u32 vcc, -1, v14
  s_nop 0
  v_add_f32_dpp v24, v112, v24 row_ror:8 row_mask:0xf bank_mask:0xf
  v_add_f32_dpp v25, v113, v25 row_ror:8 row_mask:0xf bank_mask:0xf
  v_add_f32_dpp v26, v114, v26 row_ror:8 row_mask:0xf bank_mask:0xf
  v_add_f32_dpp v27, v115, v27 row_ror:8 row_mask:0xf bank_mask:0xf
  v_add_f32_dpp v28, v116, v28 row_ror:8 row_mask:0xf bank_mask:0xf
  v_add_f32_dpp v29, v117, v29 row_ror:8 row_mask:0xf bank_mask:0xf
  v_add_f32_dpp v30, v118, v30 row_ror:8 row_mask:0xf bank_mask:0xf
  v_add_f32_dpp v31, v119, v31 row_ror:8 row_mask:0xf bank_mask:0xf
  s_cbranch_vccz L_O_d
L_O_r:
  s_add_u32 s48, s52, 0
  s_addc_u32 s49, s53, 0
  global_load_dwordx4 v[88:91], v1, s[48:49] offset:-4096 sc1
  global_load_dwordx4 v[92:95], v1, s[48:49] offset:-3072 sc1
  global_load_dwordx4 v[96:99], v1, s[48:49] offset:-2048 sc1
  global_load_dwordx4 v[100:103], v1, s[48:49] offset:-1024 sc1
  global_load_dwordx4 v[104:107], v1, s[48:49] offset:0 sc1
  global_load_dwordx4 v[108:111], v1, s[48:49] offset:1024 sc1
  global_load_dwordx4 v[112:115], v1, s[48:49] offset:2048 sc1
  global_load_dwordx4 v[116:119], v1, s[48:49] offset:3072 sc1
  s_add_u32 s48, s52, 8192
  s_addc_u32 s49, s53, 0
  global_load_dwordx4 v[120:123], v1, s[48:49] offset:-4096 sc1
  global_load_dwordx4 v[124:127], v1, s[48:49] offset:-3072 sc1
  global_load_dwordx4 v[128:131], v1, s[48:49] offset:-2048 sc1
  global_load_dwordx4 v[132:135], v1, s[48:49] offset:-1024 sc1
  global_load_dwordx4 v[136:139], v1, s[48:49] offset:0 sc1
  global_load_dwordx4 v[140:143], v1, s[48:49] offset:1024 sc1
  global_load_dwordx4 v[32:35], v1, s[48:49] offset:2048 sc1
  global_load_dwordx4 v[36:39], v1, s[48:49] offset:3072 sc1
  s_add_u32 s48, s52, 16384
  s_addc_u32 s49, s53, 0
  global_load_dwordx4 v[40:43], v1, s[48:49] offset:-4096 sc1
  global_load_dwordx4 v[44:47], v1, s[48:49] offset:-3072 sc1
  global_load_dwordx4 v[48:51], v1, s[48:49] offset:-2048 sc1
  global_load_dwordx4 v[52:55], v1, s[48:49] offset:-1024 sc1
  global_load_dwordx4 v[56:59], v1, s[48:49] offset:0 sc1
  global_load_dwordx4 v[60:63], v1, s[48:49] offset:1024 sc1
  global_load_dwordx4 v[64:67], v1, s[48:49] offset:2048 sc1
  global_load_dwordx4 v[68:71], v1, s[48:49] offset:3072 sc1
  s_add_u32 s48, s52, 24576
  s_addc_u32 s49, s53, 0
  global_load_dwordx4 v[72:75], v1, s[48:49] offset:-4096 sc1
  global_load_dwordx4 v[76:79], v1, s[48:49] offset:-3072 sc1
  global_load_dwordx4 v[80:83], v1, s[48:49] offset:-2048 sc1
  global_load_dwordx4 v[84:87], v1, s[48:49] offset:-1024 sc1
  s_waitcnt vmcnt(27)
  v_mfma_f32_16x16x32_bf16 v[24:27], a[112:115], v[88:91], 0
  v_mfma_f32_16x16x32_bf16 v[28:31], a[116:119], v[88:91], 0
  v_max3_u32 v14, v88, v89, 0
  v_max3_u32 v14, v90, v91, v14
  global_load_dwordx4 v[88:91], v1, s[48:49] offset:0 sc1
  s_waitcnt vmcnt(27)
  v_mfma_f32_16x16x32_bf16 v[24:27], a[120:123], v[92:95], v[24:27]
  v_mfma_f32_16x16x32_bf16 v[28:31], a[124:127], v[92:95], v[28:31]
  v_max3_u32 v14, v92, v93, v14
  v_max3_u32 v14, v94, v95, v14
  global_load_dwordx4 v[92:95], v1, s[48:49] offset:1024 sc1
  s_waitcnt vmcnt(27)
  v_mfma_f32_16x16x32_bf16 v[24:27], a[128:131], v[96:99], v[24:27]
  v_mfma_f32_16x16x32_bf16 v[28:31], a[132:135], v[96:99], v[28:31]
  v_max3_u32 v14, v96, v97, v14
  v_max3_u32 v14, v98, v99, v14
  global_load_dwordx4 v[96:99], v1, s[48:49] offset:2048 sc1
  s_waitcnt vmcnt(27)
  v_mfma_f32_16x16x32_bf16 v[24:27], a[136:139], v[100:103], v[24:27]
  v_mfma_f32_16x16x32_bf16 v[28:31], a[140:143], v[100:103], v[28:31]
  v_max3_u32 v14, v100, v101, v14
  v_max3_u32 v14, v102, v103, v14
  global_load_dwordx4 v[100:103], v1, s[48:49] offset:3072 sc1
  s_waitcnt vmcnt(27)
  v_mfma_f32_16x16x32_bf16 v[24:27], a[144:147], v[104:107], v[24:27]
  v_mfma_f32_16x16x32_bf16 v[28:31], a[148:151], v[104:107], v[28:31]
  v_max3_u32 v14, v104, v105, v14
  v_max3_u32 v14, v106, v107, v14
  s_waitcnt vmcnt(26)
  v_mfma_f32_16x16x32_bf16 v[24:27], a[152:155], v[108:111], v[24:27]
  v_mfma_f32_16x16x32_bf16 v[28:31], a[156:159], v[108:111], v[28:31]
  v_max3_u32 v14, v108, v109, v14
  v_max3_u32 v14, v110, v111, v14
  s_waitcnt vmcnt(25)
  v_mfma_f32_16x16x32_bf16 v[24:27], a[160:163], v[112:115], v[24:27]
  v_mfma_f32_16x16x32_bf16 v[28:31], a[164:167], v[112:115], v[28:31]
  v_max3_u32 v14, v112, v113, v14
  v_max3_u32 v14, v114, v115, v14
  s_waitcnt vmcnt(24)
  v_mfma_f32_16x16x32_bf16 v[24:27], a[168:171], v[116:119], v[24:27]
  v_mfma_f32_16x16x32_bf16 v[28:31], a[172:175], v[116:119], v[28:31]
  v_max3_u32 v14, v116, v117, v14
  v_max3_u32 v14, v118, v119, v14
  s_waitcnt vmcnt(23)
  v_mfma_f32_16x16x32_bf16 v[24:27], a[176:179], v[120:123], v[24:27]
  v_mfma_f32_16x16x32_bf16 v[28:31], a[180:183], v[120:123], v[28:31]
  v_max3_u32 v14, v120, v121, v14
  v_max3_u32 v14, v122, v123, v14
  s_waitcnt vmcnt(22)
  v_mfma_f32_16x16x32_bf16 v[24:27], a[184:187], v[124:127], v[24:27]
  v_mfma_f32_16x16x32_bf16 v[28:31], a[188:191], v[124:127], v[28:31]
  v_max3_u32 v14, v124, v125, v14
  v_max3_u32 v14, v126, v127, v14
  s_waitcnt vmcnt(21)
  v_mfma_f32_16x16x32_bf16 v[24:27], a[192:195], v[128:131], v[24:27]
  v_mfma_f32_16x16x32_bf16 v[28:31], a[196:199], v[128:131], v[28:31]
  v_max3_u32 v14, v128, v129, v14
  v_max3_u32 v14, v130, v131, v14
  s_waitcnt vmcnt(20)
  v_mfma_f32_16x16x32_bf16 v[24:27], a[200:203], v[132:135], v[24:27]
  v_mfma_f32_16x16x32_bf16 v[28:31], a[204:207], v[132:135], v[28:31]
  v_max3_u32 v14, v132, v133, v14
  v_max3_u32 v14, v134, v135, v14
  s_waitcnt vmcnt(19)
  v_mfma_f32_16x16x32_bf16 v[24:27], a[208:211], v[136:139], v[24:27]
  v_mfma_f32_16x16x32_bf16 v[28:31], a[212:215], v[136:139], v[28:31]
  v_max3_u32 v14, v136, v137, v14
  v_max3_u32 v14, v138, v139, v14
  s_waitcnt vmcnt(18)
  v_mfma_f32_16x16x32_bf16 v[24:27], a[216:219], v[140:143], v[24:27]
  v_mfma_f32_16x16x32_bf16 v[28:31], a[220:223], v[140:143], v[28:31]
  v_max3_u32 v14, v140, v141, v14
  v_max3_u32 v14, v142, v143, v14
  s_waitcnt vmcnt(17)
  v_mfma_f32_16x16x32_bf16 v[24:27], a[224:227], v[32:35], v[24:27]
  v_mfma_f32_16x16x32_bf16 v[28:31], a[228:231], v[32:35], v[28:31]
  v_max3_u32 v14, v32, v33, v14
  v_max3_u32 v14, v34, v35, v14
  s_waitcnt vmcnt(16)
  v_mfma_f32_16x16x32_bf16 v[24:27], a[232:235], v[36:39], v[24:27]
  v_mfma_f32_16x16x32_bf16 v[28:31], a[236:239], v[36:39], v[28:31]
  v_max3_u32 v14, v36, v37, v14
  v_max3_u32 v14, v38, v39, v14
  s_waitcnt vmcnt(15)
  v_mfma_f32_16x16x32_bf16 v[24:27], a[240:243], v[40:43], v[24:27]
  v_mfma_f32_16x16x32_bf16 v[28:31], a[244:247], v[40:43], v[28:31]
  v_max3_u32 v14, v40, v41, v14
  v_max3_u32 v14, v42, v43, v14
  s_waitcnt vmcnt(14)
  v_mfma_f32_16x16x32_bf16 v[24:27], a[248:251], v[44:47], v[24:27]
  v_mfma_f32_16x16x32_bf16 v[28:31], a[252:255], v[44:47], v[28:31]
  v_max3_u32 v14, v44, v45, v14
  v_max3_u32 v14, v46, v47, v14
  s_waitcnt vmcnt(13)
  v_mfma_f32_16x16x32_bf16 v[24:27], v[144:147], v[48:51], v[24:27]
  v_mfma_f32_16x16x32_bf16 v[28:31], v[148:151], v[48:51], v[28:31]
  v_max3_u32 v14, v48, v49, v14
  v_max3_u32 v14, v50, v51, v14
  s_waitcnt vmcnt(12)
  v_mfma_f32_16x16x32_bf16 v[24:27], v[152:155], v[52:55], v[24:27]
  v_mfma_f32_16x16x32_bf16 v[28:31], v[156:159], v[52:55], v[28:31]
  v_max3_u32 v14, v52, v53, v14
  v_max3_u32 v14, v54, v55, v14
  s_waitcnt vmcnt(11)
  v_mfma_f32_16x16x32_bf16 v[24:27], v[160:163], v[56:59], v[24:27]
  v_mfma_f32_16x16x32_bf16 v[28:31], v[164:167], v[56:59], v[28:31]
  v_max3_u32 v14, v56, v57, v14
  v_max3_u32 v14, v58, v59, v14
  s_waitcnt vmcnt(10)
  v_mfma_f32_16x16x32_bf16 v[24:27], v[168:171], v[60:63], v[24:27]
  v_mfma_f32_16x16x32_bf16 v[28:31], v[172:175], v[60:63], v[28:31]
  v_max3_u32 v14, v60, v61, v14
  v_max3_u32 v14, v62, v63, v14
  s_waitcnt vmcnt(9)
  v_mfma_f32_16x16x32_bf16 v[24:27], v[176:179], v[64:67], v[24:27]
  v_mfma_f32_16x16x32_bf16 v[28:31], v[180:183], v[64:67], v[28:31]
  v_max3_u32 v14, v64, v65, v14
  v_max3_u32 v14, v66, v67, v14
  s_waitcnt vmcnt(8)
  v_mfma_f32_16x16x32_bf16 v[24:27], v[184:187], v[68:71], v[24:27]
  v_mfma_f32_16x16x32_bf16 v[28:31], v[188:191], v[68:71], v[28:31]
  v_max3_u32 v14, v68, v69, v14
  v_max3_u32 v14, v70, v71, v14
  s_waitcnt vmcnt(7)
  v_mfma_f32_16x16x32_bf16 v[24:27], v[192:195], v[72:75], v[24:27]
  v_mfma_f32_16x16x32_bf16 v[28:31], v[196:199], v[72:75], v[28:31]
  v_max3_u32 v14, v72, v73, v14
  v_max3_u32 v14, v74, v75, v14
  s_waitcnt vmcnt(6)
  v_mfma_f32_16x16x32_bf16 v[24:27], v[200:203], v[76:79], v[24:27]
  v_mfma_f32_16x16x32_bf16 v[28:31], v[204:207], v[76:79], v[28:31]
  v_max3_u32 v14, v76, v77, v14
  v_max3_u32 v14, v78, v79, v14
  s_waitcnt vmcnt(5)
  v_mfma_f32_16x16x32_bf16 v[24:27], v[208:211], v[80:83], v[24:27]
  v_mfma_f32_16x16x32_bf16 v[28:31], v[212:215], v[80:83], v[28:31]
  v_max3_u32 v14, v80, v81, v14
  v_max3_u32 v14, v82, v83, v14
  s_waitcnt vmcnt(4)
  v_mfma_f32_16x16x32_bf16 v[24:27], v[216:219], v[84:87], v[24:27]
  v_mfma_f32_16x16x32_bf16 v[28:31], v[220:223], v[84:87], v[28:31]
  v_max3_u32 v14, v84, v85, v14
  v_max3_u32 v14, v86, v87, v14
  s_waitcnt vmcnt(3)
  v_mfma_f32_16x16x32_bf16 v[24:27], v[224:227], v[88:91], v[24:27]
  v_mfma_f32_16x16x32_bf16 v[28:31], v[228:231], v[88:91], v[28:31]
  v_max3_u32 v14, v88, v89, v14
  v_max3_u32 v14, v90, v91, v14
  s_waitcnt vmcnt(2)
  v_mfma_f32_16x16x32_bf16 v[24:27], v[232:235], v[92:95], v[24:27]
  v_mfma_f32_16x16x32_bf16 v[28:31], v[236:239], v[92:95], v[28:31]
  v_max3_u32 v14, v92, v93, v14
  v_max3_u32 v14, v94, v95, v14
  s_waitcnt vmcnt(1)
  v_mfma_f32_16x16x32_bf16 v[24:27], v[240:243], v[96:99], v[24:27]
  v_mfma_f32_16x16x32_bf16 v[28:31], v[244:247], v[96:99], v[28:31]
  v_max3_u32 v14, v96, v97, v14
  v_max3_u32 v14, v98, v99, v14
  s_waitcnt vmcnt(0)
  v_mfma_f32_16x16x32_bf16 v[24:27], v[248:251], v[100:103], v[24:27]
  v_mfma_f32_16x16x32_bf16 v[28:31], v[252:255], v[100:103], v[28:31]
  v_max3_u32 v14, v100, v101, v14
  v_max3_u32 v14, v102, v103, v14
  v_cmp_eq_u32 vcc, -1, v14
  s_cbranch_vccz L_O_d
  s_sub_u32 s7, s7, 1
  s_cbranch_scc0 L_O_r
  s_mov_b32 s7, 0
  s_branch L_O_d
L_O_s:
  global_load_dword v3, v13, s[52:53] offset:-900 sc1
  s_waitcnt vmcnt(2)
  v_cmp_eq_u32 vcc, -1, v3
  s_cbranch_vccz L_O_a
  s_sub_u32 s7, s7, 1
  s_cbranch_scc0 L_O_s
  s_mov_b32 s7, 0
L_O_a:
  s_cmp_ge_u32 s46, s72
  s_cbranch_scc1 L_O_pk
  s_add_u32 s48, s52, 0
  s_addc_u32 s49, s53, 0
  global_load_dwordx4 v[88:91], v1, s[48:49] offset:-4096
  global_load_dwordx4 v[92:95], v1, s[48:49] offset:-3072
  global_load_dwordx4 v[96:99], v1, s[48:49] offset:-2048
  global_load_dwordx4 v[100:103], v1, s[48:49] offset:-1024
  global_load_dwordx4 v[104:107], v1, s[48:49] offset:0
  global_load_dwordx4 v[108:111], v1, s[48:49] offset:1024
  global_load_dwordx4 v[112:115], v1, s[48:49] offset:2048
  global_load_dwordx4 v[116:119], v1, s[48:49] offset:3072
  s_add_u32 s48, s52, 8192
  s_addc_u32 s49, s53, 0
  global_load_dwordx4 v[120:123], v1, s[48:49] offset:-4096
  global_load_dwordx4 v[124:127], v1, s[48:49] offset:-3072
  global_load_dwordx4 v[128:131], v1, s[48:49] offset:-2048
  global_load_dwordx4 v[132:135], v1, s[48:49] offset:-1024
  global_load_dwordx4 v[136:139], v1, s[48:49] offset:0
  global_load_dwordx4 v[140:143], v1, s[48:49] offset:1024
  global_load_dwordx4 v[32:35], v1, s[48:49] offset:2048
  global_load_dwordx4 v[36:39], v1, s[48:49] offset:3072
  s_add_u32 s48, s52, 16384
  s_addc_u32 s49, s53, 0
  global_load_dwordx4 v[40:43], v1, s[48:49] offset:-4096
  global_load_dwordx4 v[44:47], v1, s[48:49] offset:-3072
  global_load_dwordx4 v[48:51], v1, s[48:49] offset:-2048
  global_load_dwordx4 v[52:55], v1, s[48:49] offset:-1024
  global_load_dwordx4 v[56:59], v1, s[48:49] offset:0
  global_load_dwordx4 v[60:63], v1, s[48:49] offset:1024
  global_load_dwordx4 v[64:67], v1, s[48:49] offset:2048
  global_load_dwordx4 v[68:71], v1, s[48:49] offset:3072
  s_add_u32 s48, s52, 24576
  s_addc_u32 s49, s53, 0
  global_load_dwordx4 v[72:75], v1, s[48:49] offset:-4096
  global_load_dwordx4 v[76:79], v1, s[48:49] offset:-3072
  global_load_dwordx4 v[80:83], v1, s[48:49] offset:-2048
  global_load_dwordx4 v[84:87], v1, s[48:49] offset:-1024
  s_waitcnt vmcnt(27)
  v_mfma_f32_16x16x32_bf16 v[24:27], a[112:115], v[88:91], 0
  v_mfma_f32_16x16x32_bf16 v[28:31], a[116:119], v[88:91], 0
  v_max3_u32 v14, v88, v89, 0
  v_max3_u32 v14, v90, v91, v14
  global_load_dwordx4 v[88:91], v1, s[48:49] offset:0
  s_waitcnt vmcnt(27)
  v_mfma_f32_16x16x32_bf16 v[24:27], a[120:123], v[92:95], v[24:27]
  v_mfma_f32_16x16x32_bf16 v[28:31], a[124:127], v[92:95], v[28:31]
  v_max3_u32 v14, v92, v93, v14
  v_max3_u32 v14, v94, v95, v14
  global_load_dwordx4 v[92:95], v1, s[48:49] offset:1024
  s_waitcnt vmcnt(27)
  v_mfma_f32_16x16x32_bf16 v[24:27], a[128:131], v[96:99], v[24:27]
  v_mfma_f32_16x16x32_bf16 v[28:31], a[132:135], v[96:99], v[28:31]
  v_max3_u32 v14, v96, v97, v14
  v_max3_u32 v14, v98, v99, v14
  global_load_dwordx4 v[96:99], v1, s[48:49] offset:2048
  s_waitcnt vmcnt(27)
  v_mfma_f32_16x16x32_bf16 v[24:27], a[136:139], v[100:103], v[24:27]
  v_mfma_f32_16x16x32_bf16 v[28:31], a[140:143], v[100:103], v[28:31]
  v_max3_u32 v14, v100, v101, v14
  v_max3_u32 v14, v102, v103, v14
  global_load_dwordx4 v[100:103], v1, s[48:49] offset:3072
  s_waitcnt vmcnt(27)
  v_mfma_f32_16x16x32_bf16 v[24:27], a[144:147], v[104:107], v[24:27]
  v_mfma_f32_16x16x32_bf16 v[28:31], a[148:151], v[104:107], v[28:31]
  v_max3_u32 v14, v104, v105, v14
  v_max3_u32 v14, v106, v107, v14
  s_waitcnt vmcnt(26)
  v_mfma_f32_16x16x32_bf16 v[24:27], a[152:155], v[108:111], v[24:27]
  v_mfma_f32_16x16x32_bf16 v[28:31], a[156:159], v[108:111], v[28:31]
  v_max3_u32 v14, v108, v109, v14
  v_max3_u32 v14, v110, v111, v14
  s_waitcnt vmcnt(25)
  v_mfma_f32_16x16x32_bf16 v[24:27], a[160:163], v[112:115], v[24:27]
  v_mfma_f32_16x16x32_bf16 v[28:31], a[164:167], v[112:115], v[28:31]
  v_max3_u32 v14, v112, v113, v14
  v_max3_u32 v14, v114, v115, v14
  s_waitcnt vmcnt(24)
  v_mfma_f32_16x16x32_bf16 v[24:27], a[168:171], v[116:119], v[24:27]
  v_mfma_f32_16x16x32_bf16 v[28:31], a[172:175], v[116:119], v[28:31]
  v_max3_u32 v14, v116, v117, v14
  v_max3_u32 v14, v118, v119, v14
  s_waitcnt vmcnt(23)
  v_mfma_f32_16x16x32_bf16 v[24:27], a[176:179], v[120:123], v[24:27]
  v_mfma_f32_16x16x32_bf16 v[28:31], a[180:183], v[120:123], v[28:31]
  v_max3_u32 v14, v120, v121, v14
  v_max3_u32 v14, v122, v123, v14
  s_waitcnt vmcnt(22)
  v_mfma_f32_16x16x32_bf16 v[24:27], a[184:187], v[124:127], v[24:27]
  v_mfma_f32_16x16x32_bf16 v[28:31], a[188:191], v[124:127], v[28:31]
  v_max3_u32 v14, v124, v125, v14
  v_max3_u32 v14, v126, v127, v14
  s_waitcnt vmcnt(21)
  v_mfma_f32_16x16x32_bf16 v[24:27], a[192:195], v[128:131], v[24:27]
  v_mfma_f32_16x16x32_bf16 v[28:31], a[196:199], v[128:131], v[28:31]
  v_max3_u32 v14, v128, v129, v14
  v_max3_u32 v14, v130, v131, v14
  s_waitcnt vmcnt(20)
  v_mfma_f32_16x16x32_bf16 v[24:27], a[200:203], v[132:135], v[24:27]
  v_mfma_f32_16x16x32_bf16 v[28:31], a[204:207], v[132:135], v[28:31]
  v_max3_u32 v14, v132, v133, v14
  v_max3_u32 v14, v134, v135, v14
  s_waitcnt vmcnt(19)
  v_mfma_f32_16x16x32_bf16 v[24:27], a[208:211], v[136:139], v[24:27]
  v_mfma_f32_16x16x32_bf16 v[28:31], a[212:215], v[136:139], v[28:31]
  v_max3_u32 v14, v136, v137, v14
  v_max3_u32 v14, v138, v139, v14
  s_waitcnt vmcnt(18)
  v_mfma_f32_16x16x32_bf16 v[24:27], a[216:219], v[140:143], v[24:27]
  v_mfma_f32_16x16x32_bf16 v[28:31], a[220:223], v[140:143], v[28:31]
  v_max3_u32 v14, v140, v141, v14
  v_max3_u32 v14, v142, v143, v14
  s_waitcnt vmcnt(17)
  v_mfma_f32_16x16x32_bf16 v[24:27], a[224:227], v[32:35], v[24:27]
  v_mfma_f32_16x16x32_bf16 v[28:31], a[228:231], v[32:35], v[28:31]
  v_max3_u32 v14, v32, v33, v14
  v_max3_u32 v14, v34, v35, v14
  s_waitcnt vmcnt(16)
  v_mfma_f32_16x16x32_bf16 v[24:27], a[232:235], v[36:39], v[24:27]
  v_mfma_f32_16x16x32_bf16 v[28:31], a[236:239], v[36:39], v[28:31]
  v_max3_u32 v14, v36, v37, v14
  v_max3_u32 v14, v38, v39, v14
  s_waitcnt vmcnt(15)
  v_mfma_f32_16x16x32_bf16 v[24:27], a[240:243], v[40:43], v[24:27]
  v_mfma_f32_16x16x32_bf16 v[28:31], a[244:247], v[40:43], v[28:31]
  v_max3_u32 v14, v40, v41, v14
  v_max3_u32 v14, v42, v43, v14
  s_waitcnt vmcnt(14)
  v_mfma_f32_16x16x32_bf16 v[24:27], a[248:251], v[44:47], v[24:27]
  v_mfma_f32_16x16x32_bf16 v[28:31], a[252:255], v[44:47], v[28:31]
  v_max3_u32 v14, v44, v45, v14
  v_max3_u32 v14, v46, v47, v14
  s_waitcnt vmcnt(13)
  v_mfma_f32_16x16x32_bf16 v[24:27], v[144:147], v[48:51], v[24:27]
  v_mfma_f32_16x16x32_bf16 v[28:31], v[148:151], v[48:51], v[28:31]
  v_max3_u32 v14, v48, v49, v14
  v_max3_u32 v14, v50, v51, v14
  s_waitcnt vmcnt(12)
  v_mfma_f32_16x16x32_bf16 v[24:27], v[152:155], v[52:55], v[24:27]
  v_mfma_f32_16x16x32_bf16 v[28:31], v[156:159], v[52:55], v[28:31]
  v_max3_u32 v14, v52, v53, v14
  v_max3_u32 v14, v54, v55, v14
  s_waitcnt vmcnt(11)
  v_mfma_f32_16x16x32_bf16 v[24:27], v[160:163], v[56:59], v[24:27]
  v_mfma_f32_16x16x32_bf16 v[28:31], v[164:167], v[56:59], v[28:31]
  v_max3_u32 v14, v56, v57, v14
  v_max3_u32 v14, v58, v59, v14
  s_waitcnt vmcnt(10)
  v_mfma_f32_16x16x32_bf16 v[24:27], v[168:171], v[60:63], v[24:27]
  v_mfma_f32_16x16x32_bf16 v[28:31], v[172:175], v[60:63], v[28:31]
  v_max3_u32 v14, v60, v61, v14
  v_max3_u32 v14, v62, v63, v14
  s_waitcnt vmcnt(9)
  v_mfma_f32_16x16x32_bf16 v[24:27], v[176:179], v[64:67], v[24:27]
  v_mfma_f32_16x16x32_bf16 v[28:31], v[180:183], v[64:67], v[28:31]
  v_max3_u32 v14, v64, v65, v14
  v_max3_u32 v14, v66, v67, v14
  s_waitcnt vmcnt(8)
  v_mfma_f32_16x16x32_bf16 v[24:27], v[184:187], v[68:71], v[24:27]
  v_mfma_f32_16x16x32_bf16 v[28:31], v[188:191], v[68:71], v[28:31]
  v_max3_u32 v14, v68, v69, v14
  v_max3_u32 v14, v70, v71, v14
  s_waitcnt vmcnt(7)
  v_mfma_f32_16x16x32_bf16 v[24:27], v[192:195], v[72:75], v[24:27]
  v_mfma_f32_16x16x32_bf16 v[28:31], v[196:199], v[72:75], v[28:31]
  v_max3_u32 v14, v72, v73, v14
  v_max3_u32 v14, v74, v75, v14
  s_waitcnt vmcnt(6)
  v_mfma_f32_16x16x32_bf16 v[24:27], v[200:203], v[76:79], v[24:27]
  v_mfma_f32_16x16x32_bf16 v[28:31], v[204:207], v[76:79], v[28:31]
  v_max3_u32 v14, v76, v77, v14
  v_max3_u32 v14, v78, v79, v14
  s_waitcnt vmcnt(5)
  v_mfma_f32_16x16x32_bf16 v[24:27], v[208:211], v[80:83], v[24:27]
  v_mfma_f32_16x16x32_bf16 v[28:31], v[212:215], v[80:83], v[28:31]
  v_max3_u32 v14, v80, v81, v14
  v_max3_u32 v14, v82, v83, v14
  s_waitcnt vmcnt(4)
  v_mfma_f32_16x16x32_bf16 v[24:27], v[216:219], v[84:87], v[24:27]
  v_mfma_f32_16x16x32_bf16 v[28:31], v[220:223], v[84:87], v[28:31]
  v_max3_u32 v14, v84, v85, v14
  v_max3_u32 v14, v86, v87, v14
  s_waitcnt vmcnt(3)
  v_mfma_f32_16x16x32_bf16 v[24:27], v[224:227], v[88:91], v[24:27]
  v_mfma_f32_16x16x32_bf16 v[28:31], v[228:231], v[88:91], v[28:31]
  v_max3_u32 v14, v88, v89, v14
  v_max3_u32 v14, v90, v91, v14
  s_waitcnt vmcnt(2)
  v_mfma_f32_16x16x32_bf16 v[24:27], v[232:235], v[92:95], v[24:27]
  v_mfma_f32_16x16x32_bf16 v[28:31], v[236:239], v[92:95], v[28:31]
  v_max3_u32 v14, v92, v93, v14
  v_max3_u32 v14, v94, v95, v14
  s_waitcnt vmcnt(1)
  v_mfma_f32_16x16x32_bf16 v[24:27], v[240:243], v[96:99], v[24:27]
  v_mfma_f32_16x16x32_bf16 v[28:31], v[244:247], v[96:99], v[28:31]
  v_max3_u32 v14, v96, v97, v14
  v_max3_u32 v14, v98, v99, v14
  s_waitcnt vmcnt(0)
  v_mfma_f32_16x16x32_bf16 v[24:27], v[248:251], v[100:103], v[24:27]
  v_mfma_f32_16x16x32_bf16 v[28:31], v[252:255], v[100:103], v[28:31]
  v_max3_u32 v14, v100, v101, v14
  v_max3_u32 v14, v102, v103, v14
  v_cmp_eq_u32 vcc, -1, v14
  s_cbranch_vccnz L_O_r
L_O_d:
  ds_write_b128 v6, v[16:19] offset:0
  ds_write_b128 v6, v[20:23] offset:1152
  ds_write_b128 v6, v[24:27] offset:2304
  s_nop 0
  ds_write_b128 v6, v[28:31] offset:3456
  s_waitcnt lgkmcnt(0)
  s_barrier
  ds_read_b64 v[32:33], v7 offset:0
  ds_read_b64 v[34:35], v7 offset:4608
  ds_read_b64 v[36:37], v7 offset:9216
  ds_read_b64 v[38:39], v7 offset:13824
  ds_read_b64 v[40:41], v7 offset:2304
  ds_read_b64 v[42:43], v7 offset:6912
  ds_read_b64 v[44:45], v7 offset:11520
  ds_read_b64 v[46:47], v7 offset:16128
  v_xor_b32 v6, 0x8000, v6
  v_xor_b32 v7, 0x8000, v7
  s_mov_b32 s9, 0xffff0000
  s_cmp_ge_u32 s46, s71
  v_lshlrev_b32 v11, 16, v10
  v_and_b32 v12, s9, v10
  s_waitcnt lgkmcnt(0)
  v_add_f32 v32, v32, v34
  v_add_f32 v36, v36, v38
  v_add_f32 v33, v33, v35
  v_add_f32 v37, v37, v39
  v_add_f32 v32, v32, v36
  v_add_f32 v33, v33, v37
  v_cvt_pk_bf16_f32 v34, v32, v33
  v_lshlrev_b32 v32, 16, v34
  v_and_b32 v33, s9, v34
  v_add_f32 v40, v40, v42
  v_add_f32 v44, v44, v46
  v_add_f32 v41, v41, v43
  v_add_f32 v45, v45, v47
  v_add_f32 v40, v40, v44
  v_add_f32 v41, v41, v45
  v_cvt_pk_bf16_f32 v42, v40, v41
  v_lshlrev_b32 v40, 16, v42
  v_and_b32 v41, s9, v42
  v_add_f32 v11, v11, v40
  v_add_f32 v12, v12, v41
  v_cvt_pk_bf16_f32 v12, v11, v12
  v_lshlrev_b32 v11, 16, v12
  v_and_b32 v12, s9, v12
  v_add_f32 v11, v11, v32
  v_add_f32 v12, v12, v33
  v_cvt_pk_bf16_f32 v11, v11, v12
  s_cbranch_scc1 L_O_e
  global_store_dword v9, v11, s[58:59] sc1
L_O_e:
  s_mov_b32 s46, s74
  s_mov_b32 s47, 6
  s_mov_b32 s72, 124
  s_mov_b32 s71, s73
  s_cmp_lt_u32 s75, 128
  s_cbranch_scc1 L_O_loop
  s_endpgm
L_role_KV:
  s_mov_b32 s10, s6
  s_lshl_b32 s8, s6, 8
  s_add_u32 s44, s22, s8
  s_addc_u32 s45, s23, 0
  s_add_u32 s46, s24, s8
  s_addc_u32 s47, s25, 0
  s_mov_b32 s48, 0
  s_mov_b32 s49, 1
  v_mov_b32 v2, 0
  s_lshl_b32 s63, s4, 12
  v_lshrrev_b32 v40, 4, v0
  s_and_b32 s8, s4, 1
  s_lshl_b32 s8, s8, 2
  v_or_b32 v41, s8, v40
  v_lshlrev_b32 v41, 1, v41
  v_and_b32 v30, 15, v0
  v_xor_b32 v30, v30, v41
  v_lshlrev_b32 v30, 4, v30
  s_lshl_b32 s8, s4, 4
  v_add_u32 v40, s8, v40
  v_mul_u32_u24 v40, 8192, v40
  v_add_u32 v30, v30, v40
  v_mov_b32 v24, v30
  v_add_u32 v25, 31744, v24
  v_add_u32 v26, 63488, v24
  v_add_u32 v27, 95232, v24
  s_lshr_b32 s8, s22, 8
  s_sub_u32 s8, 1, s8
  s_and_b32 s8, s8, 3
  s_and_b32 s9, s6, 28
  s_or_b32 s8, s8, s9
  s_sub_u32 s9, s6, s8
  s_and_b32 s9, s9, 3
  s_cselect_b32 s12, 15, 0
  s_cmp_eq_u32 s6, 31
  s_cselect_b32 s12, 0, s12
  s_add_u32 s9, s9, 4
  s_lshl_b32 s9, s9, 2
  s_add_u32 s9, s9, s4
  s_lshl_b32 s9, s9, 17
  s_lshl_b32 s8, s8, 8
  s_add_u32 s8, s8, s9
  v_lshrrev_b32 v40, 1, v0
  v_min_u32 v40, s12, v40
  v_lshlrev_b32 v40, 13, v40
  v_and_b32 v47, 1, v0
  v_lshl_add_u32 v47, v47, 7, v40
  v_add_u32 v47, s8, v47
  s_add_u32 m0, s63, 0
  s_add_u32 s60, s44, 0
  s_addc_u32 s61, s45, 0
  global_load_lds_dwordx4 v24, s[60:61] offset:0
  global_load_lds_dwordx4 v25, s[60:61] offset:1024
  global_load_lds_dwordx4 v26, s[60:61] offset:2048
  global_load_lds_dwordx4 v27, s[60:61] offset:3072
  s_add_u32 m0, s63, 16384
  s_add_u32 s60, s44, 524288
  s_addc_u32 s61, s45, 0
  global_load_lds_dwordx4 v24, s[60:61] offset:0
  global_load_lds_dwordx4 v25, s[60:61] offset:1024
  global_load_lds_dwordx4 v26, s[60:61] offset:2048
  global_load_lds_dwordx4 v27, s[60:61] offset:3072
  global_load_dword v48, v47, s[22:23]
  s_add_u32 m0, s63, 32768
  s_add_u32 s60, s44, 1048576
  s_addc_u32 s61, s45, 0
  global_load_lds_dwordx4 v24, s[60:61] offset:0
  global_load_lds_dwordx4 v25, s[60:61] offset:1024
  global_load_lds_dwordx4 v26, s[60:61] offset:2048
  global_load_lds_dwordx4 v27, s[60:61] offset:3072
  s_add_u32 m0, s63, 49152
  s_add_u32 s60, s44, 1572864
  s_addc_u32 s61, s45, 0
  global_load_lds_dwordx4 v24, s[60:61] offset:0
  global_load_lds_dwordx4 v25, s[60:61] offset:1024
  global_load_lds_dwordx4 v26, s[60:61] offset:2048
  global_load_lds_dwordx4 v27, s[60:61] offset:3072
  s_add_u32 m0, s63, 65536
  s_add_u32 s60, s44, 2097152
  s_addc_u32 s61, s45, 0
  global_load_lds_dwordx4 v24, s[60:61] offset:0
  global_load_lds_dwordx4 v25, s[60:61] offset:1024
  global_load_lds_dwordx4 v26, s[60:61] offset:2048
  global_load_lds_dwordx4 v27, s[60:61] offset:3072
  s_add_u32 m0, s63, 81920
  s_add_u32 s60, s44, 2621440
  s_addc_u32 s61, s45, 0
  global_load_lds_dwordx4 v24, s[60:61] offset:0
  global_load_lds_dwordx4 v25, s[60:61] offset:1024
  global_load_lds_dwordx4 v26, s[60:61] offset:2048
  global_load_lds_dwordx4 v27, s[60:61] offset:3072
  s_add_u32 m0, s63, 98304
  s_add_u32 s60, s44, 3145728
  s_addc_u32 s61, s45, 0
  global_load_lds_dwordx4 v24, s[60:61] offset:0
  global_load_lds_dwordx4 v25, s[60:61] offset:1024
  global_load_lds_dwordx4 v26, s[60:61] offset:2048
  global_load_lds_dwordx4 v27, s[60:61] offset:3072
  s_add_u32 m0, s63, 114688
  s_add_u32 s60, s44, 3670016
  s_addc_u32 s61, s45, 0
  global_load_lds_dwordx4 v24, s[60:61] offset:0
  global_load_lds_dwordx4 v25, s[60:61] offset:1024
  global_load_lds_dwordx4 v26, s[60:61] offset:2048
  global_load_lds_dwordx4 v27, s[60:61] offset:3072
  v_lshlrev_b32 v1, 4, v0
  v_mov_b32 v40, 0
  v_bfe_u32 v41, v0, 4, 1
  v_mad_u32_u24 v40, v41, 16, v40
  v_bfe_u32 v41, v0, 5, 1
  v_mad_u32_u24 v40, v41, 32, v40
  v_bfe_u32 v41, v0, 2, 1
  v_mad_u32_u24 v40, v41, 1, v40
  v_bfe_u32 v41, v0, 3, 1
  v_mad_u32_u24 v40, v41, 2, v40
  v_mov_b32 v42, 0
  v_bfe_u32 v41, v40, 0, 1
  v_lshl_or_b32 v42, v41, 0, v42
  v_bfe_u32 v41, v40, 1, 1
  v_lshl_or_b32 v42, v41, 1, v42
  v_bfe_u32 v41, v40, 4, 1
  v_lshl_or_b32 v42, v41, 2, v42
  s_lshl_b32 s8, s4, 1
  v_xor_b32 v42, s8, v42
  v_lshlrev_b32 v42, 5, v42
  v_lshl_add_u32 v32, v40, 8, v42
  v_and_b32 v41, 3, v0
  v_lshl_add_u32 v32, v41, 3, v32
  v_xor_b32 v33, 32, v32
  v_add_u32 v34, 0x10000, v32
  v_add_u32 v35, 0x10000, v33
  s_waitcnt vmcnt(29)
  s_barrier
  ds_read_b64_tr_b16 a[0:1], v32 offset:0
  ds_read_b64_tr_b16 a[2:3], v32 offset:1024
  ds_read_b64_tr_b16 a[4:5], v33 offset:0
  ds_read_b64_tr_b16 a[6:7], v33 offset:1024
  ds_read_b64_tr_b16 a[8:9], v32 offset:2048
  ds_read_b64_tr_b16 a[10:11], v32 offset:3072
  ds_read_b64_tr_b16 a[12:13], v33 offset:2048
  ds_read_b64_tr_b16 a[14:15], v33 offset:3072
  s_waitcnt lgkmcnt(0)
  s_barrier
  s_add_u32 m0, s63, 0
  s_add_u32 s60, s46, 0
  s_addc_u32 s61, s47, 0
  global_load_lds_dwordx4 v24, s[60:61] offset:0
  global_load_lds_dwordx4 v25, s[60:61] offset:1024
  global_load_lds_dwordx4 v26, s[60:61] offset:2048
  global_load_lds_dwordx4 v27, s[60:61] offset:3072
  s_waitcnt vmcnt(29)
  s_barrier
  ds_read_b64_tr_b16 a[16:17], v32 offset:16384
  ds_read_b64_tr_b16 a[18:19], v32 offset:17408
  ds_read_b64_tr_b16 a[20:21], v33 offset:16384
  ds_read_b64_tr_b16 a[22:23], v33 offset:17408
  ds_read_b64_tr_b16 a[24:25], v32 offset:18432
  ds_read_b64_tr_b16 a[26:27], v32 offset:19456
  ds_read_b64_tr_b16 a[28:29], v33 offset:18432
  ds_read_b64_tr_b16 a[30:31], v33 offset:19456
  s_waitcnt lgkmcnt(0)
  s_barrier
  s_add_u32 m0, s63, 16384
  s_add_u32 s60, s46, 524288
  s_addc_u32 s61, s47, 0
  global_load_lds_dwordx4 v24, s[60:61] offset:0
  global_load_lds_dwordx4 v25, s[60:61] offset:1024
  global_load_lds_dwordx4 v26, s[60:61] offset:2048
  global_load_lds_dwordx4 v27, s[60:61] offset:3072
  global_load_dword v48, v47, s[24:25]
  s_waitcnt vmcnt(29)
  s_barrier
  ds_read_b64_tr_b16 a[32:33], v32 offset:32768
  ds_read_b64_tr_b16 a[34:35], v32 offset:33792
  ds_read_b64_tr_b16 a[36:37], v33 offset:32768
  ds_read_b64_tr_b16 a[38:39], v33 offset:33792
  ds_read_b64_tr_b16 a[40:41], v32 offset:34816
  ds_read_b64_tr_b16 a[42:43], v32 offset:35840
  ds_read_b64_tr_b16 a[44:45], v33 offset:34816
  ds_read_b64_tr_b16 a[46:47], v33 offset:35840
  s_waitcnt lgkmcnt(0)
  s_barrier
  s_add_u32 m0, s63, 32768
  s_add_u32 s60, s46, 1048576
  s_addc_u32 s61, s47, 0
  global_load_lds_dwordx4 v24, s[60:61] offset:0
  global_load_lds_dwordx4 v25, s[60:61] offset:1024
  global_load_lds_dwordx4 v26, s[60:61] offset:2048
  global_load_lds_dwordx4 v27, s[60:61] offset:3072
  s_waitcnt vmcnt(29)
  s_barrier
  ds_read_b64_tr_b16 a[48:49], v32 offset:49152
  ds_read_b64_tr_b16 a[50:51], v32 offset:50176
  ds_read_b64_tr_b16 a[52:53], v33 offset:49152
  ds_read_b64_tr_b16 a[54:55], v33 offset:50176
  ds_read_b64_tr_b16 a[56:57], v32 offset:51200
  ds_read_b64_tr_b16 a[58:59], v32 offset:52224
  ds_read_b64_tr_b16 a[60:61], v33 offset:51200
  ds_read_b64_tr_b16 a[62:63], v33 offset:52224
  s_waitcnt lgkmcnt(0)
  s_barrier
  s_add_u32 m0, s63, 49152
  s_add_u32 s60, s46, 1572864
  s_addc_u32 s61, s47, 0
  global_load_lds_dwordx4 v24, s[60:61] offset:0
  global_load_lds_dwordx4 v25, s[60:61] offset:1024
  global_load_lds_dwordx4 v26, s[60:61] offset:2048
  global_load_lds_dwordx4 v27, s[60:61] offset:3072
  s_waitcnt vmcnt(29)
  s_barrier
  ds_read_b64_tr_b16 a[64:65], v34 offset:0
  ds_read_b64_tr_b16 a[66:67], v34 offset:1024
  ds_read_b64_tr_b16 a[68:69], v35 offset:0
  ds_read_b64_tr_b16 a[70:71], v35 offset:1024
  ds_read_b64_tr_b16 a[72:73], v34 offset:2048
  ds_read_b64_tr_b16 a[74:75], v34 offset:3072
  ds_read_b64_tr_b16 a[76:77], v35 offset:2048
  ds_read_b64_tr_b16 a[78:79], v35 offset:3072
  s_waitcnt lgkmcnt(0)
  s_barrier
  s_add_u32 m0, s63, 65536
  s_add_u32 s60, s46, 2097152
  s_addc_u32 s61, s47, 0
  global_load_lds_dwordx4 v24, s[60:61] offset:0
  global_load_lds_dwordx4 v25, s[60:61] offset:1024
  global_load_lds_dwordx4 v26, s[60:61] offset:2048
  global_load_lds_dwordx4 v27, s[60:61] offset:3072
  s_waitcnt vmcnt(29)
  s_barrier
  ds_read_b64_tr_b16 a[80:81], v34 offset:16384
  ds_read_b64_tr_b16 a[82:83], v34 offset:17408
  ds_read_b64_tr_b16 a[84:85], v35 offset:16384
  ds_read_b64_tr_b16 a[86:87], v35 offset:17408
  ds_read_b64_tr_b16 a[88:89], v34 offset:18432
  ds_read_b64_tr_b16 a[90:91], v34 offset:19456
  ds_read_b64_tr_b16 a[92:93], v35 offset:18432
  ds_read_b64_tr_b16 a[94:95], v35 offset:19456
  s_waitcnt lgkmcnt(0)
  s_barrier
  s_add_u32 m0, s63, 81920
  s_add_u32 s60, s46, 2621440
  s_addc_u32 s61, s47, 0
  global_load_lds_dwordx4 v24, s[60:61] offset:0
  global_load_lds_dwordx4 v25, s[60:61] offset:1024
  global_load_lds_dwordx4 v26, s[60:61] offset:2048
  global_load_lds_dwordx4 v27, s[60:61] offset:3072
  s_waitcnt vmcnt(29)
  s_barrier
  ds_read_b64_tr_b16 a[96:97], v34 offset:32768
  ds_read_b64_tr_b16 a[98:99], v34 offset:33792
  ds_read_b64_tr_b16 a[100:101], v35 offset:32768
  ds_read_b64_tr_b16 a[102:103], v35 offset:33792
  ds_read_b64_tr_b16 a[104:105], v34 offset:34816
  ds_read_b64_tr_b16 a[106:107], v34 offset:35840
  ds_read_b64_tr_b16 a[108:109], v35 offset:34816
  ds_read_b64_tr_b16 a[110:111], v35 offset:35840
  s_waitcnt lgkmcnt(0)
  s_barrier
  s_add_u32 m0, s63, 98304
  s_add_u32 s60, s46, 3145728
  s_addc_u32 s61, s47, 0
  global_load_lds_dwordx4 v24, s[60:61] offset:0
  global_load_lds_dwordx4 v25, s[60:61] offset:1024
  global_load_lds_dwordx4 v26, s[60:61] offset:2048
  global_load_lds_dwordx4 v27, s[60:61] offset:3072
  s_waitcnt vmcnt(29)
  s_barrier
  ds_read_b64_tr_b16 a[112:113], v34 offset:49152
  ds_read_b64_tr_b16 a[114:115], v34 offset:50176
  ds_read_b64_tr_b16 a[116:117], v35 offset:49152
  ds_read_b64_tr_b16 a[118:119], v35 offset:50176
  ds_read_b64_tr_b16 a[120:121], v34 offset:51200
  ds_read_b64_tr_b16 a[122:123], v34 offset:52224
  ds_read_b64_tr_b16 a[124:125], v35 offset:51200
  ds_read_b64_tr_b16 a[126:127], v35 offset:52224
  s_waitcnt lgkmcnt(0)
  s_barrier
  s_add_u32 m0, s63, 114688
  s_add_u32 s60, s46, 3670016
  s_addc_u32 s61, s47, 0
  global_load_lds_dwordx4 v24, s[60:61] offset:0
  global_load_lds_dwordx4 v25, s[60:61] offset:1024
  global_load_lds_dwordx4 v26, s[60:61] offset:2048
  global_load_lds_dwordx4 v27, s[60:61] offset:3072
  s_waitcnt vmcnt(29)
  s_barrier
  ds_read_b64_tr_b16 a[128:129], v32 offset:0
  ds_read_b64_tr_b16 a[130:131], v32 offset:1024
  ds_read_b64_tr_b16 a[132:133], v33 offset:0
  ds_read_b64_tr_b16 a[134:135], v33 offset:1024
  ds_read_b64_tr_b16 a[136:137], v32 offset:2048
  ds_read_b64_tr_b16 a[138:139], v32 offset:3072
  ds_read_b64_tr_b16 a[140:141], v33 offset:2048
  ds_read_b64_tr_b16 a[142:143], v33 offset:3072
  s_waitcnt lgkmcnt(0)
  s_barrier
  s_waitcnt vmcnt(25)
  s_barrier
  ds_read_b64_tr_b16 a[144:145], v32 offset:16384
  ds_read_b64_tr_b16 a[146:147], v32 offset:17408
  ds_read_b64_tr_b16 a[148:149], v33 offset:16384
  ds_read_b64_tr_b16 a[150:151], v33 offset:17408
  ds_read_b64_tr_b16 a[152:153], v32 offset:18432
  ds_read_b64_tr_b16 a[154:155], v32 offset:19456
  ds_read_b64_tr_b16 a[156:157], v33 offset:18432
  ds_read_b64_tr_b16 a[158:159], v33 offset:19456
  s_waitcnt lgkmcnt(0)
  s_barrier
  s_waitcnt vmcnt(20)
  s_barrier
  ds_read_b64_tr_b16 a[160:161], v32 offset:32768
  ds_read_b64_tr_b16 a[162:163], v32 offset:33792
  ds_read_b64_tr_b16 a[164:165], v33 offset:32768
  ds_read_b64_tr_b16 a[166:167], v33 offset:33792
  ds_read_b64_tr_b16 a[168:169], v32 offset:34816
  ds_read_b64_tr_b16 a[170:171], v32 offset:35840
  ds_read_b64_tr_b16 a[172:173], v33 offset:34816
  ds_read_b64_tr_b16 a[174:175], v33 offset:35840
  s_waitcnt lgkmcnt(0)
  s_barrier
  s_waitcnt vmcnt(16)
  s_barrier
  ds_read_b64_tr_b16 a[176:177], v32 offset:49152
  ds_read_b64_tr_b16 a[178:179], v32 offset:50176
  ds_read_b64_tr_b16 a[180:181], v33 offset:49152
  ds_read_b64_tr_b16 a[182:183], v33 offset:50176
  ds_read_b64_tr_b16 a[184:185], v32 offset:51200
  ds_read_b64_tr_b16 a[186:187], v32 offset:52224
  ds_read_b64_tr_b16 a[188:189], v33 offset:51200
  ds_read_b64_tr_b16 a[190:191], v33 offset:52224
  s_waitcnt lgkmcnt(0)
  s_barrier
  s_waitcnt vmcnt(12)
  s_barrier
  ds_read_b64_tr_b16 a[192:193], v34 offset:0
  ds_read_b64_tr_b16 a[194:195], v34 offset:1024
  ds_read_b64_tr_b16 a[196:197], v35 offset:0
  ds_read_b64_tr_b16 a[198:199], v35 offset:1024
  ds_read_b64_tr_b16 a[200:201], v34 offset:2048
  ds_read_b64_tr_b16 a[202:203], v34 offset:3072
  ds_read_b64_tr_b16 a[204:205], v35 offset:2048
  ds_read_b64_tr_b16 a[206:207], v35 offset:3072
  s_waitcnt lgkmcnt(0)
  s_barrier
  s_waitcnt vmcnt(8)
  s_barrier
  ds_read_b64_tr_b16 a[208:209], v34 offset:16384
  ds_read_b64_tr_b16 a[210:211], v34 offset:17408
  ds_read_b64_tr_b16 a[212:213], v35 offset:16384
  ds_read_b64_tr_b16 a[214:215], v35 offset:17408
  ds_read_b64_tr_b16 a[216:217], v34 offset:18432
  ds_read_b64_tr_b16 a[218:219], v34 offset:19456
  ds_read_b64_tr_b16 a[220:221], v35 offset:18432
  ds_read_b64_tr_b16 a[222:223], v35 offset:19456
  s_waitcnt lgkmcnt(0)
  s_barrier
  s_waitcnt vmcnt(4)
  s_barrier
  ds_read_b64_tr_b16 a[224:225], v34 offset:32768
  ds_read_b64_tr_b16 a[226:227], v34 offset:33792
  ds_read_b64_tr_b16 a[228:229], v35 offset:32768
  ds_read_b64_tr_b16 a[230:231], v35 offset:33792
  ds_read_b64_tr_b16 a[232:233], v34 offset:34816
  ds_read_b64_tr_b16 a[234:235], v34 offset:35840
  ds_read_b64_tr_b16 a[236:237], v35 offset:34816
  ds_read_b64_tr_b16 a[238:239], v35 offset:35840
  s_waitcnt lgkmcnt(0)
  s_barrier
  s_waitcnt vmcnt(0)
  s_barrier
  ds_read_b64_tr_b16 a[240:241], v34 offset:49152
  ds_read_b64_tr_b16 a[242:243], v34 offset:50176
  ds_read_b64_tr_b16 a[244:245], v35 offset:49152
  ds_read_b64_tr_b16 a[246:247], v35 offset:50176
  ds_read_b64_tr_b16 a[248:249], v34 offset:51200
  ds_read_b64_tr_b16 a[250:251], v34 offset:52224
  ds_read_b64_tr_b16 a[252:253], v35 offset:51200
  ds_read_b64_tr_b16 a[254:255], v35 offset:52224
  s_waitcnt lgkmcnt(0)
  s_barrier
  v_mov_b32 v3, 1
  s_cmp_lg_u32 s4, 0
  s_cbranch_scc1 Lw1_14
Lww_15:
  global_load_dword v4, v2, s[40:41] offset:164 sc1
  s_waitcnt vmcnt(0)
  v_cmp_gt_u32 vcc, 64, v4
  s_cbranch_vccz Lwd_16
  s_sleep 1
  s_sub_u32 s7, s7, 1
  s_cbranch_scc0 Lww_15
  s_mov_b32 s7, 0
Lwd_16:
Lw1_14:
  s_barrier
  v_mov_b32 v8, -1
  v_mov_b32 v9, -1
  v_mov_b32 v10, -1
  v_mov_b32 v11, -1
  s_mov_b32 s58, 0
  s_lshl_b32 s8, s5, 8
  s_lshl_b32 s9, s4, 2
  s_add_u32 s8, s8, s9
  s_add_u32 s8, s8, 172032
  s_add_u32 s56, s42, s8
  s_addc_u32 s57, s43, 0
  s_min_u32 s60, s48, 63
  s_lshl_b32 s60, s60, 15
  s_lshl_b32 s61, s4, 13
  s_add_u32 s60, s60, s61
  s_add_u32 s60, s60, 1048576
  s_add_u32 s50, s42, s60
  s_addc_u32 s51, s43, 0
  s_add_u32 m0, s61, s58
  s_nop 0
  global_load_lds_dwordx4 v1, s[50:51] offset:0
  global_load_lds_dwordx4 v1, s[50:51] offset:1024
  global_load_lds_dwordx4 v1, s[50:51] offset:2048
  global_load_lds_dwordx4 v1, s[50:51] offset:3072
  s_add_u32 s50, s50, 4096
  s_addc_u32 s51, s51, 0
  s_add_u32 m0, m0, 4096
  s_nop 0
  global_load_lds_dwordx4 v1, s[50:51] offset:0
  global_load_lds_dwordx4 v1, s[50:51] offset:1024
  global_load_lds_dwordx4 v1, s[50:51] offset:2048
  global_load_lds_dwordx4 v1, s[50:51] offset:3072
  s_mov_b32 s58, 0x8000
  s_min_u32 s60, s49, 63
  s_lshl_b32 s60, s60, 15
  s_lshl_b32 s61, s4, 13
  s_add_u32 s60, s60, s61
  s_add_u32 s60, s60, 1048576
  s_add_u32 s50, s42, s60
  s_addc_u32 s51, s43, 0
  s_add_u32 m0, s61, s58
  s_nop 0
  global_load_lds_dwordx4 v1, s[50:51] offset:0
  global_load_lds_dwordx4 v1, s[50:51] offset:1024
  global_load_lds_dwordx4 v1, s[50:51] offset:2048
  global_load_lds_dwordx4 v1, s[50:51] offset:3072
  s_add_u32 s50, s50, 4096
  s_addc_u32 s51, s51, 0
  s_add_u32 m0, m0, 4096
  s_nop 0
  global_load_lds_dwordx4 v1, s[50:51] offset:0
  global_load_lds_dwordx4 v1, s[50:51] offset:1024
  global_load_lds_dwordx4 v1, s[50:51] offset:2048
  global_load_lds_dwordx4 v1, s[50:51] offset:3072
  global_store_dword v2, v3, s[56:57] sc1
  global_store_dword v2, v3, s[56:57] sc1
  global_store_dword v2, v3, s[56:57] sc1
  global_store_dword v2, v3, s[56:57] sc1
  s_lshl_b32 s60, s10, 13
  s_lshl_b32 s61, s4, 11
  s_add_u32 s61, s61, s60
  s_add_u32 s61, s61, 16777216
  s_add_u32 s52, s42, s61
  s_addc_u32 s53, s43, 0
  s_add_u32 s54, s52, 16777216
  s_addc_u32 s55, s53, 0
  s_lshl_b32 s61, s4, 10
  s_add_u32 s61, s61, s60
  s_add_u32 s61, s61, 67633152
  s_add_u32 s66, s42, s61
  s_addc_u32 s67, s43, 0
  s_lshr_b32 s60, s60, 7
  s_lshl_b32 s61, s4, 2
  s_add_u32 s61, s61, s60
  s_add_u32 s61, s61, 4096
  s_add_u32 s68, s42, s61
  s_addc_u32 s69, s43, 0
  v_mov_b32 v6, v1
  v_mov_b32 v160, 0
  v_mov_b32 v161, 0
  v_mov_b32 v162, 0
  v_mov_b32 v163, 0
  v_mov_b32 v164, 0
  v_mov_b32 v165, 0
  v_mov_b32 v166, 0
  v_mov_b32 v167, 0
  v_mov_b32 v168, 0
  v_mov_b32 v169, 0
  v_mov_b32 v170, 0
  v_mov_b32 v171, 0
  v_mov_b32 v172, 0
  v_mov_b32 v173, 0
  v_mov_b32 v174, 0
  v_mov_b32 v175, 0
  s_mov_b32 s59, 2
  s_waitcnt vmcnt(12)
  s_barrier
  ds_read_b128 v[16:19], v6 offset:0
  ds_read_b128 v[20:23], v6 offset:1024
  ds_read_b128 v[24:27], v6 offset:2048
  ds_read_b128 v[28:31], v6 offset:3072
  ds_read_b128 v[32:35], v6 offset:4096
  ds_read_b128 v[36:39], v6 offset:5120
  ds_read_b128 v[40:43], v6 offset:6144
  ds_read_b128 v[44:47], v6 offset:7168
  ds_read_b128 v[48:51], v6 offset:8192
  ds_read_b128 v[52:55], v6 offset:9216
  ds_read_b128 v[56:59], v6 offset:10240
  ds_read_b128 v[60:63], v6 offset:11264
  ds_read_b128 v[64:67], v6 offset:12288
  ds_read_b128 v[68:71], v6 offset:13312
  ds_read_b128 v[72:75], v6 offset:14336
  ds_read_b128 v[76:79], v6 offset:15360
  ds_read_b128 v[80:83], v6 offset:16384
  ds_read_b128 v[84:87], v6 offset:17408
  ds_read_b128 v[88:91], v6 offset:18432
  ds_read_b128 v[92:95], v6 offset:19456
  ds_read_b128 v[96:99], v6 offset:20480
  ds_read_b128 v[100:103], v6 offset:21504
  ds_read_b128 v[104:107], v6 offset:22528
  ds_read_b128 v[108:111], v6 offset:23552
  ds_read_b128 v[112:115], v6 offset:24576
  ds_read_b128 v[116:119], v6 offset:25600
  ds_read_b128 v[120:123], v6 offset:26624
  ds_read_b128 v[124:127], v6 offset:27648
  ds_read_b128 v[128:131], v6 offset:28672
  ds_read_b128 v[132:135], v6 offset:29696
  ds_read_b128 v[136:139], v6 offset:30720
  ds_read_b128 v[140:143], v6 offset:31744
  s_waitcnt lgkmcnt(15)
L_KV_loop:
  v_mfma_f32_16x16x32_bf16 v[144:147], a[0:3], v[16:19], 0
  v_mfma_f32_16x16x32_bf16 v[148:151], a[0:3], v[20:23], 0
  v_mfma_f32_16x16x32_bf16 v[152:155], a[4:7], v[16:19], 0
  v_cvt_pk_bf16_f32 v184, v160, v161
  v_mfma_f32_16x16x32_bf16 v[156:159], a[4:7], v[20:23], 0
  v_cvt_pk_bf16_f32 v185, v162, v163
  v_mfma_f32_16x16x32_bf16 v[144:147], a[8:11], v[24:27], v[144:147]
  v_cvt_pk_bf16_f32 v186, v164, v165
  v_mfma_f32_16x16x32_bf16 v[148:151], a[8:11], v[28:31], v[148:151]
  v_cvt_pk_bf16_f32 v187, v166, v167
  v_mfma_f32_16x16x32_bf16 v[152:155], a[12:15], v[24:27], v[152:155]
  global_store_dwordx4 v1, v[184:187], s[54:55] offset:0 sc1
  v_mfma_f32_16x16x32_bf16 v[156:159], a[12:15], v[28:31], v[156:159]
  v_cvt_pk_bf16_f32 v188, v168, v169
  v_mfma_f32_16x16x32_bf16 v[144:147], a[16:19], v[32:35], v[144:147]
  v_cvt_pk_bf16_f32 v189, v170, v171
  v_mfma_f32_16x16x32_bf16 v[148:151], a[16:19], v[36:39], v[148:151]
  v_cvt_pk_bf16_f32 v190, v172, v173
  v_mfma_f32_16x16x32_bf16 v[152:155], a[20:23], v[32:35], v[152:155]
  v_cvt_pk_bf16_f32 v191, v174, v175
  v_mfma_f32_16x16x32_bf16 v[156:159], a[20:23], v[36:39], v[156:159]
  global_store_dwordx4 v1, v[188:191], s[54:55] offset:1024 sc1
  v_mfma_f32_16x16x32_bf16 v[144:147], a[24:27], v[40:43], v[144:147]
  s_add_u32 s54, s52, 16777216
  s_addc_u32 s55, s53, 0
  v_mfma_f32_16x16x32_bf16 v[148:151], a[24:27], v[44:47], v[148:151]
  v_mfma_f32_16x16x32_bf16 v[152:155], a[28:31], v[40:43], v[152:155]
  v_mfma_f32_16x16x32_bf16 v[156:159], a[28:31], v[44:47], v[156:159]
  v_mfma_f32_16x16x32_bf16 v[144:147], a[32:35], v[48:51], v[144:147]
  v_mfma_f32_16x16x32_bf16 v[148:151], a[32:35], v[52:55], v[148:151]
  v_mfma_f32_16x16x32_bf16 v[152:155], a[36:39], v[48:51], v[152:155]
  v_mfma_f32_16x16x32_bf16 v[156:159], a[36:39], v[52:55], v[156:159]
  v_mfma_f32_16x16x32_bf16 v[144:147], a[40:43], v[56:59], v[144:147]
  v_mfma_f32_16x16x32_bf16 v[148:151], a[40:43], v[60:63], v[148:151]
  v_mfma_f32_16x16x32_bf16 v[152:155], a[44:47], v[56:59], v[152:155]
  v_mfma_f32_16x16x32_bf16 v[156:159], a[44:47], v[60:63], v[156:159]
  v_mfma_f32_16x16x32_bf16 v[144:147], a[48:51], v[64:67], v[144:147]
  v_mfma_f32_16x16x32_bf16 v[148:151], a[48:51], v[68:71], v[148:151]
  v_mfma_f32_16x16x32_bf16 v[152:155], a[52:55], v[64:67], v[152:155]
  v_mfma_f32_16x16x32_bf16 v[156:159], a[52:55], v[68:71], v[156:159]
  v_mfma_f32_16x16x32_bf16 v[144:147], a[56:59], v[72:75], v[144:147]
  v_mfma_f32_16x16x32_bf16 v[148:151], a[56:59], v[76:79], v[148:151]
  v_mfma_f32_16x16x32_bf16 v[152:155], a[60:63], v[72:75], v[152:155]
  v_mfma_f32_16x16x32_bf16 v[156:159], a[60:63], v[76:79], v[156:159]
  s_waitcnt lgkmcnt(0)
  v_mfma_f32_16x16x32_bf16 v[144:147], a[64:67], v[80:83], v[144:147]
  v_mfma_f32_16x16x32_bf16 v[148:151], a[64:67], v[84:87], v[148:151]
  v_mfma_f32_16x16x32_bf16 v[152:155], a[68:71], v[80:83], v[152:155]
  v_mfma_f32_16x16x32_bf16 v[156:159], a[68:71], v[84:87], v[156:159]
  v_mfma_f32_16x16x32_bf16 v[144:147], a[72:75], v[88:91], v[144:147]
  v_mfma_f32_16x16x32_bf16 v[148:151], a[72:75], v[92:95], v[148:151]
  v_mfma_f32_16x16x32_bf16 v[152:155], a[76:79], v[88:91], v[152:155]
  v_mfma_f32_16x16x32_bf16 v[156:159], a[76:79], v[92:95], v[156:159]
  v_mfma_f32_16x16x32_bf16 v[144:147], a[80:83], v[96:99], v[144:147]
  s_min_u32 s60, s59, 63
  v_mfma_f32_16x16x32_bf16 v[148:151], a[80:83], v[100:103], v[148:151]
  s_lshl_b32 s60, s60, 15
  v_mfma_f32_16x16x32_bf16 v[152:155], a[84:87], v[96:99], v[152:155]
  s_lshl_b32 s61, s4, 13
  v_mfma_f32_16x16x32_bf16 v[156:159], a[84:87], v[100:103], v[156:159]
  s_add_u32 s60, s60, s61
  v_mfma_f32_16x16x32_bf16 v[144:147], a[88:91], v[104:107], v[144:147]
  s_add_u32 s60, s60, 1048576
  v_mfma_f32_16x16x32_bf16 v[148:151], a[88:91], v[108:111], v[148:151]
  s_add_u32 s50, s42, s60
  s_addc_u32 s51, s43, 0
  v_mfma_f32_16x16x32_bf16 v[152:155], a[92:95], v[104:107], v[152:155]
  s_xor_b32 s58, s58, 0x8000
  v_mfma_f32_16x16x32_bf16 v[156:159], a[92:95], v[108:111], v[156:159]
  s_add_u32 m0, s61, s58
  v_mfma_f32_16x16x32_bf16 v[144:147], a[96:99], v[112:115], v[144:147]
  v_mfma_f32_16x16x32_bf16 v[148:151], a[96:99], v[116:119], v[148:151]
  v_mfma_f32_16x16x32_bf16 v[152:155], a[100:103], v[112:115], v[152:155]
  v_mfma_f32_16x16x32_bf16 v[156:159], a[100:103], v[116:119], v[156:159]
  v_mfma_f32_16x16x32_bf16 v[144:147], a[104:107], v[120:123], v[144:147]
  v_mfma_f32_16x16x32_bf16 v[148:151], a[104:107], v[124:127], v[148:151]
  v_mfma_f32_16x16x32_bf16 v[152:155], a[108:111], v[120:123], v[152:155]
  v_mfma_f32_16x16x32_bf16 v[156:159], a[108:111], v[124:127], v[156:159]
  v_mfma_f32_16x16x32_bf16 v[144:147], a[112:115], v[128:131], v[144:147]
  v_mfma_f32_16x16x32_bf16 v[148:151], a[112:115], v[132:135], v[148:151]
  v_mfma_f32_16x16x32_bf16 v[152:155], a[116:119], v[128:131], v[152:155]
  s_waitcnt vmcnt(6)
  s_barrier
  v_xor_b32 v6, 0x8000, v6
  v_mfma_f32_16x16x32_bf16 v[156:159], a[116:119], v[132:135], v[156:159]
  global_load_lds_dwordx4 v1, s[50:51] offset:0
  v_mfma_f32_16x16x32_bf16 v[144:147], a[120:123], v[136:139], v[144:147]
  global_load_lds_dwordx4 v1, s[50:51] offset:1024
  v_mfma_f32_16x16x32_bf16 v[148:151], a[120:123], v[140:143], v[148:151]
  global_load_lds_dwordx4 v1, s[50:51] offset:2048
  v_mfma_f32_16x16x32_bf16 v[152:155], a[124:127], v[136:139], v[152:155]
  global_load_lds_dwordx4 v1, s[50:51] offset:3072
  v_mfma_f32_16x16x32_bf16 v[156:159], a[124:127], v[140:143], v[156:159]
  s_add_u32 s50, s50, 4096
  s_addc_u32 s51, s51, 0
  s_add_u32 m0, m0, 4096
  v_mfma_f32_16x16x32_bf16 v[160:163], v[16:19], a[128:131], 0
  global_load_lds_dwordx4 v1, s[50:51] offset:0
  v_mfma_f32_16x16x32_bf16 v[164:167], v[20:23], a[128:131], 0
  global_load_lds_dwordx4 v1, s[50:51] offset:1024
  v_mfma_f32_16x16x32_bf16 v[168:171], v[16:19], a[132:135], 0
  ds_read_b128 v[16:19], v6 offset:0
  global_load_lds_dwordx4 v1, s[50:51] offset:2048
  v_mfma_f32_16x16x32_bf16 v[172:175], v[20:23], a[132:135], 0
  ds_read_b128 v[20:23], v6 offset:1024
  global_load_lds_dwordx4 v1, s[50:51] offset:3072
  v_mfma_f32_16x16x32_bf16 v[160:163], v[24:27], a[136:139], v[160:163]
  v_cvt_pk_bf16_f32 v176, v144, v152
  v_mfma_f32_16x16x32_bf16 v[164:167], v[28:31], a[136:139], v[164:167]
  v_cvt_pk_bf16_f32 v177, v145, v153
  v_mfma_f32_16x16x32_bf16 v[168:171], v[24:27], a[140:143], v[168:171]
  ds_read_b128 v[24:27], v6 offset:2048
  v_cvt_pk_bf16_f32 v178, v146, v154
  v_mfma_f32_16x16x32_bf16 v[172:175], v[28:31], a[140:143], v[172:175]
  ds_read_b128 v[28:31], v6 offset:3072
  v_cvt_pk_bf16_f32 v179, v147, v155
  v_mfma_f32_16x16x32_bf16 v[160:163], v[32:35], a[144:147], v[160:163]
  global_store_dwordx4 v1, v[176:179], s[52:53] offset:0 sc1
  v_mfma_f32_16x16x32_bf16 v[164:167], v[36:39], a[144:147], v[164:167]
  v_cvt_pk_bf16_f32 v180, v148, v156
  v_mfma_f32_16x16x32_bf16 v[168:171], v[32:35], a[148:151], v[168:171]
  ds_read_b128 v[32:35], v6 offset:4096
  v_cvt_pk_bf16_f32 v181, v149, v157
  v_mfma_f32_16x16x32_bf16 v[172:175], v[36:39], a[148:151], v[172:175]
  ds_read_b128 v[36:39], v6 offset:5120
  v_cvt_pk_bf16_f32 v182, v150, v158
  v_mfma_f32_16x16x32_bf16 v[160:163], v[40:43], a[152:155], v[160:163]
  v_cvt_pk_bf16_f32 v183, v151, v159
  v_mfma_f32_16x16x32_bf16 v[164:167], v[44:47], a[152:155], v[164:167]
  global_store_dwordx4 v1, v[180:183], s[52:53] offset:1024 sc1
  v_mfma_f32_16x16x32_bf16 v[168:171], v[40:43], a[156:159], v[168:171]
  ds_read_b128 v[40:43], v6 offset:6144
  global_store_dwordx4 v1, v[8:11], s[66:67] sc1
  v_mfma_f32_16x16x32_bf16 v[172:175], v[44:47], a[156:159], v[172:175]
  ds_read_b128 v[44:47], v6 offset:7168
  v_mfma_f32_16x16x32_bf16 v[160:163], v[48:51], a[160:163], v[160:163]
  v_mfma_f32_16x16x32_bf16 v[164:167], v[52:55], a[160:163], v[164:167]
  v_mfma_f32_16x16x32_bf16 v[168:171], v[48:51], a[164:167], v[168:171]
  ds_read_b128 v[48:51], v6 offset:8192
  v_mfma_f32_16x16x32_bf16 v[172:175], v[52:55], a[164:167], v[172:175]
  ds_read_b128 v[52:55], v6 offset:9216
  v_mfma_f32_16x16x32_bf16 v[160:163], v[56:59], a[168:171], v[160:163]
  v_mfma_f32_16x16x32_bf16 v[164:167], v[60:63], a[168:171], v[164:167]
  v_mfma_f32_16x16x32_bf16 v[168:171], v[56:59], a[172:175], v[168:171]
  ds_read_b128 v[56:59], v6 offset:10240
  v_mfma_f32_16x16x32_bf16 v[172:175], v[60:63], a[172:175], v[172:175]
  ds_read_b128 v[60:63], v6 offset:11264
  v_mfma_f32_16x16x32_bf16 v[160:163], v[64:67], a[176:179], v[160:163]
  v_mfma_f32_16x16x32_bf16 v[164:167], v[68:71], a[176:179], v[164:167]
  v_mfma_f32_16x16x32_bf16 v[168:171], v[64:67], a[180:183], v[168:171]
  ds_read_b128 v[64:67], v6 offset:12288
  v_mfma_f32_16x16x32_bf16 v[172:175], v[68:71], a[180:183], v[172:175]
  ds_read_b128 v[68:71], v6 offset:13312
  v_mfma_f32_16x16x32_bf16 v[160:163], v[72:75], a[184:187], v[160:163]
  v_mfma_f32_16x16x32_bf16 v[164:167], v[76:79], a[184:187], v[164:167]
  v_mfma_f32_16x16x32_bf16 v[168:171], v[72:75], a[188:191], v[168:171]
  ds_read_b128 v[72:75], v6 offset:14336
  v_mfma_f32_16x16x32_bf16 v[172:175], v[76:79], a[188:191], v[172:175]
  ds_read_b128 v[76:79], v6 offset:15360
  v_mfma_f32_16x16x32_bf16 v[160:163], v[80:83], a[192:195], v[160:163]
  s_waitcnt vmcnt(11)
  global_store_dword v2, v3, s[56:57] sc1
  v_mfma_f32_16x16x32_bf16 v[164:167], v[84:87], a[192:195], v[164:167]
  s_mov_b64 s[56:57], s[68:69]
  v_mfma_f32_16x16x32_bf16 v[168:171], v[80:83], a[196:199], v[168:171]
  ds_read_b128 v[80:83], v6 offset:16384
  s_add_u32 s68, s68, 2048
  s_addc_u32 s69, s69, 0
  v_mfma_f32_16x16x32_bf16 v[172:175], v[84:87], a[196:199], v[172:175]
  ds_read_b128 v[84:87], v6 offset:17408
  s_add_u32 s52, s52, 262144
  s_addc_u32 s53, s53, 0
  v_mfma_f32_16x16x32_bf16 v[160:163], v[88:91], a[200:203], v[160:163]
  s_add_u32 s66, s66, 262144
  s_addc_u32 s67, s67, 0
  v_mfma_f32_16x16x32_bf16 v[164:167], v[92:95], a[200:203], v[164:167]
  s_add_u32 s59, s59, 1
  v_mfma_f32_16x16x32_bf16 v[168:171], v[88:91], a[204:207], v[168:171]
  ds_read_b128 v[88:91], v6 offset:18432
  v_mfma_f32_16x16x32_bf16 v[172:175], v[92:95], a[204:207], v[172:175]
  ds_read_b128 v[92:95], v6 offset:19456
  v_mfma_f32_16x16x32_bf16 v[160:163], v[96:99], a[208:211], v[160:163]
  v_mfma_f32_16x16x32_bf16 v[164:167], v[100:103], a[208:211], v[164:167]
  v_mfma_f32_16x16x32_bf16 v[168:171], v[96:99], a[212:215], v[168:171]
  ds_read_b128 v[96:99], v6 offset:20480
  v_mfma_f32_16x16x32_bf16 v[172:175], v[100:103], a[212:215], v[172:175]
  ds_read_b128 v[100:103], v6 offset:21504
  v_mfma_f32_16x16x32_bf16 v[160:163], v[104:107], a[216:219], v[160:163]
  v_mfma_f32_16x16x32_bf16 v[164:167], v[108:111], a[216:219], v[164:167]
  v_mfma_f32_16x16x32_bf16 v[168:171], v[104:107], a[220:223], v[168:171]
  ds_read_b128 v[104:107], v6 offset:22528
  v_mfma_f32_16x16x32_bf16 v[172:175], v[108:111], a[220:223], v[172:175]
  ds_read_b128 v[108:111], v6 offset:23552
  v_mfma_f32_16x16x32_bf16 v[160:163], v[112:115], a[224:227], v[160:163]
  v_mfma_f32_16x16x32_bf16 v[164:167], v[116:119], a[224:227], v[164:167]
  v_mfma_f32_16x16x32_bf16 v[168:171], v[112:115], a[228:231], v[168:171]
  ds_read_b128 v[112:115], v6 offset:24576
  v_mfma_f32_16x16x32_bf16 v[172:175], v[116:119], a[228:231], v[172:175]
  ds_read_b128 v[116:119], v6 offset:25600
  v_mfma_f32_16x16x32_bf16 v[160:163], v[120:123], a[232:235], v[160:163]
  v_mfma_f32_16x16x32_bf16 v[164:167], v[124:127], a[232:235], v[164:167]
  v_mfma_f32_16x16x32_bf16 v[168:171], v[120:123], a[236:239], v[168:171]
  ds_read_b128 v[120:123], v6 offset:26624
  v_mfma_f32_16x16x32_bf16 v[172:175], v[124:127], a[236:239], v[172:175]
  ds_read_b128 v[124:127], v6 offset:27648
  v_mfma_f32_16x16x32_bf16 v[160:163], v[128:131], a[240:243], v[160:163]
  v_mfma_f32_16x16x32_bf16 v[164:167], v[132:135], a[240:243], v[164:167]
  v_mfma_f32_16x16x32_bf16 v[168:171], v[128:131], a[244:247], v[168:171]
  ds_read_b128 v[128:131], v6 offset:28672
  v_mfma_f32_16x16x32_bf16 v[172:175], v[132:135], a[244:247], v[172:175]
  ds_read_b128 v[132:135], v6 offset:29696
  v_mfma_f32_16x16x32_bf16 v[160:163], v[136:139], a[248:251], v[160:163]
  v_mfma_f32_16x16x32_bf16 v[164:167], v[140:143], a[248:251], v[164:167]
  v_mfma_f32_16x16x32_bf16 v[168:171], v[136:139], a[252:255], v[168:171]
  ds_read_b128 v[136:139], v6 offset:30720
  s_cmp_lt_u32 s59, 66
  v_mfma_f32_16x16x32_bf16 v[172:175], v[140:143], a[252:255], v[172:175]
  ds_read_b128 v[140:143], v6 offset:31744
  s_waitcnt lgkmcnt(15)
  s_cbranch_scc1 L_KV_loop
  v_cvt_pk_bf16_f32 v184, v160, v161
  v_cvt_pk_bf16_f32 v185, v162, v163
  v_cvt_pk_bf16_f32 v186, v164, v165
  v_cvt_pk_bf16_f32 v187, v166, v167
  global_store_dwordx4 v1, v[184:187], s[54:55] offset:0 sc1
  v_cvt_pk_bf16_f32 v188, v168, v169
  v_cvt_pk_bf16_f32 v189, v170, v171
  v_cvt_pk_bf16_f32 v190, v172, v173
  v_cvt_pk_bf16_f32 v191, v174, v175
  global_store_dwordx4 v1, v[188:191], s[54:55] offset:1024 sc1
  s_waitcnt vmcnt(0)
  global_store_dword v2, v3, s[56:57] sc1
  s_endpgm
L_role_QG:
  s_bfe_u32 s48, s5, 0x10005
  s_mov_b32 s49, 2
  s_cmp_ge_u32 s6, 30
  s_cbranch_scc1 L_O_idle
  s_cmp_ge_u32 s6, 16
  s_cbranch_scc1 L_role_GU
  s_mov_b32 s10, s6
  s_lshl_b32 s8, s6, 9
  s_add_u32 s44, s20, s8
  s_addc_u32 s45, s21, 0
  s_add_u32 s46, s44, 256
  s_addc_u32 s47, s45, 0
  v_mov_b32 v2, 0
  s_lshl_b32 s63, s4, 12
  v_lshrrev_b32 v40, 4, v0
  s_and_b32 s8, s4, 1
  s_lshl_b32 s8, s8, 2
  v_or_b32 v41, s8, v40
  v_lshlrev_b32 v41, 1, v41
  v_and_b32 v30, 15, v0
  v_xor_b32 v30, v30, v41
  v_lshlrev_b32 v30, 4, v30
  s_lshl_b32 s8, s4, 4
  v_add_u32 v40, s8, v40
  v_mul_u32_u24 v40, 8192, v40
  v_add_u32 v30, v30, v40
  v_mov_b32 v24, v30
  v_add_u32 v25, 31744, v24
  v_add_u32 v26, 63488, v24
  v_add_u32 v27, 95232, v24
  s_add_u32 m0, s63, 0
  s_add_u32 s60, s44, 0
  s_addc_u32 s61, s45, 0
  global_load_lds_dwordx4 v24, s[60:61] offset:0
  global_load_lds_dwordx4 v25, s[60:61] offset:1024
  global_load_lds_dwordx4 v26, s[60:61] offset:2048
  global_load_lds_dwordx4 v27, s[60:61] offset:3072
  v_lshlrev_b32 v1, 4, v0
  v_mov_b32 v40, 0
  v_bfe_u32 v41, v0, 4, 1
  v_mad_u32_u24 v40, v41, 16, v40
  v_bfe_u32 v41, v0, 5, 1
  v_mad_u32_u24 v40, v41, 32, v40
  v_bfe_u32 v41, v0, 2, 1
  v_mad_u32_u24 v40, v41, 1, v40
  v_bfe_u32 v41, v0, 3, 1
  v_mad_u32_u24 v40, v41, 2, v40
  v_mov_b32 v42, 0
  v_bfe_u32 v41, v40, 0, 1
  v_lshl_or_b32 v42, v41, 0, v42
  v_bfe_u32 v41, v40, 1, 1
  v_lshl_or_b32 v42, v41, 1, v42
  v_bfe_u32 v41, v40, 4, 1
  v_lshl_or_b32 v42, v41, 2, v42
  s_lshl_b32 s8, s4, 1
  v_xor_b32 v42, s8, v42
  v_lshlrev_b32 v42, 5, v42
  v_lshl_add_u32 v32, v40, 8, v42
  v_and_b32 v41, 3, v0
  v_lshl_add_u32 v32, v41, 3, v32
  v_xor_b32 v33, 32, v32
  v_add_u32 v34, 0x10000, v32
  v_add_u32 v35, 0x10000, v33
  s_waitcnt vmcnt(0)
  s_barrier
  ds_read_b64_tr_b16 a[0:1], v32 offset:0
  ds_read_b64_tr_b16 a[2:3], v32 offset:1024
  ds_read_b64_tr_b16 a[4:5], v33 offset:0
  ds_read_b64_tr_b16 a[6:7], v33 offset:1024
  ds_read_b64_tr_b16 a[8:9], v32 offset:2048
  ds_read_b64_tr_b16 a[10:11], v32 offset:3072
  ds_read_b64_tr_b16 a[12:13], v33 offset:2048
  ds_read_b64_tr_b16 a[14:15], v33 offset:3072
  s_waitcnt lgkmcnt(0)
  s_barrier
  s_add_u32 m0, s63, 16384
  s_add_u32 s60, s44, 524288
  s_addc_u32 s61, s45, 0
  global_load_lds_dwordx4 v24, s[60:61] offset:0
  global_load_lds_dwordx4 v25, s[60:61] offset:1024
  global_load_lds_dwordx4 v26, s[60:61] offset:2048
  global_load_lds_dwordx4 v27, s[60:61] offset:3072
  s_waitcnt vmcnt(0)
  s_barrier
  ds_read_b64_tr_b16 a[16:17], v32 offset:16384
  ds_read_b64_tr_b16 a[18:19], v32 offset:17408
  ds_read_b64_tr_b16 a[20:21], v33 offset:16384
  ds_read_b64_tr_b16 a[22:23], v33 offset:17408
  ds_read_b64_tr_b16 a[24:25], v32 offset:18432
  ds_read_b64_tr_b16 a[26:27], v32 offset:19456
  ds_read_b64_tr_b16 a[28:29], v33 offset:18432
  ds_read_b64_tr_b16 a[30:31], v33 offset:19456
  s_waitcnt lgkmcnt(0)
  s_barrier
  s_add_u32 m0, s63, 32768
  s_add_u32 s60, s44, 1048576
  s_addc_u32 s61, s45, 0
  global_load_lds_dwordx4 v24, s[60:61] offset:0
  global_load_lds_dwordx4 v25, s[60:61] offset:1024
  global_load_lds_dwordx4 v26, s[60:61] offset:2048
  global_load_lds_dwordx4 v27, s[60:61] offset:3072
  s_waitcnt vmcnt(0)
  s_barrier
  ds_read_b64_tr_b16 a[32:33], v32 offset:32768
  ds_read_b64_tr_b16 a[34:35], v32 offset:33792
  ds_read_b64_tr_b16 a[36:37], v33 offset:32768
  ds_read_b64_tr_b16 a[38:39], v33 offset:33792
  ds_read_b64_tr_b16 a[40:41], v32 offset:34816
  ds_read_b64_tr_b16 a[42:43], v32 offset:35840
  ds_read_b64_tr_b16 a[44:45], v33 offset:34816
  ds_read_b64_tr_b16 a[46:47], v33 offset:35840
  s_waitcnt lgkmcnt(0)
  s_barrier
  s_add_u32 m0, s63, 49152
  s_add_u32 s60, s44, 1572864
  s_addc_u32 s61, s45, 0
  global_load_lds_dwordx4 v24, s[60:61] offset:0
  global_load_lds_dwordx4 v25, s[60:61] offset:1024
  global_load_lds_dwordx4 v26, s[60:61] offset:2048
  global_load_lds_dwordx4 v27, s[60:61] offset:3072
  s_waitcnt vmcnt(0)
  s_barrier
  ds_read_b64_tr_b16 a[48:49], v32 offset:49152
  ds_read_b64_tr_b16 a[50:51], v32 offset:50176
  ds_read_b64_tr_b16 a[52:53], v33 offset:49152
  ds_read_b64_tr_b16 a[54:55], v33 offset:50176
  ds_read_b64_tr_b16 a[56:57], v32 offset:51200
  ds_read_b64_tr_b16 a[58:59], v32 offset:52224
  ds_read_b64_tr_b16 a[60:61], v33 offset:51200
  ds_read_b64_tr_b16 a[62:63], v33 offset:52224
  s_waitcnt lgkmcnt(0)
  s_barrier
  s_add_u32 m0, s63, 65536
  s_add_u32 s60, s44, 2097152
  s_addc_u32 s61, s45, 0
  global_load_lds_dwordx4 v24, s[60:61] offset:0
  global_load_lds_dwordx4 v25, s[60:61] offset:1024
  global_load_lds_dwordx4 v26, s[60:61] offset:2048
  global_load_lds_dwordx4 v27, s[60:61] offset:3072
  s_waitcnt vmcnt(0)
  s_barrier
  ds_read_b64_tr_b16 a[64:65], v34 offset:0
  ds_read_b64_tr_b16 a[66:67], v34 offset:1024
  ds_read_b64_tr_b16 a[68:69], v35 offset:0
  ds_read_b64_tr_b16 a[70:71], v35 offset:1024
  ds_read_b64_tr_b16 a[72:73], v34 offset:2048
  ds_read_b64_tr_b16 a[74:75], v34 offset:3072
  ds_read_b64_tr_b16 a[76:77], v35 offset:2048
  ds_read_b64_tr_b16 a[78:79], v35 offset:3072
  s_waitcnt lgkmcnt(0)
  s_barrier
  s_add_u32 m0, s63, 81920
  s_add_u32 s60, s44, 2621440
  s_addc_u32 s61, s45, 0
  global_load_lds_dwordx4 v24, s[60:61] offset:0
  global_load_lds_dwordx4 v25, s[60:61] offset:1024
  global_load_lds_dwordx4 v26, s[60:61] offset:2048
  global_load_lds_dwordx4 v27, s[60:61] offset:3072
  s_waitcnt vmcnt(0)
  s_barrier
  ds_read_b64_tr_b16 a[80:81], v34 offset:16384
  ds_read_b64_tr_b16 a[82:83], v34 offset:17408
  ds_read_b64_tr_b16 a[84:85], v35 offset:16384
  ds_read_b64_tr_b16 a[86:87], v35 offset:17408
  ds_read_b64_tr_b16 a[88:89], v34 offset:18432
  ds_read_b64_tr_b16 a[90:91], v34 offset:19456
  ds_read_b64_tr_b16 a[92:93], v35 offset:18432
  ds_read_b64_tr_b16 a[94:95], v35 offset:19456
  s_waitcnt lgkmcnt(0)
  s_barrier
  s_add_u32 m0, s63, 98304
  s_add_u32 s60, s44, 3145728
  s_addc_u32 s61, s45, 0
  global_load_lds_dwordx4 v24, s[60:61] offset:0
  global_load_lds_dwordx4 v25, s[60:61] offset:1024
  global_load_lds_dwordx4 v26, s[60:61] offset:2048
  global_load_lds_dwordx4 v27, s[60:61] offset:3072
  s_waitcnt vmcnt(0)
  s_barrier
  ds_read_b64_tr_b16 a[96:97], v34 offset:32768
  ds_read_b64_tr_b16 a[98:99], v34 offset:33792
  ds_read_b64_tr_b16 a[100:101], v35 offset:32768
  ds_read_b64_tr_b16 a[102:103], v35 offset:33792
  ds_read_b64_tr_b16 a[104:105], v34 offset:34816
  ds_read_b64_tr_b16 a[106:107], v34 offset:35840
  ds_read_b64_tr_b16 a[108:109], v35 offset:34816
  ds_read_b64_tr_b16 a[110:111], v35 offset:35840
  s_waitcnt lgkmcnt(0)
  s_barrier
  s_add_u32 m0, s63, 114688
  s_add_u32 s60, s44, 3670016
  s_addc_u32 s61, s45, 0
  global_load_lds_dwordx4 v24, s[60:61] offset:0
  global_load_lds_dwordx4 v25, s[60:61] offset:1024
  global_load_lds_dwordx4 v26, s[60:61] offset:2048
  global_load_lds_dwordx4 v27, s[60:61] offset:3072
  s_waitcnt vmcnt(0)
  s_barrier
  ds_read_b64_tr_b16 a[112:113], v34 offset:49152
  ds_read_b64_tr_b16 a[114:115], v34 offset:50176
  ds_read_b64_tr_b16 a[116:117], v35 offset:49152
  ds_read_b64_tr_b16 a[118:119], v35 offset:50176
  ds_read_b64_tr_b16 a[120:121], v34 offset:51200
  ds_read_b64_tr_b16 a[122:123], v34 offset:52224
  ds_read_b64_tr_b16 a[124:125], v35 offset:51200
  ds_read_b64_tr_b16 a[126:127], v35 offset:52224
  s_waitcnt lgkmcnt(0)
  s_barrier
  s_add_u32 m0, s63, 0
  s_add_u32 s60, s46, 0
  s_addc_u32 s61, s47, 0
  global_load_lds_dwordx4 v24, s[60:61] offset:0
  global_load_lds_dwordx4 v25, s[60:61] offset:1024
  global_load_lds_dwordx4 v26, s[60:61] offset:2048
  global_load_lds_dwordx4 v27, s[60:61] offset:3072
  s_waitcnt vmcnt(0)
  s_barrier
  ds_read_b64_tr_b16 a[128:129], v32 offset:0
  ds_read_b64_tr_b16 a[130:131], v32 offset:1024
  ds_read_b64_tr_b16 a[132:133], v33 offset:0
  ds_read_b64_tr_b16 a[134:135], v33 offset:1024
  ds_read_b64_tr_b16 a[136:137], v32 offset:2048
  ds_read_b64_tr_b16 a[138:139], v32 offset:3072
  ds_read_b64_tr_b16 a[140:141], v33 offset:2048
  ds_read_b64_tr_b16 a[142:143], v33 offset:3072
  s_waitcnt lgkmcnt(0)
  s_barrier
  s_add_u32 m0, s63, 16384
  s_add_u32 s60, s46, 524288
  s_addc_u32 s61, s47, 0
  global_load_lds_dwordx4 v24, s[60:61] offset:0
  global_load_lds_dwordx4 v25, s[60:61] offset:1024
  global_load_lds_dwordx4 v26, s[60:61] offset:2048
  global_load_lds_dwordx4 v27, s[60:61] offset:3072
  s_waitcnt vmcnt(0)
  s_barrier
  ds_read_b64_tr_b16 a[144:145], v32 offset:16384
  ds_read_b64_tr_b16 a[146:147], v32 offset:17408
  ds_read_b64_tr_b16 a[148:149], v33 offset:16384
  ds_read_b64_tr_b16 a[150:151], v33 offset:17408
  ds_read_b64_tr_b16 a[152:153], v32 offset:18432
  ds_read_b64_tr_b16 a[154:155], v32 offset:19456
  ds_read_b64_tr_b16 a[156:157], v33 offset:18432
  ds_read_b64_tr_b16 a[158:159], v33 offset:19456
  s_waitcnt lgkmcnt(0)
  s_barrier
  s_add_u32 m0, s63, 32768
  s_add_u32 s60, s46, 1048576
  s_addc_u32 s61, s47, 0
  global_load_lds_dwordx4 v24, s[60:61] offset:0
  global_load_lds_dwordx4 v25, s[60:61] offset:1024
  global_load_lds_dwordx4 v26, s[60:61] offset:2048
  global_load_lds_dwordx4 v27, s[60:61] offset:3072
  s_waitcnt vmcnt(0)
  s_barrier
  ds_read_b64_tr_b16 a[160:161], v32 offset:32768
  ds_read_b64_tr_b16 a[162:163], v32 offset:33792
  ds_read_b64_tr_b16 a[164:165], v33 offset:32768
  ds_read_b64_tr_b16 a[166:167], v33 offset:33792
  ds_read_b64_tr_b16 a[168:169], v32 offset:34816
  ds_read_b64_tr_b16 a[170:171], v32 offset:35840
  ds_read_b64_tr_b16 a[172:173], v33 offset:34816
  ds_read_b64_tr_b16 a[174:175], v33 offset:35840
  s_waitcnt lgkmcnt(0)
  s_barrier
  s_add_u32 m0, s63, 49152
  s_add_u32 s60, s46, 1572864
  s_addc_u32 s61, s47, 0
  global_load_lds_dwordx4 v24, s[60:61] offset:0
  global_load_lds_dwordx4 v25, s[60:61] offset:1024
  global_load_lds_dwordx4 v26, s[60:61] offset:2048
  global_load_lds_dwordx4 v27, s[60:61] offset:3072
  s_waitcnt vmcnt(0)
  s_barrier
  ds_read_b64_tr_b16 a[176:177], v32 offset:49152
  ds_read_b64_tr_b16 a[178:179], v32 offset:50176
  ds_read_b64_tr_b16 a[180:181], v33 offset:49152
  ds_read_b64_tr_b16 a[182:183], v33 offset:50176
  ds_read_b64_tr_b16 a[184:185], v32 offset:51200
  ds_read_b64_tr_b16 a[186:187], v32 offset:52224
  ds_read_b64_tr_b16 a[188:189], v33 offset:51200
  ds_read_b64_tr_b16 a[190:191], v33 offset:52224
  s_waitcnt lgkmcnt(0)
  s_barrier
  s_add_u32 m0, s63, 65536
  s_add_u32 s60, s46, 2097152
  s_addc_u32 s61, s47, 0
  global_load_lds_dwordx4 v24, s[60:61] offset:0
  global_load_lds_dwordx4 v25, s[60:61] offset:1024
  global_load_lds_dwordx4 v26, s[60:61] offset:2048
  global_load_lds_dwordx4 v27, s[60:61] offset:3072
  s_waitcnt vmcnt(0)
  s_barrier
  ds_read_b64_tr_b16 a[192:193], v34 offset:0
  ds_read_b64_tr_b16 a[194:195], v34 offset:1024
  ds_read_b64_tr_b16 a[196:197], v35 offset:0
  ds_read_b64_tr_b16 a[198:199], v35 offset:1024
  ds_read_b64_tr_b16 a[200:201], v34 offset:2048
  ds_read_b64_tr_b16 a[202:203], v34 offset:3072
  ds_read_b64_tr_b16 a[204:205], v35 offset:2048
  ds_read_b64_tr_b16 a[206:207], v35 offset:3072
  s_waitcnt lgkmcnt(0)
  s_barrier
  s_add_u32 m0, s63, 81920
  s_add_u32 s60, s46, 2621440
  s_addc_u32 s61, s47, 0
  global_load_lds_dwordx4 v24, s[60:61] offset:0
  global_load_lds_dwordx4 v25, s[60:61] offset:1024
  global_load_lds_dwordx4 v26, s[60:61] offset:2048
  global_load_lds_dwordx4 v27, s[60:61] offset:3072
  s_waitcnt vmcnt(0)
  s_barrier
  ds_read_b64_tr_b16 a[208:209], v34 offset:16384
  ds_read_b64_tr_b16 a[210:211], v34 offset:17408
  ds_read_b64_tr_b16 a[212:213], v35 offset:16384
  ds_read_b64_tr_b16 a[214:215], v35 offset:17408
  ds_read_b64_tr_b16 a[216:217], v34 offset:18432
  ds_read_b64_tr_b16 a[218:219], v34 offset:19456
  ds_read_b64_tr_b16 a[220:221], v35 offset:18432
  ds_read_b64_tr_b16 a[222:223], v35 offset:19456
  s_waitcnt lgkmcnt(0)
  s_barrier
  s_add_u32 m0, s63, 98304
  s_add_u32 s60, s46, 3145728
  s_addc_u32 s61, s47, 0
  global_load_lds_dwordx4 v24, s[60:61] offset:0
  global_load_lds_dwordx4 v25, s[60:61] offset:1024
  global_load_lds_dwordx4 v26, s[60:61] offset:2048
  global_load_lds_dwordx4 v27, s[60:61] offset:3072
  s_waitcnt vmcnt(0)
  s_barrier
  ds_read_b64_tr_b16 a[224:225], v34 offset:32768
  ds_read_b64_tr_b16 a[226:227], v34 offset:33792
  ds_read_b64_tr_b16 a[228:229], v35 offset:32768
  ds_read_b64_tr_b16 a[230:231], v35 offset:33792
  ds_read_b64_tr_b16 a[232:233], v34 offset:34816
  ds_read_b64_tr_b16 a[234:235], v34 offset:35840
  ds_read_b64_tr_b16 a[236:237], v35 offset:34816
  ds_read_b64_tr_b16 a[238:239], v35 offset:35840
  s_waitcnt lgkmcnt(0)
  s_barrier
  s_add_u32 m0, s63, 114688
  s_add_u32 s60, s46, 3670016
  s_addc_u32 s61, s47, 0
  global_load_lds_dwordx4 v24, s[60:61] offset:0
  global_load_lds_dwordx4 v25, s[60:61] offset:1024
  global_load_lds_dwordx4 v26, s[60:61] offset:2048
  global_load_lds_dwordx4 v27, s[60:61] offset:3072
  s_waitcnt vmcnt(0)
  s_barrier
  ds_read_b64_tr_b16 a[240:241], v34 offset:49152
  ds_read_b64_tr_b16 a[242:243], v34 offset:50176
  ds_read_b64_tr_b16 a[244:245], v35 offset:49152
  ds_read_b64_tr_b16 a[246:247], v35 offset:50176
  ds_read_b64_tr_b16 a[248:249], v34 offset:51200
  ds_read_b64_tr_b16 a[250:251], v34 offset:52224
  ds_read_b64_tr_b16 a[252:253], v35 offset:51200
  ds_read_b64_tr_b16 a[254:255], v35 offset:52224
  s_waitcnt lgkmcnt(0)
  s_barrier
  v_mov_b32 v3, 1
  s_cmp_lg_u32 s4, 0
  s_cbranch_scc1 Lw1_17
Lww_18:
  global_load_dword v4, v2, s[40:41] offset:164 sc1
  s_waitcnt vmcnt(0)
  v_cmp_gt_u32 vcc, 64, v4
  s_cbranch_vccz Lwd_19
  s_sleep 4
  s_sub_u32 s7, s7, 1
  s_cbranch_scc0 Lww_18
  s_mov_b32 s7, 0
Lwd_19:
Lw1_17:
  s_barrier
  v_mov_b32 v8, -1
  v_mov_b32 v9, -1
  v_mov_b32 v10, -1
  v_mov_b32 v11, -1
  s_mov_b32 s58, 0
  s_lshl_b32 s8, s5, 8
  s_lshl_b32 s9, s4, 2
  s_add_u32 s8, s8, s9
  s_add_u32 s8, s8, 172032
  s_add_u32 s56, s42, s8
  s_addc_u32 s57, s43, 0
  s_min_u32 s60, s48, 63
  s_lshl_b32 s60, s60, 15
  s_lshl_b32 s61, s4, 13
  s_add_u32 s60, s60, s61
  s_add_u32 s60, s60, 1048576
  s_add_u32 s50, s42, s60
  s_addc_u32 s51, s43, 0
  s_add_u32 m0, s61, s58
  s_nop 0
  global_load_lds_dwordx4 v1, s[50:51] offset:0
  global_load_lds_dwordx4 v1, s[50:51] offset:1024
  global_load_lds_dwordx4 v1, s[50:51] offset:2048
  global_load_lds_dwordx4 v1, s[50:51] offset:3072
  s_add_u32 s50, s50, 4096
  s_addc_u32 s51, s51, 0
  s_add_u32 m0, m0, 4096
  s_nop 0
  global_load_lds_dwordx4 v1, s[50:51] offset:0
  global_load_lds_dwordx4 v1, s[50:51] offset:1024
  global_load_lds_dwordx4 v1, s[50:51] offset:2048
  global_load_lds_dwordx4 v1, s[50:51] offset:3072
  v_mov_b32 v6, v1
  s_waitcnt vmcnt(0)
L_Q_loop:
  s_waitcnt vmcnt(10)
  s_barrier
  s_add_u32 s59, s48, s49
  s_xor_b32 s58, s58, 0x8000
  s_min_u32 s60, s59, 63
  s_lshl_b32 s60, s60, 15
  s_lshl_b32 s61, s4, 13
  s_add_u32 s60, s60, s61
  s_add_u32 s60, s60, 1048576
  s_add_u32 s50, s42, s60
  s_addc_u32 s51, s43, 0
  s_add_u32 m0, s61, s58
  s_nop 0
  global_load_lds_dwordx4 v1, s[50:51] offset:0
  global_load_lds_dwordx4 v1, s[50:51] offset:1024
  global_load_lds_dwordx4 v1, s[50:51] offset:2048
  global_load_lds_dwordx4 v1, s[50:51] offset:3072
  s_add_u32 s50, s50, 4096
  s_addc_u32 s51, s51, 0
  s_add_u32 m0, m0, 4096
  s_nop 0
  global_load_lds_dwordx4 v1, s[50:51] offset:0
  global_load_lds_dwordx4 v1, s[50:51] offset:1024
  global_load_lds_dwordx4 v1, s[50:51] offset:2048
  global_load_lds_dwordx4 v1, s[50:51] offset:3072
  ds_read_b128 v[16:19], v6 offset:0
  ds_read_b128 v[20:23], v6 offset:1024
  ds_read_b128 v[24:27], v6 offset:2048
  ds_read_b128 v[28:31], v6 offset:3072
  ds_read_b128 v[32:35], v6 offset:4096
  ds_read_b128 v[36:39], v6 offset:5120
  ds_read_b128 v[40:43], v6 offset:6144
  ds_read_b128 v[44:47], v6 offset:7168
  s_waitcnt lgkmcnt(6)
  v_mfma_f32_16x16x32_bf16 v[64:67], a[0:3], v[16:19], 0
  v_mfma_f32_16x16x32_bf16 v[68:71], a[0:3], v[20:23], 0
  v_mfma_f32_16x16x32_bf16 v[72:75], a[4:7], v[16:19], 0
  v_mfma_f32_16x16x32_bf16 v[76:79], a[4:7], v[20:23], 0
  v_mfma_f32_16x16x32_bf16 v[80:83], a[128:131], v[16:19], 0
  v_mfma_f32_16x16x32_bf16 v[84:87], a[128:131], v[20:23], 0
  v_mfma_f32_16x16x32_bf16 v[88:91], a[132:135], v[16:19], 0
  v_mfma_f32_16x16x32_bf16 v[92:95], a[132:135], v[20:23], 0
  ds_read_b128 v[16:19], v6 offset:8192
  ds_read_b128 v[20:23], v6 offset:9216
  s_waitcnt lgkmcnt(6)
  v_mfma_f32_16x16x32_bf16 v[64:67], a[8:11], v[24:27], v[64:67]
  v_mfma_f32_16x16x32_bf16 v[68:71], a[8:11], v[28:31], v[68:71]
  v_mfma_f32_16x16x32_bf16 v[72:75], a[12:15], v[24:27], v[72:75]
  v_mfma_f32_16x16x32_bf16 v[76:79], a[12:15], v[28:31], v[76:79]
  v_mfma_f32_16x16x32_bf16 v[80:83], a[136:139], v[24:27], v[80:83]
  v_mfma_f32_16x16x32_bf16 v[84:87], a[136:139], v[28:31], v[84:87]
  v_mfma_f32_16x16x32_bf16 v[88:91], a[140:143], v[24:27], v[88:91]
  v_mfma_f32_16x16x32_bf16 v[92:95], a[140:143], v[28:31], v[92:95]
  ds_read_b128 v[24:27], v6 offset:10240
  ds_read_b128 v[28:31], v6 offset:11264
  s_waitcnt lgkmcnt(6)
  v_mfma_f32_16x16x32_bf16 v[64:67], a[16:19], v[32:35], v[64:67]
  v_mfma_f32_16x16x32_bf16 v[68:71], a[16:19], v[36:39], v[68:71]
  v_mfma_f32_16x16x32_bf16 v[72:75], a[20:23], v[32:35], v[72:75]
  v_mfma_f32_16x16x32_bf16 v[76:79], a[20:23], v[36:39], v[76:79]
  v_mfma_f32_16x16x32_bf16 v[80:83], a[144:147], v[32:35], v[80:83]
  v_mfma_f32_16x16x32_bf16 v[84:87], a[144:147], v[36:39], v[84:87]
  v_mfma_f32_16x16x32_bf16 v[88:91], a[148:151], v[32:35], v[88:91]
  v_mfma_f32_16x16x32_bf16 v[92:95], a[148:151], v[36:39], v[92:95]
  ds_read_b128 v[32:35], v6 offset:12288
  ds_read_b128 v[36:39], v6 offset:13312
  s_waitcnt lgkmcnt(6)
  v_mfma_f32_16x16x32_bf16 v[64:67], a[24:27], v[40:43], v[64:67]
  v_mfma_f32_16x16x32_bf16 v[68:71], a[24:27], v[44:47], v[68:71]
  v_mfma_f32_16x16x32_bf16 v[72:75], a[28:31], v[40:43], v[72:75]
  v_mfma_f32_16x16x32_bf16 v[76:79], a[28:31], v[44:47], v[76:79]
  v_mfma_f32_16x16x32_bf16 v[80:83], a[152:155], v[40:43], v[80:83]
  v_mfma_f32_16x16x32_bf16 v[84:87], a[152:155], v[44:47], v[84:87]
  v_mfma_f32_16x16x32_bf16 v[88:91], a[156:159], v[40:43], v[88:91]
  v_mfma_f32_16x16x32_bf16 v[92:95], a[156:159], v[44:47], v[92:95]
  ds_read_b128 v[40:43], v6 offset:14336
  ds_read_b128 v[44:47], v6 offset:15360
  s_waitcnt lgkmcnt(6)
  v_mfma_f32_16x16x32_bf16 v[64:67], a[32:35], v[16:19], v[64:67]
  v_mfma_f32_16x16x32_bf16 v[68:71], a[32:35], v[20:23], v[68:71]
  v_mfma_f32_16x16x32_bf16 v[72:75], a[36:39], v[16:19], v[72:75]
  v_mfma_f32_16x16x32_bf16 v[76:79], a[36:39], v[20:23], v[76:79]
  v_mfma_f32_16x16x32_bf16 v[80:83], a[160:163], v[16:19], v[80:83]
  v_mfma_f32_16x16x32_bf16 v[84:87], a[160:163], v[20:23], v[84:87]
  v_mfma_f32_16x16x32_bf16 v[88:91], a[164:167], v[16:19], v[88:91]
  v_mfma_f32_16x16x32_bf16 v[92:95], a[164:167], v[20:23], v[92:95]
  ds_read_b128 v[16:19], v6 offset:16384
  ds_read_b128 v[20:23], v6 offset:17408
  s_waitcnt lgkmcnt(6)
  v_mfma_f32_16x16x32_bf16 v[64:67], a[40:43], v[24:27], v[64:67]
  v_mfma_f32_16x16x32_bf16 v[68:71], a[40:43], v[28:31], v[68:71]
  v_mfma_f32_16x16x32_bf16 v[72:75], a[44:47], v[24:27], v[72:75]
  v_mfma_f32_16x16x32_bf16 v[76:79], a[44:47], v[28:31], v[76:79]
  v_mfma_f32_16x16x32_bf16 v[80:83], a[168:171], v[24:27], v[80:83]
  v_mfma_f32_16x16x32_bf16 v[84:87], a[168:171], v[28:31], v[84:87]
  v_mfma_f32_16x16x32_bf16 v[88:91], a[172:175], v[24:27], v[88:91]
  v_mfma_f32_16x16x32_bf16 v[92:95], a[172:175], v[28:31], v[92:95]
  ds_read_b128 v[24:27], v6 offset:18432
  ds_read_b128 v[28:31], v6 offset:19456
  s_waitcnt lgkmcnt(6)
  v_mfma_f32_16x16x32_bf16 v[64:67], a[48:51], v[32:35], v[64:67]
  v_mfma_f32_16x16x32_bf16 v[68:71], a[48:51], v[36:39], v[68:71]
  v_mfma_f32_16x16x32_bf16 v[72:75], a[52:55], v[32:35], v[72:75]
  v_mfma_f32_16x16x32_bf16 v[76:79], a[52:55], v[36:39], v[76:79]
  v_mfma_f32_16x16x32_bf16 v[80:83], a[176:179], v[32:35], v[80:83]
  v_mfma_f32_16x16x32_bf16 v[84:87], a[176:179], v[36:39], v[84:87]
  v_mfma_f32_16x16x32_bf16 v[88:91], a[180:183], v[32:35], v[88:91]
  v_mfma_f32_16x16x32_bf16 v[92:95], a[180:183], v[36:39], v[92:95]
  ds_read_b128 v[32:35], v6 offset:20480
  ds_read_b128 v[36:39], v6 offset:21504
  s_waitcnt lgkmcnt(6)
  v_mfma_f32_16x16x32_bf16 v[64:67], a[56:59], v[40:43], v[64:67]
  v_mfma_f32_16x16x32_bf16 v[68:71], a[56:59], v[44:47], v[68:71]
  v_mfma_f32_16x16x32_bf16 v[72:75], a[60:63], v[40:43], v[72:75]
  v_mfma_f32_16x16x32_bf16 v[76:79], a[60:63], v[44:47], v[76:79]
  v_mfma_f32_16x16x32_bf16 v[80:83], a[184:187], v[40:43], v[80:83]
  v_mfma_f32_16x16x32_bf16 v[84:87], a[184:187], v[44:47], v[84:87]
  v_mfma_f32_16x16x32_bf16 v[88:91], a[188:191], v[40:43], v[88:91]
  v_mfma_f32_16x16x32_bf16 v[92:95], a[188:191], v[44:47], v[92:95]
  ds_read_b128 v[40:43], v6 offset:22528
  ds_read_b128 v[44:47], v6 offset:23552
  s_waitcnt lgkmcnt(6)
  s_waitcnt vmcnt(8)
  global_store_dword v2, v3, s[56:57] offset:16 sc1
  global_store_dword v2, v3, s[56:57] offset:80 sc1
  v_mfma_f32_16x16x32_bf16 v[64:67], a[64:67], v[16:19], v[64:67]
  v_mfma_f32_16x16x32_bf16 v[68:71], a[64:67], v[20:23], v[68:71]
  v_mfma_f32_16x16x32_bf16 v[72:75], a[68:71], v[16:19], v[72:75]
  v_mfma_f32_16x16x32_bf16 v[76:79], a[68:71], v[20:23], v[76:79]
  v_mfma_f32_16x16x32_bf16 v[80:83], a[192:195], v[16:19], v[80:83]
  v_mfma_f32_16x16x32_bf16 v[84:87], a[192:195], v[20:23], v[84:87]
  v_mfma_f32_16x16x32_bf16 v[88:91], a[196:199], v[16:19], v[88:91]
  v_mfma_f32_16x16x32_bf16 v[92:95], a[196:199], v[20:23], v[92:95]
  ds_read_b128 v[16:19], v6 offset:24576
  ds_read_b128 v[20:23], v6 offset:25600
  s_waitcnt lgkmcnt(6)
  s_lshl_b32 s60, s48, 18
  s_lshl_b32 s61, s10, 13
  s_add_u32 s60, s60, s61
  s_lshl_b32 s61, s4, 11
  s_add_u32 s60, s60, s61
  s_add_u32 s60, s60, 84934656
  s_add_u32 s52, s42, s60
  s_addc_u32 s53, s43, 0
  s_add_u32 s54, s52, 131072
  s_addc_u32 s55, s53, 0
  v_mfma_f32_16x16x32_bf16 v[64:67], a[72:75], v[24:27], v[64:67]
  v_mfma_f32_16x16x32_bf16 v[68:71], a[72:75], v[28:31], v[68:71]
  v_mfma_f32_16x16x32_bf16 v[72:75], a[76:79], v[24:27], v[72:75]
  v_mfma_f32_16x16x32_bf16 v[76:79], a[76:79], v[28:31], v[76:79]
  v_mfma_f32_16x16x32_bf16 v[80:83], a[200:203], v[24:27], v[80:83]
  v_mfma_f32_16x16x32_bf16 v[84:87], a[200:203], v[28:31], v[84:87]
  v_mfma_f32_16x16x32_bf16 v[88:91], a[204:207], v[24:27], v[88:91]
  v_mfma_f32_16x16x32_bf16 v[92:95], a[204:207], v[28:31], v[92:95]
  ds_read_b128 v[24:27], v6 offset:26624
  ds_read_b128 v[28:31], v6 offset:27648
  s_waitcnt lgkmcnt(6)
  global_store_dwordx4 v1, v[8:11], s[52:53] offset:0 sc1
  v_mfma_f32_16x16x32_bf16 v[64:67], a[80:83], v[32:35], v[64:67]
  v_mfma_f32_16x16x32_bf16 v[68:71], a[80:83], v[36:39], v[68:71]
  v_mfma_f32_16x16x32_bf16 v[72:75], a[84:87], v[32:35], v[72:75]
  v_mfma_f32_16x16x32_bf16 v[76:79], a[84:87], v[36:39], v[76:79]
  v_mfma_f32_16x16x32_bf16 v[80:83], a[208:211], v[32:35], v[80:83]
  v_mfma_f32_16x16x32_bf16 v[84:87], a[208:211], v[36:39], v[84:87]
  v_mfma_f32_16x16x32_bf16 v[88:91], a[212:215], v[32:35], v[88:91]
  v_mfma_f32_16x16x32_bf16 v[92:95], a[212:215], v[36:39], v[92:95]
  ds_read_b128 v[32:35], v6 offset:28672
  ds_read_b128 v[36:39], v6 offset:29696
  s_waitcnt lgkmcnt(6)
  global_store_dwordx4 v1, v[8:11], s[52:53] offset:1024 sc1
  v_mfma_f32_16x16x32_bf16 v[64:67], a[88:91], v[40:43], v[64:67]
  v_mfma_f32_16x16x32_bf16 v[68:71], a[88:91], v[44:47], v[68:71]
  v_mfma_f32_16x16x32_bf16 v[72:75], a[92:95], v[40:43], v[72:75]
  v_mfma_f32_16x16x32_bf16 v[76:79], a[92:95], v[44:47], v[76:79]
  v_mfma_f32_16x16x32_bf16 v[80:83], a[216:219], v[40:43], v[80:83]
  v_mfma_f32_16x16x32_bf16 v[84:87], a[216:219], v[44:47], v[84:87]
  v_mfma_f32_16x16x32_bf16 v[88:91], a[220:223], v[40:43], v[88:91]
  v_mfma_f32_16x16x32_bf16 v[92:95], a[220:223], v[44:47], v[92:95]
  ds_read_b128 v[40:43], v6 offset:30720
  ds_read_b128 v[44:47], v6 offset:31744
  s_waitcnt lgkmcnt(6)
  global_store_dwordx4 v1, v[8:11], s[54:55] offset:0 sc1
  v_mfma_f32_16x16x32_bf16 v[64:67], a[96:99], v[16:19], v[64:67]
  v_mfma_f32_16x16x32_bf16 v[68:71], a[96:99], v[20:23], v[68:71]
  v_mfma_f32_16x16x32_bf16 v[72:75], a[100:103], v[16:19], v[72:75]
  v_mfma_f32_16x16x32_bf16 v[76:79], a[100:103], v[20:23], v[76:79]
  v_mfma_f32_16x16x32_bf16 v[80:83], a[224:227], v[16:19], v[80:83]
  v_mfma_f32_16x16x32_bf16 v[84:87], a[224:227], v[20:23], v[84:87]
  v_mfma_f32_16x16x32_bf16 v[88:91], a[228:231], v[16:19], v[88:91]
  v_mfma_f32_16x16x32_bf16 v[92:95], a[228:231], v[20:23], v[92:95]
  s_waitcnt lgkmcnt(4)
  global_store_dwordx4 v1, v[8:11], s[54:55] offset:1024 sc1
  v_mfma_f32_16x16x32_bf16 v[64:67], a[104:107], v[24:27], v[64:67]
  v_mfma_f32_16x16x32_bf16 v[68:71], a[104:107], v[28:31], v[68:71]
  v_mfma_f32_16x16x32_bf16 v[72:75], a[108:111], v[24:27], v[72:75]
  v_mfma_f32_16x16x32_bf16 v[76:79], a[108:111], v[28:31], v[76:79]
  v_mfma_f32_16x16x32_bf16 v[80:83], a[232:235], v[24:27], v[80:83]
  v_mfma_f32_16x16x32_bf16 v[84:87], a[232:235], v[28:31], v[84:87]
  v_mfma_f32_16x16x32_bf16 v[88:91], a[236:239], v[24:27], v[88:91]
  v_mfma_f32_16x16x32_bf16 v[92:95], a[236:239], v[28:31], v[92:95]
  s_waitcnt lgkmcnt(2)
  v_mfma_f32_16x16x32_bf16 v[64:67], a[112:115], v[32:35], v[64:67]
  v_mfma_f32_16x16x32_bf16 v[68:71], a[112:115], v[36:39], v[68:71]
  v_mfma_f32_16x16x32_bf16 v[72:75], a[116:119], v[32:35], v[72:75]
  v_mfma_f32_16x16x32_bf16 v[76:79], a[116:119], v[36:39], v[76:79]
  v_mfma_f32_16x16x32_bf16 v[80:83], a[240:243], v[32:35], v[80:83]
  v_mfma_f32_16x16x32_bf16 v[84:87], a[240:243], v[36:39], v[84:87]
  v_mfma_f32_16x16x32_bf16 v[88:91], a[244:247], v[32:35], v[88:91]
  v_mfma_f32_16x16x32_bf16 v[92:95], a[244:247], v[36:39], v[92:95]
  s_waitcnt lgkmcnt(0)
  v_mfma_f32_16x16x32_bf16 v[64:67], a[120:123], v[40:43], v[64:67]
  v_mfma_f32_16x16x32_bf16 v[68:71], a[120:123], v[44:47], v[68:71]
  v_mfma_f32_16x16x32_bf16 v[72:75], a[124:127], v[40:43], v[72:75]
  v_mfma_f32_16x16x32_bf16 v[76:79], a[124:127], v[44:47], v[76:79]
  v_mfma_f32_16x16x32_bf16 v[80:83], a[248:251], v[40:43], v[80:83]
  v_mfma_f32_16x16x32_bf16 v[84:87], a[248:251], v[44:47], v[84:87]
  v_mfma_f32_16x16x32_bf16 v[88:91], a[252:255], v[40:43], v[88:91]
  v_mfma_f32_16x16x32_bf16 v[92:95], a[252:255], v[44:47], v[92:95]
  v_xor_b32 v6, 0x8000, v6
  s_lshl_b32 s60, s48, 18
  s_lshl_b32 s61, s10, 14
  s_add_u32 s60, s60, s61
  s_lshr_b32 s62, s60, 7
  s_lshl_b32 s61, s4, 2
  s_add_u32 s62, s62, s61
  s_add_u32 s62, s62, 4096
  s_lshl_b32 s61, s4, 11
  s_add_u32 s60, s60, s61
  s_add_u32 s60, s60, 50331648
  s_add_u32 s52, s42, s60
  s_addc_u32 s53, s43, 0
  s_add_u32 s54, s52, 8192
  s_addc_u32 s55, s53, 0
  s_add_u32 s56, s42, s62
  s_addc_u32 s57, s43, 0
  v_cvt_pk_bf16_f32 v100, v64, v72
  v_cvt_pk_bf16_f32 v101, v65, v73
  v_cvt_pk_bf16_f32 v102, v66, v74
  v_cvt_pk_bf16_f32 v103, v67, v75
  global_store_dwordx4 v1, v[100:103], s[52:53] offset:0 sc1
  v_cvt_pk_bf16_f32 v104, v68, v76
  v_cvt_pk_bf16_f32 v105, v69, v77
  v_cvt_pk_bf16_f32 v106, v70, v78
  v_cvt_pk_bf16_f32 v107, v71, v79
  global_store_dwordx4 v1, v[104:107], s[52:53] offset:1024 sc1
  v_cvt_pk_bf16_f32 v108, v80, v88
  v_cvt_pk_bf16_f32 v109, v81, v89
  v_cvt_pk_bf16_f32 v110, v82, v90
  v_cvt_pk_bf16_f32 v111, v83, v91
  global_store_dwordx4 v1, v[108:111], s[54:55] offset:0 sc1
  v_cvt_pk_bf16_f32 v112, v84, v92
  v_cvt_pk_bf16_f32 v113, v85, v93
  v_cvt_pk_bf16_f32 v114, v86, v94
  v_cvt_pk_bf16_f32 v115, v87, v95
  global_store_dwordx4 v1, v[112:115], s[54:55] offset:1024 sc1
  s_mov_b32 s48, s59
  s_cmp_lt_u32 s48, 64
  s_cbranch_scc1 L_Q_loop
  s_waitcnt vmcnt(0)
  global_store_dword v2, v3, s[56:57] offset:16 sc1
  global_store_dword v2, v3, s[56:57] offset:80 sc1
  s_branch L_O_help
L_role_GU:
  s_sub_u32 s10, s6, 16
  s_lshl_b32 s8, s10, 8
  s_add_u32 s44, s32, s8
  s_addc_u32 s45, s33, 0
  s_add_u32 s46, s34, s8
  s_addc_u32 s47, s35, 0
  v_mov_b32 v2, 0
  s_lshl_b32 s63, s4, 12
  v_lshrrev_b32 v40, 4, v0
  s_and_b32 s8, s4, 1
  s_lshl_b32 s8, s8, 2
  v_or_b32 v41, s8, v40
  v_lshlrev_b32 v41, 1, v41
  v_and_b32 v30, 15, v0
  v_xor_b32 v30, v30, v41
  v_lshlrev_b32 v30, 4, v30
  s_lshl_b32 s8, s4, 4
  v_add_u32 v40, s8, v40
  v_mul_u32_u24 v40, 3584, v40
  v_add_u32 v30, v30, v40
  v_mov_b32 v24, v30
  v_add_u32 v25, 13312, v24
  v_add_u32 v26, 26624, v24
  v_add_u32 v27, 39936, v24
  s_add_u32 m0, s63, 0
  s_add_u32 s60, s44, 0
  s_addc_u32 s61, s45, 0
  global_load_lds_dwordx4 v24, s[60:61] offset:0
  global_load_lds_dwordx4 v25, s[60:61] offset:1024
  global_load_lds_dwordx4 v26, s[60:61] offset:2048
  global_load_lds_dwordx4 v27, s[60:61] offset:3072
  v_lshlrev_b32 v1, 4, v0
  v_mov_b32 v40, 0
  v_bfe_u32 v41, v0, 4, 1
  v_mad_u32_u24 v40, v41, 16, v40
  v_bfe_u32 v41, v0, 5, 1
  v_mad_u32_u24 v40, v41, 32, v40
  v_bfe_u32 v41, v0, 2, 1
  v_mad_u32_u24 v40, v41, 1, v40
  v_bfe_u32 v41, v0, 3, 1
  v_mad_u32_u24 v40, v41, 2, v40
  v_mov_b32 v42, 0
  v_bfe_u32 v41, v40, 0, 1
  v_lshl_or_b32 v42, v41, 0, v42
  v_bfe_u32 v41, v40, 1, 1
  v_lshl_or_b32 v42, v41, 1, v42
  v_bfe_u32 v41, v40, 4, 1
  v_lshl_or_b32 v42, v41, 2, v42
  s_lshl_b32 s8, s4, 1
  v_xor_b32 v42, s8, v42
  v_lshlrev_b32 v42, 5, v42
  v_lshl_add_u32 v32, v40, 8, v42
  v_and_b32 v41, 3, v0
  v_lshl_add_u32 v32, v41, 3, v32
  v_xor_b32 v33, 32, v32
  v_add_u32 v34, 0x10000, v32
  v_add_u32 v35, 0x10000, v33
  s_waitcnt vmcnt(0)
  s_barrier
  ds_read_b64_tr_b16 a[0:1], v32 offset:0
  ds_read_b64_tr_b16 a[2:3], v32 offset:1024
  ds_read_b64_tr_b16 a[4:5], v33 offset:0
  ds_read_b64_tr_b16 a[6:7], v33 offset:1024
  ds_read_b64_tr_b16 a[8:9], v32 offset:2048
  ds_read_b64_tr_b16 a[10:11], v32 offset:3072
  ds_read_b64_tr_b16 a[12:13], v33 offset:2048
  ds_read_b64_tr_b16 a[14:15], v33 offset:3072
  s_waitcnt lgkmcnt(0)
  s_barrier
  s_add_u32 m0, s63, 16384
  s_add_u32 s60, s44, 229376
  s_addc_u32 s61, s45, 0
  global_load_lds_dwordx4 v24, s[60:61] offset:0
  global_load_lds_dwordx4 v25, s[60:61] offset:1024
  global_load_lds_dwordx4 v26, s[60:61] offset:2048
  global_load_lds_dwordx4 v27, s[60:61] offset:3072
  s_waitcnt vmcnt(0)
  s_barrier
  ds_read_b64_tr_b16 a[16:17], v32 offset:16384
  ds_read_b64_tr_b16 a[18:19], v32 offset:17408
  ds_read_b64_tr_b16 a[20:21], v33 offset:16384
  ds_read_b64_tr_b16 a[22:23], v33 offset:17408
  ds_read_b64_tr_b16 a[24:25], v32 offset:18432
  ds_read_b64_tr_b16 a[26:27], v32 offset:19456
  ds_read_b64_tr_b16 a[28:29], v33 offset:18432
  ds_read_b64_tr_b16 a[30:31], v33 offset:19456
  s_waitcnt lgkmcnt(0)
  s_barrier
  s_add_u32 m0, s63, 32768
  s_add_u32 s60, s44, 458752
  s_addc_u32 s61, s45, 0
  global_load_lds_dwordx4 v24, s[60:61] offset:0
  global_load_lds_dwordx4 v25, s[60:61] offset:1024
  global_load_lds_dwordx4 v26, s[60:61] offset:2048
  global_load_lds_dwordx4 v27, s[60:61] offset:3072
  s_waitcnt vmcnt(0)
  s_barrier
  ds_read_b64_tr_b16 a[32:33], v32 offset:32768
  ds_read_b64_tr_b16 a[34:35], v32 offset:33792
  ds_read_b64_tr_b16 a[36:37], v33 offset:32768
  ds_read_b64_tr_b16 a[38:39], v33 offset:33792
  ds_read_b64_tr_b16 a[40:41], v32 offset:34816
  ds_read_b64_tr_b16 a[42:43], v32 offset:35840
  ds_read_b64_tr_b16 a[44:45], v33 offset:34816
  ds_read_b64_tr_b16 a[46:47], v33 offset:35840
  s_waitcnt lgkmcnt(0)
  s_barrier
  s_add_u32 m0, s63, 49152
  s_add_u32 s60, s44, 688128
  s_addc_u32 s61, s45, 0
  global_load_lds_dwordx4 v24, s[60:61] offset:0
  global_load_lds_dwordx4 v25, s[60:61] offset:1024
  global_load_lds_dwordx4 v26, s[60:61] offset:2048
  global_load_lds_dwordx4 v27, s[60:61] offset:3072
  s_waitcnt vmcnt(0)
  s_barrier
  ds_read_b64_tr_b16 a[48:49], v32 offset:49152
  ds_read_b64_tr_b16 a[50:51], v32 offset:50176
  ds_read_b64_tr_b16 a[52:53], v33 offset:49152
  ds_read_b64_tr_b16 a[54:55], v33 offset:50176
  ds_read_b64_tr_b16 a[56:57], v32 offset:51200
  ds_read_b64_tr_b16 a[58:59], v32 offset:52224
  ds_read_b64_tr_b16 a[60:61], v33 offset:51200
  ds_read_b64_tr_b16 a[62:63], v33 offset:52224
  s_waitcnt lgkmcnt(0)
  s_barrier
  s_add_u32 m0, s63, 65536
  s_add_u32 s60, s44, 917504
  s_addc_u32 s61, s45, 0
  global_load_lds_dwordx4 v24, s[60:61] offset:0
  global_load_lds_dwordx4 v25, s[60:61] offset:1024
  global_load_lds_dwordx4 v26, s[60:61] offset:2048
  global_load_lds_dwordx4 v27, s[60:61] offset:3072
  s_waitcnt vmcnt(0)
  s_barrier
  ds_read_b64_tr_b16 a[64:65], v34 offset:0
  ds_read_b64_tr_b16 a[66:67], v34 offset:1024
  ds_read_b64_tr_b16 a[68:69], v35 offset:0
  ds_read_b64_tr_b16 a[70:71], v35 offset:1024
  ds_read_b64_tr_b16 a[72:73], v34 offset:2048
  ds_read_b64_tr_b16 a[74:75], v34 offset:3072
  ds_read_b64_tr_b16 a[76:77], v35 offset:2048
  ds_read_b64_tr_b16 a[78:79], v35 offset:3072
  s_waitcnt lgkmcnt(0)
  s_barrier
  s_add_u32 m0, s63, 81920
  s_add_u32 s60, s44, 1146880
  s_addc_u32 s61, s45, 0
  global_load_lds_dwordx4 v24, s[60:61] offset:0
  global_load_lds_dwordx4 v25, s[60:61] offset:1024
  global_load_lds_dwordx4 v26, s[60:61] offset:2048
  global_load_lds_dwordx4 v27, s[60:61] offset:3072
  s_waitcnt vmcnt(0)
  s_barrier
  ds_read_b64_tr_b16 a[80:81], v34 offset:16384
  ds_read_b64_tr_b16 a[82:83], v34 offset:17408
  ds_read_b64_tr_b16 a[84:85], v35 offset:16384
  ds_read_b64_tr_b16 a[86:87], v35 offset:17408
  ds_read_b64_tr_b16 a[88:89], v34 offset:18432
  ds_read_b64_tr_b16 a[90:91], v34 offset:19456
  ds_read_b64_tr_b16 a[92:93], v35 offset:18432
  ds_read_b64_tr_b16 a[94:95], v35 offset:19456
  s_waitcnt lgkmcnt(0)
  s_barrier
  s_add_u32 m0, s63, 98304
  s_add_u32 s60, s44, 1376256
  s_addc_u32 s61, s45, 0
  global_load_lds_dwordx4 v24, s[60:61] offset:0
  global_load_lds_dwordx4 v25, s[60:61] offset:1024
  global_load_lds_dwordx4 v26, s[60:61] offset:2048
  global_load_lds_dwordx4 v27, s[60:61] offset:3072
  s_waitcnt vmcnt(0)
  s_barrier
  ds_read_b64_tr_b16 a[96:97], v34 offset:32768
  ds_read_b64_tr_b16 a[98:99], v34 offset:33792
  ds_read_b64_tr_b16 a[100:101], v35 offset:32768
  ds_read_b64_tr_b16 a[102:103], v35 offset:33792
  ds_read_b64_tr_b16 a[104:105], v34 offset:34816
  ds_read_b64_tr_b16 a[106:107], v34 offset:35840
  ds_read_b64_tr_b16 a[108:109], v35 offset:34816
  ds_read_b64_tr_b16 a[110:111], v35 offset:35840
  s_waitcnt lgkmcnt(0)
  s_barrier
  s_add_u32 m0, s63, 114688
  s_add_u32 s60, s44, 1605632
  s_addc_u32 s61, s45, 0
  global_load_lds_dwordx4 v24, s[60:61] offset:0
  global_load_lds_dwordx4 v25, s[60:61] offset:1024
  global_load_lds_dwordx4 v26, s[60:61] offset:2048
  global_load_lds_dwordx4 v27, s[60:61] offset:3072
  s_waitcnt vmcnt(0)
  s_barrier
  ds_read_b64_tr_b16 a[112:113], v34 offset:49152
  ds_read_b64_tr_b16 a[114:115], v34 offset:50176
  ds_read_b64_tr_b16 a[116:117], v35 offset:49152
  ds_read_b64_tr_b16 a[118:119], v35 offset:50176
  ds_read_b64_tr_b16 a[120:121], v34 offset:51200
  ds_read_b64_tr_b16 a[122:123], v34 offset:52224
  ds_read_b64_tr_b16 a[124:125], v35 offset:51200
  ds_read_b64_tr_b16 a[126:127], v35 offset:52224
  s_waitcnt lgkmcnt(0)
  s_barrier
  s_add_u32 m0, s63, 0
  s_add_u32 s60, s46, 0
  s_addc_u32 s61, s47, 0
  global_load_lds_dwordx4 v24, s[60:61] offset:0
  global_load_lds_dwordx4 v25, s[60:61] offset:1024
  global_load_lds_dwordx4 v26, s[60:61] offset:2048
  global_load_lds_dwordx4 v27, s[60:61] offset:3072
  s_waitcnt vmcnt(0)
  s_barrier
  ds_read_b64_tr_b16 a[128:129], v32 offset:0
  ds_read_b64_tr_b16 a[130:131], v32 offset:1024
  ds_read_b64_tr_b16 a[132:133], v33 offset:0
  ds_read_b64_tr_b16 a[134:135], v33 offset:1024
  ds_read_b64_tr_b16 a[136:137], v32 offset:2048
  ds_read_b64_tr_b16 a[138:139], v32 offset:3072
  ds_read_b64_tr_b16 a[140:141], v33 offset:2048
  ds_read_b64_tr_b16 a[142:143], v33 offset:3072
  s_waitcnt lgkmcnt(0)
  s_barrier
  s_add_u32 m0, s63, 16384
  s_add_u32 s60, s46, 229376
  s_addc_u32 s61, s47, 0
  global_load_lds_dwordx4 v24, s[60:61] offset:0
  global_load_lds_dwordx4 v25, s[60:61] offset:1024
  global_load_lds_dwordx4 v26, s[60:61] offset:2048
  global_load_lds_dwordx4 v27, s[60:61] offset:3072
  s_waitcnt vmcnt(0)
  s_barrier
  ds_read_b64_tr_b16 a[144:145], v32 offset:16384
  ds_read_b64_tr_b16 a[146:147], v32 offset:17408
  ds_read_b64_tr_b16 a[148:149], v33 offset:16384
  ds_read_b64_tr_b16 a[150:151], v33 offset:17408
  ds_read_b64_tr_b16 a[152:153], v32 offset:18432
  ds_read_b64_tr_b16 a[154:155], v32 offset:19456
  ds_read_b64_tr_b16 a[156:157], v33 offset:18432
  ds_read_b64_tr_b16 a[158:159], v33 offset:19456
  s_waitcnt lgkmcnt(0)
  s_barrier
  s_add_u32 m0, s63, 32768
  s_add_u32 s60, s46, 458752
  s_addc_u32 s61, s47, 0
  global_load_lds_dwordx4 v24, s[60:61] offset:0
  global_load_lds_dwordx4 v25, s[60:61] offset:1024
  global_load_lds_dwordx4 v26, s[60:61] offset:2048
  global_load_lds_dwordx4 v27, s[60:61] offset:3072
  s_waitcnt vmcnt(0)
  s_barrier
  ds_read_b64_tr_b16 a[160:161], v32 offset:32768
  ds_read_b64_tr_b16 a[162:163], v32 offset:33792
  ds_read_b64_tr_b16 a[164:165], v33 offset:32768
  ds_read_b64_tr_b16 a[166:167], v33 offset:33792
  ds_read_b64_tr_b16 a[168:169], v32 offset:34816
  ds_read_b64_tr_b16 a[170:171], v32 offset:35840
  ds_read_b64_tr_b16 a[172:173], v33 offset:34816
  ds_read_b64_tr_b16 a[174:175], v33 offset:35840
  s_waitcnt lgkmcnt(0)
  s_barrier
  s_add_u32 m0, s63, 49152
  s_add_u32 s60, s46, 688128
  s_addc_u32 s61, s47, 0
  global_load_lds_dwordx4 v24, s[60:61] offset:0
  global_load_lds_dwordx4 v25, s[60:61] offset:1024
  global_load_lds_dwordx4 v26, s[60:61] offset:2048
  global_load_lds_dwordx4 v27, s[60:61] offset:3072
  s_waitcnt vmcnt(0)
  s_barrier
  ds_read_b64_tr_b16 a[176:177], v32 offset:49152
  ds_read_b64_tr_b16 a[178:179], v32 offset:50176
  ds_read_b64_tr_b16 a[180:181], v33 offset:49152
  ds_read_b64_tr_b16 a[182:183], v33 offset:50176
  ds_read_b64_tr_b16 a[184:185], v32 offset:51200
  ds_read_b64_tr_b16 a[186:187], v32 offset:52224
  ds_read_b64_tr_b16 a[188:189], v33 offset:51200
  ds_read_b64_tr_b16 a[190:191], v33 offset:52224
  s_waitcnt lgkmcnt(0)
  s_barrier
  s_add_u32 m0, s63, 65536
  s_add_u32 s60, s46, 917504
  s_addc_u32 s61, s47, 0
  global_load_lds_dwordx4 v24, s[60:61] offset:0
  global_load_lds_dwordx4 v25, s[60:61] offset:1024
  global_load_lds_dwordx4 v26, s[60:61] offset:2048
  global_load_lds_dwordx4 v27, s[60:61] offset:3072
  s_waitcnt vmcnt(0)
  s_barrier
  ds_read_b64_tr_b16 a[192:193], v34 offset:0
  ds_read_b64_tr_b16 a[194:195], v34 offset:1024
  ds_read_b64_tr_b16 a[196:197], v35 offset:0
  ds_read_b64_tr_b16 a[198:199], v35 offset:1024
  ds_read_b64_tr_b16 a[200:201], v34 offset:2048
  ds_read_b64_tr_b16 a[202:203], v34 offset:3072
  ds_read_b64_tr_b16 a[204:205], v35 offset:2048
  ds_read_b64_tr_b16 a[206:207], v35 offset:3072
  s_waitcnt lgkmcnt(0)
  s_barrier
  s_add_u32 m0, s63, 81920
  s_add_u32 s60, s46, 1146880
  s_addc_u32 s61, s47, 0
  global_load_lds_dwordx4 v24, s[60:61] offset:0
  global_load_lds_dwordx4 v25, s[60:61] offset:1024
  global_load_lds_dwordx4 v26, s[60:61] offset:2048
  global_load_lds_dwordx4 v27, s[60:61] offset:3072
  s_waitcnt vmcnt(0)
  s_barrier
  ds_read_b64_tr_b16 a[208:209], v34 offset:16384
  ds_read_b64_tr_b16 a[210:211], v34 offset:17408
  ds_read_b64_tr_b16 a[212:213], v35 offset:16384
  ds_read_b64_tr_b16 a[214:215], v35 offset:17408
  ds_read_b64_tr_b16 a[216:217], v34 offset:18432
  ds_read_b64_tr_b16 a[218:219], v34 offset:19456
  ds_read_b64_tr_b16 a[220:221], v35 offset:18432
  ds_read_b64_tr_b16 a[222:223], v35 offset:19456
  s_waitcnt lgkmcnt(0)
  s_barrier
  s_add_u32 m0, s63, 98304
  s_add_u32 s60, s46, 1376256
  s_addc_u32 s61, s47, 0
  global_load_lds_dwordx4 v24, s[60:61] offset:0
  global_load_lds_dwordx4 v25, s[60:61] offset:1024
  global_load_lds_dwordx4 v26, s[60:61] offset:2048
  global_load_lds_dwordx4 v27, s[60:61] offset:3072
  s_waitcnt vmcnt(0)
  s_barrier
  ds_read_b64_tr_b16 a[224:225], v34 offset:32768
  ds_read_b64_tr_b16 a[226:227], v34 offset:33792
  ds_read_b64_tr_b16 a[228:229], v35 offset:32768
  ds_read_b64_tr_b16 a[230:231], v35 offset:33792
  ds_read_b64_tr_b16 a[232:233], v34 offset:34816
  ds_read_b64_tr_b16 a[234:235], v34 offset:35840
  ds_read_b64_tr_b16 a[236:237], v35 offset:34816
  ds_read_b64_tr_b16 a[238:239], v35 offset:35840
  s_waitcnt lgkmcnt(0)
  s_barrier
  s_add_u32 m0, s63, 114688
  s_add_u32 s60, s46, 1605632
  s_addc_u32 s61, s47, 0
  global_load_lds_dwordx4 v24, s[60:61] offset:0
  global_load_lds_dwordx4 v25, s[60:61] offset:1024
  global_load_lds_dwordx4 v26, s[60:61] offset:2048
  global_load_lds_dwordx4 v27, s[60:61] offset:3072
  s_waitcnt vmcnt(0)
  s_barrier
  ds_read_b64_tr_b16 a[240:241], v34 offset:49152
  ds_read_b64_tr_b16 a[242:243], v34 offset:50176
  ds_read_b64_tr_b16 a[244:245], v35 offset:49152
  ds_read_b64_tr_b16 a[246:247], v35 offset:50176
  ds_read_b64_tr_b16 a[248:249], v34 offset:51200
  ds_read_b64_tr_b16 a[250:251], v34 offset:52224
  ds_read_b64_tr_b16 a[252:253], v35 offset:51200
  ds_read_b64_tr_b16 a[254:255], v35 offset:52224
  s_waitcnt lgkmcnt(0)
  s_barrier
  v_mov_b32 v3, 1
  s_cmp_lg_u32 s4, 0
  s_cbranch_scc1 Lw1_20
Lww_21:
  global_load_dword v4, v2, s[40:41] offset:164 sc1
  s_waitcnt vmcnt(0)
  v_cmp_gt_u32 vcc, 64, v4
  s_cbranch_vccz Lwd_22
  s_sleep 4
  s_sub_u32 s7, s7, 1
  s_cbranch_scc0 Lww_21
  s_mov_b32 s7, 0
Lwd_22:
Lw1_20:
  s_barrier
  v_mov_b32 v8, -1
  v_mov_b32 v9, -1
  v_mov_b32 v10, -1
  v_mov_b32 v11, -1
  s_mov_b32 s58, 0
  s_lshl_b32 s8, s5, 8
  s_lshl_b32 s9, s4, 2
  s_add_u32 s8, s8, s9
  s_add_u32 s8, s8, 172032
  s_add_u32 s56, s42, s8
  s_addc_u32 s57, s43, 0
  s_min_u32 s60, s48, 63
  s_lshl_b32 s60, s60, 15
  s_lshl_b32 s61, s4, 13
  s_add_u32 s60, s60, s61
  s_add_u32 s60, s60, 1048576
  s_add_u32 s50, s42, s60
  s_addc_u32 s51, s43, 0
  s_add_u32 m0, s61, s58
  s_nop 0
  global_load_lds_dwordx4 v1, s[50:51] offset:0
  global_load_lds_dwordx4 v1, s[50:51] offset:1024
  global_load_lds_dwordx4 v1, s[50:51] offset:2048
  global_load_lds_dwordx4 v1, s[50:51] offset:3072
  s_add_u32 s50, s50, 4096
  s_addc_u32 s51, s51, 0
  s_add_u32 m0, m0, 4096
  s_nop 0
  global_load_lds_dwordx4 v1, s[50:51] offset:0
  global_load_lds_dwordx4 v1, s[50:51] offset:1024
  global_load_lds_dwordx4 v1, s[50:51] offset:2048
  global_load_lds_dwordx4 v1, s[50:51] offset:3072
  v_mov_b32 v6, v1
  s_waitcnt vmcnt(0)
L_GU_loop:
  s_waitcnt vmcnt(3)
  s_barrier
  s_add_u32 s59, s48, s49
  s_xor_b32 s58, s58, 0x8000
  s_min_u32 s60, s59, 63
  s_lshl_b32 s60, s60, 15
  s_lshl_b32 s61, s4, 13
  s_add_u32 s60, s60, s61
  s_add_u32 s60, s60, 1048576
  s_add_u32 s50, s42, s60
  s_addc_u32 s51, s43, 0
  s_add_u32 m0, s61, s58
  s_nop 0
  global_load_lds_dwordx4 v1, s[50:51] offset:0
  global_load_lds_dwordx4 v1, s[50:51] offset:1024
  global_load_lds_dwordx4 v1, s[50:51] offset:2048
  global_load_lds_dwordx4 v1, s[50:51] offset:3072
  s_add_u32 s50, s50, 4096
  s_addc_u32 s51, s51, 0
  s_add_u32 m0, m0, 4096
  s_nop 0
  global_load_lds_dwordx4 v1, s[50:51] offset:0
  global_load_lds_dwordx4 v1, s[50:51] offset:1024
  global_load_lds_dwordx4 v1, s[50:51] offset:2048
  global_load_lds_dwordx4 v1, s[50:51] offset:3072
  ds_read_b128 v[16:19], v6 offset:0
  ds_read_b128 v[20:23], v6 offset:1024
  ds_read_b128 v[24:27], v6 offset:2048
  ds_read_b128 v[28:31], v6 offset:3072
  ds_read_b128 v[32:35], v6 offset:4096
  ds_read_b128 v[36:39], v6 offset:5120
  ds_read_b128 v[40:43], v6 offset:6144
  ds_read_b128 v[44:47], v6 offset:7168
  s_waitcnt lgkmcnt(6)
  v_mfma_f32_16x16x32_bf16 v[64:67], a[0:3], v[16:19], 0
  v_mfma_f32_16x16x32_bf16 v[68:71], a[0:3], v[20:23], 0
  v_mfma_f32_16x16x32_bf16 v[72:75], a[4:7], v[16:19], 0
  v_mfma_f32_16x16x32_bf16 v[76:79], a[4:7], v[20:23], 0
  v_mfma_f32_16x16x32_bf16 v[80:83], a[128:131], v[16:19], 0
  v_mfma_f32_16x16x32_bf16 v[84:87], a[128:131], v[20:23], 0
  v_mfma_f32_16x16x32_bf16 v[88:91], a[132:135], v[16:19], 0
  v_mfma_f32_16x16x32_bf16 v[92:95], a[132:135], v[20:23], 0
  ds_read_b128 v[16:19], v6 offset:8192
  ds_read_b128 v[20:23], v6 offset:9216
  s_waitcnt lgkmcnt(6)
  v_mfma_f32_16x16x32_bf16 v[64:67], a[8:11], v[24:27], v[64:67]
  v_mfma_f32_16x16x32_bf16 v[68:71], a[8:11], v[28:31], v[68:71]
  v_mfma_f32_16x16x32_bf16 v[72:75], a[12:15], v[24:27], v[72:75]
  v_mfma_f32_16x16x32_bf16 v[76:79], a[12:15], v[28:31], v[76:79]
  v_mfma_f32_16x16x32_bf16 v[80:83], a[136:139], v[24:27], v[80:83]
  v_mfma_f32_16x16x32_bf16 v[84:87], a[136:139], v[28:31], v[84:87]
  v_mfma_f32_16x16x32_bf16 v[88:91], a[140:143], v[24:27], v[88:91]
  v_mfma_f32_16x16x32_bf16 v[92:95], a[140:143], v[28:31], v[92:95]
  ds_read_b128 v[24:27], v6 offset:10240
  ds_read_b128 v[28:31], v6 offset:11264
  s_waitcnt lgkmcnt(6)
  v_mfma_f32_16x16x32_bf16 v[64:67], a[16:19], v[32:35], v[64:67]
  v_mfma_f32_16x16x32_bf16 v[68:71], a[16:19], v[36:39], v[68:71]
  v_mfma_f32_16x16x32_bf16 v[72:75], a[20:23], v[32:35], v[72:75]
  v_mfma_f32_16x16x32_bf16 v[76:79], a[20:23], v[36:39], v[76:79]
  v_mfma_f32_16x16x32_bf16 v[80:83], a[144:147], v[32:35], v[80:83]
  v_mfma_f32_16x16x32_bf16 v[84:87], a[144:147], v[36:39], v[84:87]
  v_mfma_f32_16x16x32_bf16 v[88:91], a[148:151], v[32:35], v[88:91]
  v_mfma_f32_16x16x32_bf16 v[92:95], a[148:151], v[36:39], v[92:95]
  ds_read_b128 v[32:35], v6 offset:12288
  ds_read_b128 v[36:39], v6 offset:13312
  s_waitcnt lgkmcnt(6)
  v_mfma_f32_16x16x32_bf16 v[64:67], a[24:27], v[40:43], v[64:67]
  v_mfma_f32_16x16x32_bf16 v[68:71], a[24:27], v[44:47], v[68:71]
  v_mfma_f32_16x16x32_bf16 v[72:75], a[28:31], v[40:43], v[72:75]
  v_mfma_f32_16x16x32_bf16 v[76:79], a[28:31], v[44:47], v[76:79]
  v_mfma_f32_16x16x32_bf16 v[80:83], a[152:155], v[40:43], v[80:83]
  v_mfma_f32_16x16x32_bf16 v[84:87], a[152:155], v[44:47], v[84:87]
  v_mfma_f32_16x16x32_bf16 v[88:91], a[156:159], v[40:43], v[88:91]
  v_mfma_f32_16x16x32_bf16 v[92:95], a[156:159], v[44:47], v[92:95]
  ds_read_b128 v[40:43], v6 offset:14336
  ds_read_b128 v[44:47], v6 offset:15360
  s_waitcnt lgkmcnt(6)
  v_mfma_f32_16x16x32_bf16 v[64:67], a[32:35], v[16:19], v[64:67]
  v_mfma_f32_16x16x32_bf16 v[68:71], a[32:35], v[20:23], v[68:71]
  v_mfma_f32_16x16x32_bf16 v[72:75], a[36:39], v[16:19], v[72:75]
  v_mfma_f32_16x16x32_bf16 v[76:79], a[36:39], v[20:23], v[76:79]
  v_mfma_f32_16x16x32_bf16 v[80:83], a[160:163], v[16:19], v[80:83]
  v_mfma_f32_16x16x32_bf16 v[84:87], a[160:163], v[20:23], v[84:87]
  v_mfma_f32_16x16x32_bf16 v[88:91], a[164:167], v[16:19], v[88:91]
  v_mfma_f32_16x16x32_bf16 v[92:95], a[164:167], v[20:23], v[92:95]
  ds_read_b128 v[16:19], v6 offset:16384
  ds_read_b128 v[20:23], v6 offset:17408
  s_waitcnt lgkmcnt(6)
  v_mfma_f32_16x16x32_bf16 v[64:67], a[40:43], v[24:27], v[64:67]
  v_mfma_f32_16x16x32_bf16 v[68:71], a[40:43], v[28:31], v[68:71]
  v_mfma_f32_16x16x32_bf16 v[72:75], a[44:47], v[24:27], v[72:75]
  v_mfma_f32_16x16x32_bf16 v[76:79], a[44:47], v[28:31], v[76:79]
  v_mfma_f32_16x16x32_bf16 v[80:83], a[168:171], v[24:27], v[80:83]
  v_mfma_f32_16x16x32_bf16 v[84:87], a[168:171], v[28:31], v[84:87]
  v_mfma_f32_16x16x32_bf16 v[88:91], a[172:175], v[24:27], v[88:91]
  v_mfma_f32_16x16x32_bf16 v[92:95], a[172:175], v[28:31], v[92:95]
  ds_read_b128 v[24:27], v6 offset:18432
  ds_read_b128 v[28:31], v6 offset:19456
  s_waitcnt lgkmcnt(6)
  v_mfma_f32_16x16x32_bf16 v[64:67], a[48:51], v[32:35], v[64:67]
  v_mfma_f32_16x16x32_bf16 v[68:71], a[48:51], v[36:39], v[68:71]
  v_mfma_f32_16x16x32_bf16 v[72:75], a[52:55], v[32:35], v[72:75]
  v_mfma_f32_16x16x32_bf16 v[76:79], a[52:55], v[36:39], v[76:79]
  v_mfma_f32_16x16x32_bf16 v[80:83], a[176:179], v[32:35], v[80:83]
  v_mfma_f32_16x16x32_bf16 v[84:87], a[176:179], v[36:39], v[84:87]
  v_mfma_f32_16x16x32_bf16 v[88:91], a[180:183], v[32:35], v[88:91]
  v_mfma_f32_16x16x32_bf16 v[92:95], a[180:183], v[36:39], v[92:95]
  ds_read_b128 v[32:35], v6 offset:20480
  ds_read_b128 v[36:39], v6 offset:21504
  s_waitcnt lgkmcnt(6)
  v_mfma_f32_16x16x32_bf16 v[64:67], a[56:59], v[40:43], v[64:67]
  v_mfma_f32_16x16x32_bf16 v[68:71], a[56:59], v[44:47], v[68:71]
  v_mfma_f32_16x16x32_bf16 v[72:75], a[60:63], v[40:43], v[72:75]
  v_mfma_f32_16x16x32_bf16 v[76:79], a[60:63], v[44:47], v[76:79]
  v_mfma_f32_16x16x32_bf16 v[80:83], a[184:187], v[40:43], v[80:83]
  v_mfma_f32_16x16x32_bf16 v[84:87], a[184:187], v[44:47], v[84:87]
  v_mfma_f32_16x16x32_bf16 v[88:91], a[188:191], v[40:43], v[88:91]
  v_mfma_f32_16x16x32_bf16 v[92:95], a[188:191], v[44:47], v[92:95]
  ds_read_b128 v[40:43], v6 offset:22528
  ds_read_b128 v[44:47], v6 offset:23552
  s_waitcnt lgkmcnt(6)
  s_waitcnt vmcnt(8)
  global_store_dword v2, v3, s[56:57] sc1
  v_mfma_f32_16x16x32_bf16 v[64:67], a[64:67], v[16:19], v[64:67]
  v_mfma_f32_16x16x32_bf16 v[68:71], a[64:67], v[20:23], v[68:71]
  v_mfma_f32_16x16x32_bf16 v[72:75], a[68:71], v[16:19], v[72:75]
  v_mfma_f32_16x16x32_bf16 v[76:79], a[68:71], v[20:23], v[76:79]
  v_mfma_f32_16x16x32_bf16 v[80:83], a[192:195], v[16:19], v[80:83]
  v_mfma_f32_16x16x32_bf16 v[84:87], a[192:195], v[20:23], v[84:87]
  v_mfma_f32_16x16x32_bf16 v[88:91], a[196:199], v[16:19], v[88:91]
  v_mfma_f32_16x16x32_bf16 v[92:95], a[196:199], v[20:23], v[92:95]
  ds_read_b128 v[16:19], v6 offset:24576
  ds_read_b128 v[20:23], v6 offset:25600
  s_waitcnt lgkmcnt(6)
  v_mfma_f32_16x16x32_bf16 v[64:67], a[72:75], v[24:27], v[64:67]
  v_mfma_f32_16x16x32_bf16 v[68:71], a[72:75], v[28:31], v[68:71]
  v_mfma_f32_16x16x32_bf16 v[72:75], a[76:79], v[24:27], v[72:75]
  v_mfma_f32_16x16x32_bf16 v[76:79], a[76:79], v[28:31], v[76:79]
  v_mfma_f32_16x16x32_bf16 v[80:83], a[200:203], v[24:27], v[80:83]
  v_mfma_f32_16x16x32_bf16 v[84:87], a[200:203], v[28:31], v[84:87]
  v_mfma_f32_16x16x32_bf16 v[88:91], a[204:207], v[24:27], v[88:91]
  v_mfma_f32_16x16x32_bf16 v[92:95], a[204:207], v[28:31], v[92:95]
  ds_read_b128 v[24:27], v6 offset:26624
  ds_read_b128 v[28:31], v6 offset:27648
  s_waitcnt lgkmcnt(6)
  v_mfma_f32_16x16x32_bf16 v[64:67], a[80:83], v[32:35], v[64:67]
  v_mfma_f32_16x16x32_bf16 v[68:71], a[80:83], v[36:39], v[68:71]
  v_mfma_f32_16x16x32_bf16 v[72:75], a[84:87], v[32:35], v[72:75]
  v_mfma_f32_16x16x32_bf16 v[76:79], a[84:87], v[36:39], v[76:79]
  v_mfma_f32_16x16x32_bf16 v[80:83], a[208:211], v[32:35], v[80:83]
  v_mfma_f32_16x16x32_bf16 v[84:87], a[208:211], v[36:39], v[84:87]
  v_mfma_f32_16x16x32_bf16 v[88:91], a[212:215], v[32:35], v[88:91]
  v_mfma_f32_16x16x32_bf16 v[92:95], a[212:215], v[36:39], v[92:95]
  ds_read_b128 v[32:35], v6 offset:28672
  ds_read_b128 v[36:39], v6 offset:29696
  s_waitcnt lgkmcnt(6)
  v_mfma_f32_16x16x32_bf16 v[64:67], a[88:91], v[40:43], v[64:67]
  v_mfma_f32_16x16x32_bf16 v[68:71], a[88:91], v[44:47], v[68:71]
  v_mfma_f32_16x16x32_bf16 v[72:75], a[92:95], v[40:43], v[72:75]
  v_mfma_f32_16x16x32_bf16 v[76:79], a[92:95], v[44:47], v[76:79]
  v_mfma_f32_16x16x32_bf16 v[80:83], a[216:219], v[40:43], v[80:83]
  v_mfma_f32_16x16x32_bf16 v[84:87], a[216:219], v[44:47], v[84:87]
  v_mfma_f32_16x16x32_bf16 v[88:91], a[220:223], v[40:43], v[88:91]
  v_mfma_f32_16x16x32_bf16 v[92:95], a[220:223], v[44:47], v[92:95]
  ds_read_b128 v[40:43], v6 offset:30720
  ds_read_b128 v[44:47], v6 offset:31744
  s_waitcnt lgkmcnt(6)
  v_mfma_f32_16x16x32_bf16 v[64:67], a[96:99], v[16:19], v[64:67]
  v_mfma_f32_16x16x32_bf16 v[68:71], a[96:99], v[20:23], v[68:71]
  v_mfma_f32_16x16x32_bf16 v[72:75], a[100:103], v[16:19], v[72:75]
  v_mfma_f32_16x16x32_bf16 v[76:79], a[100:103], v[20:23], v[76:79]
  v_mfma_f32_16x16x32_bf16 v[80:83], a[224:227], v[16:19], v[80:83]
  v_mfma_f32_16x16x32_bf16 v[84:87], a[224:227], v[20:23], v[84:87]
  v_mfma_f32_16x16x32_bf16 v[88:91], a[228:231], v[16:19], v[88:91]
  v_mfma_f32_16x16x32_bf16 v[92:95], a[228:231], v[20:23], v[92:95]
  s_waitcnt lgkmcnt(4)
  v_mfma_f32_16x16x32_bf16 v[64:67], a[104:107], v[24:27], v[64:67]
  v_mfma_f32_16x16x32_bf16 v[68:71], a[104:107], v[28:31], v[68:71]
  v_mfma_f32_16x16x32_bf16 v[72:75], a[108:111], v[24:27], v[72:75]
  v_mfma_f32_16x16x32_bf16 v[76:79], a[108:111], v[28:31], v[76:79]
  v_mfma_f32_16x16x32_bf16 v[80:83], a[232:235], v[24:27], v[80:83]
  v_mfma_f32_16x16x32_bf16 v[84:87], a[232:235], v[28:31], v[84:87]
  v_mfma_f32_16x16x32_bf16 v[88:91], a[236:239], v[24:27], v[88:91]
  v_mfma_f32_16x16x32_bf16 v[92:95], a[236:239], v[28:31], v[92:95]
  s_waitcnt lgkmcnt(2)
  v_mfma_f32_16x16x32_bf16 v[64:67], a[112:115], v[32:35], v[64:67]
  v_mfma_f32_16x16x32_bf16 v[68:71], a[112:115], v[36:39], v[68:71]
  v_mfma_f32_16x16x32_bf16 v[72:75], a[116:119], v[32:35], v[72:75]
  v_mfma_f32_16x16x32_bf16 v[76:79], a[116:119], v[36:39], v[76:79]
  v_mfma_f32_16x16x32_bf16 v[80:83], a[240:243], v[32:35], v[80:83]
  v_mfma_f32_16x16x32_bf16 v[84:87], a[240:243], v[36:39], v[84:87]
  v_mfma_f32_16x16x32_bf16 v[88:91], a[244:247], v[32:35], v[88:91]
  v_mfma_f32_16x16x32_bf16 v[92:95], a[244:247], v[36:39], v[92:95]
  s_waitcnt lgkmcnt(0)
  v_mfma_f32_16x16x32_bf16 v[64:67], a[120:123], v[40:43], v[64:67]
  v_mfma_f32_16x16x32_bf16 v[68:71], a[120:123], v[44:47], v[68:71]
  v_mfma_f32_16x16x32_bf16 v[72:75], a[124:127], v[40:43], v[72:75]
  v_mfma_f32_16x16x32_bf16 v[76:79], a[124:127], v[44:47], v[76:79]
  v_mfma_f32_16x16x32_bf16 v[80:83], a[248:251], v[40:43], v[80:83]
  v_mfma_f32_16x16x32_bf16 v[84:87], a[248:251], v[44:47], v[84:87]
  v_mfma_f32_16x16x32_bf16 v[88:91], a[252:255], v[40:43], v[88:91]
  v_mfma_f32_16x16x32_bf16 v[92:95], a[252:255], v[44:47], v[92:95]
  v_xor_b32 v6, 0x8000, v6
  s_mul_i32 s60, s48, 114688
  s_lshl_b32 s61, s10, 12
  s_add_u32 s60, s60, s61
  s_lshl_b32 s61, s4, 10
  s_add_u32 s60, s60, s61
  s_add_u32 s60, s60, 4194304
  s_add_u32 s52, s42, s60
  s_addc_u32 s53, s43, 0
  s_add_u32 s54, s52, 57344
  s_addc_u32 s55, s53, 0
  s_lshl_b32 s60, s48, 8
  s_lshl_b32 s61, s10, 4
  s_add_u32 s60, s60, s61
  s_lshl_b32 s61, s4, 2
  s_add_u32 s60, s60, s61
  s_add_u32 s60, s60, 155648
  s_add_u32 s56, s42, s60
  s_addc_u32 s57, s43, 0
  s_mov_b32 s60, 0xbfb8aa3b
  s_mov_b32 s61, 0xffff0000
  v_cvt_pk_bf16_f32 v108, v64, v80
  v_cvt_pk_bf16_f32 v109, v65, v81
  v_cvt_pk_bf16_f32 v110, v66, v82
  v_cvt_pk_bf16_f32 v111, v67, v83
  v_lshlrev_b32 v64, 16, v108
  v_lshlrev_b32 v65, 16, v109
  v_lshlrev_b32 v66, 16, v110
  v_lshlrev_b32 v67, 16, v111
  v_and_b32 v80, s61, v108
  v_and_b32 v81, s61, v109
  v_and_b32 v82, s61, v110
  v_and_b32 v83, s61, v111
  v_mul_f32 v108, s60, v64
  v_mul_f32 v109, s60, v65
  v_mul_f32 v110, s60, v66
  v_mul_f32 v111, s60, v67
  v_exp_f32 v108, v108
  v_exp_f32 v109, v109
  v_exp_f32 v110, v110
  v_exp_f32 v111, v111
  v_add_f32 v108, 1.0, v108
  v_add_f32 v109, 1.0, v109
  v_add_f32 v110, 1.0, v110
  v_add_f32 v111, 1.0, v111
  v_rcp_f32 v108, v108
  v_rcp_f32 v109, v109
  v_rcp_f32 v110, v110
  v_rcp_f32 v111, v111
  v_mul_f32 v64, v64, v108
  v_mul_f32 v65, v65, v109
  v_mul_f32 v66, v66, v110
  v_mul_f32 v67, v67, v111
  v_cvt_pk_bf16_f32 v108, v64, v65
  v_cvt_pk_bf16_f32 v109, v66, v67
  v_lshlrev_b32 v64, 16, v108
  v_and_b32 v65, s61, v108
  v_lshlrev_b32 v66, 16, v109
  v_and_b32 v67, s61, v109
  v_mul_f32 v64, v64, v80
  v_mul_f32 v65, v65, v81
  v_mul_f32 v66, v66, v82
  v_mul_f32 v67, v67, v83
  v_cvt_pk_bf16_f32 v100, v64, v65
  v_cvt_pk_bf16_f32 v101, v66, v67
  v_cvt_pk_bf16_f32 v108, v72, v88
  v_cvt_pk_bf16_f32 v109, v73, v89
  v_cvt_pk_bf16_f32 v110, v74, v90
  v_cvt_pk_bf16_f32 v111, v75, v91
  v_lshlrev_b32 v72, 16, v108
  v_lshlrev_b32 v73, 16, v109
  v_lshlrev_b32 v74, 16, v110
  v_lshlrev_b32 v75, 16, v111
  v_and_b32 v88, s61, v108
  v_and_b32 v89, s61, v109
  v_and_b32 v90, s61, v110
  v_and_b32 v91, s61, v111
  v_mul_f32 v108, s60, v72
  v_mul_f32 v109, s60, v73
  v_mul_f32 v110, s60, v74
  v_mul_f32 v111, s60, v75
  v_exp_f32 v108, v108
  v_exp_f32 v109, v109
  v_exp_f32 v110, v110
  v_exp_f32 v111, v111
  v_add_f32 v108, 1.0, v108
  v_add_f32 v109, 1.0, v109
  v_add_f32 v110, 1.0, v110
  v_add_f32 v111, 1.0, v111
  v_rcp_f32 v108, v108
  v_rcp_f32 v109, v109
  v_rcp_f32 v110, v110
  v_rcp_f32 v111, v111
  v_mul_f32 v72, v72, v108
  v_mul_f32 v73, v73, v109
  v_mul_f32 v74, v74, v110
  v_mul_f32 v75, v75, v111
  v_cvt_pk_bf16_f32 v108, v72, v73
  v_cvt_pk_bf16_f32 v109, v74, v75
  v_lshlrev_b32 v72, 16, v108
  v_and_b32 v73, s61, v108
  v_lshlrev_b32 v74, 16, v109
  v_and_b32 v75, s61, v109
  v_mul_f32 v72, v72, v88
  v_mul_f32 v73, v73, v89
  v_mul_f32 v74, v74, v90
  v_mul_f32 v75, v75, v91
  v_cvt_pk_bf16_f32 v102, v72, v73
  v_cvt_pk_bf16_f32 v103, v74, v75
  global_store_dwordx4 v1, v[100:103], s[52:53] sc1
  v_cvt_pk_bf16_f32 v108, v68, v84
  v_cvt_pk_bf16_f32 v109, v69, v85
  v_cvt_pk_bf16_f32 v110, v70, v86
  v_cvt_pk_bf16_f32 v111, v71, v87
  v_lshlrev_b32 v68, 16, v108
  v_lshlrev_b32 v69, 16, v109
  v_lshlrev_b32 v70, 16, v110
  v_lshlrev_b32 v71, 16, v111
  v_and_b32 v84, s61, v108
  v_and_b32 v85, s61, v109
  v_and_b32 v86, s61, v110
  v_and_b32 v87, s61, v111
  v_mul_f32 v108, s60, v68
  v_mul_f32 v109, s60, v69
  v_mul_f32 v110, s60, v70
  v_mul_f32 v111, s60, v71
  v_exp_f32 v108, v108
  v_exp_f32 v109, v109
  v_exp_f32 v110, v110
  v_exp_f32 v111, v111
  v_add_f32 v108, 1.0, v108
  v_add_f32 v109, 1.0, v109
  v_add_f32 v110, 1.0, v110
  v_add_f32 v111, 1.0, v111
  v_rcp_f32 v108, v108
  v_rcp_f32 v109, v109
  v_rcp_f32 v110, v110
  v_rcp_f32 v111, v111
  v_mul_f32 v68, v68, v108
  v_mul_f32 v69, v69, v109
  v_mul_f32 v70, v70, v110
  v_mul_f32 v71, v71, v111
  v_cvt_pk_bf16_f32 v108, v68, v69
  v_cvt_pk_bf16_f32 v109, v70, v71
  v_lshlrev_b32 v68, 16, v108
  v_and_b32 v69, s61, v108
  v_lshlrev_b32 v70, 16, v109
  v_and_b32 v71, s61, v109
  v_mul_f32 v68, v68, v84
  v_mul_f32 v69, v69, v85
  v_mul_f32 v70, v70, v86
  v_mul_f32 v71, v71, v87
  v_cvt_pk_bf16_f32 v104, v68, v69
  v_cvt_pk_bf16_f32 v105, v70, v71
  v_cvt_pk_bf16_f32 v108, v76, v92
  v_cvt_pk_bf16_f32 v109, v77, v93
  v_cvt_pk_bf16_f32 v110, v78, v94
  v_cvt_pk_bf16_f32 v111, v79, v95
  v_lshlrev_b32 v76, 16, v108
  v_lshlrev_b32 v77, 16, v109
  v_lshlrev_b32 v78, 16, v110
  v_lshlrev_b32 v79, 16, v111
  v_and_b32 v92, s61, v108
  v_and_b32 v93, s61, v109
  v_and_b32 v94, s61, v110
  v_and_b32 v95, s61, v111
  v_mul_f32 v108, s60, v76
  v_mul_f32 v109, s60, v77
  v_mul_f32 v110, s60, v78
  v_mul_f32 v111, s60, v79
  v_exp_f32 v108, v108
  v_exp_f32 v109, v109
  v_exp_f32 v110, v110
  v_exp_f32 v111, v111
  v_add_f32 v108, 1.0, v108
  v_add_f32 v109, 1.0, v109
  v_add_f32 v110, 1.0, v110
  v_add_f32 v111, 1.0, v111
  v_rcp_f32 v108, v108
  v_rcp_f32 v109, v109
  v_rcp_f32 v110, v110
  v_rcp_f32 v111, v111
  v_mul_f32 v76, v76, v108
  v_mul_f32 v77, v77, v109
  v_mul_f32 v78, v78, v110
  v_mul_f32 v79, v79, v111
  v_cvt_pk_bf16_f32 v108, v76, v77
  v_cvt_pk_bf16_f32 v109, v78, v79
  v_lshlrev_b32 v76, 16, v108
  v_and_b32 v77, s61, v108
  v_lshlrev_b32 v78, 16, v109
  v_and_b32 v79, s61, v109
  v_mul_f32 v76, v76, v92
  v_mul_f32 v77, v77, v93
  v_mul_f32 v78, v78, v94
  v_mul_f32 v79, v79, v95
  v_cvt_pk_bf16_f32 v106, v76, v77
  v_cvt_pk_bf16_f32 v107, v78, v79
  global_store_dwordx4 v1, v[104:107], s[54:55] sc1
  s_mov_b32 s48, s59
  s_cmp_lt_u32 s48, 64
  s_cbranch_scc1 L_GU_loop
  s_waitcnt vmcnt(0)
  global_store_dword v2, v3, s[56:57] sc1
  s_branch L_O_help
.p2align 7
L_role_R:
  s_cbranch_execz L_e_wr
  s_lshl_b32 s72, s6, 13
  s_lshl_b32 s77, s4, 12
  s_lshl_b32 s10, s6, 8
  s_lshl_b32 s11, s6, 17
  v_lshrrev_b32 v40, 4, v0
  s_and_b32 s8, s4, 1
  s_lshl_b32 s8, s8, 1
  v_and_b32 v41, 1, v40
  v_or_b32 v41, s8, v41
  v_lshlrev_b32 v41, 1, v41
  v_lshlrev_b32 v41, 1, v41
  v_and_b32 v31, 15, v0
  v_xor_b32 v31, v31, v41
  v_lshlrev_b32 v31, 4, v31
  s_lshl_b32 s8, s4, 4
  v_add_u32 v40, s8, v40
  v_mul_u32_u24 v40, 1024, v40
  v_add_u32 v31, v31, v40
  v_add_u32 v28, s11, v31
  v_add_u32 v29, 3072, v28
  v_add_u32 v30, 6144, v28
  v_add_u32 v31, 9216, v28
  s_add_u32 m0, s77, 0
  s_add_u32 s74, s26, 0
  s_addc_u32 s75, s27, 0
  global_load_lds_dwordx4 v28, s[74:75] offset:0
  s_cbranch_execz L_e_wr
  global_load_lds_dwordx4 v29, s[74:75] offset:1024
  global_load_lds_dwordx4 v30, s[74:75] offset:2048
  global_load_lds_dwordx4 v31, s[74:75] offset:3072
  s_add_u32 m0, s77, 16384
  s_add_u32 s74, s26, 65536
  s_addc_u32 s75, s27, 0
  global_load_lds_dwordx4 v28, s[74:75] offset:0
  global_load_lds_dwordx4 v29, s[74:75] offset:1024
  global_load_lds_dwordx4 v30, s[74:75] offset:2048
  global_load_lds_dwordx4 v31, s[74:75] offset:3072
  s_add_u32 m0, s77, 32768
  s_add_u32 s74, s26, 256
  s_addc_u32 s75, s27, 0
  global_load_lds_dwordx4 v28, s[74:75] offset:0
  global_load_lds_dwordx4 v29, s[74:75] offset:1024
  global_load_lds_dwordx4 v30, s[74:75] offset:2048
  s_nop 0
  s_cbranch_execz L_e_wr
  global_load_lds_dwordx4 v31, s[74:75] offset:3072
  s_add_u32 m0, s77, 49152
  s_add_u32 s74, s26, 65792
  s_addc_u32 s75, s27, 0
  global_load_lds_dwordx4 v28, s[74:75] offset:0
  global_load_lds_dwordx4 v29, s[74:75] offset:1024
  global_load_lds_dwordx4 v30, s[74:75] offset:2048
  global_load_lds_dwordx4 v31, s[74:75] offset:3072
  s_add_u32 m0, s77, 65536
  s_add_u32 s74, s26, 512
  s_addc_u32 s75, s27, 0
  global_load_lds_dwordx4 v28, s[74:75] offset:0
  global_load_lds_dwordx4 v29, s[74:75] offset:1024
  global_load_lds_dwordx4 v30, s[74:75] offset:2048
  global_load_lds_dwordx4 v31, s[74:75] offset:3072
  s_add_u32 m0, s77, 81920
  s_nop 0
  s_cbranch_execz L_e_wr
  s_add_u32 s74, s26, 66048
  s_addc_u32 s75, s27, 0
  global_load_lds_dwordx4 v28, s[74:75] offset:0
  global_load_lds_dwordx4 v29, s[74:75] offset:1024
  global_load_lds_dwordx4 v30, s[74:75] offset:2048
  global_load_lds_dwordx4 v31, s[74:75] offset:3072
  s_add_u32 m0, s77, 98304
  s_add_u32 s74, s26, 768
  s_addc_u32 s75, s27, 0
  global_load_lds_dwordx4 v28, s[74:75] offset:0
  global_load_lds_dwordx4 v29, s[74:75] offset:1024
  global_load_lds_dwordx4 v30, s[74:75] offset:2048
  global_load_lds_dwordx4 v31, s[74:75] offset:3072
  s_add_u32 m0, s77, 114688
  s_add_u32 s74, s26, 66304
  s_addc_u32 s75, s27, 0
  global_load_lds_dwordx4 v28, s[74:75] offset:0
  s_cbranch_execz L_e_wr
  global_load_lds_dwordx4 v29, s[74:75] offset:1024
  global_load_lds_dwordx4 v30, s[74:75] offset:2048
  global_load_lds_dwordx4 v31, s[74:75] offset:3072
  v_lshrrev_b32 v40, 4, v0
  s_and_b32 s8, s4, 1
  s_lshl_b32 s8, s8, 2
  v_or_b32 v41, s8, v40
  v_lshlrev_b32 v41, 1, v41
  v_and_b32 v24, 15, v0
  v_xor_b32 v24, v24, v41
  v_lshlrev_b32 v24, 4, v24
  s_lshl_b32 s8, s4, 4
  v_add_u32 v40, s8, v40
  v_mul_u32_u24 v40, 8192, v40
  v_add_u32 v24, v24, v40
  v_add_u32 v24, s10, v24
  v_add_u32 v25, 31744, v24
  v_add_u32 v26, 63488, v24
  v_add_u32 v27, 95232, v24
  s_lshr_b32 s8, s22, 8
  s_sub_u32 s8, 1, s8
  s_and_b32 s8, s8, 3
  s_and_b32 s9, s6, 28
  s_or_b32 s8, s8, s9
  s_cbranch_execz L_e_wr
  s_sub_u32 s9, s6, s8
  s_and_b32 s9, s9, 3
  s_cselect_b32 s12, 15, 0
  s_cmp_eq_u32 s6, 31
  s_cselect_b32 s12, 0, s12
  s_add_u32 s9, s9, 4
  s_lshl_b32 s9, s9, 2
  s_add_u32 s9, s9, s4
  s_lshl_b32 s9, s9, 17
  s_lshl_b32 s8, s8, 8
  s_add_u32 s8, s8, s9
  v_lshrrev_b32 v40, 1, v0
  v_min_u32 v40, s12, v40
  v_lshlrev_b32 v40, 13, v40
  v_and_b32 v47, 1, v0
  v_lshl_add_u32 v47, v47, 7, v40
  v_add_u32 v47, s8, v47
  v_lshlrev_b32 v1, 4, v0
  v_and_b32 v40, 1, v0
  v_lshlrev_b32 v12, 5, v40
  v_mov_b32 v41, 0x4444
  v_mov_b32 v42, 0xeeee
  v_cmp_eq_u32 s[70:71], 1, v40
  s_nop 1
  v_cndmask_b32 v2, v41, v42, s[70:71]
  v_lshrrev_b32 v40, 4, v0
  s_cbranch_execz L_e_wr
  v_and_b32 v41, 15, v0
  v_and_b32 v43, 3, v0
  v_lshrrev_b32 v42, 2, v41
  v_lshrrev_b32 v44, 3, v0
  v_mul_u32_u24 v3, 8448, v44
  v_and_b32 v44, 7, v0
  v_lshl_add_u32 v3, v44, 3, v3
  v_lshrrev_b32 v44, 5, v0
  v_lshlrev_b32 v4, 5, v44
  v_and_b32 v44, 1, v40
  v_lshl_add_u32 v4, v44, 3, v4
  v_and_b32 v44, 1, v0
  v_lshl_add_u32 v4, v44, 4, v4
  v_bfe_u32 v44, v0, 1, 1
  v_lshl_add_u32 v4, v44, 2, v4
  v_and_b32 v44, 0, v42
  v_mul_u32_u24 v44, 65536, v44
  v_add_u32 v4, v44, v4
  v_add_u32 v5, 0x10000, v1
  v_add_u32 v6, 131072, v1
  s_lshl_b32 s8, s4, 10
  s_nop 0
  s_cbranch_execz L_e_wr
  s_add_u32 s8, s8, 155648
  v_lshlrev_b32 v7, 7, v40
  v_lshl_add_u32 v7, v41, 2, v7
  v_add_u32 v7, s8, v7
  v_lshrrev_b32 v44, 1, v41
  v_lshlrev_b32 v8, 6, v44
  v_lshl_add_u32 v8, v40, 4, v8
  v_add_u32 v8, 155648, v8
  v_and_b32 v45, 1, v41
  v_lshl_add_u32 v11, v45, 3, v8
  v_lshl_add_u32 v44, v42, 1, v45
  v_lshlrev_b32 v9, 6, v44
  v_lshl_add_u32 v9, v40, 4, v9
  v_add_u32 v9, 156160, v9
  v_mov_b32 v15, 0
  v_bfe_u32 v44, v0, 2, 1
  v_lshl_add_u32 v44, v44, 1, v43
  v_bfe_u32 v45, v0, 1, 1
  v_lshl_add_u32 v44, v45, 3, v44
  s_cbranch_execz L_e_wr
  v_bfe_u32 v45, v0, 3, 1
  v_lshlrev_b32 v45, 4, v45
  v_mov_b32 v46, 0x3f80
  v_lshlrev_b32 v46, v45, v46
  v_cmp_eq_u32 vcc, 0, v44
  s_nop 1
  v_cndmask_b32 v16, 0, v46, vcc
  v_mov_b32 v20, 0x3f803f80
  v_cmp_eq_u32 vcc, 1, v44
  s_nop 1
  v_cndmask_b32 v17, 0, v46, vcc
  v_mov_b32 v21, 0x3f803f80
  v_cmp_eq_u32 vcc, 2, v44
  s_nop 1
  v_cndmask_b32 v18, 0, v46, vcc
  v_mov_b32 v22, 0x3f803f80
  v_cmp_eq_u32 vcc, 3, v44
  s_nop 1
  v_cndmask_b32 v19, 0, v46, vcc
  v_mov_b32 v23, 0x3f803f80
  ds_write_b128 v6, v[16:19] offset:30720
  ds_write_b128 v6, v[20:23] offset:31744
  v_mov_b32 v40, 0
  s_cbranch_execz L_e_wr
  v_bfe_u32 v41, v0, 2, 1
  v_mad_u32_u24 v40, v41, 16, v40
  v_bfe_u32 v41, v0, 5, 1
  v_mad_u32_u24 v40, v41, 32, v40
  v_bfe_u32 v41, v0, 3, 1
  v_mad_u32_u24 v40, v41, 2, v40
  v_bfe_u32 v41, v0, 4, 1
  v_mad_u32_u24 v40, v41, 1, v40
  v_mov_b32 v42, 0
  v_bfe_u32 v41, v40, 0, 1
  v_lshl_or_b32 v42, v41, 0, v42
  v_bfe_u32 v41, v40, 1, 1
  v_lshl_or_b32 v42, v41, 1, v42
  v_bfe_u32 v41, v40, 4, 1
  v_lshl_or_b32 v42, v41, 2, v42
  s_lshl_b32 s8, s4, 1
  v_xor_b32 v42, s8, v42
  s_cbranch_execz L_e_wr
  v_lshlrev_b32 v42, 5, v42
  v_lshl_add_u32 v32, v40, 8, v42
  v_and_b32 v41, 3, v0
  v_lshl_add_u32 v32, v41, 3, v32
  v_xor_b32 v33, 32, v32
  v_add_u32 v34, 0x10000, v32
  v_add_u32 v35, 0x10000, v33
  v_mov_b32 v40, 0
  v_bfe_u32 v41, v0, 4, 1
  v_mad_u32_u24 v40, v41, 16, v40
  v_bfe_u32 v41, v0, 5, 1
  v_mad_u32_u24 v40, v41, 4, v40
  v_bfe_u32 v41, v0, 2, 1
  v_mad_u32_u24 v40, v41, 1, v40
  v_bfe_u32 v42, v0, 3, 1
  v_bfe_u32 v41, v40, 0, 1
  v_lshl_or_b32 v42, v41, 1, v42
  s_nop 0
  s_cbranch_execz L_e_wr
  v_bfe_u32 v41, v40, 4, 1
  v_lshl_or_b32 v42, v41, 2, v42
  s_lshl_b32 s8, s4, 1
  v_xor_b32 v42, s8, v42
  v_lshlrev_b32 v42, 5, v42
  v_lshl_add_u32 v36, v40, 8, v42
  v_and_b32 v41, 3, v0
  v_lshl_add_u32 v36, v41, 3, v36
  v_xor_b32 v37, 32, v36
  v_add_u32 v38, 0x10000, v36
  s_lshl_b32 s8, s4, 11
  s_lshr_b32 s9, s6, 4
  s_lshl_b32 s9, s9, 10
  s_add_u32 s8, s8, s9
  s_and_b32 s9, s6, 1
  s_lshl_b32 s9, s9, 9
  s_add_u32 s8, s8, s9
  s_and_b32 s9, s6, 8
  s_lshl_b32 s9, s9, 5
  s_add_u32 s8, s8, s9
  s_and_b32 s9, s6, 6
  s_lshl_b32 s9, s9, 5
  s_add_u32 s8, s8, s9
  s_mov_b32 s96, s8
  s_add_u32 s28, s42, 655359
  s_cbranch_execz L_e_wr
  s_addc_u32 s29, s43, 0
  s_and_b32 s28, s28, 0xffff0000
  s_lshl_b32 s8, s6, 6
  s_lshl_b32 s9, s4, 2
  s_add_u32 s8, s8, s9
  s_add_u32 s8, s8, 4096
  v_mov_b32 v53, s8
  v_mov_b32 v54, 0
  s_cmp_eq_u32 s4, 1
  s_cbranch_scc1 L_R_i1
  s_cmp_eq_u32 s4, 2
  s_cbranch_scc1 L_R_i2
  s_cmp_eq_u32 s4, 3
  s_cbranch_scc1 L_R_i3
L_R_i0:
  s_lshl_b32 s74, s6, 6
  s_add_u32 s75, s74, 262144
  s_add_u32 s46, s42, s75
  s_addc_u32 s47, s43, 0
  s_add_u32 s48, s46, 4096
  s_addc_u32 s49, s47, 0
  s_add_u32 s75, s74, 32
  s_add_u32 s98, s42, s75
  s_addc_u32 s99, s43, 0
  s_add_u32 s75, s74, 8192
  s_add_u32 s66, s42, s75
  s_addc_u32 s67, s43, 0
  s_cbranch_execz L_e_wr
  s_add_u32 s75, s72, 17039360
  s_add_u32 s68, s42, s75
  s_addc_u32 s69, s43, 0
  s_mul_i32 s75, s6, 8448
  s_add_u32 s75, s75, 262144
  s_add_u32 s50, s42, s75
  s_addc_u32 s51, s43, 0
  s_add_u32 s75, s72, 67371008
  s_add_u32 s64, s42, s75
  s_addc_u32 s65, s43, 0
  s_add_u32 s75, s72, 17039360
  s_add_u32 s60, s42, s75
  s_addc_u32 s61, s43, 0
  s_add_u32 s62, s60, 16515072
  s_addc_u32 s63, s61, 0
  s_and_b32 s75, s6, 0
  s_mul_i32 s75, s75, 65536
  s_add_u32 s75, s75, 2048
  s_add_u32 s54, s28, s75
  s_addc_u32 s55, s29, 0
  s_add_u32 s56, s28, s96
  s_addc_u32 s57, s29, 0
  s_nop 0
  s_cbranch_execz L_e_wr
  s_add_u32 s58, s56, 24576
  s_addc_u32 s59, s57, 0
  s_add_u32 s56, s56, 8192
  s_addc_u32 s57, s57, 0
  s_add_u32 s18, s28, 32768
  s_addc_u32 s19, s29, 0
  s_lshl_b32 s74, s6, 2
  s_add_u32 s16, s18, s74
  s_addc_u32 s17, s19, 0
  s_mov_b32 s12, 0
  s_mov_b32 m0, 131072
  s_branch L_R_ix
L_R_i1:
  s_lshl_b32 s74, s6, 6
  s_add_u32 s75, s74, 329728
  s_add_u32 s46, s42, s75
  s_addc_u32 s47, s43, 0
  s_add_u32 s48, s46, 4096
  s_addc_u32 s49, s47, 0
  s_add_u32 s75, s74, 36
  s_add_u32 s98, s42, s75
  s_addc_u32 s99, s43, 0
  s_add_u32 s75, s74, 8196
  s_add_u32 s66, s42, s75
  s_addc_u32 s67, s43, 0
  s_cbranch_execz L_e_wr
  s_add_u32 s75, s72, 17039360
  s_add_u32 s68, s42, s75
  s_addc_u32 s69, s43, 0
  s_mul_i32 s75, s6, 8448
  s_add_u32 s75, s75, 264192
  s_add_u32 s50, s42, s75
  s_addc_u32 s51, s43, 0
  s_add_u32 s75, s72, 67372032
  s_add_u32 s64, s42, s75
  s_addc_u32 s65, s43, 0
  s_add_u32 s75, s72, 17041408
  s_add_u32 s60, s42, s75
  s_addc_u32 s61, s43, 0
  s_add_u32 s62, s60, 16515072
  s_addc_u32 s63, s61, 0
  s_and_b32 s75, s6, 0
  s_mul_i32 s75, s75, 65536
  s_add_u32 s75, s75, 3072
  s_add_u32 s54, s28, s75
  s_addc_u32 s55, s29, 0
  s_add_u32 s56, s28, s96
  s_addc_u32 s57, s29, 0
  s_nop 0
  s_cbranch_execz L_e_wr
  s_add_u32 s58, s56, 24576
  s_addc_u32 s59, s57, 0
  s_add_u32 s56, s56, 8192
  s_addc_u32 s57, s57, 0
  s_add_u32 s18, s28, 37120
  s_addc_u32 s19, s29, 0
  s_lshl_b32 s74, s6, 2
  s_add_u32 s16, s18, s74
  s_addc_u32 s17, s19, 0
  s_mov_b32 s12, 0
  s_mov_b32 m0, 133120
  s_branch L_R_ix
L_R_i2:
  s_lshl_b32 s74, s6, 6
  s_add_u32 s75, s74, 397312
  s_add_u32 s46, s42, s75
  s_addc_u32 s47, s43, 0
  s_add_u32 s48, s46, 4096
  s_addc_u32 s49, s47, 0
  s_add_u32 s75, s74, 40
  s_add_u32 s98, s42, s75
  s_addc_u32 s99, s43, 0
  s_add_u32 s75, s74, 8200
  s_add_u32 s66, s42, s75
  s_addc_u32 s67, s43, 0
  s_cbranch_execz L_e_wr
  s_add_u32 s75, s72, 33816576
  s_add_u32 s68, s42, s75
  s_addc_u32 s69, s43, 0
  s_mul_i32 s75, s6, 8448
  s_add_u32 s75, s75, 266240
  s_add_u32 s50, s42, s75
  s_addc_u32 s51, s43, 0
  s_add_u32 s75, s72, 67373056
  s_add_u32 s64, s42, s75
  s_addc_u32 s65, s43, 0
  s_add_u32 s75, s72, 17043456
  s_add_u32 s60, s42, s75
  s_addc_u32 s61, s43, 0
  s_add_u32 s62, s60, 16515072
  s_addc_u32 s63, s61, 0
  s_and_b32 s75, s6, 0
  s_mul_i32 s75, s75, 65536
  s_add_u32 s75, s75, 4096
  s_add_u32 s54, s28, s75
  s_addc_u32 s55, s29, 0
  s_add_u32 s56, s28, s96
  s_addc_u32 s57, s29, 0
  s_nop 0
  s_cbranch_execz L_e_wr
  s_add_u32 s58, s56, 24576
  s_addc_u32 s59, s57, 0
  s_add_u32 s56, s56, 8192
  s_addc_u32 s57, s57, 0
  s_add_u32 s18, s28, 41472
  s_addc_u32 s19, s29, 0
  s_lshl_b32 s74, s6, 2
  s_add_u32 s16, s18, s74
  s_addc_u32 s17, s19, 0
  s_mov_b32 s12, 0
  s_mov_b32 m0, 135168
  s_branch L_R_ix
L_R_i3:
  s_lshl_b32 s74, s6, 6
  s_add_u32 s75, s74, 464896
  s_add_u32 s46, s42, s75
  s_addc_u32 s47, s43, 0
  s_add_u32 s48, s46, 4096
  s_addc_u32 s49, s47, 0
  s_add_u32 s75, s74, 44
  s_add_u32 s98, s42, s75
  s_addc_u32 s99, s43, 0
  s_add_u32 s75, s74, 8204
  s_add_u32 s66, s42, s75
  s_addc_u32 s67, s43, 0
  s_cbranch_execz L_e_wr
  s_add_u32 s75, s72, 33816576
  s_add_u32 s68, s42, s75
  s_addc_u32 s69, s43, 0
  s_mul_i32 s75, s6, 8448
  s_add_u32 s75, s75, 268288
  s_add_u32 s50, s42, s75
  s_addc_u32 s51, s43, 0
  s_add_u32 s75, s72, 67374080
  s_add_u32 s64, s42, s75
  s_addc_u32 s65, s43, 0
  s_add_u32 s75, s72, 17045504
  s_add_u32 s60, s42, s75
  s_addc_u32 s61, s43, 0
  s_add_u32 s62, s60, 16515072
  s_addc_u32 s63, s61, 0
  s_and_b32 s75, s6, 0
  s_mul_i32 s75, s75, 65536
  s_add_u32 s75, s75, 5120
  s_add_u32 s54, s28, s75
  s_addc_u32 s55, s29, 0
  s_add_u32 s56, s28, s96
  s_addc_u32 s57, s29, 0
  s_nop 0
  s_cbranch_execz L_e_wr
  s_add_u32 s58, s56, 24576
  s_addc_u32 s59, s57, 0
  s_add_u32 s56, s56, 8192
  s_addc_u32 s57, s57, 0
  s_add_u32 s18, s28, 45824
  s_addc_u32 s19, s29, 0
  s_lshl_b32 s74, s6, 2
  s_add_u32 s16, s18, s74
  s_addc_u32 s17, s19, 0
  s_mov_b32 s12, 0
  s_mov_b32 m0, 137216
L_R_ix:
  s_sub_u32 s78, s60, 0x40000
  s_subb_u32 s79, s61, 0
  s_mov_b32 s44, 0
  s_mov_b32 s52, 0x3e0293ee
  s_mov_b32 s53, 0x49800000
  v_mov_b32 v56, 0
  v_mov_b32 v57, 0
  v_mov_b32 v58, 0
  v_mov_b32 v59, 0
  v_mov_b32 v60, 0
  v_mov_b32 v61, 0
  v_mov_b32 v62, 0
  v_mov_b32 v63, 0
  s_cbranch_execz L_e_wr
  v_add_u32 v39, s77, v1
  v_add_u32 v55, 0x10000, v39
  s_waitcnt vmcnt(28)
  s_barrier
  ds_read_b64_tr_b16 a[192:193], v36 offset:0
  ds_read_b64_tr_b16 a[194:195], v36 offset:512
  ds_read_b64_tr_b16 a[196:197], v36 offset:2048
  ds_read_b64_tr_b16 a[198:199], v36 offset:2560
  ds_read_b64_tr_b16 a[200:201], v36 offset:8192
  ds_read_b64_tr_b16 a[202:203], v36 offset:8704
  ds_read_b64_tr_b16 a[204:205], v36 offset:10240
  ds_read_b64_tr_b16 a[206:207], v36 offset:10752
  s_waitcnt lgkmcnt(0)
  s_waitcnt vmcnt(24)
  s_barrier
  s_add_u32 m0, s77, 0
  s_add_u32 s74, s22, 0
  s_addc_u32 s75, s23, 0
  global_load_lds_dwordx4 v24, s[74:75] offset:0
  global_load_lds_dwordx4 v25, s[74:75] offset:1024
  s_cbranch_execz L_e_wr
  global_load_lds_dwordx4 v26, s[74:75] offset:2048
  global_load_lds_dwordx4 v27, s[74:75] offset:3072
  ds_read_b64_tr_b16 a[208:209], v36 offset:16384
  ds_read_b64_tr_b16 a[210:211], v36 offset:16896
  ds_read_b64_tr_b16 a[212:213], v36 offset:18432
  ds_read_b64_tr_b16 a[214:215], v36 offset:18944
  ds_read_b64_tr_b16 a[216:217], v36 offset:24576
  ds_read_b64_tr_b16 a[218:219], v36 offset:25088
  ds_read_b64_tr_b16 a[220:221], v36 offset:26624
  ds_read_b64_tr_b16 a[222:223], v36 offset:27136
  s_waitcnt lgkmcnt(0)
  s_waitcnt vmcnt(24)
  s_barrier
  s_add_u32 m0, s77, 16384
  s_add_u32 s74, s22, 524288
  s_addc_u32 s75, s23, 0
  global_load_lds_dwordx4 v24, s[74:75] offset:0
  s_nop 0
  s_cbranch_execz L_e_wr
  global_load_lds_dwordx4 v25, s[74:75] offset:1024
  global_load_lds_dwordx4 v26, s[74:75] offset:2048
  global_load_lds_dwordx4 v27, s[74:75] offset:3072
  global_load_dword v48, v47, s[22:23]
  ds_read_b64_tr_b16 a[224:225], v36 offset:32768
  ds_read_b64_tr_b16 a[226:227], v36 offset:33280
  ds_read_b64_tr_b16 a[228:229], v36 offset:34816
  ds_read_b64_tr_b16 a[230:231], v36 offset:35328
  ds_read_b64_tr_b16 a[232:233], v36 offset:40960
  ds_read_b64_tr_b16 a[234:235], v36 offset:41472
  ds_read_b64_tr_b16 a[236:237], v36 offset:43008
  ds_read_b64_tr_b16 a[238:239], v36 offset:43520
  s_waitcnt lgkmcnt(0)
  s_waitcnt vmcnt(25)
  s_barrier
  s_add_u32 m0, s77, 32768
  s_add_u32 s74, s22, 1048576
  s_cbranch_execz L_e_wr
  s_addc_u32 s75, s23, 0
  global_load_lds_dwordx4 v24, s[74:75] offset:0
  global_load_lds_dwordx4 v25, s[74:75] offset:1024
  global_load_lds_dwordx4 v26, s[74:75] offset:2048
  global_load_lds_dwordx4 v27, s[74:75] offset:3072
  ds_read_b64_tr_b16 a[240:241], v36 offset:49152
  ds_read_b64_tr_b16 a[242:243], v36 offset:49664
  ds_read_b64_tr_b16 a[244:245], v36 offset:51200
  ds_read_b64_tr_b16 a[246:247], v36 offset:51712
  ds_read_b64_tr_b16 a[248:249], v36 offset:57344
  ds_read_b64_tr_b16 a[250:251], v36 offset:57856
  ds_read_b64_tr_b16 a[252:253], v36 offset:59392
  ds_read_b64_tr_b16 a[254:255], v36 offset:59904
  s_waitcnt lgkmcnt(0)
  s_waitcnt vmcnt(25)
  s_barrier
  s_add_u32 m0, s77, 49152
  s_nop 0
  s_cbranch_execz L_e_wr
  s_add_u32 s74, s22, 1572864
  s_addc_u32 s75, s23, 0
  global_load_lds_dwordx4 v24, s[74:75] offset:0
  global_load_lds_dwordx4 v25, s[74:75] offset:1024
  global_load_lds_dwordx4 v26, s[74:75] offset:2048
  global_load_lds_dwordx4 v27, s[74:75] offset:3072
  ds_read_b64_tr_b16 v[64:65], v38 offset:0
  ds_read_b64_tr_b16 v[66:67], v38 offset:512
  ds_read_b64_tr_b16 v[68:69], v38 offset:2048
  ds_read_b64_tr_b16 v[70:71], v38 offset:2560
  ds_read_b64_tr_b16 v[72:73], v38 offset:8192
  ds_read_b64_tr_b16 v[74:75], v38 offset:8704
  ds_read_b64_tr_b16 v[76:77], v38 offset:10240
  ds_read_b64_tr_b16 v[78:79], v38 offset:10752
  s_waitcnt lgkmcnt(0)
  s_waitcnt vmcnt(25)
  s_barrier
  s_nop 0
  s_cbranch_execz L_e_wr
  s_add_u32 m0, s77, 65536
  s_add_u32 s74, s22, 2097152
  s_addc_u32 s75, s23, 0
  global_load_lds_dwordx4 v24, s[74:75] offset:0
  global_load_lds_dwordx4 v25, s[74:75] offset:1024
  global_load_lds_dwordx4 v26, s[74:75] offset:2048
  global_load_lds_dwordx4 v27, s[74:75] offset:3072
  ds_read_b64_tr_b16 v[80:81], v38 offset:16384
  ds_read_b64_tr_b16 v[82:83], v38 offset:16896
  ds_read_b64_tr_b16 v[84:85], v38 offset:18432
  ds_read_b64_tr_b16 v[86:87], v38 offset:18944
  ds_read_b64_tr_b16 v[88:89], v38 offset:24576
  ds_read_b64_tr_b16 v[90:91], v38 offset:25088
  ds_read_b64_tr_b16 v[92:93], v38 offset:26624
  ds_read_b64_tr_b16 v[94:95], v38 offset:27136
  s_waitcnt lgkmcnt(0)
  s_branch L_R_w
L_R_wx:
  s_cbranch_execz L_e_wr
  s_waitcnt vmcnt(25)
  s_barrier
  s_add_u32 m0, s77, 81920
  s_add_u32 s74, s22, 2621440
  s_addc_u32 s75, s23, 0
  global_load_lds_dwordx4 v24, s[74:75] offset:0
  global_load_lds_dwordx4 v25, s[74:75] offset:1024
  global_load_lds_dwordx4 v26, s[74:75] offset:2048
  global_load_lds_dwordx4 v27, s[74:75] offset:3072
  ds_read_b64_tr_b16 v[96:97], v38 offset:32768
  ds_read_b64_tr_b16 v[98:99], v38 offset:33280
  ds_read_b64_tr_b16 v[100:101], v38 offset:34816
  ds_read_b64_tr_b16 v[102:103], v38 offset:35328
  ds_read_b64_tr_b16 v[104:105], v38 offset:40960
  ds_read_b64_tr_b16 v[106:107], v38 offset:41472
  ds_read_b64_tr_b16 v[108:109], v38 offset:43008
  ds_read_b64_tr_b16 v[110:111], v38 offset:43520
  s_cbranch_execz L_e_wr
  s_waitcnt lgkmcnt(0)
  s_waitcnt vmcnt(25)
  s_barrier
  s_add_u32 m0, s77, 98304
  s_add_u32 s74, s22, 3145728
  s_addc_u32 s75, s23, 0
  global_load_lds_dwordx4 v24, s[74:75] offset:0
  global_load_lds_dwordx4 v25, s[74:75] offset:1024
  global_load_lds_dwordx4 v26, s[74:75] offset:2048
  global_load_lds_dwordx4 v27, s[74:75] offset:3072
  ds_read_b64_tr_b16 v[112:113], v38 offset:49152
  ds_read_b64_tr_b16 v[114:115], v38 offset:49664
  ds_read_b64_tr_b16 v[116:117], v38 offset:51200
  ds_read_b64_tr_b16 v[118:119], v38 offset:51712
  ds_read_b64_tr_b16 v[120:121], v38 offset:57344
  ds_read_b64_tr_b16 v[122:123], v38 offset:57856
  ds_read_b64_tr_b16 v[124:125], v38 offset:59392
  s_nop 0
  s_cbranch_execz L_e_wr
  ds_read_b64_tr_b16 v[126:127], v38 offset:59904
  s_waitcnt lgkmcnt(0)
  s_waitcnt vmcnt(25)
  s_barrier
  s_add_u32 m0, s77, 114688
  s_add_u32 s74, s22, 3670016
  s_addc_u32 s75, s23, 0
  global_load_lds_dwordx4 v24, s[74:75] offset:0
  global_load_lds_dwordx4 v25, s[74:75] offset:1024
  global_load_lds_dwordx4 v26, s[74:75] offset:2048
  global_load_lds_dwordx4 v27, s[74:75] offset:3072
  ds_read_b64_tr_b16 a[0:1], v32 offset:0
  ds_read_b64_tr_b16 a[2:3], v32 offset:1024
  ds_read_b64_tr_b16 a[4:5], v32 offset:2048
  ds_read_b64_tr_b16 a[6:7], v32 offset:3072
  ds_read_b64_tr_b16 a[8:9], v33 offset:0
  ds_read_b64_tr_b16 a[10:11], v33 offset:1024
  s_nop 0
  s_cbranch_execz L_e_wr
  ds_read_b64_tr_b16 a[12:13], v33 offset:2048
  ds_read_b64_tr_b16 a[14:15], v33 offset:3072
  s_waitcnt lgkmcnt(0)
  s_waitcnt vmcnt(25)
  s_barrier
  s_add_u32 m0, s77, 0
  s_add_u32 s74, s24, 0
  s_addc_u32 s75, s25, 0
  global_load_lds_dwordx4 v24, s[74:75] offset:0
  global_load_lds_dwordx4 v25, s[74:75] offset:1024
  global_load_lds_dwordx4 v26, s[74:75] offset:2048
  global_load_lds_dwordx4 v27, s[74:75] offset:3072
  ds_read_b64_tr_b16 a[16:17], v32 offset:16384
  ds_read_b64_tr_b16 a[18:19], v32 offset:17408
  ds_read_b64_tr_b16 a[20:21], v32 offset:18432
  ds_read_b64_tr_b16 a[22:23], v32 offset:19456
  ds_read_b64_tr_b16 a[24:25], v33 offset:16384
  ds_read_b64_tr_b16 a[26:27], v33 offset:17408
  s_nop 0
  s_cbranch_execz L_e_wr
  ds_read_b64_tr_b16 a[28:29], v33 offset:18432
  ds_read_b64_tr_b16 a[30:31], v33 offset:19456
  s_waitcnt lgkmcnt(0)
  s_waitcnt vmcnt(24)
  s_barrier
  s_add_u32 m0, s77, 16384
  s_add_u32 s74, s24, 524288
  s_addc_u32 s75, s25, 0
  global_load_lds_dwordx4 v24, s[74:75] offset:0
  global_load_lds_dwordx4 v25, s[74:75] offset:1024
  global_load_lds_dwordx4 v26, s[74:75] offset:2048
  global_load_lds_dwordx4 v27, s[74:75] offset:3072
  global_load_dword v48, v47, s[24:25]
  ds_read_b64_tr_b16 a[32:33], v32 offset:32768
  ds_read_b64_tr_b16 a[34:35], v32 offset:33792
  ds_read_b64_tr_b16 a[36:37], v32 offset:34816
  ds_read_b64_tr_b16 a[38:39], v32 offset:35840
  s_nop 0
  s_cbranch_execz L_e_wr
  ds_read_b64_tr_b16 a[40:41], v33 offset:32768
  ds_read_b64_tr_b16 a[42:43], v33 offset:33792
  ds_read_b64_tr_b16 a[44:45], v33 offset:34816
  ds_read_b64_tr_b16 a[46:47], v33 offset:35840
  s_waitcnt lgkmcnt(0)
  s_waitcnt vmcnt(25)
  s_barrier
  s_add_u32 m0, s77, 32768
  s_add_u32 s74, s24, 1048576
  s_addc_u32 s75, s25, 0
  global_load_lds_dwordx4 v24, s[74:75] offset:0
  global_load_lds_dwordx4 v25, s[74:75] offset:1024
  global_load_lds_dwordx4 v26, s[74:75] offset:2048
  global_load_lds_dwordx4 v27, s[74:75] offset:3072
  ds_read_b64_tr_b16 a[48:49], v32 offset:49152
  ds_read_b64_tr_b16 a[50:51], v32 offset:50176
  ds_read_b64_tr_b16 a[52:53], v32 offset:51200
  s_nop 0
  s_cbranch_execz L_e_wr
  ds_read_b64_tr_b16 a[54:55], v32 offset:52224
  ds_read_b64_tr_b16 a[56:57], v33 offset:49152
  ds_read_b64_tr_b16 a[58:59], v33 offset:50176
  ds_read_b64_tr_b16 a[60:61], v33 offset:51200
  ds_read_b64_tr_b16 a[62:63], v33 offset:52224
  s_waitcnt lgkmcnt(0)
  s_branch L_R_zw
L_R_zx:
  s_waitcnt vmcnt(25)
  s_barrier
  s_add_u32 m0, s77, 49152
  s_add_u32 s74, s24, 1572864
  s_addc_u32 s75, s25, 0
  global_load_lds_dwordx4 v24, s[74:75] offset:0
  global_load_lds_dwordx4 v25, s[74:75] offset:1024
  global_load_lds_dwordx4 v26, s[74:75] offset:2048
  global_load_lds_dwordx4 v27, s[74:75] offset:3072
  ds_read_b64_tr_b16 a[64:65], v34 offset:0
  ds_read_b64_tr_b16 a[66:67], v34 offset:1024
  s_cbranch_execz L_e_wr
  ds_read_b64_tr_b16 a[68:69], v34 offset:2048
  ds_read_b64_tr_b16 a[70:71], v34 offset:3072
  ds_read_b64_tr_b16 a[72:73], v35 offset:0
  ds_read_b64_tr_b16 a[74:75], v35 offset:1024
  ds_read_b64_tr_b16 a[76:77], v35 offset:2048
  ds_read_b64_tr_b16 a[78:79], v35 offset:3072
  s_waitcnt lgkmcnt(0)
  global_load_dword v49, v54, s[40:41] offset:164 sc1
  global_load_dword v51, v54, s[40:41] sc1
  s_waitcnt vmcnt(27)
  s_barrier
  s_add_u32 m0, s77, 65536
  s_add_u32 s74, s24, 2097152
  s_addc_u32 s75, s25, 0
  global_load_lds_dwordx4 v24, s[74:75] offset:0
  global_load_lds_dwordx4 v25, s[74:75] offset:1024
  global_load_lds_dwordx4 v26, s[74:75] offset:2048
  s_nop 0
  s_cbranch_execz L_e_wr
  global_load_lds_dwordx4 v27, s[74:75] offset:3072
  ds_read_b64_tr_b16 a[80:81], v34 offset:16384
  ds_read_b64_tr_b16 a[82:83], v34 offset:17408
  ds_read_b64_tr_b16 a[84:85], v34 offset:18432
  ds_read_b64_tr_b16 a[86:87], v34 offset:19456
  ds_read_b64_tr_b16 a[88:89], v35 offset:16384
  ds_read_b64_tr_b16 a[90:91], v35 offset:17408
  ds_read_b64_tr_b16 a[92:93], v35 offset:18432
  ds_read_b64_tr_b16 a[94:95], v35 offset:19456
  s_waitcnt lgkmcnt(0)
  s_waitcnt vmcnt(27)
  s_barrier
  s_add_u32 m0, s77, 81920
  s_add_u32 s74, s24, 2621440
  s_addc_u32 s75, s25, 0
  global_load_lds_dwordx4 v24, s[74:75] offset:0
  global_load_lds_dwordx4 v25, s[74:75] offset:1024
  s_nop 0
  s_cbranch_execz L_e_wr
  global_load_lds_dwordx4 v26, s[74:75] offset:2048
  global_load_lds_dwordx4 v27, s[74:75] offset:3072
  ds_read_b64_tr_b16 a[96:97], v34 offset:32768
  ds_read_b64_tr_b16 a[98:99], v34 offset:33792
  ds_read_b64_tr_b16 a[100:101], v34 offset:34816
  ds_read_b64_tr_b16 a[102:103], v34 offset:35840
  ds_read_b64_tr_b16 a[104:105], v35 offset:32768
  ds_read_b64_tr_b16 a[106:107], v35 offset:33792
  ds_read_b64_tr_b16 a[108:109], v35 offset:34816
  ds_read_b64_tr_b16 a[110:111], v35 offset:35840
  s_waitcnt lgkmcnt(0)
  s_waitcnt vmcnt(27)
  s_barrier
  s_add_u32 m0, s77, 98304
  s_add_u32 s74, s24, 3145728
  s_addc_u32 s75, s25, 0
  global_load_lds_dwordx4 v24, s[74:75] offset:0
  s_nop 0
  s_cbranch_execz L_e_wr
  global_load_lds_dwordx4 v25, s[74:75] offset:1024
  global_load_lds_dwordx4 v26, s[74:75] offset:2048
  global_load_lds_dwordx4 v27, s[74:75] offset:3072
  ds_read_b64_tr_b16 a[112:113], v34 offset:49152
  ds_read_b64_tr_b16 a[114:115], v34 offset:50176
  ds_read_b64_tr_b16 a[116:117], v34 offset:51200
  ds_read_b64_tr_b16 a[118:119], v34 offset:52224
  ds_read_b64_tr_b16 a[120:121], v35 offset:49152
  ds_read_b64_tr_b16 a[122:123], v35 offset:50176
  ds_read_b64_tr_b16 a[124:125], v35 offset:51200
  ds_read_b64_tr_b16 a[126:127], v35 offset:52224
  s_waitcnt lgkmcnt(0)
  s_waitcnt vmcnt(27)
  s_barrier
  s_add_u32 m0, s77, 114688
  s_add_u32 s74, s24, 3670016
  s_addc_u32 s75, s25, 0
  s_nop 0
  s_cbranch_execz L_e_wr
  global_load_lds_dwordx4 v24, s[74:75] offset:0
  global_load_lds_dwordx4 v25, s[74:75] offset:1024
  global_load_lds_dwordx4 v26, s[74:75] offset:2048
  global_load_lds_dwordx4 v27, s[74:75] offset:3072
  ds_read_b64_tr_b16 v[128:129], v32 offset:0
  ds_read_b64_tr_b16 v[130:131], v32 offset:1024
  ds_read_b64_tr_b16 v[132:133], v32 offset:2048
  ds_read_b64_tr_b16 v[134:135], v32 offset:3072
  ds_read_b64_tr_b16 v[136:137], v33 offset:0
  ds_read_b64_tr_b16 v[138:139], v33 offset:1024
  ds_read_b64_tr_b16 v[140:141], v33 offset:2048
  ds_read_b64_tr_b16 v[142:143], v33 offset:3072
  s_waitcnt lgkmcnt(0)
  s_waitcnt vmcnt(27)
  s_barrier
  s_add_u32 m0, s77, 0
  s_add_u32 s74, s20, 0
  s_addc_u32 s75, s21, 0
  s_nop 0
  s_cbranch_execz L_e_wr
  global_load_lds_dwordx4 v24, s[74:75] offset:0
  global_load_lds_dwordx4 v25, s[74:75] offset:1024
  global_load_lds_dwordx4 v26, s[74:75] offset:2048
  global_load_lds_dwordx4 v27, s[74:75] offset:3072
  ds_read_b64_tr_b16 v[144:145], v32 offset:16384
  ds_read_b64_tr_b16 v[146:147], v32 offset:17408
  ds_read_b64_tr_b16 v[148:149], v32 offset:18432
  ds_read_b64_tr_b16 v[150:151], v32 offset:19456
  ds_read_b64_tr_b16 v[152:153], v33 offset:16384
  ds_read_b64_tr_b16 v[154:155], v33 offset:17408
  ds_read_b64_tr_b16 v[156:157], v33 offset:18432
  ds_read_b64_tr_b16 v[158:159], v33 offset:19456
  s_waitcnt lgkmcnt(0)
  s_waitcnt vmcnt(26)
  s_barrier
  s_add_u32 m0, s77, 16384
  s_add_u32 s74, s20, 524288
  s_cbranch_execz L_e_wr
  s_addc_u32 s75, s21, 0
  global_load_lds_dwordx4 v24, s[74:75] offset:0
  global_load_lds_dwordx4 v25, s[74:75] offset:1024
  global_load_lds_dwordx4 v26, s[74:75] offset:2048
  global_load_lds_dwordx4 v27, s[74:75] offset:3072
  global_load_dword v48, v47, s[20:21]
  ds_read_b64_tr_b16 v[160:161], v32 offset:32768
  ds_read_b64_tr_b16 v[162:163], v32 offset:33792
  ds_read_b64_tr_b16 v[164:165], v32 offset:34816
  ds_read_b64_tr_b16 v[166:167], v32 offset:35840
  ds_read_b64_tr_b16 v[168:169], v33 offset:32768
  ds_read_b64_tr_b16 v[170:171], v33 offset:33792
  ds_read_b64_tr_b16 v[172:173], v33 offset:34816
  ds_read_b64_tr_b16 v[174:175], v33 offset:35840
  s_waitcnt lgkmcnt(0)
  s_waitcnt vmcnt(27)
  s_barrier
  s_nop 0
  s_cbranch_execz L_e_wr
  s_add_u32 m0, s77, 32768
  s_add_u32 s74, s20, 1048576
  s_addc_u32 s75, s21, 0
  global_load_lds_dwordx4 v24, s[74:75] offset:0
  global_load_lds_dwordx4 v25, s[74:75] offset:1024
  global_load_lds_dwordx4 v26, s[74:75] offset:2048
  global_load_lds_dwordx4 v27, s[74:75] offset:3072
  ds_read_b64_tr_b16 v[176:177], v32 offset:49152
  ds_read_b64_tr_b16 v[178:179], v32 offset:50176
  ds_read_b64_tr_b16 v[180:181], v32 offset:51200
  ds_read_b64_tr_b16 v[182:183], v32 offset:52224
  ds_read_b64_tr_b16 v[184:185], v33 offset:49152
  ds_read_b64_tr_b16 v[186:187], v33 offset:50176
  ds_read_b64_tr_b16 v[188:189], v33 offset:51200
  ds_read_b64_tr_b16 v[190:191], v33 offset:52224
  s_waitcnt lgkmcnt(0)
  s_waitcnt vmcnt(25)
  s_cbranch_execz L_e_wr
  s_barrier
  s_add_u32 m0, s77, 49152
  s_add_u32 s74, s20, 1572864
  s_addc_u32 s75, s21, 0
  global_load_lds_dwordx4 v24, s[74:75] offset:0
  global_load_lds_dwordx4 v25, s[74:75] offset:1024
  global_load_lds_dwordx4 v26, s[74:75] offset:2048
  global_load_lds_dwordx4 v27, s[74:75] offset:3072
  ds_read_b64_tr_b16 v[192:193], v34 offset:0
  ds_read_b64_tr_b16 v[194:195], v34 offset:1024
  ds_read_b64_tr_b16 v[196:197], v34 offset:2048
  ds_read_b64_tr_b16 v[198:199], v34 offset:3072
  ds_read_b64_tr_b16 v[200:201], v35 offset:0
  ds_read_b64_tr_b16 v[202:203], v35 offset:1024
  ds_read_b64_tr_b16 v[204:205], v35 offset:2048
  ds_read_b64_tr_b16 v[206:207], v35 offset:3072
  s_waitcnt lgkmcnt(0)
  s_cbranch_execz L_e_wr
  s_waitcnt vmcnt(25)
  s_barrier
  s_add_u32 m0, s77, 65536
  s_add_u32 s74, s20, 2097152
  s_addc_u32 s75, s21, 0
  global_load_lds_dwordx4 v24, s[74:75] offset:0
  global_load_lds_dwordx4 v25, s[74:75] offset:1024
  global_load_lds_dwordx4 v26, s[74:75] offset:2048
  global_load_lds_dwordx4 v27, s[74:75] offset:3072
  ds_read_b64_tr_b16 v[208:209], v34 offset:16384
  ds_read_b64_tr_b16 v[210:211], v34 offset:17408
  ds_read_b64_tr_b16 v[212:213], v34 offset:18432
  ds_read_b64_tr_b16 v[214:215], v34 offset:19456
  ds_read_b64_tr_b16 v[216:217], v35 offset:16384
  ds_read_b64_tr_b16 v[218:219], v35 offset:17408
  ds_read_b64_tr_b16 v[220:221], v35 offset:18432
  ds_read_b64_tr_b16 v[222:223], v35 offset:19456
  s_cbranch_execz L_e_wr
  s_waitcnt lgkmcnt(0)
  s_waitcnt vmcnt(25)
  s_barrier
  s_add_u32 m0, s77, 81920
  s_add_u32 s74, s20, 2621440
  s_addc_u32 s75, s21, 0
  global_load_lds_dwordx4 v24, s[74:75] offset:0
  global_load_lds_dwordx4 v25, s[74:75] offset:1024
  global_load_lds_dwordx4 v26, s[74:75] offset:2048
  global_load_lds_dwordx4 v27, s[74:75] offset:3072
  ds_read_b64_tr_b16 v[224:225], v34 offset:32768
  ds_read_b64_tr_b16 v[226:227], v34 offset:33792
  ds_read_b64_tr_b16 v[228:229], v34 offset:34816
  ds_read_b64_tr_b16 v[230:231], v34 offset:35840
  ds_read_b64_tr_b16 v[232:233], v35 offset:32768
  ds_read_b64_tr_b16 v[234:235], v35 offset:33792
  ds_read_b64_tr_b16 v[236:237], v35 offset:34816
  s_nop 0
  s_cbranch_execz L_e_wr
  ds_read_b64_tr_b16 v[238:239], v35 offset:35840
  s_waitcnt lgkmcnt(0)
  v_cmp_gt_u32 vcc, 64, v49
  s_cbranch_vccz L_R_i
Lww_23:
  global_load_dword v49, v54, s[40:41] offset:164 sc1
  s_waitcnt vmcnt(0)
  v_cmp_gt_u32 vcc, 64, v49
  s_cbranch_vccz Lwd_24
  s_sleep 1
  s_sub_u32 s7, s7, 1
  s_cbranch_scc0 Lww_23
  s_mov_b32 s7, 0
Lwd_24:
L_R_i:
  v_readfirstlane_b32 s73, v51
  s_cmp_ge_u32 s73, 32
  s_cselect_b32 s73, 0, 4
  s_add_u32 s73, s73, s4
  s_waitcnt vmcnt(25)
  s_barrier
  s_add_u32 m0, s77, 98304
  s_add_u32 s74, s20, 3145728
  s_addc_u32 s75, s21, 0
  global_load_lds_dwordx4 v24, s[74:75] offset:0
  global_load_lds_dwordx4 v25, s[74:75] offset:1024
  global_load_lds_dwordx4 v26, s[74:75] offset:2048
  s_cbranch_execz L_e_wr
  global_load_lds_dwordx4 v27, s[74:75] offset:3072
  ds_read_b64_tr_b16 v[240:241], v34 offset:49152
  ds_read_b64_tr_b16 v[242:243], v34 offset:50176
  ds_read_b64_tr_b16 v[244:245], v34 offset:51200
  ds_read_b64_tr_b16 v[246:247], v34 offset:52224
  ds_read_b64_tr_b16 v[248:249], v35 offset:49152
  ds_read_b64_tr_b16 v[250:251], v35 offset:50176
  ds_read_b64_tr_b16 v[252:253], v35 offset:51200
  ds_read_b64_tr_b16 v[254:255], v35 offset:52224
  s_waitcnt lgkmcnt(0)
  s_waitcnt vmcnt(25)
  s_barrier
  global_load_dword v49, v53, s[42:43] sc1
  s_add_u32 m0, s77, 114688
  s_add_u32 s74, s20, 3670016
  s_addc_u32 s75, s21, 0
  global_load_lds_dwordx4 v24, s[74:75] offset:0
  s_nop 0
  s_cbranch_execz L_e_wr
  global_load_lds_dwordx4 v25, s[74:75] offset:1024
  global_load_lds_dwordx4 v26, s[74:75] offset:2048
  global_load_lds_dwordx4 v27, s[74:75] offset:3072
  global_load_dwordx4 v[24:27], v1, s[54:55] offset:-2048 sc1
  global_load_dwordx4 v[28:31], v1, s[54:55] offset:2048 sc1
  s_mov_b32 s12, 0
  s_mov_b32 s11, 0
  s_lshl_b32 s8, s4, 11
  s_add_u32 m0, s8, 131072
  ds_read_b64_tr_b16 v[16:17], v32 offset:0
  ds_read_b64_tr_b16 v[18:19], v32 offset:1024
  ds_read_b64_tr_b16 v[20:21], v32 offset:2048
  ds_read_b64_tr_b16 v[22:23], v32 offset:3072
  ds_read_b64_tr_b16 a[128:129], v33 offset:0
  ds_read_b64_tr_b16 a[130:131], v33 offset:1024
  ds_read_b64_tr_b16 a[132:133], v33 offset:2048
  ds_read_b64_tr_b16 a[134:135], v33 offset:3072
  s_cbranch_execz L_e_wr
  s_waitcnt lgkmcnt(0)
  s_waitcnt vmcnt(28)
  s_barrier
  ds_read_b64_tr_b16 v[40:41], v32 offset:16384
  ds_read_b64_tr_b16 v[42:43], v32 offset:17408
  ds_read_b64_tr_b16 v[44:45], v32 offset:18432
  ds_read_b64_tr_b16 v[46:47], v32 offset:19456
  ds_read_b64_tr_b16 a[136:137], v33 offset:16384
  ds_read_b64_tr_b16 a[138:139], v33 offset:17408
  ds_read_b64_tr_b16 a[140:141], v33 offset:18432
  ds_read_b64_tr_b16 a[142:143], v33 offset:19456
  ds_write_b128 v39, v[16:19] offset:0
  ds_write_b128 v39, v[64:67] offset:2048
  ds_write_b128 v39, v[20:23] offset:1024
  ds_write_b128 v39, v[68:71] offset:3072
  s_waitcnt lgkmcnt(0)
  s_waitcnt vmcnt(23)
  s_barrier
  s_nop 0
  s_cbranch_execz L_e_wr
  ds_read_b64_tr_b16 v[16:17], v32 offset:32768
  ds_read_b64_tr_b16 v[18:19], v32 offset:33792
  ds_read_b64_tr_b16 v[20:21], v32 offset:34816
  ds_read_b64_tr_b16 v[22:23], v32 offset:35840
  ds_read_b64_tr_b16 a[144:145], v33 offset:32768
  ds_read_b64_tr_b16 a[146:147], v33 offset:33792
  ds_read_b64_tr_b16 a[148:149], v33 offset:34816
  ds_read_b64_tr_b16 a[150:151], v33 offset:35840
  ds_write_b128 v39, v[40:43] offset:16384
  ds_write_b128 v39, v[72:75] offset:18432
  ds_write_b128 v39, v[44:47] offset:17408
  ds_write_b128 v39, v[76:79] offset:19456
  s_waitcnt lgkmcnt(0)
  s_waitcnt vmcnt(19)
  s_barrier
  ds_read_b64_tr_b16 v[40:41], v32 offset:49152
  ds_read_b64_tr_b16 v[42:43], v32 offset:50176
  s_cbranch_execz L_e_wr
  ds_read_b64_tr_b16 v[44:45], v32 offset:51200
  ds_read_b64_tr_b16 v[46:47], v32 offset:52224
  ds_read_b64_tr_b16 a[152:153], v33 offset:49152
  ds_read_b64_tr_b16 a[154:155], v33 offset:50176
  ds_read_b64_tr_b16 a[156:157], v33 offset:51200
  ds_read_b64_tr_b16 a[158:159], v33 offset:52224
  ds_write_b128 v39, v[16:19] offset:32768
  ds_write_b128 v39, v[80:83] offset:34816
  ds_write_b128 v39, v[20:23] offset:33792
  ds_write_b128 v39, v[84:87] offset:35840
  s_waitcnt lgkmcnt(0)
  global_load_dword v50, v53, s[42:43] offset:2048 sc1
  v_readfirstlane_b32 s8, v51
  s_cmp_ge_u32 s8, 32
  s_cbranch_scc1 L_R_pw
  s_waitcnt vmcnt(0)
  s_branch L_R_px
L_R_pw:
  v_mov_b32 v36, -1
  v_mov_b32 v37, -1
  v_and_b32 v38, 0, v0
  s_cbranch_execz L_e_wr
  v_mul_u32_u24 v38, 65536, v38
  v_and_b32 v52, 0x80, v1
  v_add_u32 v38, v38, v52
  s_lshl_b32 s8, s4, 13
  s_add_u32 s8, s8, s10
  s_add_u32 s14, s28, s8
  s_addc_u32 s15, s29, 0
  global_load_dword v48, v38, s[14:15]
  s_mul_i32 s8, s6, 8448
  s_lshl_b32 s9, s4, 11
  s_add_u32 s8, s8, s9
  s_add_u32 s8, s8, 262144
  s_add_u32 s14, s42, s8
  s_addc_u32 s15, s43, 0
  v_lshlrev_b32 v38, 1, v1
  global_load_dword v48, v38, s[14:15]
  s_add_u32 s8, s96, 8192
  s_add_u32 s14, s28, s8
  s_addc_u32 s15, s29, 0
  global_store_dword v4, v36, s[14:15]
  s_add_u32 s8, s96, 16384
  s_add_u32 s14, s28, s8
  s_cbranch_execz L_e_wr
  s_addc_u32 s15, s29, 0
  global_store_dword v4, v36, s[14:15]
  s_mul_i32 s8, s4, 67584
  s_lshl_b32 s9, s6, 6
  s_add_u32 s8, s8, s9
  s_add_u32 s8, s8, 266240
  s_add_u32 s14, s42, s8
  s_addc_u32 s15, s43, 0
L_R_px:
  s_waitcnt vmcnt(20)
  s_barrier
  ds_read_b64_tr_b16 v[16:17], v34 offset:0
  ds_read_b64_tr_b16 v[18:19], v34 offset:1024
  ds_read_b64_tr_b16 v[20:21], v34 offset:2048
  ds_read_b64_tr_b16 v[22:23], v34 offset:3072
  ds_read_b64_tr_b16 a[160:161], v35 offset:0
  ds_read_b64_tr_b16 a[162:163], v35 offset:1024
  ds_read_b64_tr_b16 a[164:165], v35 offset:2048
  ds_read_b64_tr_b16 a[166:167], v35 offset:3072
  ds_write_b128 v39, v[40:43] offset:49152
  s_cbranch_execz L_e_wr
  ds_write_b128 v39, v[88:91] offset:51200
  ds_write_b128 v39, v[44:47] offset:50176
  ds_write_b128 v39, v[92:95] offset:52224
  v_mfma_f32_16x16x1_4b_f32 v[64:79], v15, v15, 0
  s_waitcnt lgkmcnt(0)
  s_waitcnt vmcnt(16)
  s_barrier
  ds_read_b64_tr_b16 v[40:41], v34 offset:16384
  ds_read_b64_tr_b16 v[42:43], v34 offset:17408
  ds_read_b64_tr_b16 v[44:45], v34 offset:18432
  ds_read_b64_tr_b16 v[46:47], v34 offset:19456
  ds_read_b64_tr_b16 a[168:169], v35 offset:16384
  ds_read_b64_tr_b16 a[170:171], v35 offset:17408
  ds_read_b64_tr_b16 a[172:173], v35 offset:18432
  ds_read_b64_tr_b16 a[174:175], v35 offset:19456
  ds_write_b128 v55, v[16:19] offset:0
  ds_write_b128 v55, v[96:99] offset:2048
  s_cbranch_execz L_e_wr
  ds_write_b128 v55, v[20:23] offset:1024
  ds_write_b128 v55, v[100:103] offset:3072
  s_waitcnt lgkmcnt(0)
  s_waitcnt vmcnt(12)
  s_waitcnt vmcnt(11)
  v_cmp_eq_u32 vcc, 0, v49
  v_mov_b32 v0, 0
  s_cbranch_vccz L_R_k0
  s_mov_b32 s11, 1
  s_waitcnt vmcnt(0)
  s_branch L_R_k1
L_R_k0:
  global_load_lds_dwordx4 v1, s[78:79] offset:0 sc1
  global_load_lds_dwordx4 v1, s[78:79] offset:1024 sc1
L_R_k1:
  s_barrier
  ds_read_b64_tr_b16 v[16:17], v34 offset:32768
  ds_read_b64_tr_b16 v[18:19], v34 offset:33792
  ds_read_b64_tr_b16 v[20:21], v34 offset:34816
  ds_read_b64_tr_b16 v[22:23], v34 offset:35840
  ds_read_b64_tr_b16 a[176:177], v35 offset:32768
  ds_read_b64_tr_b16 a[178:179], v35 offset:33792
  s_nop 0
  s_cbranch_execz L_e_wr
  ds_read_b64_tr_b16 a[180:181], v35 offset:34816
  ds_read_b64_tr_b16 a[182:183], v35 offset:35840
  ds_write_b128 v55, v[40:43] offset:16384
  ds_write_b128 v55, v[104:107] offset:18432
  ds_write_b128 v55, v[44:47] offset:17408
  ds_write_b128 v55, v[108:111] offset:19456
  s_waitcnt lgkmcnt(0)
  s_waitcnt vmcnt(9)
  s_barrier
  ds_read_b64_tr_b16 v[40:41], v34 offset:49152
  ds_read_b64_tr_b16 v[42:43], v34 offset:50176
  ds_read_b64_tr_b16 v[44:45], v34 offset:51200
  ds_read_b64_tr_b16 v[46:47], v34 offset:52224
  ds_read_b64_tr_b16 a[184:185], v35 offset:49152
  ds_read_b64_tr_b16 a[186:187], v35 offset:50176
  ds_read_b64_tr_b16 a[188:189], v35 offset:51200
  ds_read_b64_tr_b16 a[190:191], v35 offset:52224
  s_cbranch_execz L_e_wr
  ds_write_b128 v55, v[16:19] offset:32768
  ds_write_b128 v55, v[112:115] offset:34816
  ds_write_b128 v55, v[20:23] offset:33792
  ds_write_b128 v55, v[116:119] offset:35840
  s_waitcnt lgkmcnt(0)
  s_barrier
  ds_write_b128 v55, v[40:43] offset:49152
  ds_write_b128 v55, v[120:123] offset:51200
  ds_write_b128 v55, v[44:47] offset:50176
  ds_write_b128 v55, v[124:127] offset:52224
  s_waitcnt vmcnt(6)
  v_cmp_eq_u32 vcc, 0, v50
  s_cmp_eq_u32 s11, 0
  s_cbranch_scc1 L_R_f
Lww_25:
  global_load_dword v49, v53, s[42:43] offset:0 sc1
  s_waitcnt vmcnt(0)
  v_cmp_gt_u32 vcc, 1, v49
  s_cbranch_vccz Lwd_26
  s_sleep 1
  s_sub_u32 s7, s7, 1
  s_cbranch_scc0 Lww_25
  s_mov_b32 s7, 0
Lwd_26:
  s_cbranch_execz L_e_wr
  global_load_lds_dwordx4 v1, s[78:79] offset:0 sc1
  global_load_lds_dwordx4 v1, s[78:79] offset:1024 sc1
  v_cmp_eq_u32 vcc, 0, v50
L_R_f:
  s_cbranch_vccz L_R_g
Lww_27:
  global_load_dword v49, v53, s[42:43] offset:2048 sc1
  s_waitcnt vmcnt(0)
  v_cmp_gt_u32 vcc, 1, v49
  s_cbranch_vccz Lwd_28
  s_sub_u32 s7, s7, 1
  s_cbranch_scc0 Lww_27
  s_mov_b32 s7, 0
Lwd_28:
L_R_g:
  s_mov_b32 s8, s73
  s_cmp_eq_u32 s8, 0
  s_cbranch_scc1 L_R0
  s_cmp_eq_u32 s8, 1
  s_cbranch_scc1 L_R1
  s_cmp_eq_u32 s8, 2
  s_cbranch_scc1 L_R2
  s_cmp_eq_u32 s8, 3
  s_cbranch_scc1 L_R3
  s_cmp_eq_u32 s8, 4
  s_cbranch_scc1 L_R4
  s_cmp_eq_u32 s8, 5
  s_cbranch_scc1 L_R5
  s_cmp_eq_u32 s8, 6
  s_cbranch_scc1 L_R6
  s_cmp_eq_u32 s8, 7
  s_cbranch_scc1 L_R7
L_send_R:
  s_cbranch_execz L_e_wr
  s_endpgm
.p2align 2
L_R_w:
  s_mov_b64 exec, 0
  s_mov_b64 vcc, -1
  s_mov_b32 s8, s6
  s_cmp_eq_u32 s4, 1
  s_cbranch_scc1 L_R_wd1
  s_cmp_eq_u32 s4, 2
  s_cbranch_scc1 L_R_wd2
  s_cmp_eq_u32 s4, 3
  s_cbranch_scc1 L_R_wd3
L_R_wd0:
  s_sub_u32 s8, s8, 1
  s_cbranch_scc1 L_R0_h0
  s_sub_u32 s8, s8, 1
  s_cbranch_scc1 L_R0_h1
  s_sub_u32 s8, s8, 1
  s_cbranch_scc1 L_R0_h2
  s_sub_u32 s8, s8, 1
  s_cbranch_scc1 L_R0_h3
  s_sub_u32 s8, s8, 1
  s_cbranch_scc1 L_R0_h4
  s_sub_u32 s8, s8, 1
  s_cbranch_scc1 L_R0_h5
  s_sub_u32 s8, s8, 1
  s_cbranch_scc1 L_R0_h6
  s_sub_u32 s8, s8, 1
  s_cbranch_scc1 L_R0_h7
  s_sub_u32 s8, s8, 1
  s_cbranch_scc1 L_R0_h8
  s_sub_u32 s8, s8, 1
  s_cbranch_scc1 L_R0_h9
  s_sub_u32 s8, s8, 1
  s_cbranch_scc1 L_R0_h10
  s_sub_u32 s8, s8, 1
  s_cbranch_scc1 L_R0_h11
  s_sub_u32 s8, s8, 1
  s_cbranch_scc1 L_R0_h12
  s_sub_u32 s8, s8, 1
  s_cbranch_scc1 L_R0_h13
  s_sub_u32 s8, s8, 1
  s_cbranch_scc1 L_R0_h14
  s_sub_u32 s8, s8, 1
  s_cbranch_scc1 L_R0_h15
  s_sub_u32 s8, s8, 1
  s_cbranch_scc1 L_R0_h16
  s_sub_u32 s8, s8, 1
  s_cbranch_scc1 L_R0_h17
  s_sub_u32 s8, s8, 1
  s_cbranch_scc1 L_R0_h18
  s_sub_u32 s8, s8, 1
  s_cbranch_scc1 L_R0_h19
  s_sub_u32 s8, s8, 1
  s_cbranch_scc1 L_R0_h20
  s_sub_u32 s8, s8, 1
  s_cbranch_scc1 L_R0_h21
  s_sub_u32 s8, s8, 1
  s_cbranch_scc1 L_R0_h22
  s_sub_u32 s8, s8, 1
  s_cbranch_scc1 L_R0_h23
  s_sub_u32 s8, s8, 1
  s_cbranch_scc1 L_R0_h24
  s_sub_u32 s8, s8, 1
  s_cbranch_scc1 L_R0_h25
  s_sub_u32 s8, s8, 1
  s_cbranch_scc1 L_R0_h26
  s_branch L_R_wr
L_R_wd1:
  s_sub_u32 s8, s8, 1
  s_cbranch_scc1 L_R1_h0
  s_sub_u32 s8, s8, 1
  s_cbranch_scc1 L_R1_h1
  s_sub_u32 s8, s8, 1
  s_cbranch_scc1 L_R1_h2
  s_sub_u32 s8, s8, 1
  s_cbranch_scc1 L_R1_h3
  s_sub_u32 s8, s8, 1
  s_cbranch_scc1 L_R1_h4
  s_sub_u32 s8, s8, 1
  s_cbranch_scc1 L_R1_h5
  s_sub_u32 s8, s8, 1
  s_cbranch_scc1 L_R1_h6
  s_sub_u32 s8, s8, 1
  s_cbranch_scc1 L_R1_h7
  s_sub_u32 s8, s8, 1
  s_cbranch_scc1 L_R1_h8
  s_sub_u32 s8, s8, 1
  s_cbranch_scc1 L_R1_h9
  s_sub_u32 s8, s8, 1
  s_cbranch_scc1 L_R1_h10
  s_sub_u32 s8, s8, 1
  s_cbranch_scc1 L_R1_h11
  s_sub_u32 s8, s8, 1
  s_cbranch_scc1 L_R1_h12
  s_sub_u32 s8, s8, 1
  s_cbranch_scc1 L_R1_h13
  s_sub_u32 s8, s8, 1
  s_cbranch_scc1 L_R1_h14
  s_sub_u32 s8, s8, 1
  s_cbranch_scc1 L_R1_h15
  s_sub_u32 s8, s8, 1
  s_cbranch_scc1 L_R1_h16
  s_sub_u32 s8, s8, 1
  s_cbranch_scc1 L_R1_h17
  s_sub_u32 s8, s8, 1
  s_cbranch_scc1 L_R1_h18
  s_sub_u32 s8, s8, 1
  s_cbranch_scc1 L_R1_h19
  s_sub_u32 s8, s8, 1
  s_cbranch_scc1 L_R1_h20
  s_sub_u32 s8, s8, 1
  s_cbranch_scc1 L_R1_h21
  s_sub_u32 s8, s8, 1
  s_cbranch_scc1 L_R1_h22
  s_sub_u32 s8, s8, 1
  s_cbranch_scc1 L_R1_h23
  s_sub_u32 s8, s8, 1
  s_cbranch_scc1 L_R1_h24
  s_branch L_R_wr
L_R_wd2:
  s_sub_u32 s8, s8, 1
  s_cbranch_scc1 L_R2_h0
  s_sub_u32 s8, s8, 1
  s_cbranch_scc1 L_R2_h1
  s_sub_u32 s8, s8, 1
  s_cbranch_scc1 L_R2_h2
  s_sub_u32 s8, s8, 1
  s_cbranch_scc1 L_R2_h3
  s_sub_u32 s8, s8, 1
  s_cbranch_scc1 L_R2_h4
  s_sub_u32 s8, s8, 1
  s_cbranch_scc1 L_R2_h5
  s_sub_u32 s8, s8, 1
  s_cbranch_scc1 L_R2_h6
  s_sub_u32 s8, s8, 1
  s_cbranch_scc1 L_R2_h7
  s_sub_u32 s8, s8, 1
  s_cbranch_scc1 L_R2_h8
  s_sub_u32 s8, s8, 1
  s_cbranch_scc1 L_R2_h9
  s_sub_u32 s8, s8, 1
  s_cbranch_scc1 L_R2_h10
  s_sub_u32 s8, s8, 1
  s_cbranch_scc1 L_R2_h11
  s_sub_u32 s8, s8, 1
  s_cbranch_scc1 L_R2_h12
  s_sub_u32 s8, s8, 1
  s_cbranch_scc1 L_R2_h13
  s_sub_u32 s8, s8, 1
  s_cbranch_scc1 L_R2_h14
  s_sub_u32 s8, s8, 1
  s_cbranch_scc1 L_R2_h15
  s_sub_u32 s8, s8, 1
  s_cbranch_scc1 L_R2_h16
  s_sub_u32 s8, s8, 1
  s_cbranch_scc1 L_R2_h17
  s_sub_u32 s8, s8, 1
  s_cbranch_scc1 L_R2_h18
  s_sub_u32 s8, s8, 1
  s_cbranch_scc1 L_R2_h19
  s_sub_u32 s8, s8, 1
  s_cbranch_scc1 L_R2_h20
  s_sub_u32 s8, s8, 1
  s_cbranch_scc1 L_R2_h21
  s_sub_u32 s8, s8, 1
  s_cbranch_scc1 L_R2_h22
  s_sub_u32 s8, s8, 1
  s_cbranch_scc1 L_R2_h23
  s_sub_u32 s8, s8, 1
  s_cbranch_scc1 L_R2_h24
  s_sub_u32 s8, s8, 1
  s_cbranch_scc1 L_R2_h25
  s_sub_u32 s8, s8, 1
  s_cbranch_scc1 L_R2_h26
  s_sub_u32 s8, s8, 1
  s_cbranch_scc1 L_R2_h27
  s_branch L_R_wr
L_R_wd3:
  s_sub_u32 s8, s8, 1
  s_cbranch_scc1 L_R3_h0
  s_sub_u32 s8, s8, 1
  s_cbranch_scc1 L_R3_h1
  s_sub_u32 s8, s8, 1
  s_cbranch_scc1 L_R3_h2
  s_sub_u32 s8, s8, 1
  s_cbranch_scc1 L_R3_h3
  s_sub_u32 s8, s8, 1
  s_cbranch_scc1 L_R3_h4
  s_sub_u32 s8, s8, 1
  s_cbranch_scc1 L_R3_h5
  s_sub_u32 s8, s8, 1
  s_cbranch_scc1 L_R3_h6
  s_sub_u32 s8, s8, 1
  s_cbranch_scc1 L_R3_h7
  s_sub_u32 s8, s8, 1
  s_cbranch_scc1 L_R3_h8
  s_sub_u32 s8, s8, 1
  s_cbranch_scc1 L_R3_h9
  s_sub_u32 s8, s8, 1
  s_cbranch_scc1 L_R3_h10
  s_sub_u32 s8, s8, 1
  s_cbranch_scc1 L_R3_h11
  s_sub_u32 s8, s8, 1
  s_cbranch_scc1 L_R3_h12
  s_sub_u32 s8, s8, 1
  s_cbranch_scc1 L_R3_h13
  s_sub_u32 s8, s8, 1
  s_cbranch_scc1 L_R3_h14
  s_sub_u32 s8, s8, 1
  s_cbranch_scc1 L_R3_h15
  s_sub_u32 s8, s8, 1
  s_cbranch_scc1 L_R3_h16
  s_sub_u32 s8, s8, 1
  s_cbranch_scc1 L_R3_h17
  s_sub_u32 s8, s8, 1
  s_cbranch_scc1 L_R3_h18
  s_sub_u32 s8, s8, 1
  s_cbranch_scc1 L_R3_h19
  s_sub_u32 s8, s8, 1
  s_cbranch_scc1 L_R3_h20
  s_sub_u32 s8, s8, 1
  s_cbranch_scc1 L_R3_h21
  s_sub_u32 s8, s8, 1
  s_cbranch_scc1 L_R3_h22
  s_sub_u32 s8, s8, 1
  s_cbranch_scc1 L_R3_h23
  s_sub_u32 s8, s8, 1
  s_cbranch_scc1 L_R3_h24
  s_sub_u32 s8, s8, 1
  s_cbranch_scc1 L_R3_h25
L_R_wr:
  s_mov_b64 exec, -1
  s_branch L_R_wx
L_R_zw:
  s_mov_b64 exec, 0
  s_cmp_eq_u32 s4, 0
  s_cbranch_scc1 L_R0_zh0
  s_cmp_eq_u32 s4, 1
  s_cbranch_scc1 L_R1_zh0
  s_cmp_eq_u32 s4, 2
  s_cbranch_scc1 L_R2_zh0
  s_cmp_eq_u32 s4, 3
  s_cbranch_scc1 L_R3_zh0
L_R_zr:
  s_mov_b64 exec, -1
  s_branch L_R_zx
.p2align 7
L_R0:
  ds_read_b128 v[88:91], v1 offset:0
  ds_read_b128 v[92:95], v1 offset:1024
  ds_read_b128 v[96:99], v5 offset:0
  ds_read_b128 v[100:103], v5 offset:1024
  ds_read_b128 v[104:107], v1 offset:16384
  ds_read_b128 v[108:111], v1 offset:17408
  ds_read_b128 v[112:115], v1 offset:32768
  ds_read_b128 v[116:119], v1 offset:33792
  ds_read_b128 v[120:123], v1 offset:49152
  ds_read_b128 v[124:127], v1 offset:50176
  v_mov_b32 v19, -1
  v_lshlrev_b32 v10, 3, v1
  global_load_dwordx4 v[80:83], v1, s[62:63]
  global_load_dwordx4 v[84:87], v1, s[62:63] offset:1024
  s_waitcnt vmcnt(2) lgkmcnt(0)
  s_branch L_R0_p2
L_R0_h0:
  s_branch L_R_wr
.p2align 5
L_R0_fe:
  s_cbranch_execz L_R_wr
  s_mov_b64 exec, vcc
  global_load_dwordx4 v[24:27], v1, s[54:55] offset:-2048 sc1
  s_mov_b64 exec, -1
  v_mov_b32 v19, -1
  v_mov_b32 v19, -1
  v_mov_b32 v19, -1
  v_mov_b32 v19, -1
  v_mfma_f32_16x16x1_4b_f32 v[56:71], v0, v0, 0
  s_waitcnt vmcnt(4)
  v_max3_u32 v16, v24, v25, v26
  v_max_u32 v16, v16, v27
  v_cmp_eq_u32 vcc, -1, v16
  s_cbranch_vccz L_R0_p2a
  s_mov_b64 exec, vcc
  global_load_dwordx4 v[24:27], v1, s[54:55] offset:-2048 sc1
  s_mov_b64 exec, -1
  s_waitcnt vmcnt(3)
  v_max3_u32 v16, v24, v25, v26
L_R0_h1:
  s_cbranch_execz L_R_wr
  v_max_u32 v16, v16, v27
  v_cmp_eq_u32 vcc, -1, v16
  s_cbranch_vccz L_R0_p2a
  s_mov_b64 exec, vcc
  global_load_dwordx4 v[24:27], v1, s[54:55] offset:-2048 sc1
  s_mov_b64 exec, -1
  s_waitcnt vmcnt(2)
  v_max3_u32 v16, v24, v25, v26
  v_max_u32 v16, v16, v27
  v_cmp_eq_u32 vcc, -1, v16
  s_cbranch_vccz L_R0_p2a
L_R0_fe2:
  s_mov_b64 exec, vcc
  global_load_dwordx4 v[24:27], v1, s[54:55] offset:-2048 sc1
  s_mov_b64 exec, -1
  s_waitcnt vmcnt(2)
  v_max3_u32 v16, v24, v25, v26
  v_max_u32 v16, v16, v27
  v_cmp_eq_u32 vcc, -1, v16
  s_cbranch_vccz L_R0_p2a
  s_sub_u32 s7, s7, 1
  s_cbranch_scc0 L_R0_fe2
  s_mov_b32 s7, 0
  v_mov_b32 v16, 0
  s_branch L_R0_p2a
L_R0_h2:
  s_branch L_R_wr
.p2align 5
L_R0_fl:
  s_cbranch_execz L_R_wr
  s_mov_b64 exec, vcc
  global_load_dwordx4 v[28:31], v1, s[54:55] offset:2048 sc1
  s_mov_b64 exec, -1
  s_waitcnt vmcnt(2)
  v_max3_u32 v16, v28, v29, v30
  v_max_u32 v16, v16, v31
  v_cmp_eq_u32 vcc, -1, v16
  ds_write_b128 v6, v[28:31] offset:20480
  s_cbranch_vccz L_R0_cl
L_R0_fl2:
  s_mov_b64 exec, vcc
  global_load_dwordx4 v[28:31], v1, s[54:55] offset:2048 sc1
  s_mov_b64 exec, -1
  s_waitcnt vmcnt(2)
  v_max3_u32 v16, v28, v29, v30
  v_max_u32 v16, v16, v31
  v_cmp_eq_u32 vcc, -1, v16
  ds_write_b128 v6, v[28:31] offset:20480
  s_cbranch_vccz L_R0_cl
  s_sub_u32 s7, s7, 1
  s_cbranch_scc0 L_R0_fl2
  s_mov_b32 s7, 0
  s_branch L_R0_cl
L_R0_h3:
  s_branch L_R_wr
.p2align 6
L_R0_p2:
  s_waitcnt vmcnt(4)
  v_max3_u32 v16, v24, v25, v26
  v_max_u32 v16, v16, v27
L_R0_p2a:
  v_smfmac_f32_16x16x64_bf16 v[56:59], v[24:27], v[88:95], v2
  ds_write_b128 v6, v[24:27] offset:16384
  v_cmp_eq_u32 vcc, -1, v16
  v_smfmac_f32_16x16x64_bf16 v[60:63], v[24:27], a[128:135], v2
  v_smfmac_f32_16x16x64_bf16 v[64:67], v[24:27], a[0:7], v2
L_R0_h4:
  s_cbranch_vccnz L_R0_fe
  v_smfmac_f32_16x16x64_bf16 v[68:71], v[24:27], a[8:15], v2
  global_load_dwordx4 v[28:31], v1, s[54:55] offset:2048 sc1
  ds_read_b128 v[88:91], v5 offset:16384
  v_smfmac_f32_16x16x64_bf16 v[72:75], v[24:27], v[128:135], v2
  s_waitcnt lgkmcnt(1)
  s_barrier
  s_waitcnt vmcnt(3)
  v_max3_u32 v16, v28, v29, v30
  v_max_u32 v16, v16, v31
  v_cmp_eq_u32 vcc, -1, v16
  v_smfmac_f32_16x16x64_bf16 v[76:79], v[24:27], v[136:143], v2
  ds_write_b128 v6, v[28:31] offset:20480
L_R0_h5:
  s_cbranch_vccnz L_R0_fl
L_R0_cl:
  v_smfmac_f32_16x16x64_bf16 v[56:59], v[28:31], v[96:103], v2
  ds_read_b128 v[32:35], v6 offset:17408
  global_load_dwordx4 v[80:83], v1, s[62:63]
  v_smfmac_f32_16x16x64_bf16 v[60:63], v[28:31], a[160:167], v2
  ds_read_b128 v[36:39], v6 offset:18432
  global_load_dwordx4 v[84:87], v1, s[62:63] offset:1024
  v_smfmac_f32_16x16x64_bf16 v[64:67], v[28:31], a[64:71], v2
  s_waitcnt lgkmcnt(2)
  s_barrier
  ds_read_b128 v[40:43], v6 offset:19456
  v_smfmac_f32_16x16x64_bf16 v[68:71], v[28:31], a[72:79], v2
  ds_read_b128 v[44:47], v6 offset:21504
  global_load_dword v10, v10, s[68:69]
  v_smfmac_f32_16x16x64_bf16 v[72:75], v[28:31], v[192:199], v2
  ds_read_b128 v[48:51], v6 offset:22528
  v_smfmac_f32_16x16x64_bf16 v[76:79], v[28:31], v[200:207], v2
  ds_read_b128 v[52:55], v6 offset:23552
  global_store_dwordx4 v1, v[20:23], s[64:65] sc1
  s_waitcnt lgkmcnt(5)
  v_smfmac_f32_16x16x64_bf16 v[56:59], v[32:35], v[104:111], v2
  ds_read_b128 v[92:95], v5 offset:17408
  v_smfmac_f32_16x16x64_bf16 v[60:63], v[32:35], a[136:143], v2
  ds_read_b128 v[96:99], v5 offset:32768
  s_waitcnt lgkmcnt(6)
  v_smfmac_f32_16x16x64_bf16 v[56:59], v[36:39], v[112:119], v2
L_R0_h6:
  s_cbranch_execz L_R_wr
  ds_read_b128 v[100:103], v5 offset:33792
  v_smfmac_f32_16x16x64_bf16 v[60:63], v[36:39], a[144:151], v2
  ds_read_b128 v[104:107], v5 offset:49152
  s_waitcnt lgkmcnt(7)
  v_smfmac_f32_16x16x64_bf16 v[56:59], v[40:43], v[120:127], v2
  ds_read_b128 v[108:111], v5 offset:50176
  v_smfmac_f32_16x16x64_bf16 v[60:63], v[40:43], a[152:159], v2
  ds_read_b128 v[112:115], v6 offset:0
  s_waitcnt lgkmcnt(5)
  v_smfmac_f32_16x16x64_bf16 v[56:59], v[44:47], v[88:95], v2
  ds_read_b128 v[116:119], v6 offset:2048
  v_smfmac_f32_16x16x64_bf16 v[60:63], v[44:47], a[168:175], v2
  ds_read_b128 v[120:123], v6 offset:4096
  s_waitcnt lgkmcnt(5)
  v_smfmac_f32_16x16x64_bf16 v[56:59], v[48:51], v[96:103], v2
  global_load_dword v10, v0, s[66:67] sc1
  ds_read_b128 v[124:127], v6 offset:6144
  v_smfmac_f32_16x16x64_bf16 v[60:63], v[48:51], a[176:183], v2
  ds_write_b32 v11, v19 offset:4100
  s_waitcnt lgkmcnt(5)
  v_smfmac_f32_16x16x64_bf16 v[56:59], v[52:55], v[104:111], v2
  v_smfmac_f32_16x16x64_bf16 v[60:63], v[52:55], a[184:191], v2
  s_waitcnt vmcnt(5)
  ds_read_b128 v[24:27], v6 offset:1024
  v_smfmac_f32_16x16x64_bf16 v[64:67], v[32:35], a[16:23], v2
  ds_read_b128 v[28:31], v6 offset:3072
  v_add_f32 v56, v56, v57
  v_add_f32 v58, v58, v59
  v_smfmac_f32_16x16x64_bf16 v[68:71], v[32:35], a[24:31], v2
  v_add_f32 v60, v60, v61
  v_add_f32 v62, v62, v63
  v_smfmac_f32_16x16x64_bf16 v[64:67], v[36:39], a[32:39], v2
  v_cvt_pk_bf16_f32 v16, v56, v60
  v_cvt_pk_bf16_f32 v17, v58, v62
  v_smfmac_f32_16x16x64_bf16 v[68:71], v[36:39], a[40:47], v2
  ds_write2_b32 v7, v16, v17 offset0:0 offset1:16
  v_smfmac_f32_16x16x64_bf16 v[64:67], v[40:43], a[48:55], v2
L_R0_h7:
  s_cbranch_execz L_R_wr
  v_smfmac_f32_16x16x64_bf16 v[68:71], v[40:43], a[56:63], v2
  v_smfmac_f32_16x16x64_bf16 v[64:67], v[44:47], a[80:87], v2
  v_smfmac_f32_16x16x64_bf16 v[68:71], v[44:47], a[88:95], v2
  s_waitcnt lgkmcnt(0)
  s_barrier
  v_smfmac_f32_16x16x64_bf16 v[64:67], v[48:51], a[96:103], v2
  ds_read_b128 v[96:99], v8 offset:0
  v_smfmac_f32_16x16x64_bf16 v[68:71], v[48:51], a[104:111], v2
L_R0_h8:
  s_cbranch_execz L_R_wr
  ds_read_b128 v[100:103], v8 offset:1024
  v_smfmac_f32_16x16x64_bf16 v[64:67], v[52:55], a[112:119], v2
  ds_read_b128 v[104:107], v8 offset:2048
  v_smfmac_f32_16x16x64_bf16 v[68:71], v[52:55], a[120:127], v2
  ds_read_b128 v[108:111], v8 offset:3072
  v_smfmac_f32_16x16x64_bf16 v[72:75], v[32:35], v[144:151], v2
  ds_read_b128 v[88:91], v6 offset:5120
  v_add_f32 v64, v64, v65
  v_smfmac_f32_16x16x64_bf16 v[76:79], v[32:35], v[152:159], v2
  ds_read_b128 v[92:95], v6 offset:7168
  v_add_f32 v66, v66, v67
  s_waitcnt lgkmcnt(5)
  v_mfma_f32_16x16x32_bf16 v[56:59], v[112:115], v[96:99], 0
  v_add_f32 v68, v68, v69
  v_add_f32 v70, v70, v71
  s_waitcnt lgkmcnt(4)
  v_mfma_f32_16x16x32_bf16 v[56:59], v[116:119], v[100:103], v[56:59]
  v_cvt_pk_bf16_f32 v20, v64, v68
  v_cvt_pk_bf16_f32 v21, v66, v70
  s_waitcnt lgkmcnt(3)
  v_mfma_f32_16x16x32_bf16 v[56:59], v[120:123], v[104:107], v[56:59]
  ds_write2_b32 v7, v20, v21 offset0:128 offset1:144
  s_waitcnt lgkmcnt(3)
  v_mfma_f32_16x16x32_bf16 v[56:59], v[124:127], v[108:111], v[56:59]
  ds_read_b128 v[124:127], v6 offset:31744
  v_mfma_f32_16x16x32_bf16 v[60:63], v[24:27], v[96:99], 0
  v_mfma_f32_16x16x32_bf16 v[60:63], v[28:31], v[100:103], v[60:63]
  s_waitcnt lgkmcnt(3)
  v_max3_f32 v16, v56, v57, v58
  v_max_f32 v18, v16, v59
  v_max_f32 v19, v16, v59
  v_mfma_f32_16x16x32_bf16 v[60:63], v[88:91], v[104:107], v[60:63]
  s_waitcnt lgkmcnt(1)
  s_barrier
  v_permlane32_swap_b32 v18, v19
  v_max_f32 v16, v18, v19
  v_max_f32 v17, v18, v19
  v_mfma_f32_16x16x32_bf16 v[60:63], v[92:95], v[108:111], v[60:63]
  ds_read_b128 v[64:67], v9 offset:0
  v_permlane16_swap_b32 v16, v17
  v_max_f32 v16, v16, v17
  v_mul_f32 v13, 0xbe0293ee, v16
  v_smfmac_f32_16x16x64_bf16 v[72:75], v[36:39], v[160:167], v2
  ds_read_b128 v[68:71], v9 offset:1024
  v_fma_f32 v56, v56, s52, v13
  v_fma_f32 v57, v57, s52, v13
  v_smfmac_f32_16x16x64_bf16 v[76:79], v[36:39], v[168:175], v2
  ds_read_b128 v[112:115], v9 offset:2048
  v_exp_f32 v56, v56
  v_smfmac_f32_16x16x64_bf16 v[72:75], v[40:43], v[176:183], v2
  ds_read_b128 v[116:119], v9 offset:3072
  v_fma_f32 v58, v58, s52, v13
  v_exp_f32 v57, v57
  v_smfmac_f32_16x16x64_bf16 v[76:79], v[40:43], v[184:191], v2
  ds_read_b128 v[24:27], v1 offset:2048
  s_waitcnt lgkmcnt(4)
  v_fma_f32 v59, v59, s52, v13
  v_mfma_f32_16x16x32_bf16 v[120:123], v[64:67], v[96:99], 0
L_R0_h9:
  s_cbranch_execz L_R_wr
  v_exp_f32 v58, v58
  v_cvt_pk_bf16_f32 v56, v56, v57
  s_waitcnt lgkmcnt(3)
  v_mfma_f32_16x16x32_bf16 v[120:123], v[68:71], v[100:103], v[120:123]
  v_exp_f32 v59, v59
  v_fma_f32 v60, v60, s52, v13
  s_waitcnt lgkmcnt(2)
  v_mfma_f32_16x16x32_bf16 v[120:123], v[112:115], v[104:107], v[120:123]
  s_waitcnt lgkmcnt(1)
  v_cvt_pk_bf16_f32 v57, v58, v59
  v_fma_f32 v61, v61, s52, v13
  v_exp_f32 v60, v60
  v_mfma_f32_16x16x32_bf16 v[120:123], v[116:119], v[108:111], v[120:123]
  v_fma_f32 v62, v62, s52, v13
  v_exp_f32 v61, v61
  v_smfmac_f32_16x16x64_bf16 v[72:75], v[44:47], v[208:215], v2
  ds_read_b128 v[28:31], v1 offset:3072
  v_fma_f32 v63, v63, s52, v13
  v_smfmac_f32_16x16x64_bf16 v[76:79], v[44:47], v[216:223], v2
  ds_read_b128 v[88:91], v5 offset:2048
  v_exp_f32 v62, v62
  v_smfmac_f32_16x16x64_bf16 v[72:75], v[48:51], v[224:231], v2
  ds_read_b128 v[92:95], v5 offset:3072
  v_exp_f32 v63, v63
  v_smfmac_f32_16x16x64_bf16 v[76:79], v[48:51], v[232:239], v2
  ds_read_b128 v[112:115], v1 offset:18432
  v_cvt_pk_bf16_f32 v58, v60, v61
  v_cvt_pk_bf16_f32 v59, v62, v63
  s_nop 1
  v_mfma_f32_16x16x32_bf16 v[104:107], v[124:127], v[56:59], 0
  s_waitcnt vmcnt(3)
  v_fma_f32 v120, v120, s52, v13
  v_fma_f32 v121, v121, s52, v13
  v_mfma_f32_16x16x32_bf16 v[96:99], v[80:83], v[56:59], 0
L_R0_h10:
  s_cbranch_execz L_R_wr
  v_exp_f32 v18, v120
  v_mfma_f32_16x16x32_bf16 v[100:103], v[84:87], v[56:59], 0
  v_exp_f32 v19, v121
  v_smfmac_f32_16x16x64_bf16 v[72:75], v[52:55], v[240:247], v2
  ds_read_b128 v[116:119], v1 offset:19456
  v_cvt_pk_bf16_f32 v14, v18, v19
  v_lshlrev_b64 v[16:17], v12, v[14:15]
  v_smfmac_f32_16x16x64_bf16 v[76:79], v[52:55], v[248:255], v2
  v_cndmask_b32 v96, v96, v100, s[70:71]
  v_mfma_f32_16x16x16_bf16 v[108:111], v[124:125], v[16:17], v[104:107]
  v_cndmask_b32 v97, v97, v101, s[70:71]
  v_cndmask_b32 v98, v98, v102, s[70:71]
  v_cndmask_b32 v99, v99, v103, s[70:71]
  v_add_f32 v72, v72, v73
  v_add_f32 v74, v74, v75
  v_add_f32 v76, v76, v77
  v_add_f32 v78, v78, v79
  v_cvt_pk_bf16_f32 v22, v72, v74
  v_cvt_pk_bf16_f32 v23, v76, v78
  v_mov_b32 v19, -1
  v_mov_b32 v19, -1
  v_mfma_f32_16x16x16_bf16 v[60:63], v[22:23], v[16:17], v[96:99]
  v_cmp_nge_f32 vcc, s53, v108
  v_rcp_f32 v18, v108
  v_mov_b32 v19, -1
  v_mov_b32 v19, -1
  v_mov_b32 v19, -1
  v_mfma_i32_16x16x4_4b_i8 v[32:47], v0, v0, 0
  v_mov_b32 v19, -1
L_R0_h11:
  s_cbranch_vccnz L_R0_slow
L_R0_sy:
  v_mul_f32 v60, v60, v18
  v_mul_f32 v61, v61, v18
  v_cvt_pk_bf16_f32 v16, v60, v61
  v_mul_f32 v62, v62, v18
  v_mul_f32 v63, v63, v18
  v_cvt_pk_bf16_f32 v17, v62, v63
  ds_write_b64 v11, v[16:17] offset:4096
  v_mov_b32_dpp v72, v16 quad_perm:[0,0,2,2] row_mask:0xf bank_mask:0xf
  v_mov_b32_dpp v74, v16 quad_perm:[1,1,3,3] row_mask:0xf bank_mask:0xf
  v_mov_b32_dpp v73, v17 quad_perm:[0,0,2,2] row_mask:0xf bank_mask:0xf
  v_mov_b32_dpp v75, v17 quad_perm:[1,1,3,3] row_mask:0xf bank_mask:0xf
  ds_read_b128 v[48:51], v8 offset:4608
  s_nop 0
  v_smfmac_f32_16x16x64_bf16 v[32:35], v[72:75], a[192:199], v2
  ds_read_b128 v[52:55], v8 offset:5120
  v_smfmac_f32_16x16x64_bf16 v[36:39], v[72:75], a[224:231], v2
  ds_read_b128 v[76:79], v8 offset:5632
  global_load_lds_dwordx4 v1, s[60:61]
  s_waitcnt lgkmcnt(4)
  v_smfmac_f32_16x16x64_bf16 v[40:43], v[72:75], v[24:31], v2
  global_load_lds_dwordx4 v1, s[60:61] offset:1024
  ds_read_b128 v[64:67], v1 offset:34816
  v_smfmac_f32_16x16x64_bf16 v[44:47], v[72:75], v[88:95], v2
  ds_read_b128 v[68:71], v1 offset:35840
L_R0_ok:
  s_waitcnt lgkmcnt(4)
  v_smfmac_f32_16x16x64_bf16 v[32:35], v[48:51], a[200:207], v2
  ds_read_b128 v[120:123], v1 offset:51200
  v_max_u32 v18, v49, v51
  s_waitcnt lgkmcnt(4)
  v_smfmac_f32_16x16x64_bf16 v[32:35], v[52:55], a[208:215], v2
  ds_read_b128 v[124:127], v1 offset:52224
  v_max3_u32 v18, v18, v53, v55
  s_waitcnt lgkmcnt(4)
  v_smfmac_f32_16x16x64_bf16 v[32:35], v[76:79], a[216:223], v2
  ds_read_b128 v[96:99], v5 offset:18432
  v_max3_u32 v18, v18, v77, v79
  v_smfmac_f32_16x16x64_bf16 v[36:39], v[48:51], a[232:239], v2
  ds_read_b128 v[100:103], v5 offset:19456
  v_smfmac_f32_16x16x64_bf16 v[36:39], v[52:55], a[240:247], v2
  ds_read_b128 v[104:107], v5 offset:34816
  v_cmp_eq_u32 vcc, -1, v18
  v_cvt_pk_bf16_f32 v33, v33, v35
  v_cvt_pk_bf16_f32 v32, v32, v34
  v_and_or_b32 v33, v33, -2, s12
  v_smfmac_f32_16x16x64_bf16 v[36:39], v[76:79], a[248:255], v2
L_R0_h12:
  s_cbranch_vccnz L_R0_of
  global_store_dwordx2 v3, v[32:33], s[46:47] offset:0
  ds_read_b128 v[108:111], v5 offset:35840
  v_smfmac_f32_16x16x64_bf16 v[40:43], v[48:51], v[112:119], v2
  ds_read_b128 v[56:59], v5 offset:51200
  s_waitcnt lgkmcnt(7)
  v_smfmac_f32_16x16x64_bf16 v[40:43], v[52:55], v[64:71], v2
  ds_read_b128 v[60:63], v5 offset:52224
  s_waitcnt lgkmcnt(6)
  v_cvt_pk_bf16_f32 v37, v37, v39
  v_cvt_pk_bf16_f32 v36, v36, v38
  v_and_or_b32 v37, v37, -2, s12
  v_smfmac_f32_16x16x64_bf16 v[40:43], v[76:79], v[120:127], v2
  global_store_dwordx2 v3, v[36:37], s[46:47] offset:2048
  s_waitcnt lgkmcnt(4)
  v_smfmac_f32_16x16x64_bf16 v[44:47], v[48:51], v[96:103], v2
  s_waitcnt lgkmcnt(2)
  v_smfmac_f32_16x16x64_bf16 v[44:47], v[52:55], v[104:111], v2
  ds_read_b128 v[48:51], v6 offset:30720
  v_cvt_pk_bf16_f32 v41, v41, v43
  v_cvt_pk_bf16_f32 v40, v40, v42
  v_and_or_b32 v41, v41, -2, s12
  s_waitcnt lgkmcnt(1)
  v_smfmac_f32_16x16x64_bf16 v[44:47], v[76:79], v[56:63], v2
  global_store_dwordx2 v3, v[40:41], s[48:49] offset:0
  v_mov_b32 v72, 0
  v_mov_b32 v73, 0
  v_mov_b32 v74, 0
  v_mov_b32 v75, 0
  s_nop 2
  v_cvt_pk_bf16_f32 v45, v45, v47
  v_cvt_pk_bf16_f32 v44, v44, v46
  v_and_or_b32 v45, v45, -2, s12
  global_store_dwordx2 v3, v[44:45], s[48:49] offset:2048
  s_add_u32 s54, s54, 0x2000
  s_bitset0_b32 s54, 15
  v_mov_b32 v76, 0
  ds_read_b128 v[88:91], v1 offset:0
  v_mov_b32 v77, 0
  ds_read_b128 v[92:95], v1 offset:1024
  v_mov_b32 v78, 0
  ds_read_b128 v[96:99], v5 offset:0
  v_mov_b32 v79, 0
  ds_read_b128 v[100:103], v5 offset:1024
  v_mov_b32 v19, -1
  ds_read_b128 v[104:107], v1 offset:16384
  v_mov_b32 v19, -1
  ds_read_b128 v[108:111], v1 offset:17408
  v_mov_b32 v19, -1
  ds_read_b128 v[112:115], v1 offset:32768
  global_load_dwordx4 v[80:83], v1, s[50:51] sc1
  global_load_dwordx4 v[84:87], v1, s[50:51] offset:1024 sc1
  v_mov_b32 v19, -1
  ds_read_b128 v[116:119], v1 offset:33792
  v_mov_b32 v19, -1
  ds_read_b128 v[120:123], v1 offset:49152
  v_mov_b32 v19, -1
  ds_read_b128 v[124:127], v1 offset:50176
  v_mov_b32 v19, -1
  s_add_u32 s60, s60, 262144
  s_addc_u32 s61, s61, 0
  v_mov_b32 v19, -1
  s_add_u32 s68, s68, 262144
  s_addc_u32 s69, s69, 0
  v_mov_b32 v19, -1
  s_add_u32 s62, s62, 262144
  s_addc_u32 s63, s63, 0
  v_mov_b32 v19, -1
  s_add_u32 s64, s64, 262144
  s_addc_u32 s65, s65, 0
  v_mov_b32 v19, -1
  v_mov_b32 v19, -1
L_R0_h13:
  s_cbranch_execz L_R_wr
  v_mov_b32 v19, -1
  v_mov_b32 v19, -1
  v_mov_b32 v19, -1
  v_mov_b32 v19, -1
  v_mov_b32 v19, -1
  v_mov_b32 v19, -1
  v_mov_b32 v19, -1
  v_mov_b32 v19, -1
  v_mov_b32 v19, -1
  global_load_dwordx4 v[80:83], v1, s[50:51] sc1
  global_load_dwordx4 v[84:87], v1, s[50:51] offset:1024 sc1
  v_mov_b32 v19, -1
  v_mov_b32 v19, -1
  v_mov_b32 v19, -1
  v_mov_b32 v19, -1
  v_mov_b32 v19, -1
  s_waitcnt lgkmcnt(10)
  v_mfma_f32_16x16x1_4b_f32 v[56:71], v0, v0, 0
  s_waitcnt vmcnt(3)
  v_bitop3_b32 v16, v81, v83, s12 bitop3:0x7e
  v_mfma_f32_16x16x32_bf16 v[52:55], v[48:51], v[80:83], 0
  s_waitcnt vmcnt(2)
  v_bitop3_b32 v17, v85, v87, s12 bitop3:0x7e
  v_mfma_f32_16x16x32_bf16 v[52:55], v[48:51], v[84:87], v[52:55]
  v_bitop3_b32 v16, v16, v17, 1 bitop3:0xa8
  v_cmp_ne_u32 vcc, 0, v16
  v_readfirstlane_b32 s79, v10
  v_mov_b32 v19, -1
  v_mov_b32 v19, -1
  v_mov_b32_e64 v19, -1
  v_mov_b32_e64 v19, -1
  v_mov_b32_e64 v19, -1
L_R0_c1:
  v_add_f32_dpp v52, v52, v52 row_ror:4 row_mask:0xf bank_mask:0xf
  v_add_f32_dpp v53, v53, v53 row_ror:4 row_mask:0xf bank_mask:0xf
L_R0_h14:
  s_cbranch_vccnz L_R0_pf
  v_add_f32_dpp v52, v52, v52 row_ror:8 row_mask:0xf bank_mask:0xf
  v_add_f32_dpp v53, v53, v53 row_ror:8 row_mask:0xf bank_mask:0xf
  v_cvt_pk_bf16_f32 v16, v52, v53
  global_store_dword v4, v16, s[56:57]
  s_cmp_eq_u32 s79, 0
  s_cbranch_scc1 L_R0_fw
L_R0_fok:
  v_mov_b32 v19, -1
  global_store_dword v4, v19, s[58:59]
  s_add_u32 s58, s58, 0x2000
  s_bitset0_b32 s58, 15
  v_mov_b32 v19, -1
  s_cmp_lt_u32 s44, 61
  s_cselect_b32 s74, 2048, 0
  v_mov_b32 v19, -1
  s_add_u32 s66, s66, s74
  s_addc_u32 s67, s67, 0
  v_mov_b32 v19, -1
  s_add_u32 s56, s56, 0x2000
  s_bitset0_b32 s56, 15
  v_mov_b32 v19, -1
  s_xor_b32 s12, s12, 1
  s_add_u32 s44, s44, 1
  v_lshlrev_b32 v10, 3, v1
  s_cmp_eq_u32 s44, 63
  v_mov_b32 v19, -1
L_R0_h15:
  s_cbranch_execz L_R_wr
  v_mov_b32 v19, -1
  v_mov_b32 v19, -1
  v_mov_b32 v19, -1
  v_mov_b32 v19, -1
  v_mov_b32 v19, -1
L_R0_h16:
  s_cbranch_execz L_R_wr
  v_mov_b32 v19, -1
  v_mov_b32 v19, -1
  v_mov_b32 v19, -1
  v_mov_b32 v19, -1
  v_mov_b32 v19, -1
  v_mov_b32 v19, -1
  v_mov_b32 v19, -1
  v_mov_b32 v19, -1
  v_mov_b32 v19, -1
  v_mov_b32 v19, -1
  v_mov_b32 v19, -1
  v_mov_b32 v19, -1
  v_mov_b32 v19, -1
  v_mov_b32 v19, -1
  v_mov_b32 v19, -1
  v_mov_b32 v19, -1
  v_mov_b32 v19, -1
  v_mov_b32 v19, -1
  v_mov_b32 v19, -1
  v_mov_b32 v19, -1
  v_mov_b32 v19, -1
  v_mov_b32 v19, -1
  v_mov_b32 v19, -1
  v_mov_b32 v19, -1
  v_mov_b32 v19, -1
  v_mov_b32 v19, -1
  global_load_dwordx4 v[24:27], v1, s[54:55] offset:-2048 sc1
  v_mov_b32 v19, -1
  v_mov_b32 v19, -1
  v_mov_b32 v19, -1
L_R0_h17:
  s_cbranch_execz L_R_wr
  v_mov_b32 v19, -1
  v_mov_b32 v19, -1
  v_mov_b32 v19, -1
  v_mov_b32 v19, -1
  v_mov_b32 v19, -1
  v_mov_b32 v19, -1
  v_mov_b32 v19, -1
  v_mov_b32 v19, -1
  global_load_dwordx4 v[24:27], v1, s[54:55] offset:-2048 sc1
  v_mov_b32 v19, -1
  v_mov_b32 v19, -1
  v_mov_b32 v19, -1
  v_mov_b32 v19, -1
  v_mov_b32 v19, -1
  v_mov_b32 v19, -1
  global_load_dwordx4 v[28:31], v1, s[54:55] offset:2048 sc1
  v_mov_b32 v19, -1
  v_mov_b32 v19, -1
  v_mov_b32 v19, -1
  v_mov_b32 v19, -1
  v_mov_b32 v19, -1
  v_mov_b32 v19, -1
  v_mov_b32 v19, -1
  v_mov_b32 v19, -1
  v_mov_b32 v19, -1
  v_mov_b32 v19, -1
  v_mov_b32 v19, -1
  v_mov_b32 v19, -1
  global_load_dwordx4 v[24:27], v1, s[54:55] offset:-2048 sc1
  v_mov_b32 v19, -1
  v_mov_b32 v19, -1
  v_mov_b32 v19, -1
  v_mov_b32_e64 v19, -1
  v_mov_b32_e64 v19, -1
  v_mov_b32_e64 v19, -1
  global_load_dwordx4 v[28:31], v1, s[54:55] offset:2048 sc1
  v_mov_b32_e64 v19, -1
  v_mov_b32_e64 v19, -1
  s_cbranch_scc1 L_R0_z
  s_waitcnt lgkmcnt(0)
  v_mfma_f32_16x16x1_4b_f32 v[56:71], v0, v0, 0
  s_branch L_R0_p2
L_R0_h18:
  s_branch L_R_wr
.p2align 2
L_R0_zfe:
L_R0_zh0:
  s_cbranch_execz L_R0_zh1
  global_load_dwordx4 v[24:27], v1, s[54:55] offset:-2048 sc1
  v_mfma_f32_16x16x1_4b_f32 v[56:71], v0, v0, 0
  s_sub_u32 s7, s7, 1
  s_cbranch_scc0 L_R0_ze
  s_mov_b32 s7, 0
  s_branch L_R0_ze1
L_R0_zfl:
  global_load_dwordx4 v[28:31], v1, s[54:55] offset:2048 sc1
L_R0_zh1:
  s_cbranch_execz L_R0_zh2
L_R0_h19:
  s_cbranch_execz L_R_wr
  s_sub_u32 s7, s7, 1
  s_cbranch_scc0 L_R0_zl
  s_mov_b32 s7, 0
  s_branch L_R0_zl1
L_R0_z:
  global_store_dwordx4 v1, v[20:23], s[64:65] sc1
  s_add_u32 s64, s64, 262144
  s_addc_u32 s65, s65, 0
  s_waitcnt lgkmcnt(0)
L_R0_ze:
  s_waitcnt vmcnt(5)
  v_max3_u32 v16, v24, v25, v26
L_R0_zh2:
  s_cbranch_execz L_R0_zh3
  v_max_u32 v16, v16, v27
  v_smfmac_f32_16x16x64_bf16 v[64:67], v[24:27], a[0:7], v2
  ds_write_b128 v6, v[24:27] offset:16384
  v_cmp_eq_u32 vcc, -1, v16
  v_smfmac_f32_16x16x64_bf16 v[68:71], v[24:27], a[8:15], v2
  v_mov_b32 v19, -1
  v_mov_b32 v19, -1
  v_mov_b32 v19, -1
  v_mov_b32 v19, -1
  s_cbranch_vccnz L_R0_zfe
L_R0_ze1:
  v_smfmac_f32_16x16x64_bf16 v[72:75], v[24:27], v[128:135], v2
L_R0_zh3:
  s_cbranch_execz L_R0_zh4
L_R0_h20:
  s_cbranch_execz L_R_wr
  v_smfmac_f32_16x16x64_bf16 v[76:79], v[24:27], v[136:143], v2
  s_waitcnt lgkmcnt(0)
  s_barrier
L_R0_zl:
  s_waitcnt vmcnt(3)
  v_max3_u32 v16, v28, v29, v30
  v_max_u32 v16, v16, v31
  v_cmp_eq_u32 vcc, -1, v16
  ds_read_b128 v[32:35], v6 offset:17408
  ds_read_b128 v[36:39], v6 offset:18432
  ds_read_b128 v[40:43], v6 offset:19456
L_R0_zh4:
  s_cbranch_execz L_R0_zh5
  ds_write_b128 v6, v[28:31] offset:20480
  s_cbranch_vccnz L_R0_zfl
L_R0_zl1:
  v_smfmac_f32_16x16x64_bf16 v[64:67], v[28:31], a[64:71], v2
  v_smfmac_f32_16x16x64_bf16 v[68:71], v[28:31], a[72:79], v2
  v_smfmac_f32_16x16x64_bf16 v[72:75], v[28:31], v[192:199], v2
  s_waitcnt lgkmcnt(0)
  s_barrier
  v_smfmac_f32_16x16x64_bf16 v[76:79], v[28:31], v[200:207], v2
  v_smfmac_f32_16x16x64_bf16 v[64:67], v[32:35], a[16:23], v2
L_R0_zh5:
  s_cbranch_execz L_R0_zh6
L_R0_h21:
  s_cbranch_execz L_R_wr
  ds_read_b128 v[44:47], v6 offset:21504
  v_smfmac_f32_16x16x64_bf16 v[68:71], v[32:35], a[24:31], v2
  ds_read_b128 v[48:51], v6 offset:22528
  v_smfmac_f32_16x16x64_bf16 v[72:75], v[32:35], v[144:151], v2
  ds_read_b128 v[52:55], v6 offset:23552
  v_smfmac_f32_16x16x64_bf16 v[76:79], v[32:35], v[152:159], v2
  v_smfmac_f32_16x16x64_bf16 v[64:67], v[36:39], a[32:39], v2
L_R0_zh6:
  s_cbranch_execz L_R0_zh7
  v_smfmac_f32_16x16x64_bf16 v[68:71], v[36:39], a[40:47], v2
  v_smfmac_f32_16x16x64_bf16 v[72:75], v[36:39], v[160:167], v2
  v_smfmac_f32_16x16x64_bf16 v[76:79], v[36:39], v[168:175], v2
  v_smfmac_f32_16x16x64_bf16 v[64:67], v[40:43], a[48:55], v2
  v_smfmac_f32_16x16x64_bf16 v[68:71], v[40:43], a[56:63], v2
  v_smfmac_f32_16x16x64_bf16 v[72:75], v[40:43], v[176:183], v2
  v_smfmac_f32_16x16x64_bf16 v[76:79], v[40:43], v[184:191], v2
L_R0_zh7:
  s_cbranch_execz L_R0_zh8
L_R0_h22:
  s_cbranch_execz L_R_wr
  s_waitcnt lgkmcnt(0)
  v_smfmac_f32_16x16x64_bf16 v[64:67], v[44:47], a[80:87], v2
  v_smfmac_f32_16x16x64_bf16 v[68:71], v[44:47], a[88:95], v2
  v_smfmac_f32_16x16x64_bf16 v[64:67], v[48:51], a[96:103], v2
  v_smfmac_f32_16x16x64_bf16 v[68:71], v[48:51], a[104:111], v2
  v_smfmac_f32_16x16x64_bf16 v[64:67], v[52:55], a[112:119], v2
  v_smfmac_f32_16x16x64_bf16 v[68:71], v[52:55], a[120:127], v2
  v_smfmac_f32_16x16x64_bf16 v[72:75], v[44:47], v[208:215], v2
L_R0_zh8:
  s_cbranch_execz L_R0_zh9
  v_smfmac_f32_16x16x64_bf16 v[76:79], v[44:47], v[216:223], v2
  v_smfmac_f32_16x16x64_bf16 v[72:75], v[48:51], v[224:231], v2
  v_add_f32 v64, v64, v65
  v_add_f32 v66, v66, v67
  v_smfmac_f32_16x16x64_bf16 v[76:79], v[48:51], v[232:239], v2
  v_add_f32 v68, v68, v69
  v_add_f32 v70, v70, v71
  v_smfmac_f32_16x16x64_bf16 v[72:75], v[52:55], v[240:247], v2
  v_cvt_pk_bf16_f32 v20, v64, v68
L_R0_zh9:
  s_cbranch_execz L_R0_zh10
L_R0_h23:
  s_cbranch_execz L_R_wr
  v_cvt_pk_bf16_f32 v21, v66, v70
  v_smfmac_f32_16x16x64_bf16 v[76:79], v[52:55], v[248:255], v2
  v_mov_b32 v19, -1
  v_mov_b32 v19, -1
  v_mov_b32 v19, -1
  v_mov_b32 v19, -1
  v_add_f32 v72, v72, v73
  v_add_f32 v74, v74, v75
  v_cvt_pk_bf16_f32 v22, v72, v74
  v_mov_b32 v19, -1
  v_add_f32 v76, v76, v77
L_R0_zh10:
  s_cbranch_execz L_R_zr
  v_add_f32 v78, v78, v79
  v_cvt_pk_bf16_f32 v23, v76, v78
L_R0_fin:
  global_store_dwordx4 v1, v[20:23], s[64:65] sc1
  s_endpgm
.p2align 2
.p2align 5
L_R0_pf:
  s_cbranch_execz L_R_wr
  s_mov_b64 exec, vcc
  global_load_dwordx4 v[80:83], v1, s[50:51] sc1
  global_load_dwordx4 v[84:87], v1, s[50:51] offset:1024 sc1
  s_mov_b64 exec, -1
  s_waitcnt vmcnt(3)
  v_bitop3_b32 v16, v81, v83, s12 bitop3:0x7e
  v_mfma_f32_16x16x32_bf16 v[52:55], v[48:51], v[80:83], 0
  s_waitcnt vmcnt(2)
  v_bitop3_b32 v17, v85, v87, s12 bitop3:0x7e
  v_mfma_f32_16x16x32_bf16 v[52:55], v[48:51], v[84:87], v[52:55]
  v_bitop3_b32 v16, v16, v17, 1 bitop3:0xa8
  v_cmp_ne_u32 vcc, 0, v16
  s_nop 2
  s_cbranch_vccz L_R0_c1
L_R0_pf2:
  s_mov_b64 exec, vcc
  global_load_dwordx4 v[80:83], v1, s[50:51] sc1
  global_load_dwordx4 v[84:87], v1, s[50:51] offset:1024 sc1
  s_mov_b64 exec, -1
  s_waitcnt vmcnt(3)
  v_bitop3_b32 v16, v81, v83, s12 bitop3:0x7e
  v_mfma_f32_16x16x32_bf16 v[52:55], v[48:51], v[80:83], 0
L_R0_h24:
  s_cbranch_execz L_R_wr
  s_waitcnt vmcnt(2)
  v_bitop3_b32 v17, v85, v87, s12 bitop3:0x7e
  v_mfma_f32_16x16x32_bf16 v[52:55], v[48:51], v[84:87], v[52:55]
  v_bitop3_b32 v16, v16, v17, 1 bitop3:0xa8
  v_cmp_ne_u32 vcc, 0, v16
  s_nop 2
  s_cbranch_vccz L_R0_c1
  s_sub_u32 s7, s7, 1
  s_cbranch_scc0 L_R0_pf2
  s_mov_b32 s7, 0
  s_mov_b64 vcc, 0
  s_branch L_R0_c1
L_R0_h25:
  s_branch L_R_wr
L_R0_of:
  s_cbranch_execz L_R_wr
  s_nop 7
  ds_read_b128 v[48:51], v8 offset:4608
  ds_read_b128 v[52:55], v8 offset:5120
  ds_read_b128 v[76:79], v8 offset:5632
  s_waitcnt lgkmcnt(0)
  v_max_u32 v18, v49, v51
  v_max3_u32 v18, v18, v53, v55
  v_max3_u32 v18, v18, v77, v79
  v_cmp_eq_u32 vcc, -1, v18
  s_cbranch_vccz L_R0_og
  s_sub_u32 s7, s7, 1
  s_cbranch_scc0 L_R0_of
  s_mov_b32 s7, 0
  v_min_u32 v49, -2, v49
  v_min_u32 v51, -2, v51
  v_min_u32 v53, -2, v53
  v_min_u32 v55, -2, v55
  v_min_u32 v77, -2, v77
  v_min_u32 v79, -2, v79
L_R0_og:
  v_mfma_i32_16x16x4_4b_i8 v[32:47], v0, v0, 0
  s_nop 11
  v_smfmac_f32_16x16x64_bf16 v[32:35], v[72:75], a[192:199], v2
  v_smfmac_f32_16x16x64_bf16 v[36:39], v[72:75], a[224:231], v2
  v_smfmac_f32_16x16x64_bf16 v[40:43], v[72:75], v[24:31], v2
  v_smfmac_f32_16x16x64_bf16 v[44:47], v[72:75], v[88:95], v2
  s_branch L_R0_ok
L_R0_h26:
  s_branch L_R_wr
L_R0_fw:
Lww_29:
  global_load_dword v19, v0, s[66:67] offset:0 sc1
  s_waitcnt vmcnt(0)
  v_cmp_gt_u32 vcc, 1, v19
  s_cbranch_vccz Lwd_30
  s_sub_u32 s7, s7, 1
  s_cbranch_scc0 Lww_29
  s_mov_b32 s7, 0
Lwd_30:
  s_branch L_R0_fok
.p2align 2
L_R0_slow:
  s_cbranch_execz L_R_wr
  s_nop 7
  s_nop 7
  ds_read_b128 v[32:35], v6 offset:0
  ds_read_b128 v[36:39], v6 offset:1024
  ds_read_b128 v[40:43], v8 offset:0
  ds_read_b128 v[44:47], v9 offset:0
  s_waitcnt lgkmcnt(0)
  v_mfma_f32_16x16x32_bf16 v[56:59], v[32:35], v[40:43], 0
  v_mfma_f32_16x16x32_bf16 v[60:63], v[36:39], v[40:43], 0
  v_mfma_f32_16x16x32_bf16 v[120:123], v[44:47], v[40:43], 0
  s_nop 7
  ds_read_b128 v[32:35], v6 offset:2048
  ds_read_b128 v[36:39], v6 offset:3072
  ds_read_b128 v[40:43], v8 offset:1024
  ds_read_b128 v[44:47], v9 offset:1024
  s_waitcnt lgkmcnt(0)
  v_mfma_f32_16x16x32_bf16 v[56:59], v[32:35], v[40:43], v[56:59]
  v_mfma_f32_16x16x32_bf16 v[60:63], v[36:39], v[40:43], v[60:63]
  v_mfma_f32_16x16x32_bf16 v[120:123], v[44:47], v[40:43], v[120:123]
  s_nop 7
  ds_read_b128 v[32:35], v6 offset:4096
  ds_read_b128 v[36:39], v6 offset:5120
  ds_read_b128 v[40:43], v8 offset:2048
  ds_read_b128 v[44:47], v9 offset:2048
  s_waitcnt lgkmcnt(0)
  v_mfma_f32_16x16x32_bf16 v[56:59], v[32:35], v[40:43], v[56:59]
  v_mfma_f32_16x16x32_bf16 v[60:63], v[36:39], v[40:43], v[60:63]
  v_mfma_f32_16x16x32_bf16 v[120:123], v[44:47], v[40:43], v[120:123]
  s_nop 7
  ds_read_b128 v[32:35], v6 offset:6144
  ds_read_b128 v[36:39], v6 offset:7168
  ds_read_b128 v[40:43], v8 offset:3072
  ds_read_b128 v[44:47], v9 offset:3072
  s_waitcnt lgkmcnt(0)
  v_mfma_f32_16x16x32_bf16 v[56:59], v[32:35], v[40:43], v[56:59]
  v_mfma_f32_16x16x32_bf16 v[60:63], v[36:39], v[40:43], v[60:63]
  v_mfma_f32_16x16x32_bf16 v[120:123], v[44:47], v[40:43], v[120:123]
  s_nop 7
  v_mfma_i32_16x16x4_4b_i8 v[32:47], v0, v0, 0
  v_max3_f32 v16, v56, v57, v58
  v_max3_f32 v17, v59, v60, v61
  v_max3_f32 v16, v16, v62, v63
  v_max3_f32 v17, v17, v120, v121
  v_max_f32 v18, v16, v17
  v_max_f32 v19, v16, v17
  s_nop 1
  v_permlane32_swap_b32 v18, v19
  v_max_f32 v16, v18, v19
  v_max_f32 v17, v18, v19
  s_nop 1
  v_permlane16_swap_b32 v16, v17
  v_max_f32 v16, v16, v17
  v_mul_f32 v13, 0xbe0293ee, v16
  v_fma_f32 v56, v56, s52, v13
  v_fma_f32 v57, v57, s52, v13
  v_exp_f32 v56, v56
  v_fma_f32 v58, v58, s52, v13
  v_exp_f32 v57, v57
  v_fma_f32 v59, v59, s52, v13
  v_exp_f32 v58, v58
  v_cvt_pk_bf16_f32 v56, v56, v57
  v_exp_f32 v59, v59
  v_fma_f32 v60, v60, s52, v13
  v_cvt_pk_bf16_f32 v57, v58, v59
  v_fma_f32 v61, v61, s52, v13
  v_exp_f32 v60, v60
  v_fma_f32 v62, v62, s52, v13
  v_exp_f32 v61, v61
  v_fma_f32 v63, v63, s52, v13
  v_exp_f32 v62, v62
  v_exp_f32 v63, v63
  v_cvt_pk_bf16_f32 v58, v60, v61
  v_cvt_pk_bf16_f32 v59, v62, v63
  v_fma_f32 v120, v120, s52, v13
  v_fma_f32 v121, v121, s52, v13
  v_exp_f32 v18, v120
  v_exp_f32 v19, v121
  v_mfma_f32_16x16x32_bf16 v[104:107], v[124:127], v[56:59], 0
  v_mfma_f32_16x16x32_bf16 v[96:99], v[80:83], v[56:59], 0
  v_mfma_f32_16x16x32_bf16 v[100:103], v[84:87], v[56:59], 0
  v_cvt_pk_bf16_f32 v14, v18, v19
  v_lshlrev_b64 v[16:17], v12, v[14:15]
  s_nop 1
  v_mfma_f32_16x16x16_bf16 v[108:111], v[124:125], v[16:17], v[104:107]
  s_nop 2
  v_cndmask_b32 v96, v96, v100, s[70:71]
  v_cndmask_b32 v97, v97, v101, s[70:71]
  v_cndmask_b32 v98, v98, v102, s[70:71]
  v_cndmask_b32 v99, v99, v103, s[70:71]
  s_nop 1
  v_mfma_f32_16x16x16_bf16 v[60:63], v[22:23], v[16:17], v[96:99]
  v_rcp_f32 v18, v108
  s_nop 7
  s_barrier
  s_branch L_R0_sy
.p2align 7
L_R1:
  ds_read_b128 v[88:91], v1 offset:20480
  ds_read_b128 v[92:95], v1 offset:21504
  ds_read_b128 v[96:99], v5 offset:20480
  ds_read_b128 v[100:103], v5 offset:21504
  ds_read_b128 v[104:107], v1 offset:36864
  ds_read_b128 v[108:111], v1 offset:37888
  ds_read_b128 v[112:115], v1 offset:53248
  ds_read_b128 v[116:119], v1 offset:54272
  ds_read_b128 v[120:123], v1 offset:4096
  ds_read_b128 v[124:127], v1 offset:5120
  v_mov_b32 v19, -1
  v_lshlrev_b32 v10, 3, v1
  global_load_dwordx4 v[80:83], v1, s[62:63]
  global_load_dwordx4 v[84:87], v1, s[62:63] offset:1024
  s_waitcnt vmcnt(2) lgkmcnt(0)
  s_branch L_R1_p2
L_R1_h0:
  s_branch L_R_wr
.p2align 5
L_R1_fe:
  s_cbranch_execz L_R_wr
  s_mov_b64 exec, vcc
  global_load_dwordx4 v[24:27], v1, s[54:55] offset:-2048 sc1
  s_mov_b64 exec, -1
  v_mov_b32 v19, -1
  v_mov_b32 v19, -1
  v_mov_b32 v19, -1
  v_mov_b32 v19, -1
  v_mfma_f32_16x16x1_4b_f32 v[56:71], v0, v0, 0
  s_waitcnt vmcnt(4)
  v_max3_u32 v16, v24, v25, v26
  v_max_u32 v16, v16, v27
  v_cmp_eq_u32 vcc, -1, v16
  s_cbranch_vccz L_R1_p2a
  s_mov_b64 exec, vcc
  global_load_dwordx4 v[24:27], v1, s[54:55] offset:-2048 sc1
  s_mov_b64 exec, -1
  s_waitcnt vmcnt(3)
  v_max3_u32 v16, v24, v25, v26
L_R1_h1:
  s_cbranch_execz L_R_wr
  v_max_u32 v16, v16, v27
  v_cmp_eq_u32 vcc, -1, v16
  s_cbranch_vccz L_R1_p2a
  s_mov_b64 exec, vcc
  global_load_dwordx4 v[24:27], v1, s[54:55] offset:-2048 sc1
  s_mov_b64 exec, -1
  s_waitcnt vmcnt(2)
  v_max3_u32 v16, v24, v25, v26
  v_max_u32 v16, v16, v27
  v_cmp_eq_u32 vcc, -1, v16
  s_cbranch_vccz L_R1_p2a
L_R1_fe2:
  s_mov_b64 exec, vcc
  global_load_dwordx4 v[24:27], v1, s[54:55] offset:-2048 sc1
  s_mov_b64 exec, -1
  s_waitcnt vmcnt(2)
  v_max3_u32 v16, v24, v25, v26
  v_max_u32 v16, v16, v27
  v_cmp_eq_u32 vcc, -1, v16
  s_cbranch_vccz L_R1_p2a
  s_sub_u32 s7, s7, 1
  s_cbranch_scc0 L_R1_fe2
  s_mov_b32 s7, 0
  v_mov_b32 v16, 0
  s_branch L_R1_p2a
L_R1_h2:
  s_branch L_R_wr
.p2align 5
L_R1_fl:
  s_cbranch_execz L_R_wr
  s_mov_b64 exec, vcc
  global_load_dwordx4 v[28:31], v1, s[54:55] offset:2048 sc1
  s_mov_b64 exec, -1
  s_waitcnt vmcnt(2)
  v_max3_u32 v16, v28, v29, v30
  v_max_u32 v16, v16, v31
  v_cmp_eq_u32 vcc, -1, v16
  ds_write_b128 v6, v[28:31] offset:21504
  s_cbranch_vccz L_R1_cl
L_R1_fl2:
  s_mov_b64 exec, vcc
  global_load_dwordx4 v[28:31], v1, s[54:55] offset:2048 sc1
  s_mov_b64 exec, -1
  s_waitcnt vmcnt(2)
  v_max3_u32 v16, v28, v29, v30
  v_max_u32 v16, v16, v31
  v_cmp_eq_u32 vcc, -1, v16
  ds_write_b128 v6, v[28:31] offset:21504
  s_cbranch_vccz L_R1_cl
  s_sub_u32 s7, s7, 1
  s_cbranch_scc0 L_R1_fl2
  s_mov_b32 s7, 0
  s_branch L_R1_cl
L_R1_h3:
  s_branch L_R_wr
.p2align 6
L_R1_p2:
  s_waitcnt vmcnt(4)
  v_max3_u32 v16, v24, v25, v26
  v_max_u32 v16, v16, v27
L_R1_p2a:
  v_smfmac_f32_16x16x64_bf16 v[56:59], v[24:27], v[88:95], v2
  ds_write_b128 v6, v[24:27] offset:17408
  v_cmp_eq_u32 vcc, -1, v16
  v_smfmac_f32_16x16x64_bf16 v[60:63], v[24:27], a[136:143], v2
  v_smfmac_f32_16x16x64_bf16 v[64:67], v[24:27], a[16:23], v2
L_R1_h4:
  s_cbranch_vccnz L_R1_fe
  v_smfmac_f32_16x16x64_bf16 v[68:71], v[24:27], a[24:31], v2
  global_load_dwordx4 v[28:31], v1, s[54:55] offset:2048 sc1
  ds_read_b128 v[88:91], v5 offset:36864
  v_smfmac_f32_16x16x64_bf16 v[72:75], v[24:27], v[144:151], v2
  s_waitcnt lgkmcnt(1)
  s_barrier
  s_waitcnt vmcnt(3)
  v_max3_u32 v16, v28, v29, v30
  v_max_u32 v16, v16, v31
  v_cmp_eq_u32 vcc, -1, v16
  v_smfmac_f32_16x16x64_bf16 v[76:79], v[24:27], v[152:159], v2
  ds_write_b128 v6, v[28:31] offset:21504
L_R1_h5:
  s_cbranch_vccnz L_R1_fl
L_R1_cl:
  v_smfmac_f32_16x16x64_bf16 v[56:59], v[28:31], v[96:103], v2
  ds_read_b128 v[32:35], v6 offset:18432
  global_load_dwordx4 v[80:83], v1, s[62:63]
  v_smfmac_f32_16x16x64_bf16 v[60:63], v[28:31], a[168:175], v2
  ds_read_b128 v[36:39], v6 offset:19456
  global_load_dwordx4 v[84:87], v1, s[62:63] offset:1024
  v_smfmac_f32_16x16x64_bf16 v[64:67], v[28:31], a[80:87], v2
  s_waitcnt lgkmcnt(2)
  s_barrier
  ds_read_b128 v[40:43], v6 offset:16384
  v_smfmac_f32_16x16x64_bf16 v[68:71], v[28:31], a[88:95], v2
  ds_read_b128 v[44:47], v6 offset:22528
  v_smfmac_f32_16x16x64_bf16 v[72:75], v[28:31], v[208:215], v2
  ds_read_b128 v[48:51], v6 offset:23552
  v_smfmac_f32_16x16x64_bf16 v[76:79], v[28:31], v[216:223], v2
  ds_read_b128 v[52:55], v6 offset:20480
  s_waitcnt lgkmcnt(5)
  v_smfmac_f32_16x16x64_bf16 v[56:59], v[32:35], v[104:111], v2
  ds_read_b128 v[92:95], v5 offset:37888
  v_smfmac_f32_16x16x64_bf16 v[60:63], v[32:35], a[144:151], v2
  global_store_dwordx4 v1, v[20:23], s[64:65] sc1
  ds_read_b128 v[96:99], v5 offset:53248
  s_waitcnt lgkmcnt(6)
  v_smfmac_f32_16x16x64_bf16 v[56:59], v[36:39], v[112:119], v2
  ds_read_b128 v[100:103], v5 offset:54272
  v_smfmac_f32_16x16x64_bf16 v[60:63], v[36:39], a[152:159], v2
  ds_read_b128 v[104:107], v5 offset:4096
  s_waitcnt lgkmcnt(7)
  v_smfmac_f32_16x16x64_bf16 v[56:59], v[40:43], v[120:127], v2
  ds_read_b128 v[108:111], v5 offset:5120
  v_smfmac_f32_16x16x64_bf16 v[60:63], v[40:43], a[128:135], v2
  ds_read_b128 v[112:115], v6 offset:0
  s_waitcnt lgkmcnt(5)
  v_smfmac_f32_16x16x64_bf16 v[56:59], v[44:47], v[88:95], v2
L_R1_h6:
  s_cbranch_execz L_R_wr
  ds_read_b128 v[116:119], v6 offset:2048
  v_smfmac_f32_16x16x64_bf16 v[60:63], v[44:47], a[176:183], v2
  ds_read_b128 v[120:123], v6 offset:4096
  s_waitcnt lgkmcnt(5)
  v_smfmac_f32_16x16x64_bf16 v[56:59], v[48:51], v[96:103], v2
  global_load_dword v10, v0, s[66:67] sc1
  ds_read_b128 v[124:127], v6 offset:6144
  v_smfmac_f32_16x16x64_bf16 v[60:63], v[48:51], a[184:191], v2
  ds_write_b32 v11, v19 offset:4612
  s_waitcnt lgkmcnt(5)
  v_smfmac_f32_16x16x64_bf16 v[56:59], v[52:55], v[104:111], v2
  v_smfmac_f32_16x16x64_bf16 v[60:63], v[52:55], a[160:167], v2
  s_waitcnt vmcnt(4)
  ds_read_b128 v[24:27], v6 offset:1024
  v_smfmac_f32_16x16x64_bf16 v[64:67], v[32:35], a[32:39], v2
  ds_read_b128 v[28:31], v6 offset:3072
  v_add_f32 v56, v56, v57
  v_add_f32 v58, v58, v59
  v_smfmac_f32_16x16x64_bf16 v[68:71], v[32:35], a[40:47], v2
L_R1_h7:
  s_cbranch_execz L_R_wr
  v_add_f32 v60, v60, v61
  v_add_f32 v62, v62, v63
  v_smfmac_f32_16x16x64_bf16 v[64:67], v[36:39], a[48:55], v2
  v_cvt_pk_bf16_f32 v16, v56, v60
  v_cvt_pk_bf16_f32 v17, v58, v62
  v_smfmac_f32_16x16x64_bf16 v[68:71], v[36:39], a[56:63], v2
  ds_write2_b32 v7, v16, v17 offset0:0 offset1:16
  v_smfmac_f32_16x16x64_bf16 v[64:67], v[40:43], a[0:7], v2
  v_smfmac_f32_16x16x64_bf16 v[68:71], v[40:43], a[8:15], v2
  v_smfmac_f32_16x16x64_bf16 v[64:67], v[44:47], a[96:103], v2
  v_smfmac_f32_16x16x64_bf16 v[68:71], v[44:47], a[104:111], v2
  s_waitcnt lgkmcnt(0)
  s_barrier
  v_smfmac_f32_16x16x64_bf16 v[64:67], v[48:51], a[112:119], v2
  ds_read_b128 v[96:99], v8 offset:0
  v_smfmac_f32_16x16x64_bf16 v[68:71], v[48:51], a[120:127], v2
  ds_read_b128 v[100:103], v8 offset:1024
  v_smfmac_f32_16x16x64_bf16 v[64:67], v[52:55], a[64:71], v2
  ds_read_b128 v[104:107], v8 offset:2048
  v_smfmac_f32_16x16x64_bf16 v[68:71], v[52:55], a[72:79], v2
  ds_read_b128 v[108:111], v8 offset:3072
  v_smfmac_f32_16x16x64_bf16 v[72:75], v[32:35], v[160:167], v2
  ds_read_b128 v[88:91], v6 offset:5120
  v_add_f32 v64, v64, v65
  v_smfmac_f32_16x16x64_bf16 v[76:79], v[32:35], v[168:175], v2
  ds_read_b128 v[92:95], v6 offset:7168
  v_add_f32 v66, v66, v67
  s_waitcnt lgkmcnt(5)
  v_mfma_f32_16x16x32_bf16 v[56:59], v[112:115], v[96:99], 0
  v_add_f32 v68, v68, v69
  v_add_f32 v70, v70, v71
  s_waitcnt lgkmcnt(4)
  v_mfma_f32_16x16x32_bf16 v[56:59], v[116:119], v[100:103], v[56:59]
  v_cvt_pk_bf16_f32 v20, v64, v68
  v_cvt_pk_bf16_f32 v21, v66, v70
  s_waitcnt lgkmcnt(3)
  v_mfma_f32_16x16x32_bf16 v[56:59], v[120:123], v[104:107], v[56:59]
  ds_write2_b32 v7, v20, v21 offset0:128 offset1:144
  s_waitcnt lgkmcnt(3)
  v_mfma_f32_16x16x32_bf16 v[56:59], v[124:127], v[108:111], v[56:59]
  ds_read_b128 v[124:127], v6 offset:31744
  v_mfma_f32_16x16x32_bf16 v[60:63], v[24:27], v[96:99], 0
  v_mfma_f32_16x16x32_bf16 v[60:63], v[28:31], v[100:103], v[60:63]
  s_waitcnt lgkmcnt(3)
  v_max3_f32 v16, v56, v57, v58
  v_max_f32 v18, v16, v59
  v_max_f32 v19, v16, v59
  v_mfma_f32_16x16x32_bf16 v[60:63], v[88:91], v[104:107], v[60:63]
  s_waitcnt lgkmcnt(1)
  s_barrier
  v_permlane32_swap_b32 v18, v19
  v_max_f32 v16, v18, v19
  v_max_f32 v17, v18, v19
  v_mfma_f32_16x16x32_bf16 v[60:63], v[92:95], v[108:111], v[60:63]
  ds_read_b128 v[64:67], v9 offset:0
  v_permlane16_swap_b32 v16, v17
  v_max_f32 v16, v16, v17
  v_mul_f32 v13, 0xbe0293ee, v16
  v_smfmac_f32_16x16x64_bf16 v[72:75], v[36:39], v[176:183], v2
  ds_read_b128 v[68:71], v9 offset:1024
  v_fma_f32 v56, v56, s52, v13
  v_fma_f32 v57, v57, s52, v13
  v_smfmac_f32_16x16x64_bf16 v[76:79], v[36:39], v[184:191], v2
  ds_read_b128 v[112:115], v9 offset:2048
  v_exp_f32 v56, v56
  v_smfmac_f32_16x16x64_bf16 v[72:75], v[40:43], v[128:135], v2
  ds_read_b128 v[116:119], v9 offset:3072
  v_fma_f32 v58, v58, s52, v13
  v_exp_f32 v57, v57
  v_smfmac_f32_16x16x64_bf16 v[76:79], v[40:43], v[136:143], v2
  ds_read_b128 v[24:27], v1 offset:22528
  s_waitcnt lgkmcnt(4)
  v_fma_f32 v59, v59, s52, v13
  v_mfma_f32_16x16x32_bf16 v[120:123], v[64:67], v[96:99], 0
  v_exp_f32 v58, v58
  v_cvt_pk_bf16_f32 v56, v56, v57
  s_waitcnt lgkmcnt(3)
  v_mfma_f32_16x16x32_bf16 v[120:123], v[68:71], v[100:103], v[120:123]
  v_exp_f32 v59, v59
  v_fma_f32 v60, v60, s52, v13
  s_waitcnt lgkmcnt(2)
  v_mfma_f32_16x16x32_bf16 v[120:123], v[112:115], v[104:107], v[120:123]
  s_waitcnt lgkmcnt(1)
  v_cvt_pk_bf16_f32 v57, v58, v59
  v_fma_f32 v61, v61, s52, v13
  v_exp_f32 v60, v60
  v_mfma_f32_16x16x32_bf16 v[120:123], v[116:119], v[108:111], v[120:123]
  v_fma_f32 v62, v62, s52, v13
  v_exp_f32 v61, v61
  v_smfmac_f32_16x16x64_bf16 v[72:75], v[44:47], v[224:231], v2
  ds_read_b128 v[28:31], v1 offset:23552
  v_fma_f32 v63, v63, s52, v13
  v_smfmac_f32_16x16x64_bf16 v[76:79], v[44:47], v[232:239], v2
  ds_read_b128 v[88:91], v5 offset:22528
  v_exp_f32 v62, v62
  v_smfmac_f32_16x16x64_bf16 v[72:75], v[48:51], v[240:247], v2
  ds_read_b128 v[92:95], v5 offset:23552
  v_exp_f32 v63, v63
  v_smfmac_f32_16x16x64_bf16 v[76:79], v[48:51], v[248:255], v2
  ds_read_b128 v[112:115], v1 offset:38912
  v_cvt_pk_bf16_f32 v58, v60, v61
  v_cvt_pk_bf16_f32 v59, v62, v63
  s_nop 1
  v_mfma_f32_16x16x32_bf16 v[104:107], v[124:127], v[56:59], 0
  s_waitcnt vmcnt(2)
  v_fma_f32 v120, v120, s52, v13
  v_fma_f32 v121, v121, s52, v13
  v_mfma_f32_16x16x32_bf16 v[96:99], v[80:83], v[56:59], 0
  v_exp_f32 v18, v120
  v_mfma_f32_16x16x32_bf16 v[100:103], v[84:87], v[56:59], 0
L_R1_h8:
  s_cbranch_execz L_R_wr
  v_exp_f32 v19, v121
  v_smfmac_f32_16x16x64_bf16 v[72:75], v[52:55], v[192:199], v2
  ds_read_b128 v[116:119], v1 offset:39936
  v_cvt_pk_bf16_f32 v14, v18, v19
  v_lshlrev_b64 v[16:17], v12, v[14:15]
  v_smfmac_f32_16x16x64_bf16 v[76:79], v[52:55], v[200:207], v2
  v_cndmask_b32 v96, v96, v100, s[70:71]
  v_mfma_f32_16x16x16_bf16 v[108:111], v[124:125], v[16:17], v[104:107]
  v_cndmask_b32 v97, v97, v101, s[70:71]
  v_cndmask_b32 v98, v98, v102, s[70:71]
  v_cndmask_b32 v99, v99, v103, s[70:71]
  v_add_f32 v72, v72, v73
  v_add_f32 v74, v74, v75
  v_add_f32 v76, v76, v77
  v_add_f32 v78, v78, v79
  v_cvt_pk_bf16_f32 v22, v72, v74
  v_cvt_pk_bf16_f32 v23, v76, v78
  v_mov_b32 v19, -1
  v_mov_b32 v19, -1
  v_mfma_f32_16x16x16_bf16 v[60:63], v[22:23], v[16:17], v[96:99]
  v_cmp_nge_f32 vcc, s53, v108
  v_rcp_f32 v18, v108
  v_mov_b32_e64 v19, -1
  v_mov_b32_e64 v19, -1
  v_mov_b32_e64 v19, -1
  v_mfma_i32_16x16x4_4b_i8 v[32:47], v0, v0, 0
  v_mov_b32_e64 v19, -1
L_R1_h9:
  s_cbranch_vccnz L_R1_slow
L_R1_sy:
  v_mul_f32 v60, v60, v18
  v_mul_f32 v61, v61, v18
  v_cvt_pk_bf16_f32 v16, v60, v61
  v_mul_f32 v62, v62, v18
  v_mul_f32 v63, v63, v18
  v_cvt_pk_bf16_f32 v17, v62, v63
  ds_write_b64 v11, v[16:17] offset:4608
  v_mov_b32_dpp v72, v16 quad_perm:[0,0,2,2] row_mask:0xf bank_mask:0xf
  v_mov_b32_dpp v74, v16 quad_perm:[1,1,3,3] row_mask:0xf bank_mask:0xf
  v_mov_b32_dpp v73, v17 quad_perm:[0,0,2,2] row_mask:0xf bank_mask:0xf
  v_mov_b32_dpp v75, v17 quad_perm:[1,1,3,3] row_mask:0xf bank_mask:0xf
  ds_read_b128 v[48:51], v8 offset:5120
  s_nop 0
  v_smfmac_f32_16x16x64_bf16 v[32:35], v[72:75], a[200:207], v2
  ds_read_b128 v[52:55], v8 offset:5632
  v_smfmac_f32_16x16x64_bf16 v[36:39], v[72:75], a[232:239], v2
  ds_read_b128 v[76:79], v8 offset:4096
  global_load_lds_dwordx4 v1, s[60:61]
  s_waitcnt lgkmcnt(4)
  v_smfmac_f32_16x16x64_bf16 v[40:43], v[72:75], v[24:31], v2
  global_load_lds_dwordx4 v1, s[60:61] offset:1024
  ds_read_b128 v[64:67], v1 offset:55296
  v_smfmac_f32_16x16x64_bf16 v[44:47], v[72:75], v[88:95], v2
  ds_read_b128 v[68:71], v1 offset:56320
L_R1_ok:
  s_waitcnt lgkmcnt(4)
  v_smfmac_f32_16x16x64_bf16 v[32:35], v[48:51], a[208:215], v2
  ds_read_b128 v[120:123], v1 offset:6144
  v_max_u32 v18, v49, v51
  s_waitcnt lgkmcnt(4)
  v_smfmac_f32_16x16x64_bf16 v[32:35], v[52:55], a[216:223], v2
  ds_read_b128 v[124:127], v1 offset:7168
  v_max3_u32 v18, v18, v53, v55
  s_waitcnt lgkmcnt(4)
  v_smfmac_f32_16x16x64_bf16 v[32:35], v[76:79], a[192:199], v2
  ds_read_b128 v[96:99], v5 offset:38912
  v_max3_u32 v18, v18, v77, v79
  v_smfmac_f32_16x16x64_bf16 v[36:39], v[48:51], a[240:247], v2
  ds_read_b128 v[100:103], v5 offset:39936
  v_smfmac_f32_16x16x64_bf16 v[36:39], v[52:55], a[248:255], v2
  ds_read_b128 v[104:107], v5 offset:55296
  v_cmp_eq_u32 vcc, -1, v18
  v_cvt_pk_bf16_f32 v33, v33, v35
  v_cvt_pk_bf16_f32 v32, v32, v34
  v_and_or_b32 v33, v33, -2, s12
  v_smfmac_f32_16x16x64_bf16 v[36:39], v[76:79], a[224:231], v2
L_R1_h10:
  s_cbranch_vccnz L_R1_of
  global_store_dwordx2 v3, v[32:33], s[46:47] offset:0
  ds_read_b128 v[108:111], v5 offset:56320
  v_smfmac_f32_16x16x64_bf16 v[40:43], v[48:51], v[112:119], v2
  ds_read_b128 v[56:59], v5 offset:6144
  s_waitcnt lgkmcnt(7)
  v_smfmac_f32_16x16x64_bf16 v[40:43], v[52:55], v[64:71], v2
  ds_read_b128 v[60:63], v5 offset:7168
  s_waitcnt lgkmcnt(6)
  v_cvt_pk_bf16_f32 v37, v37, v39
  v_cvt_pk_bf16_f32 v36, v36, v38
  v_and_or_b32 v37, v37, -2, s12
  v_smfmac_f32_16x16x64_bf16 v[40:43], v[76:79], v[120:127], v2
  global_store_dwordx2 v3, v[36:37], s[46:47] offset:2048
  s_waitcnt lgkmcnt(4)
  v_smfmac_f32_16x16x64_bf16 v[44:47], v[48:51], v[96:103], v2
  s_waitcnt lgkmcnt(2)
  v_smfmac_f32_16x16x64_bf16 v[44:47], v[52:55], v[104:111], v2
  ds_read_b128 v[48:51], v6 offset:30720
  v_cvt_pk_bf16_f32 v41, v41, v43
  v_cvt_pk_bf16_f32 v40, v40, v42
  v_and_or_b32 v41, v41, -2, s12
  s_waitcnt lgkmcnt(1)
  v_smfmac_f32_16x16x64_bf16 v[44:47], v[76:79], v[56:63], v2
  global_store_dwordx2 v3, v[40:41], s[48:49] offset:0
  v_mov_b32 v72, 0
  v_mov_b32 v73, 0
  v_mov_b32 v74, 0
  v_mov_b32 v75, 0
  s_nop 2
  v_cvt_pk_bf16_f32 v45, v45, v47
  v_cvt_pk_bf16_f32 v44, v44, v46
  v_and_or_b32 v45, v45, -2, s12
  global_store_dwordx2 v3, v[44:45], s[48:49] offset:2048
  s_add_u32 s54, s54, 0x2000
  s_bitset0_b32 s54, 15
  v_mov_b32 v76, 0
  ds_read_b128 v[88:91], v1 offset:20480
  v_mov_b32 v77, 0
  ds_read_b128 v[92:95], v1 offset:21504
  v_mov_b32 v78, 0
  ds_read_b128 v[96:99], v5 offset:20480
  v_mov_b32 v79, 0
  ds_read_b128 v[100:103], v5 offset:21504
  v_mov_b32 v19, -1
  ds_read_b128 v[104:107], v1 offset:36864
  v_mov_b32 v19, -1
  ds_read_b128 v[108:111], v1 offset:37888
  v_mov_b32 v19, -1
  ds_read_b128 v[112:115], v1 offset:53248
  v_mov_b32 v19, -1
  ds_read_b128 v[116:119], v1 offset:54272
  v_mov_b32 v19, -1
  ds_read_b128 v[120:123], v1 offset:4096
  v_mov_b32 v19, -1
  ds_read_b128 v[124:127], v1 offset:5120
  global_load_dwordx4 v[80:83], v1, s[50:51] sc1
  global_load_dwordx4 v[84:87], v1, s[50:51] offset:1024 sc1
  v_mov_b32 v19, -1
  s_add_u32 s60, s60, 262144
  s_addc_u32 s61, s61, 0
  v_mov_b32 v19, -1
  s_add_u32 s68, s68, 262144
  s_addc_u32 s69, s69, 0
  v_mov_b32 v19, -1
  s_add_u32 s62, s62, 262144
  s_addc_u32 s63, s63, 0
  v_mov_b32 v19, -1
  s_add_u32 s64, s64, 262144
  s_addc_u32 s65, s65, 0
  v_mov_b32 v19, -1
  v_mov_b32 v19, -1
L_R1_h11:
  s_cbranch_execz L_R_wr
  v_mov_b32 v19, -1
  v_mov_b32 v19, -1
  v_mov_b32 v19, -1
  v_mov_b32 v19, -1
  v_mov_b32 v19, -1
  v_mov_b32 v19, -1
  v_mov_b32 v19, -1
  v_mov_b32 v19, -1
  v_mov_b32 v19, -1
  v_mov_b32 v19, -1
  v_mov_b32 v19, -1
  v_mov_b32 v19, -1
  v_mov_b32 v19, -1
  v_mov_b32 v19, -1
  v_mov_b32 v19, -1
  v_mov_b32 v19, -1
  v_mov_b32 v19, -1
  v_mov_b32 v19, -1
  v_mov_b32 v19, -1
  global_load_dwordx4 v[80:83], v1, s[50:51] sc1
  global_load_dwordx4 v[84:87], v1, s[50:51] offset:1024 sc1
  v_mov_b32 v19, -1
  v_mov_b32 v19, -1
  v_mov_b32 v19, -1
  v_mov_b32 v19, -1
  v_mov_b32 v19, -1
  s_waitcnt lgkmcnt(10)
  v_mfma_f32_16x16x1_4b_f32 v[56:71], v0, v0, 0
L_R1_h12:
  s_cbranch_execz L_R_wr
  s_waitcnt vmcnt(3)
  v_bitop3_b32 v16, v81, v83, s12 bitop3:0x7e
  v_mfma_f32_16x16x32_bf16 v[52:55], v[48:51], v[80:83], 0
  s_waitcnt vmcnt(2)
  v_bitop3_b32 v17, v85, v87, s12 bitop3:0x7e
  v_mfma_f32_16x16x32_bf16 v[52:55], v[48:51], v[84:87], v[52:55]
  v_bitop3_b32 v16, v16, v17, 1 bitop3:0xa8
  v_cmp_ne_u32 vcc, 0, v16
  v_readfirstlane_b32 s79, v10
  v_mov_b32 v19, -1
  v_mov_b32 v19, -1
  v_mov_b32 v19, -1
  v_mov_b32 v19, -1
  v_mov_b32 v19, -1
L_R1_c1:
  v_add_f32_dpp v52, v52, v52 row_ror:4 row_mask:0xf bank_mask:0xf
  v_add_f32_dpp v53, v53, v53 row_ror:4 row_mask:0xf bank_mask:0xf
L_R1_h13:
  s_cbranch_vccnz L_R1_pf
  v_add_f32_dpp v52, v52, v52 row_ror:8 row_mask:0xf bank_mask:0xf
  v_add_f32_dpp v53, v53, v53 row_ror:8 row_mask:0xf bank_mask:0xf
  v_cvt_pk_bf16_f32 v16, v52, v53
  global_store_dword v4, v16, s[56:57]
  s_cmp_eq_u32 s79, 0
  s_cbranch_scc1 L_R1_fw
L_R1_fok:
  v_mov_b32 v19, -1
  global_store_dword v4, v19, s[58:59]
  s_add_u32 s58, s58, 0x2000
  s_bitset0_b32 s58, 15
  v_mov_b32 v19, -1
  s_cmp_lt_u32 s44, 61
  s_cselect_b32 s74, 2048, 0
  v_mov_b32 v19, -1
  s_add_u32 s66, s66, s74
  s_addc_u32 s67, s67, 0
  v_mov_b32 v19, -1
  s_add_u32 s56, s56, 0x2000
  s_bitset0_b32 s56, 15
  v_mov_b32 v19, -1
  s_xor_b32 s12, s12, 1
  s_add_u32 s44, s44, 1
  v_lshlrev_b32 v10, 3, v1
  s_cmp_eq_u32 s44, 63
  v_mov_b32 v19, -1
L_R1_h14:
  s_cbranch_execz L_R_wr
  v_mov_b32 v19, -1
  v_mov_b32 v19, -1
  v_mov_b32 v19, -1
  v_mov_b32 v19, -1
  v_mov_b32 v19, -1
  v_mov_b32 v19, -1
  v_mov_b32 v19, -1
  v_mov_b32 v19, -1
  v_mov_b32 v19, -1
  v_mov_b32 v19, -1
  v_mov_b32 v19, -1
  v_mov_b32 v19, -1
  v_mov_b32 v19, -1
  v_mov_b32 v19, -1
  v_mov_b32 v19, -1
  v_mov_b32 v19, -1
  v_mov_b32 v19, -1
  v_mov_b32 v19, -1
  v_mov_b32 v19, -1
  v_mov_b32 v19, -1
  v_mov_b32 v19, -1
  v_mov_b32 v19, -1
  global_load_dwordx4 v[24:27], v1, s[54:55] offset:-2048 sc1
  v_mov_b32 v19, -1
  v_mov_b32 v19, -1
  v_mov_b32 v19, -1
  v_mov_b32 v19, -1
  v_mov_b32 v19, -1
L_R1_h15:
  s_cbranch_execz L_R_wr
  v_mov_b32 v19, -1
  v_mov_b32 v19, -1
  v_mov_b32 v19, -1
  v_mov_b32 v19, -1
  v_mov_b32 v19, -1
  v_mov_b32 v19, -1
  global_load_dwordx4 v[24:27], v1, s[54:55] offset:-2048 sc1
  v_mov_b32 v19, -1
  v_mov_b32 v19, -1
  v_mov_b32 v19, -1
  v_mov_b32 v19, -1
  v_mov_b32 v19, -1
  v_mov_b32 v19, -1
  global_load_dwordx4 v[28:31], v1, s[54:55] offset:2048 sc1
  v_mov_b32 v19, -1
  v_mov_b32 v19, -1
  v_mov_b32 v19, -1
  v_mov_b32 v19, -1
  v_mov_b32 v19, -1
  v_mov_b32 v19, -1
  v_mov_b32 v19, -1
  v_mov_b32 v19, -1
  v_mov_b32 v19, -1
  v_mov_b32 v19, -1
  v_mov_b32 v19, -1
  v_mov_b32 v19, -1
  global_load_dwordx4 v[24:27], v1, s[54:55] offset:-2048 sc1
  v_mov_b32 v19, -1
  v_mov_b32_e64 v19, -1
  v_mov_b32_e64 v19, -1
  v_mov_b32_e64 v19, -1
  v_mov_b32_e64 v19, -1
  v_mov_b32_e64 v19, -1
  global_load_dwordx4 v[28:31], v1, s[54:55] offset:2048 sc1
  v_mov_b32_e64 v19, -1
  v_mov_b32_e64 v19, -1
  s_cbranch_scc1 L_R1_z
  s_waitcnt lgkmcnt(0)
  v_mfma_f32_16x16x1_4b_f32 v[56:71], v0, v0, 0
  s_branch L_R1_p2
L_R1_h16:
  s_branch L_R_wr
.p2align 2
L_R1_zfe:
L_R1_zh0:
  s_cbranch_execz L_R1_zh1
  global_load_dwordx4 v[24:27], v1, s[54:55] offset:-2048 sc1
  v_mfma_f32_16x16x1_4b_f32 v[56:71], v0, v0, 0
  s_sub_u32 s7, s7, 1
  s_cbranch_scc0 L_R1_ze
  s_mov_b32 s7, 0
  s_branch L_R1_ze1
L_R1_zfl:
  global_load_dwordx4 v[28:31], v1, s[54:55] offset:2048 sc1
L_R1_zh1:
  s_cbranch_execz L_R1_zh2
L_R1_h17:
  s_cbranch_execz L_R_wr
  s_sub_u32 s7, s7, 1
  s_cbranch_scc0 L_R1_zl
  s_mov_b32 s7, 0
  s_branch L_R1_zl1
L_R1_z:
  global_store_dwordx4 v1, v[20:23], s[64:65] sc1
  s_add_u32 s64, s64, 262144
  s_addc_u32 s65, s65, 0
  s_waitcnt lgkmcnt(0)
L_R1_ze:
  s_waitcnt vmcnt(5)
  v_max3_u32 v16, v24, v25, v26
L_R1_zh2:
  s_cbranch_execz L_R1_zh3
  v_max_u32 v16, v16, v27
  v_smfmac_f32_16x16x64_bf16 v[64:67], v[24:27], a[16:23], v2
  ds_write_b128 v6, v[24:27] offset:17408
  v_cmp_eq_u32 vcc, -1, v16
  v_smfmac_f32_16x16x64_bf16 v[68:71], v[24:27], a[24:31], v2
  v_mov_b32 v19, -1
  v_mov_b32 v19, -1
  v_mov_b32 v19, -1
  v_mov_b32 v19, -1
  s_cbranch_vccnz L_R1_zfe
L_R1_ze1:
  v_smfmac_f32_16x16x64_bf16 v[72:75], v[24:27], v[144:151], v2
L_R1_zh3:
  s_cbranch_execz L_R1_zh4
L_R1_h18:
  s_cbranch_execz L_R_wr
  v_smfmac_f32_16x16x64_bf16 v[76:79], v[24:27], v[152:159], v2
  s_waitcnt lgkmcnt(0)
  s_barrier
L_R1_zl:
  s_waitcnt vmcnt(3)
  v_max3_u32 v16, v28, v29, v30
  v_max_u32 v16, v16, v31
  v_cmp_eq_u32 vcc, -1, v16
  ds_read_b128 v[32:35], v6 offset:18432
  ds_read_b128 v[36:39], v6 offset:19456
  ds_read_b128 v[40:43], v6 offset:16384
L_R1_zh4:
  s_cbranch_execz L_R1_zh5
  ds_write_b128 v6, v[28:31] offset:21504
  s_cbranch_vccnz L_R1_zfl
L_R1_zl1:
  v_smfmac_f32_16x16x64_bf16 v[64:67], v[28:31], a[80:87], v2
  v_smfmac_f32_16x16x64_bf16 v[68:71], v[28:31], a[88:95], v2
  v_smfmac_f32_16x16x64_bf16 v[72:75], v[28:31], v[208:215], v2
  s_waitcnt lgkmcnt(0)
  s_barrier
  v_smfmac_f32_16x16x64_bf16 v[76:79], v[28:31], v[216:223], v2
  v_smfmac_f32_16x16x64_bf16 v[64:67], v[32:35], a[32:39], v2
L_R1_zh5:
  s_cbranch_execz L_R1_zh6
L_R1_h19:
  s_cbranch_execz L_R_wr
  ds_read_b128 v[44:47], v6 offset:22528
  v_smfmac_f32_16x16x64_bf16 v[68:71], v[32:35], a[40:47], v2
  ds_read_b128 v[48:51], v6 offset:23552
  v_smfmac_f32_16x16x64_bf16 v[72:75], v[32:35], v[160:167], v2
  ds_read_b128 v[52:55], v6 offset:20480
  v_smfmac_f32_16x16x64_bf16 v[76:79], v[32:35], v[168:175], v2
  v_smfmac_f32_16x16x64_bf16 v[64:67], v[36:39], a[48:55], v2
L_R1_zh6:
  s_cbranch_execz L_R1_zh7
  v_smfmac_f32_16x16x64_bf16 v[68:71], v[36:39], a[56:63], v2
  v_smfmac_f32_16x16x64_bf16 v[72:75], v[36:39], v[176:183], v2
  v_smfmac_f32_16x16x64_bf16 v[76:79], v[36:39], v[184:191], v2
  v_smfmac_f32_16x16x64_bf16 v[64:67], v[40:43], a[0:7], v2
  v_smfmac_f32_16x16x64_bf16 v[68:71], v[40:43], a[8:15], v2
  v_smfmac_f32_16x16x64_bf16 v[72:75], v[40:43], v[128:135], v2
  v_smfmac_f32_16x16x64_bf16 v[76:79], v[40:43], v[136:143], v2
L_R1_zh7:
  s_cbranch_execz L_R1_zh8
L_R1_h20:
  s_cbranch_execz L_R_wr
  s_waitcnt lgkmcnt(0)
  v_smfmac_f32_16x16x64_bf16 v[64:67], v[44:47], a[96:103], v2
  v_smfmac_f32_16x16x64_bf16 v[68:71], v[44:47], a[104:111], v2
  v_smfmac_f32_16x16x64_bf16 v[64:67], v[48:51], a[112:119], v2
  v_smfmac_f32_16x16x64_bf16 v[68:71], v[48:51], a[120:127], v2
  v_smfmac_f32_16x16x64_bf16 v[64:67], v[52:55], a[64:71], v2
  v_smfmac_f32_16x16x64_bf16 v[68:71], v[52:55], a[72:79], v2
  v_smfmac_f32_16x16x64_bf16 v[72:75], v[44:47], v[224:231], v2
L_R1_zh8:
  s_cbranch_execz L_R1_zh9
  v_smfmac_f32_16x16x64_bf16 v[76:79], v[44:47], v[232:239], v2
  v_smfmac_f32_16x16x64_bf16 v[72:75], v[48:51], v[240:247], v2
  v_add_f32 v64, v64, v65
  v_add_f32 v66, v66, v67
  v_smfmac_f32_16x16x64_bf16 v[76:79], v[48:51], v[248:255], v2
  v_add_f32 v68, v68, v69
  v_add_f32 v70, v70, v71
  v_smfmac_f32_16x16x64_bf16 v[72:75], v[52:55], v[192:199], v2
  v_cvt_pk_bf16_f32 v20, v64, v68
L_R1_zh9:
  s_cbranch_execz L_R1_zh10
L_R1_h21:
  s_cbranch_execz L_R_wr
  v_cvt_pk_bf16_f32 v21, v66, v70
  v_smfmac_f32_16x16x64_bf16 v[76:79], v[52:55], v[200:207], v2
  v_mov_b32 v19, -1
  v_mov_b32 v19, -1
  v_mov_b32 v19, -1
  v_mov_b32 v19, -1
  v_add_f32 v72, v72, v73
  v_add_f32 v74, v74, v75
  v_cvt_pk_bf16_f32 v22, v72, v74
  v_mov_b32 v19, -1
  v_add_f32 v76, v76, v77
L_R1_zh10:
  s_cbranch_execz L_R_zr
  v_add_f32 v78, v78, v79
  v_cvt_pk_bf16_f32 v23, v76, v78
L_R1_fin:
  global_store_dwordx4 v1, v[20:23], s[64:65] sc1
  s_endpgm
.p2align 2
.p2align 5
L_R1_pf:
  s_cbranch_execz L_R_wr
  s_mov_b64 exec, vcc
  global_load_dwordx4 v[80:83], v1, s[50:51] sc1
  global_load_dwordx4 v[84:87], v1, s[50:51] offset:1024 sc1
  s_mov_b64 exec, -1
  s_waitcnt vmcnt(3)
  v_bitop3_b32 v16, v81, v83, s12 bitop3:0x7e
  v_mfma_f32_16x16x32_bf16 v[52:55], v[48:51], v[80:83], 0
  s_waitcnt vmcnt(2)
  v_bitop3_b32 v17, v85, v87, s12 bitop3:0x7e
  v_mfma_f32_16x16x32_bf16 v[52:55], v[48:51], v[84:87], v[52:55]
  v_bitop3_b32 v16, v16, v17, 1 bitop3:0xa8
  v_cmp_ne_u32 vcc, 0, v16
  s_nop 2
  s_cbranch_vccz L_R1_c1
L_R1_pf2:
  s_mov_b64 exec, vcc
  global_load_dwordx4 v[80:83], v1, s[50:51] sc1
  global_load_dwordx4 v[84:87], v1, s[50:51] offset:1024 sc1
  s_mov_b64 exec, -1
  s_waitcnt vmcnt(3)
  v_bitop3_b32 v16, v81, v83, s12 bitop3:0x7e
  v_mfma_f32_16x16x32_bf16 v[52:55], v[48:51], v[80:83], 0
L_R1_h22:
  s_cbranch_execz L_R_wr
  s_waitcnt vmcnt(2)
  v_bitop3_b32 v17, v85, v87, s12 bitop3:0x7e
  v_mfma_f32_16x16x32_bf16 v[52:55], v[48:51], v[84:87], v[52:55]
  v_bitop3_b32 v16, v16, v17, 1 bitop3:0xa8
  v_cmp_ne_u32 vcc, 0, v16
  s_nop 2
  s_cbranch_vccz L_R1_c1
  s_sub_u32 s7, s7, 1
  s_cbranch_scc0 L_R1_pf2
  s_mov_b32 s7, 0
  s_mov_b64 vcc, 0
  s_branch L_R1_c1
L_R1_h23:
  s_branch L_R_wr
L_R1_of:
  s_cbranch_execz L_R_wr
  s_nop 7
  ds_read_b128 v[48:51], v8 offset:5120
  ds_read_b128 v[52:55], v8 offset:5632
  ds_read_b128 v[76:79], v8 offset:4096
  s_waitcnt lgkmcnt(0)
  v_max_u32 v18, v49, v51
  v_max3_u32 v18, v18, v53, v55
  v_max3_u32 v18, v18, v77, v79
  v_cmp_eq_u32 vcc, -1, v18
  s_cbranch_vccz L_R1_og
  s_sub_u32 s7, s7, 1
  s_cbranch_scc0 L_R1_of
  s_mov_b32 s7, 0
  v_min_u32 v49, -2, v49
  v_min_u32 v51, -2, v51
  v_min_u32 v53, -2, v53
  v_min_u32 v55, -2, v55
  v_min_u32 v77, -2, v77
  v_min_u32 v79, -2, v79
L_R1_og:
  v_mfma_i32_16x16x4_4b_i8 v[32:47], v0, v0, 0
  s_nop 11
  v_smfmac_f32_16x16x64_bf16 v[32:35], v[72:75], a[200:207], v2
  v_smfmac_f32_16x16x64_bf16 v[36:39], v[72:75], a[232:239], v2
  v_smfmac_f32_16x16x64_bf16 v[40:43], v[72:75], v[24:31], v2
  v_smfmac_f32_16x16x64_bf16 v[44:47], v[72:75], v[88:95], v2
  s_branch L_R1_ok
L_R1_h24:
  s_branch L_R_wr
L_R1_fw:
Lww_31:
  global_load_dword v19, v0, s[66:67] offset:0 sc1
  s_waitcnt vmcnt(0)
  v_cmp_gt_u32 vcc, 1, v19
  s_cbranch_vccz Lwd_32
  s_sub_u32 s7, s7, 1
  s_cbranch_scc0 Lww_31
  s_mov_b32 s7, 0
Lwd_32:
  s_branch L_R1_fok
.p2align 2
L_R1_slow:
  s_cbranch_execz L_R_wr
  s_nop 7
  s_nop 7
  ds_read_b128 v[32:35], v6 offset:0
  ds_read_b128 v[36:39], v6 offset:1024
  ds_read_b128 v[40:43], v8 offset:0
  ds_read_b128 v[44:47], v9 offset:0
  s_waitcnt lgkmcnt(0)
  v_mfma_f32_16x16x32_bf16 v[56:59], v[32:35], v[40:43], 0
  v_mfma_f32_16x16x32_bf16 v[60:63], v[36:39], v[40:43], 0
  v_mfma_f32_16x16x32_bf16 v[120:123], v[44:47], v[40:43], 0
  s_nop 7
  ds_read_b128 v[32:35], v6 offset:2048
  ds_read_b128 v[36:39], v6 offset:3072
  ds_read_b128 v[40:43], v8 offset:1024
  ds_read_b128 v[44:47], v9 offset:1024
  s_waitcnt lgkmcnt(0)
  v_mfma_f32_16x16x32_bf16 v[56:59], v[32:35], v[40:43], v[56:59]
  v_mfma_f32_16x16x32_bf16 v[60:63], v[36:39], v[40:43], v[60:63]
  v_mfma_f32_16x16x32_bf16 v[120:123], v[44:47], v[40:43], v[120:123]
  s_nop 7
  ds_read_b128 v[32:35], v6 offset:4096
  ds_read_b128 v[36:39], v6 offset:5120
  ds_read_b128 v[40:43], v8 offset:2048
  ds_read_b128 v[44:47], v9 offset:2048
  s_waitcnt lgkmcnt(0)
  v_mfma_f32_16x16x32_bf16 v[56:59], v[32:35], v[40:43], v[56:59]
  v_mfma_f32_16x16x32_bf16 v[60:63], v[36:39], v[40:43], v[60:63]
  v_mfma_f32_16x16x32_bf16 v[120:123], v[44:47], v[40:43], v[120:123]
  s_nop 7
  ds_read_b128 v[32:35], v6 offset:6144
  ds_read_b128 v[36:39], v6 offset:7168
  ds_read_b128 v[40:43], v8 offset:3072
  ds_read_b128 v[44:47], v9 offset:3072
  s_waitcnt lgkmcnt(0)
  v_mfma_f32_16x16x32_bf16 v[56:59], v[32:35], v[40:43], v[56:59]
  v_mfma_f32_16x16x32_bf16 v[60:63], v[36:39], v[40:43], v[60:63]
  v_mfma_f32_16x16x32_bf16 v[120:123], v[44:47], v[40:43], v[120:123]
  s_nop 7
  v_mfma_i32_16x16x4_4b_i8 v[32:47], v0, v0, 0
  v_max3_f32 v16, v56, v57, v58
  v_max3_f32 v17, v59, v60, v61
  v_max3_f32 v16, v16, v62, v63
  v_max3_f32 v17, v17, v120, v121
  v_max_f32 v18, v16, v17
  v_max_f32 v19, v16, v17
  s_nop 1
  v_permlane32_swap_b32 v18, v19
  v_max_f32 v16, v18, v19
  v_max_f32 v17, v18, v19
  s_nop 1
  v_permlane16_swap_b32 v16, v17
  v_max_f32 v16, v16, v17
  v_mul_f32 v13, 0xbe0293ee, v16
  v_fma_f32 v56, v56, s52, v13
  v_fma_f32 v57, v57, s52, v13
  v_exp_f32 v56, v56
  v_fma_f32 v58, v58, s52, v13
  v_exp_f32 v57, v57
  v_fma_f32 v59, v59, s52, v13
  v_exp_f32 v58, v58
  v_cvt_pk_bf16_f32 v56, v56, v57
  v_exp_f32 v59, v59
  v_fma_f32 v60, v60, s52, v13
  v_cvt_pk_bf16_f32 v57, v58, v59
  v_fma_f32 v61, v61, s52, v13
  v_exp_f32 v60, v60
  v_fma_f32 v62, v62, s52, v13
  v_exp_f32 v61, v61
  v_fma_f32 v63, v63, s52, v13
  v_exp_f32 v62, v62
  v_exp_f32 v63, v63
  v_cvt_pk_bf16_f32 v58, v60, v61
  v_cvt_pk_bf16_f32 v59, v62, v63
  v_fma_f32 v120, v120, s52, v13
  v_fma_f32 v121, v121, s52, v13
  v_exp_f32 v18, v120
  v_exp_f32 v19, v121
  v_mfma_f32_16x16x32_bf16 v[104:107], v[124:127], v[56:59], 0
  v_mfma_f32_16x16x32_bf16 v[96:99], v[80:83], v[56:59], 0
  v_mfma_f32_16x16x32_bf16 v[100:103], v[84:87], v[56:59], 0
  v_cvt_pk_bf16_f32 v14, v18, v19
  v_lshlrev_b64 v[16:17], v12, v[14:15]
  s_nop 1
  v_mfma_f32_16x16x16_bf16 v[108:111], v[124:125], v[16:17], v[104:107]
  s_nop 2
  v_cndmask_b32 v96, v96, v100, s[70:71]
  v_cndmask_b32 v97, v97, v101, s[70:71]
  v_cndmask_b32 v98, v98, v102, s[70:71]
  v_cndmask_b32 v99, v99, v103, s[70:71]
  s_nop 1
  v_mfma_f32_16x16x16_bf16 v[60:63], v[22:23], v[16:17], v[96:99]
  v_rcp_f32 v18, v108
  s_nop 7
  s_barrier
  s_branch L_R1_sy
.p2align 7
L_R2:
  ds_read_b128 v[88:91], v1 offset:40960
  ds_read_b128 v[92:95], v1 offset:41984
  ds_read_b128 v[96:99], v5 offset:40960
  ds_read_b128 v[100:103], v5 offset:41984
  ds_read_b128 v[104:107], v1 offset:57344
  ds_read_b128 v[108:111], v1 offset:58368
  ds_read_b128 v[112:115], v1 offset:8192
  ds_read_b128 v[116:119], v1 offset:9216
  ds_read_b128 v[120:123], v1 offset:24576
  ds_read_b128 v[124:127], v1 offset:25600
  v_mov_b32 v19, -1
  v_lshlrev_b32 v10, 3, v1
  global_load_dwordx4 v[80:83], v1, s[62:63]
  global_load_dwordx4 v[84:87], v1, s[62:63] offset:1024
  s_waitcnt vmcnt(2) lgkmcnt(0)
  s_branch L_R2_p2
L_R2_h0:
  s_branch L_R_wr
.p2align 5
L_R2_fe:
  s_cbranch_execz L_R_wr
  s_mov_b64 exec, vcc
  global_load_dwordx4 v[24:27], v1, s[54:55] offset:-2048 sc1
  s_mov_b64 exec, -1
  v_mov_b32 v19, -1
  v_mov_b32 v19, -1
  v_mov_b32 v19, -1
  v_mov_b32 v19, -1
  v_mfma_f32_16x16x1_4b_f32 v[56:71], v0, v0, 0
  s_waitcnt vmcnt(4)
  v_max3_u32 v16, v24, v25, v26
  v_max_u32 v16, v16, v27
  v_cmp_eq_u32 vcc, -1, v16
  s_cbranch_vccz L_R2_p2a
  s_mov_b64 exec, vcc
  global_load_dwordx4 v[24:27], v1, s[54:55] offset:-2048 sc1
  s_mov_b64 exec, -1
  s_waitcnt vmcnt(3)
  v_max3_u32 v16, v24, v25, v26
L_R2_h1:
  s_cbranch_execz L_R_wr
  v_max_u32 v16, v16, v27
  v_cmp_eq_u32 vcc, -1, v16
  s_cbranch_vccz L_R2_p2a
  s_mov_b64 exec, vcc
  global_load_dwordx4 v[24:27], v1, s[54:55] offset:-2048 sc1
  s_mov_b64 exec, -1
  s_waitcnt vmcnt(2)
  v_max3_u32 v16, v24, v25, v26
  v_max_u32 v16, v16, v27
  v_cmp_eq_u32 vcc, -1, v16
  s_cbranch_vccz L_R2_p2a
L_R2_fe2:
  s_mov_b64 exec, vcc
  global_load_dwordx4 v[24:27], v1, s[54:55] offset:-2048 sc1
  s_mov_b64 exec, -1
  s_waitcnt vmcnt(2)
  v_max3_u32 v16, v24, v25, v26
  v_max_u32 v16, v16, v27
  v_cmp_eq_u32 vcc, -1, v16
  s_cbranch_vccz L_R2_p2a
  s_sub_u32 s7, s7, 1
  s_cbranch_scc0 L_R2_fe2
  s_mov_b32 s7, 0
  v_mov_b32 v16, 0
  s_branch L_R2_p2a
L_R2_h2:
  s_branch L_R_wr
.p2align 5
L_R2_fl:
  s_cbranch_execz L_R_wr
  s_mov_b64 exec, vcc
  global_load_dwordx4 v[28:31], v1, s[54:55] offset:2048 sc1
  s_mov_b64 exec, -1
  s_waitcnt vmcnt(2)
  v_max3_u32 v16, v28, v29, v30
  v_max_u32 v16, v16, v31
  v_cmp_eq_u32 vcc, -1, v16
  ds_write_b128 v6, v[28:31] offset:22528
  s_cbranch_vccz L_R2_cl
L_R2_fl2:
  s_mov_b64 exec, vcc
  global_load_dwordx4 v[28:31], v1, s[54:55] offset:2048 sc1
  s_mov_b64 exec, -1
  s_waitcnt vmcnt(2)
  v_max3_u32 v16, v28, v29, v30
  v_max_u32 v16, v16, v31
  v_cmp_eq_u32 vcc, -1, v16
  ds_write_b128 v6, v[28:31] offset:22528
  s_cbranch_vccz L_R2_cl
  s_sub_u32 s7, s7, 1
  s_cbranch_scc0 L_R2_fl2
  s_mov_b32 s7, 0
  s_branch L_R2_cl
L_R2_h3:
  s_branch L_R_wr
.p2align 6
L_R2_p2:
  s_waitcnt vmcnt(4)
  v_max3_u32 v16, v24, v25, v26
  v_max_u32 v16, v16, v27
L_R2_p2a:
  v_smfmac_f32_16x16x64_bf16 v[56:59], v[24:27], v[88:95], v2
  ds_write_b128 v6, v[24:27] offset:18432
  v_cmp_eq_u32 vcc, -1, v16
  v_smfmac_f32_16x16x64_bf16 v[60:63], v[24:27], a[144:151], v2
  v_smfmac_f32_16x16x64_bf16 v[64:67], v[24:27], a[32:39], v2
L_R2_h4:
  s_cbranch_vccnz L_R2_fe
  v_smfmac_f32_16x16x64_bf16 v[68:71], v[24:27], a[40:47], v2
  global_load_dwordx4 v[28:31], v1, s[54:55] offset:2048 sc1
  ds_read_b128 v[88:91], v5 offset:57344
  v_smfmac_f32_16x16x64_bf16 v[72:75], v[24:27], v[160:167], v2
  s_waitcnt lgkmcnt(1)
  s_barrier
  s_waitcnt vmcnt(3)
  v_max3_u32 v16, v28, v29, v30
  v_max_u32 v16, v16, v31
  v_cmp_eq_u32 vcc, -1, v16
  v_smfmac_f32_16x16x64_bf16 v[76:79], v[24:27], v[168:175], v2
  ds_write_b128 v6, v[28:31] offset:22528
L_R2_h5:
  s_cbranch_vccnz L_R2_fl
L_R2_cl:
  v_smfmac_f32_16x16x64_bf16 v[56:59], v[28:31], v[96:103], v2
  ds_read_b128 v[32:35], v6 offset:19456
  global_load_dwordx4 v[80:83], v1, s[62:63]
  v_smfmac_f32_16x16x64_bf16 v[60:63], v[28:31], a[176:183], v2
  ds_read_b128 v[36:39], v6 offset:16384
  global_load_dwordx4 v[84:87], v1, s[62:63] offset:1024
  v_smfmac_f32_16x16x64_bf16 v[64:67], v[28:31], a[96:103], v2
  s_waitcnt lgkmcnt(2)
  s_barrier
  ds_read_b128 v[40:43], v6 offset:17408
  v_smfmac_f32_16x16x64_bf16 v[68:71], v[28:31], a[104:111], v2
  ds_read_b128 v[44:47], v6 offset:23552
  global_load_dword v10, v10, s[68:69]
  v_smfmac_f32_16x16x64_bf16 v[72:75], v[28:31], v[224:231], v2
  ds_read_b128 v[48:51], v6 offset:20480
  v_smfmac_f32_16x16x64_bf16 v[76:79], v[28:31], v[232:239], v2
  ds_read_b128 v[52:55], v6 offset:21504
  s_waitcnt lgkmcnt(5)
  v_smfmac_f32_16x16x64_bf16 v[56:59], v[32:35], v[104:111], v2
  ds_read_b128 v[92:95], v5 offset:58368
  v_smfmac_f32_16x16x64_bf16 v[60:63], v[32:35], a[152:159], v2
  ds_read_b128 v[96:99], v5 offset:8192
  s_waitcnt lgkmcnt(6)
  v_smfmac_f32_16x16x64_bf16 v[56:59], v[36:39], v[112:119], v2
  ds_read_b128 v[100:103], v5 offset:9216
  v_smfmac_f32_16x16x64_bf16 v[60:63], v[36:39], a[128:135], v2
  global_store_dwordx4 v1, v[20:23], s[64:65] sc1
  ds_read_b128 v[104:107], v5 offset:24576
  s_waitcnt lgkmcnt(7)
  v_smfmac_f32_16x16x64_bf16 v[56:59], v[40:43], v[120:127], v2
L_R2_h6:
  s_cbranch_execz L_R_wr
  ds_read_b128 v[108:111], v5 offset:25600
  v_smfmac_f32_16x16x64_bf16 v[60:63], v[40:43], a[136:143], v2
  ds_read_b128 v[112:115], v6 offset:0
  s_waitcnt lgkmcnt(5)
  v_smfmac_f32_16x16x64_bf16 v[56:59], v[44:47], v[88:95], v2
  ds_read_b128 v[116:119], v6 offset:2048
  v_smfmac_f32_16x16x64_bf16 v[60:63], v[44:47], a[184:191], v2
  ds_read_b128 v[120:123], v6 offset:4096
  s_waitcnt lgkmcnt(5)
  v_smfmac_f32_16x16x64_bf16 v[56:59], v[48:51], v[96:103], v2
  global_load_dword v10, v0, s[66:67] sc1
  ds_read_b128 v[124:127], v6 offset:6144
  v_smfmac_f32_16x16x64_bf16 v[60:63], v[48:51], a[160:167], v2
  ds_write_b32 v11, v19 offset:5124
  s_waitcnt lgkmcnt(5)
  v_smfmac_f32_16x16x64_bf16 v[56:59], v[52:55], v[104:111], v2
  v_smfmac_f32_16x16x64_bf16 v[60:63], v[52:55], a[168:175], v2
  s_waitcnt vmcnt(5)
  ds_read_b128 v[24:27], v6 offset:1024
  v_smfmac_f32_16x16x64_bf16 v[64:67], v[32:35], a[48:55], v2
  ds_read_b128 v[28:31], v6 offset:3072
  v_add_f32 v56, v56, v57
  v_add_f32 v58, v58, v59
  v_smfmac_f32_16x16x64_bf16 v[68:71], v[32:35], a[56:63], v2
  v_add_f32 v60, v60, v61
  v_add_f32 v62, v62, v63
  v_smfmac_f32_16x16x64_bf16 v[64:67], v[36:39], a[0:7], v2
  v_cvt_pk_bf16_f32 v16, v56, v60
  v_cvt_pk_bf16_f32 v17, v58, v62
  v_smfmac_f32_16x16x64_bf16 v[68:71], v[36:39], a[8:15], v2
  ds_write2_b32 v7, v16, v17 offset0:0 offset1:16
  v_smfmac_f32_16x16x64_bf16 v[64:67], v[40:43], a[16:23], v2
L_R2_h7:
  s_cbranch_execz L_R_wr
  v_smfmac_f32_16x16x64_bf16 v[68:71], v[40:43], a[24:31], v2
  v_smfmac_f32_16x16x64_bf16 v[64:67], v[44:47], a[112:119], v2
  v_smfmac_f32_16x16x64_bf16 v[68:71], v[44:47], a[120:127], v2
  s_waitcnt lgkmcnt(0)
  s_barrier
  v_smfmac_f32_16x16x64_bf16 v[64:67], v[48:51], a[64:71], v2
  ds_read_b128 v[96:99], v8 offset:0
  v_smfmac_f32_16x16x64_bf16 v[68:71], v[48:51], a[72:79], v2
L_R2_h8:
  s_cbranch_execz L_R_wr
  ds_read_b128 v[100:103], v8 offset:1024
  v_smfmac_f32_16x16x64_bf16 v[64:67], v[52:55], a[80:87], v2
  ds_read_b128 v[104:107], v8 offset:2048
  v_smfmac_f32_16x16x64_bf16 v[68:71], v[52:55], a[88:95], v2
  ds_read_b128 v[108:111], v8 offset:3072
  v_smfmac_f32_16x16x64_bf16 v[72:75], v[32:35], v[176:183], v2
  ds_read_b128 v[88:91], v6 offset:5120
  v_add_f32 v64, v64, v65
  v_smfmac_f32_16x16x64_bf16 v[76:79], v[32:35], v[184:191], v2
  ds_read_b128 v[92:95], v6 offset:7168
  v_add_f32 v66, v66, v67
  s_waitcnt lgkmcnt(5)
  v_mfma_f32_16x16x32_bf16 v[56:59], v[112:115], v[96:99], 0
  v_add_f32 v68, v68, v69
  v_add_f32 v70, v70, v71
  s_waitcnt lgkmcnt(4)
  v_mfma_f32_16x16x32_bf16 v[56:59], v[116:119], v[100:103], v[56:59]
  v_cvt_pk_bf16_f32 v20, v64, v68
  v_cvt_pk_bf16_f32 v21, v66, v70
  s_waitcnt lgkmcnt(3)
  v_mfma_f32_16x16x32_bf16 v[56:59], v[120:123], v[104:107], v[56:59]
  ds_write2_b32 v7, v20, v21 offset0:128 offset1:144
  s_waitcnt lgkmcnt(3)
  v_mfma_f32_16x16x32_bf16 v[56:59], v[124:127], v[108:111], v[56:59]
  ds_read_b128 v[124:127], v6 offset:31744
  v_mfma_f32_16x16x32_bf16 v[60:63], v[24:27], v[96:99], 0
  v_mfma_f32_16x16x32_bf16 v[60:63], v[28:31], v[100:103], v[60:63]
  s_waitcnt lgkmcnt(3)
  v_max3_f32 v16, v56, v57, v58
  v_max_f32 v18, v16, v59
  v_max_f32 v19, v16, v59
  v_mfma_f32_16x16x32_bf16 v[60:63], v[88:91], v[104:107], v[60:63]
  s_waitcnt lgkmcnt(1)
  s_barrier
  v_permlane32_swap_b32 v18, v19
  v_max_f32 v16, v18, v19
  v_max_f32 v17, v18, v19
  v_mfma_f32_16x16x32_bf16 v[60:63], v[92:95], v[108:111], v[60:63]
  ds_read_b128 v[64:67], v9 offset:0
  v_permlane16_swap_b32 v16, v17
  v_max_f32 v16, v16, v17
  v_mul_f32 v13, 0xbe0293ee, v16
  v_smfmac_f32_16x16x64_bf16 v[72:75], v[36:39], v[128:135], v2
  ds_read_b128 v[68:71], v9 offset:1024
  v_fma_f32 v56, v56, s52, v13
  v_fma_f32 v57, v57, s52, v13
  v_smfmac_f32_16x16x64_bf16 v[76:79], v[36:39], v[136:143], v2
  ds_read_b128 v[112:115], v9 offset:2048
  v_exp_f32 v56, v56
  v_smfmac_f32_16x16x64_bf16 v[72:75], v[40:43], v[144:151], v2
  ds_read_b128 v[116:119], v9 offset:3072
  v_fma_f32 v58, v58, s52, v13
  v_exp_f32 v57, v57
  v_smfmac_f32_16x16x64_bf16 v[76:79], v[40:43], v[152:159], v2
  ds_read_b128 v[24:27], v1 offset:43008
  s_waitcnt lgkmcnt(4)
  v_fma_f32 v59, v59, s52, v13
  v_mfma_f32_16x16x32_bf16 v[120:123], v[64:67], v[96:99], 0
L_R2_h9:
  s_cbranch_execz L_R_wr
  v_exp_f32 v58, v58
  v_cvt_pk_bf16_f32 v56, v56, v57
  s_waitcnt lgkmcnt(3)
  v_mfma_f32_16x16x32_bf16 v[120:123], v[68:71], v[100:103], v[120:123]
  v_exp_f32 v59, v59
  v_fma_f32 v60, v60, s52, v13
  s_waitcnt lgkmcnt(2)
  v_mfma_f32_16x16x32_bf16 v[120:123], v[112:115], v[104:107], v[120:123]
  s_waitcnt lgkmcnt(1)
  v_cvt_pk_bf16_f32 v57, v58, v59
  v_fma_f32 v61, v61, s52, v13
  v_exp_f32 v60, v60
  v_mfma_f32_16x16x32_bf16 v[120:123], v[116:119], v[108:111], v[120:123]
  v_fma_f32 v62, v62, s52, v13
  v_exp_f32 v61, v61
  v_smfmac_f32_16x16x64_bf16 v[72:75], v[44:47], v[240:247], v2
  ds_read_b128 v[28:31], v1 offset:44032
  v_fma_f32 v63, v63, s52, v13
  v_smfmac_f32_16x16x64_bf16 v[76:79], v[44:47], v[248:255], v2
  ds_read_b128 v[88:91], v5 offset:43008
  v_exp_f32 v62, v62
  v_smfmac_f32_16x16x64_bf16 v[72:75], v[48:51], v[192:199], v2
  ds_read_b128 v[92:95], v5 offset:44032
  v_exp_f32 v63, v63
  v_smfmac_f32_16x16x64_bf16 v[76:79], v[48:51], v[200:207], v2
  ds_read_b128 v[112:115], v1 offset:59392
  v_cvt_pk_bf16_f32 v58, v60, v61
  v_cvt_pk_bf16_f32 v59, v62, v63
  s_nop 1
  v_mfma_f32_16x16x32_bf16 v[104:107], v[124:127], v[56:59], 0
  s_waitcnt vmcnt(3)
  v_fma_f32 v120, v120, s52, v13
  v_fma_f32 v121, v121, s52, v13
  v_mfma_f32_16x16x32_bf16 v[96:99], v[80:83], v[56:59], 0
L_R2_h10:
  s_cbranch_execz L_R_wr
  v_exp_f32 v18, v120
  v_mfma_f32_16x16x32_bf16 v[100:103], v[84:87], v[56:59], 0
  v_exp_f32 v19, v121
  v_smfmac_f32_16x16x64_bf16 v[72:75], v[52:55], v[208:215], v2
  ds_read_b128 v[116:119], v1 offset:60416
  v_cvt_pk_bf16_f32 v14, v18, v19
  v_lshlrev_b64 v[16:17], v12, v[14:15]
  v_smfmac_f32_16x16x64_bf16 v[76:79], v[52:55], v[216:223], v2
  v_cndmask_b32 v96, v96, v100, s[70:71]
  v_mfma_f32_16x16x16_bf16 v[108:111], v[124:125], v[16:17], v[104:107]
  v_cndmask_b32 v97, v97, v101, s[70:71]
  v_cndmask_b32 v98, v98, v102, s[70:71]
  v_cndmask_b32 v99, v99, v103, s[70:71]
  v_add_f32 v72, v72, v73
  v_add_f32 v74, v74, v75
  v_add_f32 v76, v76, v77
  v_add_f32 v78, v78, v79
  v_cvt_pk_bf16_f32 v22, v72, v74
  v_cvt_pk_bf16_f32 v23, v76, v78
  v_mov_b32 v19, -1
  v_mov_b32 v19, -1
  v_mfma_f32_16x16x16_bf16 v[60:63], v[22:23], v[16:17], v[96:99]
  v_cmp_nge_f32 vcc, s53, v108
  v_rcp_f32 v18, v108
  v_mov_b32 v19, -1
  v_mov_b32 v19, -1
  v_mov_b32 v19, -1
  v_mfma_i32_16x16x4_4b_i8 v[32:47], v0, v0, 0
  v_mov_b32 v19, -1
L_R2_h11:
  s_cbranch_vccnz L_R2_slow
L_R2_sy:
  v_mul_f32 v60, v60, v18
  v_mul_f32 v61, v61, v18
  v_cvt_pk_bf16_f32 v16, v60, v61
  v_mul_f32 v62, v62, v18
  v_mul_f32 v63, v63, v18
  v_cvt_pk_bf16_f32 v17, v62, v63
  ds_write_b64 v11, v[16:17] offset:5120
  v_mov_b32_dpp v72, v16 quad_perm:[0,0,2,2] row_mask:0xf bank_mask:0xf
  v_mov_b32_dpp v74, v16 quad_perm:[1,1,3,3] row_mask:0xf bank_mask:0xf
  v_mov_b32_dpp v73, v17 quad_perm:[0,0,2,2] row_mask:0xf bank_mask:0xf
  v_mov_b32_dpp v75, v17 quad_perm:[1,1,3,3] row_mask:0xf bank_mask:0xf
  ds_read_b128 v[48:51], v8 offset:5632
  s_nop 0
  v_smfmac_f32_16x16x64_bf16 v[32:35], v[72:75], a[208:215], v2
  ds_read_b128 v[52:55], v8 offset:4096
  v_smfmac_f32_16x16x64_bf16 v[36:39], v[72:75], a[240:247], v2
  ds_read_b128 v[76:79], v8 offset:4608
  global_load_lds_dwordx4 v1, s[60:61]
  s_waitcnt lgkmcnt(4)
  v_smfmac_f32_16x16x64_bf16 v[40:43], v[72:75], v[24:31], v2
  global_load_lds_dwordx4 v1, s[60:61] offset:1024
  ds_read_b128 v[64:67], v1 offset:10240
  v_smfmac_f32_16x16x64_bf16 v[44:47], v[72:75], v[88:95], v2
  ds_read_b128 v[68:71], v1 offset:11264
L_R2_ok:
  s_waitcnt lgkmcnt(4)
  v_smfmac_f32_16x16x64_bf16 v[32:35], v[48:51], a[216:223], v2
  ds_read_b128 v[120:123], v1 offset:26624
  v_max_u32 v18, v49, v51
  s_waitcnt lgkmcnt(4)
  v_smfmac_f32_16x16x64_bf16 v[32:35], v[52:55], a[192:199], v2
  ds_read_b128 v[124:127], v1 offset:27648
  v_max3_u32 v18, v18, v53, v55
  s_waitcnt lgkmcnt(4)
  v_smfmac_f32_16x16x64_bf16 v[32:35], v[76:79], a[200:207], v2
  ds_read_b128 v[96:99], v5 offset:59392
  v_max3_u32 v18, v18, v77, v79
  v_smfmac_f32_16x16x64_bf16 v[36:39], v[48:51], a[248:255], v2
  ds_read_b128 v[100:103], v5 offset:60416
  v_smfmac_f32_16x16x64_bf16 v[36:39], v[52:55], a[224:231], v2
  ds_read_b128 v[104:107], v5 offset:10240
  v_cmp_eq_u32 vcc, -1, v18
  v_cvt_pk_bf16_f32 v33, v33, v35
  v_cvt_pk_bf16_f32 v32, v32, v34
  v_and_or_b32 v33, v33, -2, s12
  v_smfmac_f32_16x16x64_bf16 v[36:39], v[76:79], a[232:239], v2
L_R2_h12:
  s_cbranch_vccnz L_R2_of
  global_store_dwordx2 v3, v[32:33], s[46:47] offset:0
  ds_read_b128 v[108:111], v5 offset:11264
  v_smfmac_f32_16x16x64_bf16 v[40:43], v[48:51], v[112:119], v2
  ds_read_b128 v[56:59], v5 offset:26624
  s_waitcnt lgkmcnt(7)
  v_smfmac_f32_16x16x64_bf16 v[40:43], v[52:55], v[64:71], v2
  ds_read_b128 v[60:63], v5 offset:27648
  s_waitcnt lgkmcnt(6)
  v_cvt_pk_bf16_f32 v37, v37, v39
  v_cvt_pk_bf16_f32 v36, v36, v38
  v_and_or_b32 v37, v37, -2, s12
  v_smfmac_f32_16x16x64_bf16 v[40:43], v[76:79], v[120:127], v2
  global_store_dwordx2 v3, v[36:37], s[46:47] offset:2048
  s_waitcnt lgkmcnt(4)
  v_smfmac_f32_16x16x64_bf16 v[44:47], v[48:51], v[96:103], v2
  s_waitcnt lgkmcnt(2)
  v_smfmac_f32_16x16x64_bf16 v[44:47], v[52:55], v[104:111], v2
  ds_read_b128 v[48:51], v6 offset:30720
  v_cvt_pk_bf16_f32 v41, v41, v43
  v_cvt_pk_bf16_f32 v40, v40, v42
  v_and_or_b32 v41, v41, -2, s12
  s_waitcnt lgkmcnt(1)
  v_smfmac_f32_16x16x64_bf16 v[44:47], v[76:79], v[56:63], v2
  global_store_dwordx2 v3, v[40:41], s[48:49] offset:0
  v_mov_b32 v72, 0
  v_mov_b32 v73, 0
  v_mov_b32 v74, 0
  v_mov_b32 v75, 0
  s_nop 2
  v_cvt_pk_bf16_f32 v45, v45, v47
  v_cvt_pk_bf16_f32 v44, v44, v46
  v_and_or_b32 v45, v45, -2, s12
  global_store_dwordx2 v3, v[44:45], s[48:49] offset:2048
  s_add_u32 s54, s54, 0x2000
  s_bitset0_b32 s54, 15
  v_mov_b32 v76, 0
  ds_read_b128 v[88:91], v1 offset:40960
  v_mov_b32 v77, 0
  ds_read_b128 v[92:95], v1 offset:41984
  v_mov_b32 v78, 0
  ds_read_b128 v[96:99], v5 offset:40960
  v_mov_b32 v79, 0
  ds_read_b128 v[100:103], v5 offset:41984
  v_mov_b32 v19, -1
  ds_read_b128 v[104:107], v1 offset:57344
  v_mov_b32 v19, -1
  ds_read_b128 v[108:111], v1 offset:58368
  v_mov_b32 v19, -1
  ds_read_b128 v[112:115], v1 offset:8192
  v_mov_b32 v19, -1
  ds_read_b128 v[116:119], v1 offset:9216
  v_mov_b32 v19, -1
  ds_read_b128 v[120:123], v1 offset:24576
  v_mov_b32 v19, -1
  ds_read_b128 v[124:127], v1 offset:25600
  v_mov_b32 v19, -1
  s_add_u32 s60, s60, 262144
  s_addc_u32 s61, s61, 0
  v_mov_b32 v19, -1
  s_add_u32 s68, s68, 262144
  s_addc_u32 s69, s69, 0
  v_mov_b32 v19, -1
  s_add_u32 s62, s62, 262144
  s_addc_u32 s63, s63, 0
  v_mov_b32 v19, -1
  s_add_u32 s64, s64, 262144
  s_addc_u32 s65, s65, 0
  v_mov_b32 v19, -1
  v_mov_b32 v19, -1
  v_mov_b32 v19, -1
  v_mov_b32 v19, -1
  global_load_dwordx4 v[80:83], v1, s[50:51] sc1
  global_load_dwordx4 v[84:87], v1, s[50:51] offset:1024 sc1
  v_mov_b32 v19, -1
L_R2_h13:
  s_cbranch_execz L_R_wr
  v_mov_b32 v19, -1
  v_mov_b32 v19, -1
  v_mov_b32 v19, -1
  v_mov_b32 v19, -1
  v_mov_b32 v19, -1
  v_mov_b32 v19, -1
  v_mov_b32 v19, -1
  v_mov_b32 v19, -1
  v_mov_b32 v19, -1
  v_mov_b32 v19, -1
  v_mov_b32 v19, -1
  v_mov_b32 v19, -1
  v_mov_b32 v19, -1
  v_mov_b32 v19, -1
  v_mov_b32 v19, -1
  v_mov_b32 v19, -1
  v_mov_b32 v19, -1
  v_mov_b32 v19, -1
  v_mov_b32 v19, -1
  v_mov_b32 v19, -1
L_R2_h14:
  s_cbranch_execz L_R_wr
  v_mov_b32 v19, -1
  v_mov_b32 v19, -1
  v_mov_b32 v19, -1
  v_mov_b32 v19, -1
  v_mov_b32 v19, -1
  v_mov_b32 v19, -1
  v_mov_b32 v19, -1
  v_mov_b32 v19, -1
  v_mov_b32 v19, -1
  v_mov_b32 v19, -1
  v_mov_b32 v19, -1
  v_mov_b32 v19, -1
  global_load_dwordx4 v[80:83], v1, s[50:51] sc1
  global_load_dwordx4 v[84:87], v1, s[50:51] offset:1024 sc1
  v_mov_b32 v19, -1
  v_mov_b32 v19, -1
  v_mov_b32 v19, -1
  v_mov_b32 v19, -1
  v_mov_b32 v19, -1
  v_mov_b32_e64 v19, -1
  s_waitcnt lgkmcnt(10)
  v_mfma_f32_16x16x1_4b_f32 v[56:71], v0, v0, 0
  s_waitcnt vmcnt(3)
  v_bitop3_b32 v16, v81, v83, s12 bitop3:0x7e
  v_mfma_f32_16x16x32_bf16 v[52:55], v[48:51], v[80:83], 0
  s_waitcnt vmcnt(2)
  v_bitop3_b32 v17, v85, v87, s12 bitop3:0x7e
  v_mfma_f32_16x16x32_bf16 v[52:55], v[48:51], v[84:87], v[52:55]
  v_bitop3_b32 v16, v16, v17, 1 bitop3:0xa8
  v_cmp_ne_u32_e64 vcc, 0, v16
  v_readfirstlane_b32 s79, v10
  v_mov_b32_e64 v19, -1
  v_mov_b32_e64 v19, -1
  v_mov_b32_e64 v19, -1
  v_mov_b32_e64 v19, -1
  v_mov_b32_e64 v19, -1
L_R2_c1:
  v_add_f32_dpp v52, v52, v52 row_ror:4 row_mask:0xf bank_mask:0xf
  v_add_f32_dpp v53, v53, v53 row_ror:4 row_mask:0xf bank_mask:0xf
L_R2_h15:
  s_cbranch_vccnz L_R2_pf
  v_add_f32_dpp v52, v52, v52 row_ror:8 row_mask:0xf bank_mask:0xf
  v_add_f32_dpp v53, v53, v53 row_ror:8 row_mask:0xf bank_mask:0xf
  v_cvt_pk_bf16_f32 v16, v52, v53
  global_store_dword v4, v16, s[56:57]
  s_cmp_eq_u32 s79, 0
  s_cbranch_scc1 L_R2_fw
L_R2_fok:
  v_mov_b32 v19, -1
  global_store_dword v4, v19, s[58:59]
  s_add_u32 s58, s58, 0x2000
  s_bitset0_b32 s58, 15
  v_mov_b32 v19, -1
  s_cmp_lt_u32 s44, 61
  s_cselect_b32 s74, 2048, 0
  v_mov_b32 v19, -1
  s_add_u32 s66, s66, s74
  s_addc_u32 s67, s67, 0
  v_mov_b32 v19, -1
  s_add_u32 s56, s56, 0x2000
  s_bitset0_b32 s56, 15
  v_mov_b32 v19, -1
  s_xor_b32 s12, s12, 1
  s_add_u32 s44, s44, 1
  v_lshlrev_b32 v10, 3, v1
  s_cmp_eq_u32 s44, 63
  v_mov_b32 v19, -1
L_R2_h16:
  s_cbranch_execz L_R_wr
  v_mov_b32 v19, -1
  v_mov_b32 v19, -1
  v_mov_b32 v19, -1
  v_mov_b32 v19, -1
  v_mov_b32 v19, -1
L_R2_h17:
  s_cbranch_execz L_R_wr
  v_mov_b32 v19, -1
  v_mov_b32 v19, -1
  v_mov_b32 v19, -1
  v_mov_b32 v19, -1
  v_mov_b32 v19, -1
  v_mov_b32 v19, -1
  global_load_dwordx4 v[24:27], v1, s[54:55] offset:-2048 sc1
  v_mov_b32 v19, -1
  v_mov_b32 v19, -1
  v_mov_b32 v19, -1
  v_mov_b32 v19, -1
  v_mov_b32 v19, -1
  v_mov_b32 v19, -1
  v_mov_b32 v19, -1
  v_mov_b32 v19, -1
  v_mov_b32 v19, -1
  v_mov_b32 v19, -1
  v_mov_b32 v19, -1
  v_mov_b32 v19, -1
  global_load_dwordx4 v[24:27], v1, s[54:55] offset:-2048 sc1
  v_mov_b32 v19, -1
  v_mov_b32 v19, -1
  v_mov_b32 v19, -1
  v_mov_b32 v19, -1
  v_mov_b32 v19, -1
  v_mov_b32 v19, -1
  global_load_dwordx4 v[28:31], v1, s[54:55] offset:2048 sc1
  v_mov_b32 v19, -1
L_R2_h18:
  s_cbranch_execz L_R_wr
  v_mov_b32 v19, -1
  v_mov_b32 v19, -1
  v_mov_b32 v19, -1
  v_mov_b32 v19, -1
  v_mov_b32 v19, -1
  v_mov_b32 v19, -1
  v_mov_b32 v19, -1
  v_mov_b32 v19, -1
  v_mov_b32 v19, -1
  v_mov_b32 v19, -1
  global_load_dwordx4 v[24:27], v1, s[54:55] offset:-2048 sc1
  v_mov_b32 v19, -1
  v_mov_b32 v19, -1
  v_mov_b32 v19, -1
  v_mov_b32 v19, -1
  v_mov_b32 v19, -1
  v_mov_b32 v19, -1
  global_load_dwordx4 v[28:31], v1, s[54:55] offset:2048 sc1
  v_mov_b32 v19, -1
  v_mov_b32_e64 v19, -1
  s_cbranch_scc1 L_R2_z
  s_waitcnt lgkmcnt(0)
  v_mfma_f32_16x16x1_4b_f32 v[56:71], v0, v0, 0
  s_branch L_R2_p2
.p2align 2
L_R2_zfe:
L_R2_zh0:
  s_cbranch_execz L_R2_zh1
  global_load_dwordx4 v[24:27], v1, s[54:55] offset:-2048 sc1
L_R2_zh1:
  s_cbranch_execz L_R2_zh2
L_R2_h19:
  s_cbranch_execz L_R_wr
  v_mfma_f32_16x16x1_4b_f32 v[56:71], v0, v0, 0
  s_sub_u32 s7, s7, 1
  s_cbranch_scc0 L_R2_ze
  s_mov_b32 s7, 0
  s_branch L_R2_ze1
L_R2_zfl:
  global_load_dwordx4 v[28:31], v1, s[54:55] offset:2048 sc1
  s_sub_u32 s7, s7, 1
  s_cbranch_scc0 L_R2_zl
  s_mov_b32 s7, 0
  s_branch L_R2_zl1
L_R2_z:
  global_store_dwordx4 v1, v[20:23], s[64:65] sc1
L_R2_zh2:
  s_cbranch_execz L_R2_zh3
  s_add_u32 s64, s64, 262144
  s_addc_u32 s65, s65, 0
  s_waitcnt lgkmcnt(0)
L_R2_ze:
  s_waitcnt vmcnt(5)
  v_max3_u32 v16, v24, v25, v26
  v_max_u32 v16, v16, v27
  v_smfmac_f32_16x16x64_bf16 v[64:67], v[24:27], a[32:39], v2
  ds_write_b128 v6, v[24:27] offset:18432
  v_cmp_eq_u32 vcc, -1, v16
  v_smfmac_f32_16x16x64_bf16 v[68:71], v[24:27], a[40:47], v2
L_R2_zh3:
  s_cbranch_execz L_R2_zh4
L_R2_h20:
  s_cbranch_execz L_R_wr
  v_mov_b32 v19, -1
  v_mov_b32 v19, -1
  v_mov_b32 v19, -1
  v_mov_b32 v19, -1
  s_cbranch_vccnz L_R2_zfe
L_R2_ze1:
  v_smfmac_f32_16x16x64_bf16 v[72:75], v[24:27], v[160:167], v2
  v_smfmac_f32_16x16x64_bf16 v[76:79], v[24:27], v[168:175], v2
  s_waitcnt lgkmcnt(0)
  s_barrier
L_R2_zl:
  s_waitcnt vmcnt(3)
  v_max3_u32 v16, v28, v29, v30
L_R2_zh4:
  s_cbranch_execz L_R2_zh5
  v_max_u32 v16, v16, v31
  v_cmp_eq_u32 vcc, -1, v16
  ds_read_b128 v[32:35], v6 offset:19456
  ds_read_b128 v[36:39], v6 offset:16384
  ds_read_b128 v[40:43], v6 offset:17408
  ds_write_b128 v6, v[28:31] offset:22528
  s_cbranch_vccnz L_R2_zfl
L_R2_zl1:
  v_smfmac_f32_16x16x64_bf16 v[64:67], v[28:31], a[96:103], v2
  v_smfmac_f32_16x16x64_bf16 v[68:71], v[28:31], a[104:111], v2
L_R2_zh5:
  s_cbranch_execz L_R2_zh6
L_R2_h21:
  s_cbranch_execz L_R_wr
  v_smfmac_f32_16x16x64_bf16 v[72:75], v[28:31], v[224:231], v2
  s_waitcnt lgkmcnt(0)
  s_barrier
  v_smfmac_f32_16x16x64_bf16 v[76:79], v[28:31], v[232:239], v2
  v_smfmac_f32_16x16x64_bf16 v[64:67], v[32:35], a[48:55], v2
  ds_read_b128 v[44:47], v6 offset:23552
  v_smfmac_f32_16x16x64_bf16 v[68:71], v[32:35], a[56:63], v2
  ds_read_b128 v[48:51], v6 offset:20480
L_R2_zh6:
  s_cbranch_execz L_R2_zh7
  v_smfmac_f32_16x16x64_bf16 v[72:75], v[32:35], v[176:183], v2
  ds_read_b128 v[52:55], v6 offset:21504
  v_smfmac_f32_16x16x64_bf16 v[76:79], v[32:35], v[184:191], v2
  v_smfmac_f32_16x16x64_bf16 v[64:67], v[36:39], a[0:7], v2
  v_smfmac_f32_16x16x64_bf16 v[68:71], v[36:39], a[8:15], v2
  v_smfmac_f32_16x16x64_bf16 v[72:75], v[36:39], v[128:135], v2
  v_smfmac_f32_16x16x64_bf16 v[76:79], v[36:39], v[136:143], v2
  v_smfmac_f32_16x16x64_bf16 v[64:67], v[40:43], a[16:23], v2
L_R2_zh7:
  s_cbranch_execz L_R2_zh8
L_R2_h22:
  s_cbranch_execz L_R_wr
  v_smfmac_f32_16x16x64_bf16 v[68:71], v[40:43], a[24:31], v2
  v_smfmac_f32_16x16x64_bf16 v[72:75], v[40:43], v[144:151], v2
  v_smfmac_f32_16x16x64_bf16 v[76:79], v[40:43], v[152:159], v2
  s_waitcnt lgkmcnt(0)
  v_smfmac_f32_16x16x64_bf16 v[64:67], v[44:47], a[112:119], v2
  v_smfmac_f32_16x16x64_bf16 v[68:71], v[44:47], a[120:127], v2
  v_smfmac_f32_16x16x64_bf16 v[64:67], v[48:51], a[64:71], v2
L_R2_zh8:
  s_cbranch_execz L_R2_zh9
  v_smfmac_f32_16x16x64_bf16 v[68:71], v[48:51], a[72:79], v2
  v_smfmac_f32_16x16x64_bf16 v[64:67], v[52:55], a[80:87], v2
  v_smfmac_f32_16x16x64_bf16 v[68:71], v[52:55], a[88:95], v2
  v_smfmac_f32_16x16x64_bf16 v[72:75], v[44:47], v[240:247], v2
  v_smfmac_f32_16x16x64_bf16 v[76:79], v[44:47], v[248:255], v2
  v_smfmac_f32_16x16x64_bf16 v[72:75], v[48:51], v[192:199], v2
  v_add_f32 v64, v64, v65
  v_add_f32 v66, v66, v67
  v_smfmac_f32_16x16x64_bf16 v[76:79], v[48:51], v[200:207], v2
L_R2_zh9:
  s_cbranch_execz L_R2_zh10
L_R2_h23:
  s_cbranch_execz L_R_wr
  v_add_f32 v68, v68, v69
  v_add_f32 v70, v70, v71
  v_smfmac_f32_16x16x64_bf16 v[72:75], v[52:55], v[208:215], v2
  v_cvt_pk_bf16_f32 v20, v64, v68
  v_cvt_pk_bf16_f32 v21, v66, v70
  v_smfmac_f32_16x16x64_bf16 v[76:79], v[52:55], v[216:223], v2
  v_mov_b32 v19, -1
  v_mov_b32 v19, -1
  v_mov_b32 v19, -1
L_R2_zh10:
  s_cbranch_execz L_R_zr
  v_mov_b32 v19, -1
  v_add_f32 v72, v72, v73
  v_add_f32 v74, v74, v75
  v_cvt_pk_bf16_f32 v22, v72, v74
  v_mov_b32 v19, -1
  v_add_f32 v76, v76, v77
  v_add_f32 v78, v78, v79
  v_cvt_pk_bf16_f32 v23, v76, v78
L_R2_fin:
  global_store_dwordx4 v1, v[20:23], s[64:65] sc1
  s_endpgm
.p2align 2
.p2align 5
L_R2_pf:
  s_cbranch_execz L_R_wr
  s_mov_b64 exec, vcc
  global_load_dwordx4 v[80:83], v1, s[50:51] sc1
  global_load_dwordx4 v[84:87], v1, s[50:51] offset:1024 sc1
  s_mov_b64 exec, -1
  s_waitcnt vmcnt(3)
  v_bitop3_b32 v16, v81, v83, s12 bitop3:0x7e
  v_mfma_f32_16x16x32_bf16 v[52:55], v[48:51], v[80:83], 0
  s_waitcnt vmcnt(2)
  v_bitop3_b32 v17, v85, v87, s12 bitop3:0x7e
  v_mfma_f32_16x16x32_bf16 v[52:55], v[48:51], v[84:87], v[52:55]
  v_bitop3_b32 v16, v16, v17, 1 bitop3:0xa8
  v_cmp_ne_u32 vcc, 0, v16
  s_nop 2
  s_cbranch_vccz L_R2_c1
L_R2_pf2:
  s_mov_b64 exec, vcc
  global_load_dwordx4 v[80:83], v1, s[50:51] sc1
  global_load_dwordx4 v[84:87], v1, s[50:51] offset:1024 sc1
  s_mov_b64 exec, -1
L_R2_h24:
  s_cbranch_execz L_R_wr
  s_waitcnt vmcnt(3)
  v_bitop3_b32 v16, v81, v83, s12 bitop3:0x7e
  v_mfma_f32_16x16x32_bf16 v[52:55], v[48:51], v[80:83], 0
  s_waitcnt vmcnt(2)
  v_bitop3_b32 v17, v85, v87, s12 bitop3:0x7e
  v_mfma_f32_16x16x32_bf16 v[52:55], v[48:51], v[84:87], v[52:55]
  v_bitop3_b32 v16, v16, v17, 1 bitop3:0xa8
  v_cmp_ne_u32 vcc, 0, v16
  s_nop 2
  s_cbranch_vccz L_R2_c1
  s_sub_u32 s7, s7, 1
  s_cbranch_scc0 L_R2_pf2
  s_mov_b32 s7, 0
  s_mov_b64 vcc, 0
  s_branch L_R2_c1
L_R2_h25:
  s_branch L_R_wr
L_R2_of:
  s_cbranch_execz L_R_wr
  s_nop 7
  ds_read_b128 v[48:51], v8 offset:5632
  ds_read_b128 v[52:55], v8 offset:4096
  ds_read_b128 v[76:79], v8 offset:4608
  s_waitcnt lgkmcnt(0)
  v_max_u32 v18, v49, v51
  v_max3_u32 v18, v18, v53, v55
  v_max3_u32 v18, v18, v77, v79
  v_cmp_eq_u32 vcc, -1, v18
  s_cbranch_vccz L_R2_og
  s_sub_u32 s7, s7, 1
  s_cbranch_scc0 L_R2_of
  s_mov_b32 s7, 0
  v_min_u32 v49, -2, v49
  v_min_u32 v51, -2, v51
  v_min_u32 v53, -2, v53
  v_min_u32 v55, -2, v55
  v_min_u32 v77, -2, v77
  v_min_u32 v79, -2, v79
L_R2_og:
  v_mfma_i32_16x16x4_4b_i8 v[32:47], v0, v0, 0
  s_nop 11
  v_smfmac_f32_16x16x64_bf16 v[32:35], v[72:75], a[208:215], v2
  v_smfmac_f32_16x16x64_bf16 v[36:39], v[72:75], a[240:247], v2
  v_smfmac_f32_16x16x64_bf16 v[40:43], v[72:75], v[24:31], v2
  v_smfmac_f32_16x16x64_bf16 v[44:47], v[72:75], v[88:95], v2
  s_branch L_R2_ok
L_R2_h26:
  s_branch L_R_wr
L_R2_fw:
Lww_33:
  global_load_dword v19, v0, s[66:67] offset:0 sc1
  s_waitcnt vmcnt(0)
  v_cmp_gt_u32 vcc, 1, v19
  s_cbranch_vccz Lwd_34
  s_sub_u32 s7, s7, 1
  s_cbranch_scc0 Lww_33
  s_mov_b32 s7, 0
Lwd_34:
  s_branch L_R2_fok
L_R2_h27:
  s_branch L_R_wr
.p2align 2
L_R2_slow:
  s_cbranch_execz L_R_wr
  s_nop 7
  s_nop 7
  ds_read_b128 v[32:35], v6 offset:0
  ds_read_b128 v[36:39], v6 offset:1024
  ds_read_b128 v[40:43], v8 offset:0
  ds_read_b128 v[44:47], v9 offset:0
  s_waitcnt lgkmcnt(0)
  v_mfma_f32_16x16x32_bf16 v[56:59], v[32:35], v[40:43], 0
  v_mfma_f32_16x16x32_bf16 v[60:63], v[36:39], v[40:43], 0
  v_mfma_f32_16x16x32_bf16 v[120:123], v[44:47], v[40:43], 0
  s_nop 7
  ds_read_b128 v[32:35], v6 offset:2048
  ds_read_b128 v[36:39], v6 offset:3072
  ds_read_b128 v[40:43], v8 offset:1024
  ds_read_b128 v[44:47], v9 offset:1024
  s_waitcnt lgkmcnt(0)
  v_mfma_f32_16x16x32_bf16 v[56:59], v[32:35], v[40:43], v[56:59]
  v_mfma_f32_16x16x32_bf16 v[60:63], v[36:39], v[40:43], v[60:63]
  v_mfma_f32_16x16x32_bf16 v[120:123], v[44:47], v[40:43], v[120:123]
  s_nop 7
  ds_read_b128 v[32:35], v6 offset:4096
  ds_read_b128 v[36:39], v6 offset:5120
  ds_read_b128 v[40:43], v8 offset:2048
  ds_read_b128 v[44:47], v9 offset:2048
  s_waitcnt lgkmcnt(0)
  v_mfma_f32_16x16x32_bf16 v[56:59], v[32:35], v[40:43], v[56:59]
  v_mfma_f32_16x16x32_bf16 v[60:63], v[36:39], v[40:43], v[60:63]
  v_mfma_f32_16x16x32_bf16 v[120:123], v[44:47], v[40:43], v[120:123]
  s_nop 7
  ds_read_b128 v[32:35], v6 offset:6144
  ds_read_b128 v[36:39], v6 offset:7168
  ds_read_b128 v[40:43], v8 offset:3072
  ds_read_b128 v[44:47], v9 offset:3072
  s_waitcnt lgkmcnt(0)
  v_mfma_f32_16x16x32_bf16 v[56:59], v[32:35], v[40:43], v[56:59]
  v_mfma_f32_16x16x32_bf16 v[60:63], v[36:39], v[40:43], v[60:63]
  v_mfma_f32_16x16x32_bf16 v[120:123], v[44:47], v[40:43], v[120:123]
  s_nop 7
  v_mfma_i32_16x16x4_4b_i8 v[32:47], v0, v0, 0
  v_max3_f32 v16, v56, v57, v58
  v_max3_f32 v17, v59, v60, v61
  v_max3_f32 v16, v16, v62, v63
  v_max3_f32 v17, v17, v120, v121
  v_max_f32 v18, v16, v17
  v_max_f32 v19, v16, v17
  s_nop 1
  v_permlane32_swap_b32 v18, v19
  v_max_f32 v16, v18, v19
  v_max_f32 v17, v18, v19
  s_nop 1
  v_permlane16_swap_b32 v16, v17
  v_max_f32 v16, v16, v17
  v_mul_f32 v13, 0xbe0293ee, v16
  v_fma_f32 v56, v56, s52, v13
  v_fma_f32 v57, v57, s52, v13
  v_exp_f32 v56, v56
  v_fma_f32 v58, v58, s52, v13
  v_exp_f32 v57, v57
  v_fma_f32 v59, v59, s52, v13
  v_exp_f32 v58, v58
  v_cvt_pk_bf16_f32 v56, v56, v57
  v_exp_f32 v59, v59
  v_fma_f32 v60, v60, s52, v13
  v_cvt_pk_bf16_f32 v57, v58, v59
  v_fma_f32 v61, v61, s52, v13
  v_exp_f32 v60, v60
  v_fma_f32 v62, v62, s52, v13
  v_exp_f32 v61, v61
  v_fma_f32 v63, v63, s52, v13
  v_exp_f32 v62, v62
  v_exp_f32 v63, v63
  v_cvt_pk_bf16_f32 v58, v60, v61
  v_cvt_pk_bf16_f32 v59, v62, v63
  v_fma_f32 v120, v120, s52, v13
  v_fma_f32 v121, v121, s52, v13
  v_exp_f32 v18, v120
  v_exp_f32 v19, v121
  v_mfma_f32_16x16x32_bf16 v[104:107], v[124:127], v[56:59], 0
  v_mfma_f32_16x16x32_bf16 v[96:99], v[80:83], v[56:59], 0
  v_mfma_f32_16x16x32_bf16 v[100:103], v[84:87], v[56:59], 0
  v_cvt_pk_bf16_f32 v14, v18, v19
  v_lshlrev_b64 v[16:17], v12, v[14:15]
  s_nop 1
  v_mfma_f32_16x16x16_bf16 v[108:111], v[124:125], v[16:17], v[104:107]
  s_nop 2
  v_cndmask_b32 v96, v96, v100, s[70:71]
  v_cndmask_b32 v97, v97, v101, s[70:71]
  v_cndmask_b32 v98, v98, v102, s[70:71]
  v_cndmask_b32 v99, v99, v103, s[70:71]
  s_nop 1
  v_mfma_f32_16x16x16_bf16 v[60:63], v[22:23], v[16:17], v[96:99]
  v_rcp_f32 v18, v108
  s_nop 7
  s_barrier
  s_branch L_R2_sy
.p2align 7
L_R3:
  ds_read_b128 v[88:91], v1 offset:61440
  ds_read_b128 v[92:95], v1 offset:62464
  ds_read_b128 v[96:99], v5 offset:61440
  ds_read_b128 v[100:103], v5 offset:62464
  ds_read_b128 v[104:107], v1 offset:12288
  ds_read_b128 v[108:111], v1 offset:13312
  ds_read_b128 v[112:115], v1 offset:28672
  ds_read_b128 v[116:119], v1 offset:29696
  ds_read_b128 v[120:123], v1 offset:45056
  ds_read_b128 v[124:127], v1 offset:46080
  v_mov_b32 v19, -1
  v_lshlrev_b32 v10, 3, v1
  global_load_dwordx4 v[80:83], v1, s[62:63]
  global_load_dwordx4 v[84:87], v1, s[62:63] offset:1024
  s_waitcnt vmcnt(2) lgkmcnt(0)
  s_branch L_R3_p2
L_R3_h0:
  s_branch L_R_wr
.p2align 5
L_R3_fe:
  s_cbranch_execz L_R_wr
  s_mov_b64 exec, vcc
  global_load_dwordx4 v[24:27], v1, s[54:55] offset:-2048 sc1
  s_mov_b64 exec, -1
  v_mov_b32 v19, -1
  v_mov_b32 v19, -1
  v_mov_b32 v19, -1
  v_mov_b32 v19, -1
  v_mfma_f32_16x16x1_4b_f32 v[56:71], v0, v0, 0
  s_waitcnt vmcnt(4)
  v_max3_u32 v16, v24, v25, v26
  v_max_u32 v16, v16, v27
  v_cmp_eq_u32 vcc, -1, v16
  s_cbranch_vccz L_R3_p2a
  s_mov_b64 exec, vcc
  global_load_dwordx4 v[24:27], v1, s[54:55] offset:-2048 sc1
  s_mov_b64 exec, -1
  s_waitcnt vmcnt(3)
  v_max3_u32 v16, v24, v25, v26
L_R3_h1:
  s_cbranch_execz L_R_wr
  v_max_u32 v16, v16, v27
  v_cmp_eq_u32 vcc, -1, v16
  s_cbranch_vccz L_R3_p2a
  s_mov_b64 exec, vcc
  global_load_dwordx4 v[24:27], v1, s[54:55] offset:-2048 sc1
  s_mov_b64 exec, -1
  s_waitcnt vmcnt(2)
  v_max3_u32 v16, v24, v25, v26
  v_max_u32 v16, v16, v27
  v_cmp_eq_u32 vcc, -1, v16
  s_cbranch_vccz L_R3_p2a
L_R3_fe2:
  s_mov_b64 exec, vcc
  global_load_dwordx4 v[24:27], v1, s[54:55] offset:-2048 sc1
  s_mov_b64 exec, -1
  s_waitcnt vmcnt(2)
  v_max3_u32 v16, v24, v25, v26
  v_max_u32 v16, v16, v27
  v_cmp_eq_u32 vcc, -1, v16
  s_cbranch_vccz L_R3_p2a
  s_sub_u32 s7, s7, 1
  s_cbranch_scc0 L_R3_fe2
  s_mov_b32 s7, 0
  v_mov_b32 v16, 0
  s_branch L_R3_p2a
L_R3_h2:
  s_branch L_R_wr
.p2align 5
L_R3_fl:
  s_cbranch_execz L_R_wr
  s_mov_b64 exec, vcc
  global_load_dwordx4 v[28:31], v1, s[54:55] offset:2048 sc1
  s_mov_b64 exec, -1
  s_waitcnt vmcnt(2)
  v_max3_u32 v16, v28, v29, v30
  v_max_u32 v16, v16, v31
  v_cmp_eq_u32 vcc, -1, v16
  ds_write_b128 v6, v[28:31] offset:23552
  s_cbranch_vccz L_R3_cl
L_R3_fl2:
  s_mov_b64 exec, vcc
  global_load_dwordx4 v[28:31], v1, s[54:55] offset:2048 sc1
  s_mov_b64 exec, -1
  s_waitcnt vmcnt(2)
  v_max3_u32 v16, v28, v29, v30
  v_max_u32 v16, v16, v31
  v_cmp_eq_u32 vcc, -1, v16
  ds_write_b128 v6, v[28:31] offset:23552
  s_cbranch_vccz L_R3_cl
  s_sub_u32 s7, s7, 1
  s_cbranch_scc0 L_R3_fl2
  s_mov_b32 s7, 0
  s_branch L_R3_cl
L_R3_h3:
  s_branch L_R_wr
.p2align 6
L_R3_p2:
  s_waitcnt vmcnt(4)
  v_max3_u32 v16, v24, v25, v26
  v_max_u32 v16, v16, v27
L_R3_p2a:
  v_smfmac_f32_16x16x64_bf16 v[56:59], v[24:27], v[88:95], v2
  ds_write_b128 v6, v[24:27] offset:19456
  v_cmp_eq_u32 vcc, -1, v16
  v_smfmac_f32_16x16x64_bf16 v[60:63], v[24:27], a[152:159], v2
  v_smfmac_f32_16x16x64_bf16 v[64:67], v[24:27], a[48:55], v2
L_R3_h4:
  s_cbranch_vccnz L_R3_fe
  v_smfmac_f32_16x16x64_bf16 v[68:71], v[24:27], a[56:63], v2
  global_load_dwordx4 v[28:31], v1, s[54:55] offset:2048 sc1
  ds_read_b128 v[88:91], v5 offset:12288
  v_smfmac_f32_16x16x64_bf16 v[72:75], v[24:27], v[176:183], v2
  s_waitcnt lgkmcnt(1)
  s_barrier
  s_waitcnt vmcnt(3)
  v_max3_u32 v16, v28, v29, v30
  v_max_u32 v16, v16, v31
  v_cmp_eq_u32 vcc, -1, v16
  v_smfmac_f32_16x16x64_bf16 v[76:79], v[24:27], v[184:191], v2
  ds_write_b128 v6, v[28:31] offset:23552
L_R3_h5:
  s_cbranch_vccnz L_R3_fl
L_R3_cl:
  v_smfmac_f32_16x16x64_bf16 v[56:59], v[28:31], v[96:103], v2
  ds_read_b128 v[32:35], v6 offset:16384
  global_load_dwordx4 v[80:83], v1, s[62:63]
  v_smfmac_f32_16x16x64_bf16 v[60:63], v[28:31], a[184:191], v2
  ds_read_b128 v[36:39], v6 offset:17408
  global_load_dwordx4 v[84:87], v1, s[62:63] offset:1024
  v_smfmac_f32_16x16x64_bf16 v[64:67], v[28:31], a[112:119], v2
  s_waitcnt lgkmcnt(2)
  s_barrier
  ds_read_b128 v[40:43], v6 offset:18432
  v_smfmac_f32_16x16x64_bf16 v[68:71], v[28:31], a[120:127], v2
  ds_read_b128 v[44:47], v6 offset:20480
  v_smfmac_f32_16x16x64_bf16 v[72:75], v[28:31], v[240:247], v2
  ds_read_b128 v[48:51], v6 offset:21504
  v_smfmac_f32_16x16x64_bf16 v[76:79], v[28:31], v[248:255], v2
  ds_read_b128 v[52:55], v6 offset:22528
  s_waitcnt lgkmcnt(5)
  v_smfmac_f32_16x16x64_bf16 v[56:59], v[32:35], v[104:111], v2
  ds_read_b128 v[92:95], v5 offset:13312
  v_smfmac_f32_16x16x64_bf16 v[60:63], v[32:35], a[128:135], v2
  ds_read_b128 v[96:99], v5 offset:28672
  s_waitcnt lgkmcnt(6)
  v_smfmac_f32_16x16x64_bf16 v[56:59], v[36:39], v[112:119], v2
  ds_read_b128 v[100:103], v5 offset:29696
  v_smfmac_f32_16x16x64_bf16 v[60:63], v[36:39], a[136:143], v2
  ds_read_b128 v[104:107], v5 offset:45056
  s_waitcnt lgkmcnt(7)
  v_smfmac_f32_16x16x64_bf16 v[56:59], v[40:43], v[120:127], v2
  ds_read_b128 v[108:111], v5 offset:46080
  v_smfmac_f32_16x16x64_bf16 v[60:63], v[40:43], a[144:151], v2
  global_store_dwordx4 v1, v[20:23], s[64:65] sc1
  ds_read_b128 v[112:115], v6 offset:0
  s_waitcnt lgkmcnt(5)
  v_smfmac_f32_16x16x64_bf16 v[56:59], v[44:47], v[88:95], v2
L_R3_h6:
  s_cbranch_execz L_R_wr
  ds_read_b128 v[116:119], v6 offset:2048
  v_smfmac_f32_16x16x64_bf16 v[60:63], v[44:47], a[160:167], v2
  ds_read_b128 v[120:123], v6 offset:4096
  s_waitcnt lgkmcnt(5)
  v_smfmac_f32_16x16x64_bf16 v[56:59], v[48:51], v[96:103], v2
  global_load_dword v10, v0, s[66:67] sc1
  ds_read_b128 v[124:127], v6 offset:6144
  v_smfmac_f32_16x16x64_bf16 v[60:63], v[48:51], a[168:175], v2
  ds_write_b32 v11, v19 offset:5636
  s_waitcnt lgkmcnt(5)
  v_smfmac_f32_16x16x64_bf16 v[56:59], v[52:55], v[104:111], v2
  v_smfmac_f32_16x16x64_bf16 v[60:63], v[52:55], a[176:183], v2
  s_waitcnt vmcnt(4)
  ds_read_b128 v[24:27], v6 offset:1024
  v_smfmac_f32_16x16x64_bf16 v[64:67], v[32:35], a[0:7], v2
  ds_read_b128 v[28:31], v6 offset:3072
  v_add_f32 v56, v56, v57
  v_add_f32 v58, v58, v59
  v_smfmac_f32_16x16x64_bf16 v[68:71], v[32:35], a[8:15], v2
L_R3_h7:
  s_cbranch_execz L_R_wr
  v_add_f32 v60, v60, v61
  v_add_f32 v62, v62, v63
  v_smfmac_f32_16x16x64_bf16 v[64:67], v[36:39], a[16:23], v2
  v_cvt_pk_bf16_f32 v16, v56, v60
  v_cvt_pk_bf16_f32 v17, v58, v62
  v_smfmac_f32_16x16x64_bf16 v[68:71], v[36:39], a[24:31], v2
  ds_write2_b32 v7, v16, v17 offset0:0 offset1:16
  v_smfmac_f32_16x16x64_bf16 v[64:67], v[40:43], a[32:39], v2
  v_smfmac_f32_16x16x64_bf16 v[68:71], v[40:43], a[40:47], v2
  v_smfmac_f32_16x16x64_bf16 v[64:67], v[44:47], a[64:71], v2
  v_smfmac_f32_16x16x64_bf16 v[68:71], v[44:47], a[72:79], v2
  s_waitcnt lgkmcnt(0)
  s_barrier
  v_smfmac_f32_16x16x64_bf16 v[64:67], v[48:51], a[80:87], v2
  ds_read_b128 v[96:99], v8 offset:0
  v_smfmac_f32_16x16x64_bf16 v[68:71], v[48:51], a[88:95], v2
  ds_read_b128 v[100:103], v8 offset:1024
  v_smfmac_f32_16x16x64_bf16 v[64:67], v[52:55], a[96:103], v2
  ds_read_b128 v[104:107], v8 offset:2048
  v_smfmac_f32_16x16x64_bf16 v[68:71], v[52:55], a[104:111], v2
  ds_read_b128 v[108:111], v8 offset:3072
  v_smfmac_f32_16x16x64_bf16 v[72:75], v[32:35], v[128:135], v2
  ds_read_b128 v[88:91], v6 offset:5120
  v_add_f32 v64, v64, v65
  v_smfmac_f32_16x16x64_bf16 v[76:79], v[32:35], v[136:143], v2
  ds_read_b128 v[92:95], v6 offset:7168
  v_add_f32 v66, v66, v67
  s_waitcnt lgkmcnt(5)
  v_mfma_f32_16x16x32_bf16 v[56:59], v[112:115], v[96:99], 0
  v_add_f32 v68, v68, v69
  v_add_f32 v70, v70, v71
  s_waitcnt lgkmcnt(4)
  v_mfma_f32_16x16x32_bf16 v[56:59], v[116:119], v[100:103], v[56:59]
  v_cvt_pk_bf16_f32 v20, v64, v68
  v_cvt_pk_bf16_f32 v21, v66, v70
  s_waitcnt lgkmcnt(3)
  v_mfma_f32_16x16x32_bf16 v[56:59], v[120:123], v[104:107], v[56:59]
  ds_write2_b32 v7, v20, v21 offset0:128 offset1:144
  s_waitcnt lgkmcnt(3)
  v_mfma_f32_16x16x32_bf16 v[56:59], v[124:127], v[108:111], v[56:59]
  ds_read_b128 v[124:127], v6 offset:31744
  v_mfma_f32_16x16x32_bf16 v[60:63], v[24:27], v[96:99], 0
  v_mfma_f32_16x16x32_bf16 v[60:63], v[28:31], v[100:103], v[60:63]
  s_waitcnt lgkmcnt(3)
  v_max3_f32 v16, v56, v57, v58
  v_max_f32 v18, v16, v59
  v_max_f32 v19, v16, v59
  v_mfma_f32_16x16x32_bf16 v[60:63], v[88:91], v[104:107], v[60:63]
  s_waitcnt lgkmcnt(1)
  s_barrier
  v_permlane32_swap_b32 v18, v19
  v_max_f32 v16, v18, v19
  v_max_f32 v17, v18, v19
  v_mfma_f32_16x16x32_bf16 v[60:63], v[92:95], v[108:111], v[60:63]
  ds_read_b128 v[64:67], v9 offset:0
  v_permlane16_swap_b32 v16, v17
  v_max_f32 v16, v16, v17
  v_mul_f32 v13, 0xbe0293ee, v16
  v_smfmac_f32_16x16x64_bf16 v[72:75], v[36:39], v[144:151], v2
  ds_read_b128 v[68:71], v9 offset:1024
  v_fma_f32 v56, v56, s52, v13
  v_fma_f32 v57, v57, s52, v13
  v_smfmac_f32_16x16x64_bf16 v[76:79], v[36:39], v[152:159], v2
  ds_read_b128 v[112:115], v9 offset:2048
  v_exp_f32 v56, v56
  v_smfmac_f32_16x16x64_bf16 v[72:75], v[40:43], v[160:167], v2
  ds_read_b128 v[116:119], v9 offset:3072
  v_fma_f32 v58, v58, s52, v13
  v_exp_f32 v57, v57
  v_smfmac_f32_16x16x64_bf16 v[76:79], v[40:43], v[168:175], v2
  ds_read_b128 v[24:27], v1 offset:63488
  s_waitcnt lgkmcnt(4)
  v_fma_f32 v59, v59, s52, v13
  v_mfma_f32_16x16x32_bf16 v[120:123], v[64:67], v[96:99], 0
  v_exp_f32 v58, v58
  v_cvt_pk_bf16_f32 v56, v56, v57
  s_waitcnt lgkmcnt(3)
  v_mfma_f32_16x16x32_bf16 v[120:123], v[68:71], v[100:103], v[120:123]
  v_exp_f32 v59, v59
  v_fma_f32 v60, v60, s52, v13
  s_waitcnt lgkmcnt(2)
  v_mfma_f32_16x16x32_bf16 v[120:123], v[112:115], v[104:107], v[120:123]
  s_waitcnt lgkmcnt(1)
  v_cvt_pk_bf16_f32 v57, v58, v59
  v_fma_f32 v61, v61, s52, v13
  v_exp_f32 v60, v60
  v_mfma_f32_16x16x32_bf16 v[120:123], v[116:119], v[108:111], v[120:123]
  v_fma_f32 v62, v62, s52, v13
  v_exp_f32 v61, v61
  v_smfmac_f32_16x16x64_bf16 v[72:75], v[44:47], v[192:199], v2
  ds_read_b128 v[28:31], v1 offset:64512
  v_fma_f32 v63, v63, s52, v13
  v_smfmac_f32_16x16x64_bf16 v[76:79], v[44:47], v[200:207], v2
  ds_read_b128 v[88:91], v5 offset:63488
  v_exp_f32 v62, v62
  v_smfmac_f32_16x16x64_bf16 v[72:75], v[48:51], v[208:215], v2
  ds_read_b128 v[92:95], v5 offset:64512
  v_exp_f32 v63, v63
  v_smfmac_f32_16x16x64_bf16 v[76:79], v[48:51], v[216:223], v2
  ds_read_b128 v[112:115], v1 offset:14336
  v_cvt_pk_bf16_f32 v58, v60, v61
  v_cvt_pk_bf16_f32 v59, v62, v63
  s_nop 1
  v_mfma_f32_16x16x32_bf16 v[104:107], v[124:127], v[56:59], 0
  s_waitcnt vmcnt(2)
  v_fma_f32 v120, v120, s52, v13
  v_fma_f32 v121, v121, s52, v13
  v_mfma_f32_16x16x32_bf16 v[96:99], v[80:83], v[56:59], 0
  v_exp_f32 v18, v120
  v_mfma_f32_16x16x32_bf16 v[100:103], v[84:87], v[56:59], 0
L_R3_h8:
  s_cbranch_execz L_R_wr
  v_exp_f32 v19, v121
  v_smfmac_f32_16x16x64_bf16 v[72:75], v[52:55], v[224:231], v2
  ds_read_b128 v[116:119], v1 offset:15360
  v_cvt_pk_bf16_f32 v14, v18, v19
  v_lshlrev_b64 v[16:17], v12, v[14:15]
  v_smfmac_f32_16x16x64_bf16 v[76:79], v[52:55], v[232:239], v2
  v_cndmask_b32 v96, v96, v100, s[70:71]
  v_mfma_f32_16x16x16_bf16 v[108:111], v[124:125], v[16:17], v[104:107]
  v_cndmask_b32 v97, v97, v101, s[70:71]
  v_cndmask_b32 v98, v98, v102, s[70:71]
  v_cndmask_b32 v99, v99, v103, s[70:71]
  v_add_f32 v72, v72, v73
  v_add_f32 v74, v74, v75
  v_add_f32 v76, v76, v77
  v_add_f32 v78, v78, v79
  v_cvt_pk_bf16_f32 v22, v72, v74
  v_cvt_pk_bf16_f32 v23, v76, v78
  v_mov_b32 v19, -1
  v_mov_b32 v19, -1
  v_mfma_f32_16x16x16_bf16 v[60:63], v[22:23], v[16:17], v[96:99]
  v_cmp_nge_f32 vcc, s53, v108
  v_rcp_f32 v18, v108
  v_mov_b32_e64 v19, -1
  v_mov_b32_e64 v19, -1
  v_mov_b32_e64 v19, -1
  v_mfma_i32_16x16x4_4b_i8 v[32:47], v0, v0, 0
  v_mov_b32_e64 v19, -1
L_R3_h9:
  s_cbranch_vccnz L_R3_slow
L_R3_sy:
  v_mul_f32 v60, v60, v18
  v_mul_f32 v61, v61, v18
  v_cvt_pk_bf16_f32 v16, v60, v61
  v_mul_f32 v62, v62, v18
  v_mul_f32 v63, v63, v18
  v_cvt_pk_bf16_f32 v17, v62, v63
  ds_write_b64 v11, v[16:17] offset:5632
  v_mov_b32_dpp v72, v16 quad_perm:[0,0,2,2] row_mask:0xf bank_mask:0xf
  v_mov_b32_dpp v74, v16 quad_perm:[1,1,3,3] row_mask:0xf bank_mask:0xf
  v_mov_b32_dpp v73, v17 quad_perm:[0,0,2,2] row_mask:0xf bank_mask:0xf
  v_mov_b32_dpp v75, v17 quad_perm:[1,1,3,3] row_mask:0xf bank_mask:0xf
  ds_read_b128 v[48:51], v8 offset:4096
  s_nop 0
  v_smfmac_f32_16x16x64_bf16 v[32:35], v[72:75], a[216:223], v2
  ds_read_b128 v[52:55], v8 offset:4608
  v_smfmac_f32_16x16x64_bf16 v[36:39], v[72:75], a[248:255], v2
  ds_read_b128 v[76:79], v8 offset:5120
  global_load_lds_dwordx4 v1, s[60:61]
  s_waitcnt lgkmcnt(4)
  v_smfmac_f32_16x16x64_bf16 v[40:43], v[72:75], v[24:31], v2
  global_load_lds_dwordx4 v1, s[60:61] offset:1024
  ds_read_b128 v[64:67], v1 offset:30720
  v_smfmac_f32_16x16x64_bf16 v[44:47], v[72:75], v[88:95], v2
  ds_read_b128 v[68:71], v1 offset:31744
L_R3_ok:
  s_waitcnt lgkmcnt(4)
  v_smfmac_f32_16x16x64_bf16 v[32:35], v[48:51], a[192:199], v2
  ds_read_b128 v[120:123], v1 offset:47104
  v_max_u32 v18, v49, v51
  s_waitcnt lgkmcnt(4)
  v_smfmac_f32_16x16x64_bf16 v[32:35], v[52:55], a[200:207], v2
  ds_read_b128 v[124:127], v1 offset:48128
  v_max3_u32 v18, v18, v53, v55
  s_waitcnt lgkmcnt(4)
  v_smfmac_f32_16x16x64_bf16 v[32:35], v[76:79], a[208:215], v2
  ds_read_b128 v[96:99], v5 offset:14336
  v_max3_u32 v18, v18, v77, v79
  v_smfmac_f32_16x16x64_bf16 v[36:39], v[48:51], a[224:231], v2
  ds_read_b128 v[100:103], v5 offset:15360
  v_smfmac_f32_16x16x64_bf16 v[36:39], v[52:55], a[232:239], v2
  ds_read_b128 v[104:107], v5 offset:30720
  v_cmp_eq_u32 vcc, -1, v18
  v_cvt_pk_bf16_f32 v33, v33, v35
  v_cvt_pk_bf16_f32 v32, v32, v34
  v_and_or_b32 v33, v33, -2, s12
  v_smfmac_f32_16x16x64_bf16 v[36:39], v[76:79], a[240:247], v2
L_R3_h10:
  s_cbranch_vccnz L_R3_of
  global_store_dwordx2 v3, v[32:33], s[46:47] offset:0
  ds_read_b128 v[108:111], v5 offset:31744
  v_smfmac_f32_16x16x64_bf16 v[40:43], v[48:51], v[112:119], v2
  ds_read_b128 v[56:59], v5 offset:47104
  s_waitcnt lgkmcnt(7)
  v_smfmac_f32_16x16x64_bf16 v[40:43], v[52:55], v[64:71], v2
  ds_read_b128 v[60:63], v5 offset:48128
  s_waitcnt lgkmcnt(6)
  v_cvt_pk_bf16_f32 v37, v37, v39
  v_cvt_pk_bf16_f32 v36, v36, v38
  v_and_or_b32 v37, v37, -2, s12
  v_smfmac_f32_16x16x64_bf16 v[40:43], v[76:79], v[120:127], v2
  global_store_dwordx2 v3, v[36:37], s[46:47] offset:2048
  s_waitcnt lgkmcnt(4)
  v_smfmac_f32_16x16x64_bf16 v[44:47], v[48:51], v[96:103], v2
  s_waitcnt lgkmcnt(2)
  v_smfmac_f32_16x16x64_bf16 v[44:47], v[52:55], v[104:111], v2
  ds_read_b128 v[48:51], v6 offset:30720
  v_cvt_pk_bf16_f32 v41, v41, v43
  v_cvt_pk_bf16_f32 v40, v40, v42
  v_and_or_b32 v41, v41, -2, s12
  s_waitcnt lgkmcnt(1)
  v_smfmac_f32_16x16x64_bf16 v[44:47], v[76:79], v[56:63], v2
  global_store_dwordx2 v3, v[40:41], s[48:49] offset:0
  v_mov_b32 v72, 0
  v_mov_b32 v73, 0
  v_mov_b32 v74, 0
  v_mov_b32 v75, 0
  s_nop 2
  v_cvt_pk_bf16_f32 v45, v45, v47
  v_cvt_pk_bf16_f32 v44, v44, v46
  v_and_or_b32 v45, v45, -2, s12
  global_store_dwordx2 v3, v[44:45], s[48:49] offset:2048
  s_add_u32 s54, s54, 0x2000
  s_bitset0_b32 s54, 15
  v_mov_b32 v76, 0
  ds_read_b128 v[88:91], v1 offset:61440
  v_mov_b32 v77, 0
  ds_read_b128 v[92:95], v1 offset:62464
  v_mov_b32 v78, 0
  ds_read_b128 v[96:99], v5 offset:61440
  v_mov_b32 v79, 0
  ds_read_b128 v[100:103], v5 offset:62464
  v_mov_b32 v19, -1
  ds_read_b128 v[104:107], v1 offset:12288
  v_mov_b32 v19, -1
  ds_read_b128 v[108:111], v1 offset:13312
  v_mov_b32 v19, -1
  ds_read_b128 v[112:115], v1 offset:28672
  v_mov_b32 v19, -1
  ds_read_b128 v[116:119], v1 offset:29696
  v_mov_b32 v19, -1
  ds_read_b128 v[120:123], v1 offset:45056
  v_mov_b32 v19, -1
  ds_read_b128 v[124:127], v1 offset:46080
  v_mov_b32 v19, -1
  s_add_u32 s60, s60, 262144
  s_addc_u32 s61, s61, 0
  v_mov_b32 v19, -1
  s_add_u32 s68, s68, 262144
  s_addc_u32 s69, s69, 0
  v_mov_b32 v19, -1
  s_add_u32 s62, s62, 262144
  s_addc_u32 s63, s63, 0
  v_mov_b32 v19, -1
  s_add_u32 s64, s64, 262144
  s_addc_u32 s65, s65, 0
  v_mov_b32 v19, -1
L_R3_h11:
  s_cbranch_execz L_R_wr
  v_mov_b32 v19, -1
  v_mov_b32 v19, -1
  v_mov_b32 v19, -1
  v_mov_b32 v19, -1
  v_mov_b32 v19, -1
  v_mov_b32 v19, -1
  v_mov_b32 v19, -1
  v_mov_b32 v19, -1
  v_mov_b32 v19, -1
  v_mov_b32 v19, -1
  v_mov_b32 v19, -1
  v_mov_b32 v19, -1
  global_load_dwordx4 v[80:83], v1, s[50:51] sc1
  global_load_dwordx4 v[84:87], v1, s[50:51] offset:1024 sc1
  v_mov_b32 v19, -1
  v_mov_b32 v19, -1
  v_mov_b32 v19, -1
  v_mov_b32 v19, -1
  v_mov_b32 v19, -1
  v_mov_b32 v19, -1
  v_mov_b32 v19, -1
  v_mov_b32 v19, -1
  v_mov_b32 v19, -1
  v_mov_b32 v19, -1
  v_mov_b32 v19, -1
  v_mov_b32 v19, -1
L_R3_h12:
  s_cbranch_execz L_R_wr
  v_mov_b32 v19, -1
  v_mov_b32 v19, -1
  v_mov_b32 v19, -1
  v_mov_b32 v19, -1
  v_mov_b32 v19, -1
  v_mov_b32 v19, -1
  v_mov_b32 v19, -1
  v_mov_b32 v19, -1
  v_mov_b32 v19, -1
  v_mov_b32 v19, -1
  v_mov_b32 v19, -1
  v_mov_b32 v19, -1
  v_mov_b32 v19, -1
  v_mov_b32 v19, -1
  v_mov_b32 v19, -1
  v_mov_b32 v19, -1
  v_mov_b32 v19, -1
  v_mov_b32 v19, -1
  v_mov_b32 v19, -1
  v_mov_b32 v19, -1
  v_mov_b32 v19, -1
  v_mov_b32 v19, -1
  global_load_dwordx4 v[80:83], v1, s[50:51] sc1
  global_load_dwordx4 v[84:87], v1, s[50:51] offset:1024 sc1
  v_mov_b32 v19, -1
  v_mov_b32 v19, -1
  v_mov_b32 v19, -1
  v_mov_b32 v19, -1
  v_mov_b32 v19, -1
  v_mov_b32 v19, -1
  s_waitcnt lgkmcnt(10)
  v_mfma_f32_16x16x1_4b_f32 v[56:71], v0, v0, 0
L_R3_h13:
  s_cbranch_execz L_R_wr
  s_waitcnt vmcnt(3)
  v_bitop3_b32 v16, v81, v83, s12 bitop3:0x7e
  v_mfma_f32_16x16x32_bf16 v[52:55], v[48:51], v[80:83], 0
  s_waitcnt vmcnt(2)
  v_bitop3_b32 v17, v85, v87, s12 bitop3:0x7e
  v_mfma_f32_16x16x32_bf16 v[52:55], v[48:51], v[84:87], v[52:55]
  v_bitop3_b32 v16, v16, v17, 1 bitop3:0xa8
  v_cmp_ne_u32 vcc, 0, v16
  v_readfirstlane_b32 s79, v10
  v_mov_b32 v19, -1
  v_mov_b32_e64 v19, -1
  v_mov_b32_e64 v19, -1
  v_mov_b32_e64 v19, -1
  v_mov_b32_e64 v19, -1
L_R3_c1:
  v_add_f32_dpp v52, v52, v52 row_ror:4 row_mask:0xf bank_mask:0xf
  v_add_f32_dpp v53, v53, v53 row_ror:4 row_mask:0xf bank_mask:0xf
L_R3_h14:
  s_cbranch_vccnz L_R3_pf
  v_add_f32_dpp v52, v52, v52 row_ror:8 row_mask:0xf bank_mask:0xf
  v_add_f32_dpp v53, v53, v53 row_ror:8 row_mask:0xf bank_mask:0xf
  v_cvt_pk_bf16_f32 v16, v52, v53
  global_store_dword v4, v16, s[56:57]
  s_cmp_eq_u32 s79, 0
  s_cbranch_scc1 L_R3_fw
L_R3_fok:
  v_mov_b32 v19, -1
  global_store_dword v4, v19, s[58:59]
  s_add_u32 s58, s58, 0x2000
  s_bitset0_b32 s58, 15
  v_mov_b32 v19, -1
  s_cmp_lt_u32 s44, 61
  s_cselect_b32 s74, 2048, 0
  v_mov_b32 v19, -1
  s_add_u32 s66, s66, s74
  s_addc_u32 s67, s67, 0
  v_mov_b32 v19, -1
  s_add_u32 s56, s56, 0x2000
  s_bitset0_b32 s56, 15
  v_mov_b32 v19, -1
  s_xor_b32 s12, s12, 1
  s_add_u32 s44, s44, 1
  v_lshlrev_b32 v10, 3, v1
  s_cmp_eq_u32 s44, 63
  v_mov_b32 v19, -1
  v_mov_b32 v19, -1
  v_mov_b32 v19, -1
  v_mov_b32 v19, -1
  global_load_dwordx4 v[24:27], v1, s[54:55] offset:-2048 sc1
  v_mov_b32 v19, -1
L_R3_h15:
  s_cbranch_execz L_R_wr
  v_mov_b32 v19, -1
  v_mov_b32 v19, -1
  v_mov_b32 v19, -1
  v_mov_b32 v19, -1
  v_mov_b32 v19, -1
  v_mov_b32 v19, -1
  v_mov_b32 v19, -1
  v_mov_b32 v19, -1
  v_mov_b32 v19, -1
  v_mov_b32 v19, -1
  global_load_dwordx4 v[24:27], v1, s[54:55] offset:-2048 sc1
  v_mov_b32 v19, -1
  v_mov_b32 v19, -1
  v_mov_b32 v19, -1
  v_mov_b32 v19, -1
  v_mov_b32 v19, -1
  v_mov_b32 v19, -1
  global_load_dwordx4 v[28:31], v1, s[54:55] offset:2048 sc1
  v_mov_b32 v19, -1
  v_mov_b32 v19, -1
  v_mov_b32 v19, -1
L_R3_h16:
  s_cbranch_execz L_R_wr
  v_mov_b32 v19, -1
  v_mov_b32 v19, -1
  v_mov_b32 v19, -1
  v_mov_b32 v19, -1
  v_mov_b32 v19, -1
  v_mov_b32 v19, -1
  v_mov_b32 v19, -1
  v_mov_b32 v19, -1
  global_load_dwordx4 v[24:27], v1, s[54:55] offset:-2048 sc1
  v_mov_b32 v19, -1
  v_mov_b32 v19, -1
  v_mov_b32 v19, -1
  v_mov_b32 v19, -1
  v_mov_b32 v19, -1
  v_mov_b32_e64 v19, -1
  global_load_dwordx4 v[28:31], v1, s[54:55] offset:2048 sc1
  v_mov_b32_e64 v19, -1
  v_mov_b32_e64 v19, -1
  s_cbranch_scc1 L_R3_z
  s_waitcnt lgkmcnt(0)
  v_mfma_f32_16x16x1_4b_f32 v[56:71], v0, v0, 0
  s_branch L_R3_p2
.p2align 2
L_R3_zfe:
L_R3_zh0:
  s_cbranch_execz L_R3_zh1
  global_load_dwordx4 v[24:27], v1, s[54:55] offset:-2048 sc1
L_R3_zh1:
  s_cbranch_execz L_R3_zh2
L_R3_h17:
  s_cbranch_execz L_R_wr
  v_mfma_f32_16x16x1_4b_f32 v[56:71], v0, v0, 0
  s_sub_u32 s7, s7, 1
  s_cbranch_scc0 L_R3_ze
  s_mov_b32 s7, 0
  s_branch L_R3_ze1
L_R3_zfl:
  global_load_dwordx4 v[28:31], v1, s[54:55] offset:2048 sc1
  s_sub_u32 s7, s7, 1
  s_cbranch_scc0 L_R3_zl
  s_mov_b32 s7, 0
  s_branch L_R3_zl1
L_R3_z:
  global_store_dwordx4 v1, v[20:23], s[64:65] sc1
L_R3_zh2:
  s_cbranch_execz L_R3_zh3
  s_add_u32 s64, s64, 262144
  s_addc_u32 s65, s65, 0
  s_waitcnt lgkmcnt(0)
L_R3_ze:
  s_waitcnt vmcnt(5)
  v_max3_u32 v16, v24, v25, v26
  v_max_u32 v16, v16, v27
  v_smfmac_f32_16x16x64_bf16 v[64:67], v[24:27], a[48:55], v2
  ds_write_b128 v6, v[24:27] offset:19456
  v_cmp_eq_u32 vcc, -1, v16
  v_smfmac_f32_16x16x64_bf16 v[68:71], v[24:27], a[56:63], v2
L_R3_zh3:
  s_cbranch_execz L_R3_zh4
L_R3_h18:
  s_cbranch_execz L_R_wr
  v_mov_b32 v19, -1
  v_mov_b32 v19, -1
  v_mov_b32 v19, -1
  v_mov_b32 v19, -1
  s_cbranch_vccnz L_R3_zfe
L_R3_ze1:
  v_smfmac_f32_16x16x64_bf16 v[72:75], v[24:27], v[176:183], v2
  v_smfmac_f32_16x16x64_bf16 v[76:79], v[24:27], v[184:191], v2
  s_waitcnt lgkmcnt(0)
  s_barrier
L_R3_zl:
  s_waitcnt vmcnt(3)
  v_max3_u32 v16, v28, v29, v30
L_R3_zh4:
  s_cbranch_execz L_R3_zh5
  v_max_u32 v16, v16, v31
  v_cmp_eq_u32 vcc, -1, v16
  ds_read_b128 v[32:35], v6 offset:16384
  ds_read_b128 v[36:39], v6 offset:17408
  ds_read_b128 v[40:43], v6 offset:18432
  ds_write_b128 v6, v[28:31] offset:23552
  s_cbranch_vccnz L_R3_zfl
L_R3_zl1:
  v_smfmac_f32_16x16x64_bf16 v[64:67], v[28:31], a[112:119], v2
  v_smfmac_f32_16x16x64_bf16 v[68:71], v[28:31], a[120:127], v2
L_R3_zh5:
  s_cbranch_execz L_R3_zh6
L_R3_h19:
  s_cbranch_execz L_R_wr
  v_smfmac_f32_16x16x64_bf16 v[72:75], v[28:31], v[240:247], v2
  s_waitcnt lgkmcnt(0)
  s_barrier
  v_smfmac_f32_16x16x64_bf16 v[76:79], v[28:31], v[248:255], v2
  v_smfmac_f32_16x16x64_bf16 v[64:67], v[32:35], a[0:7], v2
  ds_read_b128 v[44:47], v6 offset:20480
  v_smfmac_f32_16x16x64_bf16 v[68:71], v[32:35], a[8:15], v2
  ds_read_b128 v[48:51], v6 offset:21504
L_R3_zh6:
  s_cbranch_execz L_R3_zh7
  v_smfmac_f32_16x16x64_bf16 v[72:75], v[32:35], v[128:135], v2
  ds_read_b128 v[52:55], v6 offset:22528
  v_smfmac_f32_16x16x64_bf16 v[76:79], v[32:35], v[136:143], v2
  v_smfmac_f32_16x16x64_bf16 v[64:67], v[36:39], a[16:23], v2
  v_smfmac_f32_16x16x64_bf16 v[68:71], v[36:39], a[24:31], v2
  v_smfmac_f32_16x16x64_bf16 v[72:75], v[36:39], v[144:151], v2
  v_smfmac_f32_16x16x64_bf16 v[76:79], v[36:39], v[152:159], v2
  v_smfmac_f32_16x16x64_bf16 v[64:67], v[40:43], a[32:39], v2
L_R3_zh7:
  s_cbranch_execz L_R3_zh8
L_R3_h20:
  s_cbranch_execz L_R_wr
  v_smfmac_f32_16x16x64_bf16 v[68:71], v[40:43], a[40:47], v2
  v_smfmac_f32_16x16x64_bf16 v[72:75], v[40:43], v[160:167], v2
  v_smfmac_f32_16x16x64_bf16 v[76:79], v[40:43], v[168:175], v2
  s_waitcnt lgkmcnt(0)
  v_smfmac_f32_16x16x64_bf16 v[64:67], v[44:47], a[64:71], v2
  v_smfmac_f32_16x16x64_bf16 v[68:71], v[44:47], a[72:79], v2
  v_smfmac_f32_16x16x64_bf16 v[64:67], v[48:51], a[80:87], v2
L_R3_zh8:
  s_cbranch_execz L_R3_zh9
  v_smfmac_f32_16x16x64_bf16 v[68:71], v[48:51], a[88:95], v2
  v_smfmac_f32_16x16x64_bf16 v[64:67], v[52:55], a[96:103], v2
  v_smfmac_f32_16x16x64_bf16 v[68:71], v[52:55], a[104:111], v2
  v_smfmac_f32_16x16x64_bf16 v[72:75], v[44:47], v[192:199], v2
  v_smfmac_f32_16x16x64_bf16 v[76:79], v[44:47], v[200:207], v2
  v_smfmac_f32_16x16x64_bf16 v[72:75], v[48:51], v[208:215], v2
  v_add_f32 v64, v64, v65
  v_add_f32 v66, v66, v67
  v_smfmac_f32_16x16x64_bf16 v[76:79], v[48:51], v[216:223], v2
L_R3_zh9:
  s_cbranch_execz L_R3_zh10
L_R3_h21:
  s_cbranch_execz L_R_wr
  v_add_f32 v68, v68, v69
  v_add_f32 v70, v70, v71
  v_smfmac_f32_16x16x64_bf16 v[72:75], v[52:55], v[224:231], v2
  v_cvt_pk_bf16_f32 v20, v64, v68
  v_cvt_pk_bf16_f32 v21, v66, v70
  v_smfmac_f32_16x16x64_bf16 v[76:79], v[52:55], v[232:239], v2
  v_mov_b32 v19, -1
  v_mov_b32 v19, -1
  v_mov_b32 v19, -1
L_R3_zh10:
  s_cbranch_execz L_R_zr
  v_mov_b32 v19, -1
  v_add_f32 v72, v72, v73
  v_add_f32 v74, v74, v75
  v_cvt_pk_bf16_f32 v22, v72, v74
  v_mov_b32 v19, -1
  v_add_f32 v76, v76, v77
  v_add_f32 v78, v78, v79
  v_cvt_pk_bf16_f32 v23, v76, v78
L_R3_fin:
  global_store_dwordx4 v1, v[20:23], s[64:65] sc1
  s_endpgm
.p2align 2
.p2align 5
L_R3_pf:
  s_cbranch_execz L_R_wr
  s_mov_b64 exec, vcc
  global_load_dwordx4 v[80:83], v1, s[50:51] sc1
  global_load_dwordx4 v[84:87], v1, s[50:51] offset:1024 sc1
  s_mov_b64 exec, -1
  s_waitcnt vmcnt(3)
  v_bitop3_b32 v16, v81, v83, s12 bitop3:0x7e
  v_mfma_f32_16x16x32_bf16 v[52:55], v[48:51], v[80:83], 0
  s_waitcnt vmcnt(2)
  v_bitop3_b32 v17, v85, v87, s12 bitop3:0x7e
  v_mfma_f32_16x16x32_bf16 v[52:55], v[48:51], v[84:87], v[52:55]
  v_bitop3_b32 v16, v16, v17, 1 bitop3:0xa8
  v_cmp_ne_u32 vcc, 0, v16
  s_nop 2
  s_cbranch_vccz L_R3_c1
L_R3_pf2:
  s_mov_b64 exec, vcc
  global_load_dwordx4 v[80:83], v1, s[50:51] sc1
  global_load_dwordx4 v[84:87], v1, s[50:51] offset:1024 sc1
  s_mov_b64 exec, -1
L_R3_h22:
  s_cbranch_execz L_R_wr
  s_waitcnt vmcnt(3)
  v_bitop3_b32 v16, v81, v83, s12 bitop3:0x7e
  v_mfma_f32_16x16x32_bf16 v[52:55], v[48:51], v[80:83], 0
  s_waitcnt vmcnt(2)
  v_bitop3_b32 v17, v85, v87, s12 bitop3:0x7e
  v_mfma_f32_16x16x32_bf16 v[52:55], v[48:51], v[84:87], v[52:55]
  v_bitop3_b32 v16, v16, v17, 1 bitop3:0xa8
  v_cmp_ne_u32 vcc, 0, v16
  s_nop 2
  s_cbranch_vccz L_R3_c1
  s_sub_u32 s7, s7, 1
  s_cbranch_scc0 L_R3_pf2
  s_mov_b32 s7, 0
  s_mov_b64 vcc, 0
  s_branch L_R3_c1
L_R3_h23:
  s_branch L_R_wr
L_R3_of:
  s_cbranch_execz L_R_wr
  s_nop 7
  ds_read_b128 v[48:51], v8 offset:4096
  ds_read_b128 v[52:55], v8 offset:4608
  ds_read_b128 v[76:79], v8 offset:5120
  s_waitcnt lgkmcnt(0)
  v_max_u32 v18, v49, v51
  v_max3_u32 v18, v18, v53, v55
  v_max3_u32 v18, v18, v77, v79
  v_cmp_eq_u32 vcc, -1, v18
  s_cbranch_vccz L_R3_og
  s_sub_u32 s7, s7, 1
  s_cbranch_scc0 L_R3_of
  s_mov_b32 s7, 0
  v_min_u32 v49, -2, v49
  v_min_u32 v51, -2, v51
  v_min_u32 v53, -2, v53
  v_min_u32 v55, -2, v55
  v_min_u32 v77, -2, v77
  v_min_u32 v79, -2, v79
L_R3_og:
  v_mfma_i32_16x16x4_4b_i8 v[32:47], v0, v0, 0
  s_nop 11
  v_smfmac_f32_16x16x64_bf16 v[32:35], v[72:75], a[216:223], v2
  v_smfmac_f32_16x16x64_bf16 v[36:39], v[72:75], a[248:255], v2
  v_smfmac_f32_16x16x64_bf16 v[40:43], v[72:75], v[24:31], v2
  v_smfmac_f32_16x16x64_bf16 v[44:47], v[72:75], v[88:95], v2
  s_branch L_R3_ok
L_R3_h24:
  s_branch L_R_wr
L_R3_fw:
Lww_35:
  global_load_dword v19, v0, s[66:67] offset:0 sc1
  s_waitcnt vmcnt(0)
  v_cmp_gt_u32 vcc, 1, v19
  s_cbranch_vccz Lwd_36
  s_sub_u32 s7, s7, 1
  s_cbranch_scc0 Lww_35
  s_mov_b32 s7, 0
Lwd_36:
  s_branch L_R3_fok
L_R3_h25:
  s_branch L_R_wr
.p2align 2
L_R3_slow:
  s_cbranch_execz L_R_wr
  s_nop 7
  s_nop 7
  ds_read_b128 v[32:35], v6 offset:0
  ds_read_b128 v[36:39], v6 offset:1024
  ds_read_b128 v[40:43], v8 offset:0
  ds_read_b128 v[44:47], v9 offset:0
  s_waitcnt lgkmcnt(0)
  v_mfma_f32_16x16x32_bf16 v[56:59], v[32:35], v[40:43], 0
  v_mfma_f32_16x16x32_bf16 v[60:63], v[36:39], v[40:43], 0
  v_mfma_f32_16x16x32_bf16 v[120:123], v[44:47], v[40:43], 0
  s_nop 7
  ds_read_b128 v[32:35], v6 offset:2048
  ds_read_b128 v[36:39], v6 offset:3072
  ds_read_b128 v[40:43], v8 offset:1024
  ds_read_b128 v[44:47], v9 offset:1024
  s_waitcnt lgkmcnt(0)
  v_mfma_f32_16x16x32_bf16 v[56:59], v[32:35], v[40:43], v[56:59]
  v_mfma_f32_16x16x32_bf16 v[60:63], v[36:39], v[40:43], v[60:63]
  v_mfma_f32_16x16x32_bf16 v[120:123], v[44:47], v[40:43], v[120:123]
  s_nop 7
  ds_read_b128 v[32:35], v6 offset:4096
  ds_read_b128 v[36:39], v6 offset:5120
  ds_read_b128 v[40:43], v8 offset:2048
  ds_read_b128 v[44:47], v9 offset:2048
  s_waitcnt lgkmcnt(0)
  v_mfma_f32_16x16x32_bf16 v[56:59], v[32:35], v[40:43], v[56:59]
  v_mfma_f32_16x16x32_bf16 v[60:63], v[36:39], v[40:43], v[60:63]
  v_mfma_f32_16x16x32_bf16 v[120:123], v[44:47], v[40:43], v[120:123]
  s_nop 7
  ds_read_b128 v[32:35], v6 offset:6144
  ds_read_b128 v[36:39], v6 offset:7168
  ds_read_b128 v[40:43], v8 offset:3072
  ds_read_b128 v[44:47], v9 offset:3072
  s_waitcnt lgkmcnt(0)
  v_mfma_f32_16x16x32_bf16 v[56:59], v[32:35], v[40:43], v[56:59]
  v_mfma_f32_16x16x32_bf16 v[60:63], v[36:39], v[40:43], v[60:63]
  v_mfma_f32_16x16x32_bf16 v[120:123], v[44:47], v[40:43], v[120:123]
  s_nop 7
  v_mfma_i32_16x16x4_4b_i8 v[32:47], v0, v0, 0
  v_max3_f32 v16, v56, v57, v58
  v_max3_f32 v17, v59, v60, v61
  v_max3_f32 v16, v16, v62, v63
  v_max3_f32 v17, v17, v120, v121
  v_max_f32 v18, v16, v17
  v_max_f32 v19, v16, v17
  s_nop 1
  v_permlane32_swap_b32 v18, v19
  v_max_f32 v16, v18, v19
  v_max_f32 v17, v18, v19
  s_nop 1
  v_permlane16_swap_b32 v16, v17
  v_max_f32 v16, v16, v17
  v_mul_f32 v13, 0xbe0293ee, v16
  v_fma_f32 v56, v56, s52, v13
  v_fma_f32 v57, v57, s52, v13
  v_exp_f32 v56, v56
  v_fma_f32 v58, v58, s52, v13
  v_exp_f32 v57, v57
  v_fma_f32 v59, v59, s52, v13
  v_exp_f32 v58, v58
  v_cvt_pk_bf16_f32 v56, v56, v57
  v_exp_f32 v59, v59
  v_fma_f32 v60, v60, s52, v13
  v_cvt_pk_bf16_f32 v57, v58, v59
  v_fma_f32 v61, v61, s52, v13
  v_exp_f32 v60, v60
  v_fma_f32 v62, v62, s52, v13
  v_exp_f32 v61, v61
  v_fma_f32 v63, v63, s52, v13
  v_exp_f32 v62, v62
  v_exp_f32 v63, v63
  v_cvt_pk_bf16_f32 v58, v60, v61
  v_cvt_pk_bf16_f32 v59, v62, v63
  v_fma_f32 v120, v120, s52, v13
  v_fma_f32 v121, v121, s52, v13
  v_exp_f32 v18, v120
  v_exp_f32 v19, v121
  v_mfma_f32_16x16x32_bf16 v[104:107], v[124:127], v[56:59], 0
  v_mfma_f32_16x16x32_bf16 v[96:99], v[80:83], v[56:59], 0
  v_mfma_f32_16x16x32_bf16 v[100:103], v[84:87], v[56:59], 0
  v_cvt_pk_bf16_f32 v14, v18, v19
  v_lshlrev_b64 v[16:17], v12, v[14:15]
  s_nop 1
  v_mfma_f32_16x16x16_bf16 v[108:111], v[124:125], v[16:17], v[104:107]
  s_nop 2
  v_cndmask_b32 v96, v96, v100, s[70:71]
  v_cndmask_b32 v97, v97, v101, s[70:71]
  v_cndmask_b32 v98, v98, v102, s[70:71]
  v_cndmask_b32 v99, v99, v103, s[70:71]
  s_nop 1
  v_mfma_f32_16x16x16_bf16 v[60:63], v[22:23], v[16:17], v[96:99]
  v_rcp_f32 v18, v108
  s_nop 7
  s_barrier
  s_branch L_R3_sy
.p2align 7
L_R4:
  ds_read_b128 v[88:91], v1 offset:0
  ds_read_b128 v[92:95], v1 offset:1024
  ds_read_b128 v[96:99], v5 offset:0
  ds_read_b128 v[100:103], v5 offset:1024
  ds_read_b128 v[104:107], v1 offset:16384
  ds_read_b128 v[108:111], v1 offset:17408
  ds_read_b128 v[112:115], v1 offset:32768
  ds_read_b128 v[116:119], v1 offset:33792
  ds_read_b128 v[120:123], v1 offset:49152
  ds_read_b128 v[124:127], v1 offset:50176
  v_mov_b32 v19, -1
  v_lshlrev_b32 v10, 3, v1
  global_load_dwordx4 v[80:83], v1, s[62:63]
  global_load_dwordx4 v[84:87], v1, s[62:63] offset:1024
  s_waitcnt vmcnt(2) lgkmcnt(0)
  s_branch L_R4_p2
.p2align 5
L_R4_fe:
  s_mov_b64 exec, vcc
  global_load_dwordx4 v[24:27], v1, s[54:55] offset:-2048 sc1
  s_mov_b64 exec, -1
  v_mov_b32 v19, -1
  v_mov_b32 v19, -1
  v_mov_b32 v19, -1
  v_mov_b32 v19, -1
  v_mfma_f32_16x16x1_4b_f32 v[56:71], v0, v0, 0
  s_waitcnt vmcnt(4)
  v_max3_u32 v16, v24, v25, v26
  v_max_u32 v16, v16, v27
  v_cmp_eq_u32 vcc, -1, v16
  s_cbranch_vccz L_R4_p2a
  s_mov_b64 exec, vcc
  global_load_dwordx4 v[24:27], v1, s[54:55] offset:-2048 sc1
  s_mov_b64 exec, -1
  s_waitcnt vmcnt(3)
  v_max3_u32 v16, v24, v25, v26
  v_max_u32 v16, v16, v27
  v_cmp_eq_u32 vcc, -1, v16
  s_cbranch_vccz L_R4_p2a
  s_mov_b64 exec, vcc
  global_load_dwordx4 v[24:27], v1, s[54:55] offset:-2048 sc1
  s_mov_b64 exec, -1
  s_waitcnt vmcnt(2)
  v_max3_u32 v16, v24, v25, v26
  v_max_u32 v16, v16, v27
  v_cmp_eq_u32 vcc, -1, v16
  s_cbranch_vccz L_R4_p2a
L_R4_fe2:
  s_mov_b64 exec, vcc
  global_load_dwordx4 v[24:27], v1, s[54:55] offset:-2048 sc1
  s_mov_b64 exec, -1
  s_waitcnt vmcnt(2)
  v_max3_u32 v16, v24, v25, v26
  v_max_u32 v16, v16, v27
  v_cmp_eq_u32 vcc, -1, v16
  s_cbranch_vccz L_R4_p2a
  s_sub_u32 s7, s7, 1
  s_cbranch_scc0 L_R4_fe2
  s_mov_b32 s7, 0
  v_mov_b32 v16, 0
  s_branch L_R4_p2a
.p2align 5
L_R4_fl:
  s_mov_b64 exec, vcc
  global_load_dwordx4 v[28:31], v1, s[54:55] offset:2048 sc1
  s_mov_b64 exec, -1
  s_waitcnt vmcnt(2)
  v_max3_u32 v16, v28, v29, v30
  v_max_u32 v16, v16, v31
  v_cmp_eq_u32 vcc, -1, v16
  ds_write_b128 v6, v[28:31] offset:20480
  s_cbranch_vccz L_R4_cl
L_R4_fl2:
  s_mov_b64 exec, vcc
  global_load_dwordx4 v[28:31], v1, s[54:55] offset:2048 sc1
  s_mov_b64 exec, -1
  s_waitcnt vmcnt(2)
  v_max3_u32 v16, v28, v29, v30
  v_max_u32 v16, v16, v31
  v_cmp_eq_u32 vcc, -1, v16
  ds_write_b128 v6, v[28:31] offset:20480
  s_cbranch_vccz L_R4_cl
  s_sub_u32 s7, s7, 1
  s_cbranch_scc0 L_R4_fl2
  s_mov_b32 s7, 0
  s_branch L_R4_cl
.p2align 6
L_R4_p2:
  s_waitcnt vmcnt(4)
  v_max3_u32 v16, v24, v25, v26
  v_max_u32 v16, v16, v27
L_R4_p2a:
  v_smfmac_f32_16x16x64_bf16 v[56:59], v[24:27], v[88:95], v2
  ds_write_b128 v6, v[24:27] offset:16384
  v_cmp_eq_u32 vcc, -1, v16
  v_smfmac_f32_16x16x64_bf16 v[60:63], v[24:27], a[128:135], v2
  v_smfmac_f32_16x16x64_bf16 v[64:67], v[24:27], a[0:7], v2
  s_cbranch_vccnz L_R4_fe
  v_smfmac_f32_16x16x64_bf16 v[68:71], v[24:27], a[8:15], v2
  global_load_dwordx4 v[28:31], v1, s[54:55] offset:2048 sc1
  ds_read_b128 v[88:91], v5 offset:16384
  v_smfmac_f32_16x16x64_bf16 v[72:75], v[24:27], v[128:135], v2
  s_waitcnt lgkmcnt(1)
  s_barrier
  s_waitcnt vmcnt(3)
  v_max3_u32 v16, v28, v29, v30
  v_max_u32 v16, v16, v31
  v_cmp_eq_u32 vcc, -1, v16
  v_smfmac_f32_16x16x64_bf16 v[76:79], v[24:27], v[136:143], v2
  ds_write_b128 v6, v[28:31] offset:20480
  s_cbranch_vccnz L_R4_fl
L_R4_cl:
  v_smfmac_f32_16x16x64_bf16 v[56:59], v[28:31], v[96:103], v2
  ds_read_b128 v[32:35], v6 offset:17408
  global_load_dwordx4 v[80:83], v1, s[62:63]
  v_smfmac_f32_16x16x64_bf16 v[60:63], v[28:31], a[160:167], v2
  ds_read_b128 v[36:39], v6 offset:18432
  global_load_dwordx4 v[84:87], v1, s[62:63] offset:1024
  v_smfmac_f32_16x16x64_bf16 v[64:67], v[28:31], a[64:71], v2
  s_waitcnt lgkmcnt(2)
  s_barrier
  ds_read_b128 v[40:43], v6 offset:19456
  v_smfmac_f32_16x16x64_bf16 v[68:71], v[28:31], a[72:79], v2
  ds_read_b128 v[44:47], v6 offset:21504
  global_load_dword v10, v10, s[68:69]
  v_smfmac_f32_16x16x64_bf16 v[72:75], v[28:31], v[192:199], v2
  ds_read_b128 v[48:51], v6 offset:22528
  v_smfmac_f32_16x16x64_bf16 v[76:79], v[28:31], v[200:207], v2
  ds_read_b128 v[52:55], v6 offset:23552
  global_store_dwordx4 v1, v[20:23], s[64:65] sc1
  s_waitcnt lgkmcnt(5)
  v_smfmac_f32_16x16x64_bf16 v[56:59], v[32:35], v[104:111], v2
  ds_read_b128 v[92:95], v5 offset:17408
  v_smfmac_f32_16x16x64_bf16 v[60:63], v[32:35], a[136:143], v2
  ds_read_b128 v[96:99], v5 offset:32768
  s_waitcnt lgkmcnt(6)
  v_smfmac_f32_16x16x64_bf16 v[56:59], v[36:39], v[112:119], v2
  ds_read_b128 v[100:103], v5 offset:33792
  v_smfmac_f32_16x16x64_bf16 v[60:63], v[36:39], a[144:151], v2
  ds_read_b128 v[104:107], v5 offset:49152
  s_waitcnt lgkmcnt(7)
  v_smfmac_f32_16x16x64_bf16 v[56:59], v[40:43], v[120:127], v2
  ds_read_b128 v[108:111], v5 offset:50176
  v_smfmac_f32_16x16x64_bf16 v[60:63], v[40:43], a[152:159], v2
  ds_read_b128 v[112:115], v6 offset:0
  s_waitcnt lgkmcnt(5)
  v_smfmac_f32_16x16x64_bf16 v[56:59], v[44:47], v[88:95], v2
  ds_read_b128 v[116:119], v6 offset:2048
  v_smfmac_f32_16x16x64_bf16 v[60:63], v[44:47], a[168:175], v2
  ds_read_b128 v[120:123], v6 offset:4096
  s_waitcnt lgkmcnt(5)
  v_smfmac_f32_16x16x64_bf16 v[56:59], v[48:51], v[96:103], v2
  global_load_dword v10, v0, s[66:67] sc1
  ds_read_b128 v[124:127], v6 offset:6144
  v_smfmac_f32_16x16x64_bf16 v[60:63], v[48:51], a[176:183], v2
  ds_write_b32 v11, v19 offset:4100
  s_waitcnt lgkmcnt(5)
  v_smfmac_f32_16x16x64_bf16 v[56:59], v[52:55], v[104:111], v2
  v_smfmac_f32_16x16x64_bf16 v[60:63], v[52:55], a[184:191], v2
  s_waitcnt vmcnt(5)
  ds_read_b128 v[24:27], v6 offset:1024
  v_smfmac_f32_16x16x64_bf16 v[64:67], v[32:35], a[16:23], v2
  ds_read_b128 v[28:31], v6 offset:3072
  v_add_f32 v56, v56, v57
  v_add_f32 v58, v58, v59
  v_smfmac_f32_16x16x64_bf16 v[68:71], v[32:35], a[24:31], v2
  v_add_f32 v60, v60, v61
  v_add_f32 v62, v62, v63
  v_smfmac_f32_16x16x64_bf16 v[64:67], v[36:39], a[32:39], v2
  v_cvt_pk_bf16_f32 v16, v56, v60
  v_cvt_pk_bf16_f32 v17, v58, v62
  v_smfmac_f32_16x16x64_bf16 v[68:71], v[36:39], a[40:47], v2
  ds_write2_b32 v7, v16, v17 offset0:0 offset1:16
  v_smfmac_f32_16x16x64_bf16 v[64:67], v[40:43], a[48:55], v2
  v_smfmac_f32_16x16x64_bf16 v[68:71], v[40:43], a[56:63], v2
  v_smfmac_f32_16x16x64_bf16 v[64:67], v[44:47], a[80:87], v2
  v_smfmac_f32_16x16x64_bf16 v[68:71], v[44:47], a[88:95], v2
  s_waitcnt lgkmcnt(0)
  s_barrier
  v_smfmac_f32_16x16x64_bf16 v[64:67], v[48:51], a[96:103], v2
  ds_read_b128 v[96:99], v8 offset:0
  v_smfmac_f32_16x16x64_bf16 v[68:71], v[48:51], a[104:111], v2
  ds_read_b128 v[100:103], v8 offset:1024
  v_smfmac_f32_16x16x64_bf16 v[64:67], v[52:55], a[112:119], v2
  ds_read_b128 v[104:107], v8 offset:2048
  v_smfmac_f32_16x16x64_bf16 v[68:71], v[52:55], a[120:127], v2
  ds_read_b128 v[108:111], v8 offset:3072
  v_smfmac_f32_16x16x64_bf16 v[72:75], v[32:35], v[144:151], v2
  ds_read_b128 v[88:91], v6 offset:5120
  v_add_f32 v64, v64, v65
  v_smfmac_f32_16x16x64_bf16 v[76:79], v[32:35], v[152:159], v2
  ds_read_b128 v[92:95], v6 offset:7168
  v_add_f32 v66, v66, v67
  s_waitcnt lgkmcnt(5)
  v_mfma_f32_16x16x32_bf16 v[56:59], v[112:115], v[96:99], 0
  v_add_f32 v68, v68, v69
  v_add_f32 v70, v70, v71
  s_waitcnt lgkmcnt(4)
  v_mfma_f32_16x16x32_bf16 v[56:59], v[116:119], v[100:103], v[56:59]
  v_cvt_pk_bf16_f32 v20, v64, v68
  v_cvt_pk_bf16_f32 v21, v66, v70
  s_waitcnt lgkmcnt(3)
  v_mfma_f32_16x16x32_bf16 v[56:59], v[120:123], v[104:107], v[56:59]
  ds_write2_b32 v7, v20, v21 offset0:128 offset1:144
  s_waitcnt lgkmcnt(3)
  v_mfma_f32_16x16x32_bf16 v[56:59], v[124:127], v[108:111], v[56:59]
  ds_read_b128 v[124:127], v6 offset:31744
  v_mfma_f32_16x16x32_bf16 v[60:63], v[24:27], v[96:99], 0
  v_mfma_f32_16x16x32_bf16 v[60:63], v[28:31], v[100:103], v[60:63]
  s_waitcnt lgkmcnt(3)
  v_max3_f32 v16, v56, v57, v58
  v_max_f32 v18, v16, v59
  v_max_f32 v19, v16, v59
  v_mfma_f32_16x16x32_bf16 v[60:63], v[88:91], v[104:107], v[60:63]
  s_waitcnt lgkmcnt(1)
  s_barrier
  v_permlane32_swap_b32 v18, v19
  v_max_f32 v16, v18, v19
  v_max_f32 v17, v18, v19
  v_mfma_f32_16x16x32_bf16 v[60:63], v[92:95], v[108:111], v[60:63]
  ds_read_b128 v[64:67], v9 offset:0
  v_permlane16_swap_b32 v16, v17
  v_max_f32 v16, v16, v17
  v_mul_f32 v13, 0xbe0293ee, v16
  v_smfmac_f32_16x16x64_bf16 v[72:75], v[36:39], v[160:167], v2
  ds_read_b128 v[68:71], v9 offset:1024
  v_fma_f32 v56, v56, s52, v13
  v_fma_f32 v57, v57, s52, v13
  v_smfmac_f32_16x16x64_bf16 v[76:79], v[36:39], v[168:175], v2
  ds_read_b128 v[112:115], v9 offset:2048
  v_exp_f32 v56, v56
  v_smfmac_f32_16x16x64_bf16 v[72:75], v[40:43], v[176:183], v2
  ds_read_b128 v[116:119], v9 offset:3072
  v_fma_f32 v58, v58, s52, v13
  v_exp_f32 v57, v57
  v_smfmac_f32_16x16x64_bf16 v[76:79], v[40:43], v[184:191], v2
  ds_read_b128 v[24:27], v1 offset:2048
  s_waitcnt lgkmcnt(4)
  v_fma_f32 v59, v59, s52, v13
  v_mfma_f32_16x16x32_bf16 v[120:123], v[64:67], v[96:99], 0
  v_exp_f32 v58, v58
  v_cvt_pk_bf16_f32 v56, v56, v57
  s_waitcnt lgkmcnt(3)
  v_mfma_f32_16x16x32_bf16 v[120:123], v[68:71], v[100:103], v[120:123]
  v_exp_f32 v59, v59
  v_fma_f32 v60, v60, s52, v13
  s_waitcnt lgkmcnt(2)
  v_mfma_f32_16x16x32_bf16 v[120:123], v[112:115], v[104:107], v[120:123]
  s_waitcnt lgkmcnt(1)
  v_cvt_pk_bf16_f32 v57, v58, v59
  v_fma_f32 v61, v61, s52, v13
  v_exp_f32 v60, v60
  v_mfma_f32_16x16x32_bf16 v[120:123], v[116:119], v[108:111], v[120:123]
  v_fma_f32 v62, v62, s52, v13
  v_exp_f32 v61, v61
  v_smfmac_f32_16x16x64_bf16 v[72:75], v[44:47], v[208:215], v2
  ds_read_b128 v[28:31], v1 offset:3072
  v_fma_f32 v63, v63, s52, v13
  v_smfmac_f32_16x16x64_bf16 v[76:79], v[44:47], v[216:223], v2
  ds_read_b128 v[88:91], v5 offset:2048
  v_exp_f32 v62, v62
  v_smfmac_f32_16x16x64_bf16 v[72:75], v[48:51], v[224:231], v2
  ds_read_b128 v[92:95], v5 offset:3072
  v_exp_f32 v63, v63
  v_smfmac_f32_16x16x64_bf16 v[76:79], v[48:51], v[232:239], v2
  ds_read_b128 v[112:115], v1 offset:18432
  v_cvt_pk_bf16_f32 v58, v60, v61
  v_cvt_pk_bf16_f32 v59, v62, v63
  s_nop 1
  v_mfma_f32_16x16x32_bf16 v[104:107], v[124:127], v[56:59], 0
  s_waitcnt vmcnt(3)
  v_fma_f32 v120, v120, s52, v13
  v_fma_f32 v121, v121, s52, v13
  v_mfma_f32_16x16x32_bf16 v[96:99], v[80:83], v[56:59], 0
  v_exp_f32 v18, v120
  v_mfma_f32_16x16x32_bf16 v[100:103], v[84:87], v[56:59], 0
  v_exp_f32 v19, v121
  v_smfmac_f32_16x16x64_bf16 v[72:75], v[52:55], v[240:247], v2
  ds_read_b128 v[116:119], v1 offset:19456
  v_cvt_pk_bf16_f32 v14, v18, v19
  v_lshlrev_b64 v[16:17], v12, v[14:15]
  v_smfmac_f32_16x16x64_bf16 v[76:79], v[52:55], v[248:255], v2
  v_cndmask_b32 v96, v96, v100, s[70:71]
  v_mfma_f32_16x16x16_bf16 v[108:111], v[124:125], v[16:17], v[104:107]
  v_cndmask_b32 v97, v97, v101, s[70:71]
  v_cndmask_b32 v98, v98, v102, s[70:71]
  v_cndmask_b32 v99, v99, v103, s[70:71]
  v_add_f32 v72, v72, v73
  v_add_f32 v74, v74, v75
  v_add_f32 v76, v76, v77
  v_add_f32 v78, v78, v79
  v_cvt_pk_bf16_f32 v22, v72, v74
  v_cvt_pk_bf16_f32 v23, v76, v78
  s_cmp_eq_u32 s44, 63
  v_mov_b32 v19, -1
  v_mfma_f32_16x16x16_bf16 v[60:63], v[22:23], v[16:17], v[96:99]
  v_cmp_nge_f32 vcc, s53, v108
  v_rcp_f32_e64 v18, v108
  v_mov_b32_e64 v19, -1
  v_mov_b32_e64 v19, -1
  v_mov_b32_e64 v19, -1
  v_mfma_i32_16x16x4_4b_i8 v[32:47], v0, v0, 0
  v_mov_b32_e64 v19, -1
  s_cbranch_vccnz L_R4_slow
L_R4_sy:
  v_mul_f32 v60, v60, v18
  v_mul_f32 v61, v61, v18
  v_cvt_pk_bf16_f32 v16, v60, v61
  v_mul_f32 v62, v62, v18
  v_mul_f32 v63, v63, v18
  v_cvt_pk_bf16_f32 v17, v62, v63
  ds_write_b64 v11, v[16:17] offset:4096
  v_mov_b32_dpp v72, v16 quad_perm:[0,0,2,2] row_mask:0xf bank_mask:0xf
  v_mov_b32_dpp v74, v16 quad_perm:[1,1,3,3] row_mask:0xf bank_mask:0xf
  v_mov_b32_dpp v73, v17 quad_perm:[0,0,2,2] row_mask:0xf bank_mask:0xf
  v_mov_b32_dpp v75, v17 quad_perm:[1,1,3,3] row_mask:0xf bank_mask:0xf
  ds_read_b128 v[48:51], v8 offset:4608
  s_nop 0
  v_smfmac_f32_16x16x64_bf16 v[32:35], v[72:75], a[192:199], v2
  ds_read_b128 v[52:55], v8 offset:5120
  v_smfmac_f32_16x16x64_bf16 v[36:39], v[72:75], a[224:231], v2
  ds_read_b128 v[76:79], v8 offset:5632
  global_load_lds_dwordx4 v1, s[60:61]
  s_waitcnt lgkmcnt(4)
  v_smfmac_f32_16x16x64_bf16 v[40:43], v[72:75], v[24:31], v2
  global_load_lds_dwordx4 v1, s[60:61] offset:1024
  ds_read_b128 v[64:67], v1 offset:34816
  v_smfmac_f32_16x16x64_bf16 v[44:47], v[72:75], v[88:95], v2
  ds_read_b128 v[68:71], v1 offset:35840
L_R4_ok:
  s_waitcnt lgkmcnt(4)
  v_smfmac_f32_16x16x64_bf16 v[32:35], v[48:51], a[200:207], v2
  ds_read_b128 v[120:123], v1 offset:51200
  v_max_u32 v18, v49, v51
  s_waitcnt lgkmcnt(4)
  v_smfmac_f32_16x16x64_bf16 v[32:35], v[52:55], a[208:215], v2
  ds_read_b128 v[124:127], v1 offset:52224
  v_max3_u32 v18, v18, v53, v55
  s_waitcnt lgkmcnt(4)
  v_smfmac_f32_16x16x64_bf16 v[32:35], v[76:79], a[216:223], v2
  ds_read_b128 v[96:99], v5 offset:18432
  v_max3_u32 v18, v18, v77, v79
  v_smfmac_f32_16x16x64_bf16 v[36:39], v[48:51], a[232:239], v2
  ds_read_b128 v[100:103], v5 offset:19456
  v_smfmac_f32_16x16x64_bf16 v[36:39], v[52:55], a[240:247], v2
  ds_read_b128 v[104:107], v5 offset:34816
  v_cmp_eq_u32 vcc, -1, v18
  v_cvt_pk_bf16_f32 v33, v33, v35
  v_cvt_pk_bf16_f32 v32, v32, v34
  v_and_or_b32 v33, v33, -2, s12
  v_smfmac_f32_16x16x64_bf16 v[36:39], v[76:79], a[248:255], v2
  s_cbranch_vccnz L_R4_of
  global_store_dwordx2 v3, v[32:33], s[46:47] offset:0 sc1
  ds_read_b128 v[108:111], v5 offset:35840
  v_smfmac_f32_16x16x64_bf16 v[40:43], v[48:51], v[112:119], v2
  ds_read_b128 v[56:59], v5 offset:51200
  s_waitcnt lgkmcnt(7)
  v_smfmac_f32_16x16x64_bf16 v[40:43], v[52:55], v[64:71], v2
  ds_read_b128 v[60:63], v5 offset:52224
  s_waitcnt lgkmcnt(6)
  v_cvt_pk_bf16_f32 v37, v37, v39
  v_cvt_pk_bf16_f32 v36, v36, v38
  v_and_or_b32 v37, v37, -2, s12
  v_smfmac_f32_16x16x64_bf16 v[40:43], v[76:79], v[120:127], v2
  global_store_dwordx2 v3, v[36:37], s[46:47] offset:2048 sc1
  s_waitcnt lgkmcnt(4)
  v_smfmac_f32_16x16x64_bf16 v[44:47], v[48:51], v[96:103], v2
  s_waitcnt lgkmcnt(2)
  v_smfmac_f32_16x16x64_bf16 v[44:47], v[52:55], v[104:111], v2
  ds_read_b128 v[48:51], v6 offset:30720
  v_cvt_pk_bf16_f32 v41, v41, v43
  v_cvt_pk_bf16_f32 v40, v40, v42
  v_and_or_b32 v41, v41, -2, s12
  s_waitcnt lgkmcnt(1)
  v_smfmac_f32_16x16x64_bf16 v[44:47], v[76:79], v[56:63], v2
  global_store_dwordx2 v3, v[40:41], s[48:49] offset:0 sc1
  v_mov_b32 v72, 0
  v_mov_b32 v73, 0
  v_mov_b32 v74, 0
  v_mov_b32 v75, 0
  s_nop 2
  v_cvt_pk_bf16_f32 v45, v45, v47
  v_cvt_pk_bf16_f32 v44, v44, v46
  v_and_or_b32 v45, v45, -2, s12
  global_store_dwordx2 v3, v[44:45], s[48:49] offset:2048 sc1
  s_add_u32 s54, s54, 0x2000
  s_bitset0_b32 s54, 15
  v_mov_b32 v76, 0
  ds_read_b128 v[88:91], v1 offset:0
  v_mov_b32 v77, 0
  ds_read_b128 v[92:95], v1 offset:1024
  v_mov_b32 v78, 0
  ds_read_b128 v[96:99], v5 offset:0
  v_mov_b32 v79, 0
  ds_read_b128 v[100:103], v5 offset:1024
  v_mov_b32 v19, -1
  ds_read_b128 v[104:107], v1 offset:16384
  v_mov_b32 v19, -1
  ds_read_b128 v[108:111], v1 offset:17408
  v_mov_b32 v19, -1
  ds_read_b128 v[112:115], v1 offset:32768
  global_load_dwordx4 v[80:83], v1, s[50:51] sc1
  global_load_dwordx4 v[84:87], v1, s[50:51] offset:1024 sc1
  v_mov_b32 v19, -1
  ds_read_b128 v[116:119], v1 offset:33792
  v_mov_b32 v19, -1
  ds_read_b128 v[120:123], v1 offset:49152
  v_mov_b32 v19, -1
  ds_read_b128 v[124:127], v1 offset:50176
  v_mov_b32 v19, -1
  s_add_u32 s60, s60, 262144
  s_addc_u32 s61, s61, 0
  v_mov_b32 v19, -1
  s_add_u32 s68, s68, 262144
  s_addc_u32 s69, s69, 0
  v_mov_b32 v19, -1
  s_add_u32 s62, s62, 262144
  s_addc_u32 s63, s63, 0
  v_mov_b32 v19, -1
  s_add_u32 s64, s64, 262144
  s_addc_u32 s65, s65, 0
  v_mov_b32 v19, -1
  v_mov_b32 v19, -1
  v_mov_b32 v19, -1
  v_mov_b32 v19, -1
  v_mov_b32 v19, -1
  v_mov_b32 v19, -1
  v_mov_b32 v19, -1
  v_mov_b32 v19, -1
  v_mov_b32 v19, -1
  v_mov_b32 v19, -1
  v_mov_b32 v19, -1
  v_mov_b32 v19, -1
  global_load_dwordx4 v[80:83], v1, s[50:51] sc1
  global_load_dwordx4 v[84:87], v1, s[50:51] offset:1024 sc1
  v_mov_b32 v19, -1
  v_mov_b32 v19, -1
  v_mov_b32 v19, -1
  v_mov_b32 v19, -1
  v_mov_b32 v19, -1
  s_waitcnt lgkmcnt(10)
  v_mfma_f32_16x16x1_4b_f32 v[56:71], v0, v0, 0
  s_waitcnt vmcnt(3)
  v_bitop3_b32 v16, v81, v83, s12 bitop3:0x7e
  v_mfma_f32_16x16x32_bf16 v[52:55], v[48:51], v[80:83], 0
  s_waitcnt vmcnt(2)
  v_bitop3_b32 v17, v85, v87, s12 bitop3:0x7e
  v_mfma_f32_16x16x32_bf16 v[52:55], v[48:51], v[84:87], v[52:55]
  v_bitop3_b32 v16, v16, v17, 1 bitop3:0xa8
  v_cmp_ne_u32 vcc, 0, v16
  v_readfirstlane_b32 s79, v10
  v_mov_b32 v19, -1
  v_mov_b32 v19, -1
  v_mov_b32_e64 v19, -1
  v_mov_b32_e64 v19, -1
  v_mov_b32_e64 v19, -1
L_R4_c1:
  v_add_f32_dpp v52, v52, v52 row_ror:4 row_mask:0xf bank_mask:0xf
  v_add_f32_dpp v53, v53, v53 row_ror:4 row_mask:0xf bank_mask:0xf
  s_cbranch_vccnz L_R4_pf
  v_add_f32_dpp v52, v52, v52 row_ror:8 row_mask:0xf bank_mask:0xf
  v_add_f32_dpp v53, v53, v53 row_ror:8 row_mask:0xf bank_mask:0xf
  v_cvt_pk_bf16_f32 v16, v52, v53
  global_store_dword v4, v16, s[56:57] sc1
  s_cmp_eq_u32 s79, 0
  s_cbranch_scc1 L_R4_fw
L_R4_fok:
  v_mov_b32 v19, -1
  global_store_dword v4, v19, s[58:59] sc1
  s_add_u32 s58, s58, 0x2000
  s_bitset0_b32 s58, 15
  v_mov_b32 v19, -1
  s_cmp_lt_u32 s44, 61
  s_cselect_b32 s74, 2048, 0
  v_mov_b32 v19, -1
  s_add_u32 s66, s66, s74
  s_addc_u32 s67, s67, 0
  v_mov_b32 v19, -1
  s_add_u32 s56, s56, 0x2000
  s_bitset0_b32 s56, 15
  v_mov_b32 v19, -1
  s_xor_b32 s12, s12, 1
  s_add_u32 s44, s44, 1
  v_lshlrev_b32 v10, 3, v1
  s_cmp_eq_u32 s44, 63
  s_cselect_b32 s53, -1, s53
  v_mov_b32 v19, -1
  v_mov_b32 v19, -1
  v_mov_b32 v19, -1
  v_mov_b32 v19, -1
  v_mov_b32 v19, -1
  v_mov_b32 v19, -1
  v_mov_b32 v19, -1
  v_mov_b32 v19, -1
  v_mov_b32 v19, -1
  v_mov_b32 v19, -1
  v_mov_b32 v19, -1
  v_mov_b32 v19, -1
  v_mov_b32 v19, -1
  v_mov_b32 v19, -1
  v_mov_b32 v19, -1
  v_mov_b32 v19, -1
  v_mov_b32 v19, -1
  v_mov_b32 v19, -1
  v_mov_b32 v19, -1
  v_mov_b32 v19, -1
  v_mov_b32 v19, -1
  v_mov_b32 v19, -1
  v_mov_b32 v19, -1
  v_mov_b32 v19, -1
  v_mov_b32 v19, -1
  v_mov_b32 v19, -1
  v_mov_b32 v19, -1
  v_mov_b32 v19, -1
  v_mov_b32 v19, -1
  v_mov_b32 v19, -1
  v_mov_b32 v19, -1
  v_mov_b32 v19, -1
  v_mov_b32 v19, -1
  global_load_dwordx4 v[24:27], v1, s[54:55] offset:-2048 sc1
  v_mov_b32 v19, -1
  v_mov_b32 v19, -1
  v_mov_b32 v19, -1
  v_mov_b32 v19, -1
  v_mov_b32 v19, -1
  v_mov_b32 v19, -1
  v_mov_b32 v19, -1
  v_mov_b32 v19, -1
  v_mov_b32 v19, -1
  v_mov_b32 v19, -1
  v_mov_b32 v19, -1
  v_mov_b32 v19, -1
  global_load_dwordx4 v[24:27], v1, s[54:55] offset:-2048 sc1
  v_mov_b32 v19, -1
  v_mov_b32 v19, -1
  v_mov_b32 v19, -1
  v_mov_b32 v19, -1
  v_mov_b32 v19, -1
  v_mov_b32 v19, -1
  global_load_dwordx4 v[28:31], v1, s[54:55] offset:2048 sc1
  v_mov_b32 v19, -1
  v_mov_b32 v19, -1
  v_mov_b32 v19, -1
  v_mov_b32 v19, -1
  v_mov_b32 v19, -1
  v_mov_b32 v19, -1
  v_mov_b32 v19, -1
  v_mov_b32 v19, -1
  v_mov_b32 v19, -1
  v_mov_b32 v19, -1
  v_mov_b32 v19, -1
  v_mov_b32 v19, -1
  global_load_dwordx4 v[24:27], v1, s[54:55] offset:-2048 sc1
  v_mov_b32 v19, -1
  v_mov_b32 v19, -1
  v_mov_b32 v19, -1
  v_mov_b32 v19, -1
  v_mov_b32 v19, -1
  v_mov_b32 v19, -1
  global_load_dwordx4 v[28:31], v1, s[54:55] offset:2048 sc1
  v_mov_b32_e64 v19, -1
  v_mov_b32_e64 v19, -1
  s_waitcnt lgkmcnt(0)
  v_mfma_f32_16x16x1_4b_f32 v[56:71], v0, v0, 0
  s_branch L_R4_p2
L_R4_slow:
  s_cbranch_scc0 L_R4_slow2
L_R4_fin:
  s_add_u32 s64, s64, 262144
  s_addc_u32 s65, s65, 0
  global_store_dwordx4 v1, v[20:23], s[64:65] sc1
  s_endpgm
.p2align 5
L_R4_pf:
  s_mov_b64 exec, vcc
  global_load_dwordx4 v[80:83], v1, s[50:51] sc1
  global_load_dwordx4 v[84:87], v1, s[50:51] offset:1024 sc1
  s_mov_b64 exec, -1
  s_waitcnt vmcnt(3)
  v_bitop3_b32 v16, v81, v83, s12 bitop3:0x7e
  v_mfma_f32_16x16x32_bf16 v[52:55], v[48:51], v[80:83], 0
  s_waitcnt vmcnt(2)
  v_bitop3_b32 v17, v85, v87, s12 bitop3:0x7e
  v_mfma_f32_16x16x32_bf16 v[52:55], v[48:51], v[84:87], v[52:55]
  v_bitop3_b32 v16, v16, v17, 1 bitop3:0xa8
  v_cmp_ne_u32 vcc, 0, v16
  s_nop 2
  s_cbranch_vccz L_R4_c1
L_R4_pf2:
  s_mov_b64 exec, vcc
  global_load_dwordx4 v[80:83], v1, s[50:51] sc1
  global_load_dwordx4 v[84:87], v1, s[50:51] offset:1024 sc1
  s_mov_b64 exec, -1
  s_waitcnt vmcnt(3)
  v_bitop3_b32 v16, v81, v83, s12 bitop3:0x7e
  v_mfma_f32_16x16x32_bf16 v[52:55], v[48:51], v[80:83], 0
  s_waitcnt vmcnt(2)
  v_bitop3_b32 v17, v85, v87, s12 bitop3:0x7e
  v_mfma_f32_16x16x32_bf16 v[52:55], v[48:51], v[84:87], v[52:55]
  v_bitop3_b32 v16, v16, v17, 1 bitop3:0xa8
  v_cmp_ne_u32 vcc, 0, v16
  s_nop 2
  s_cbranch_vccz L_R4_c1
  s_sub_u32 s7, s7, 1
  s_cbranch_scc0 L_R4_pf2
  s_mov_b32 s7, 0
  s_mov_b64 vcc, 0
  s_branch L_R4_c1
L_R4_of:
  s_nop 7
  ds_read_b128 v[48:51], v8 offset:4608
  ds_read_b128 v[52:55], v8 offset:5120
  ds_read_b128 v[76:79], v8 offset:5632
  s_waitcnt lgkmcnt(0)
  v_max_u32 v18, v49, v51
  v_max3_u32 v18, v18, v53, v55
  v_max3_u32 v18, v18, v77, v79
  v_cmp_eq_u32 vcc, -1, v18
  s_cbranch_vccz L_R4_og
  s_sub_u32 s7, s7, 1
  s_cbranch_scc0 L_R4_of
  s_mov_b32 s7, 0
  v_min_u32 v49, -2, v49
  v_min_u32 v51, -2, v51
  v_min_u32 v53, -2, v53
  v_min_u32 v55, -2, v55
  v_min_u32 v77, -2, v77
  v_min_u32 v79, -2, v79
L_R4_og:
  v_mfma_i32_16x16x4_4b_i8 v[32:47], v0, v0, 0
  s_nop 11
  v_smfmac_f32_16x16x64_bf16 v[32:35], v[72:75], a[192:199], v2
  v_smfmac_f32_16x16x64_bf16 v[36:39], v[72:75], a[224:231], v2
  v_smfmac_f32_16x16x64_bf16 v[40:43], v[72:75], v[24:31], v2
  v_smfmac_f32_16x16x64_bf16 v[44:47], v[72:75], v[88:95], v2
  s_branch L_R4_ok
L_R4_fw:
Lww_37:
  global_load_dword v19, v0, s[66:67] offset:0 sc1
  s_waitcnt vmcnt(0)
  v_cmp_gt_u32 vcc, 1, v19
  s_cbranch_vccz Lwd_38
  s_sub_u32 s7, s7, 1
  s_cbranch_scc0 Lww_37
  s_mov_b32 s7, 0
Lwd_38:
  s_branch L_R4_fok
.p2align 2
L_R4_slow2:
  s_nop 7
  s_nop 7
  ds_read_b128 v[32:35], v6 offset:0
  ds_read_b128 v[36:39], v6 offset:1024
  ds_read_b128 v[40:43], v8 offset:0
  ds_read_b128 v[44:47], v9 offset:0
  s_waitcnt lgkmcnt(0)
  v_mfma_f32_16x16x32_bf16 v[56:59], v[32:35], v[40:43], 0
  v_mfma_f32_16x16x32_bf16 v[60:63], v[36:39], v[40:43], 0
  v_mfma_f32_16x16x32_bf16 v[120:123], v[44:47], v[40:43], 0
  s_nop 7
  ds_read_b128 v[32:35], v6 offset:2048
  ds_read_b128 v[36:39], v6 offset:3072
  ds_read_b128 v[40:43], v8 offset:1024
  ds_read_b128 v[44:47], v9 offset:1024
  s_waitcnt lgkmcnt(0)
  v_mfma_f32_16x16x32_bf16 v[56:59], v[32:35], v[40:43], v[56:59]
  v_mfma_f32_16x16x32_bf16 v[60:63], v[36:39], v[40:43], v[60:63]
  v_mfma_f32_16x16x32_bf16 v[120:123], v[44:47], v[40:43], v[120:123]
  s_nop 7
  ds_read_b128 v[32:35], v6 offset:4096
  ds_read_b128 v[36:39], v6 offset:5120
  ds_read_b128 v[40:43], v8 offset:2048
  ds_read_b128 v[44:47], v9 offset:2048
  s_waitcnt lgkmcnt(0)
  v_mfma_f32_16x16x32_bf16 v[56:59], v[32:35], v[40:43], v[56:59]
  v_mfma_f32_16x16x32_bf16 v[60:63], v[36:39], v[40:43], v[60:63]
  v_mfma_f32_16x16x32_bf16 v[120:123], v[44:47], v[40:43], v[120:123]
  s_nop 7
  ds_read_b128 v[32:35], v6 offset:6144
  ds_read_b128 v[36:39], v6 offset:7168
  ds_read_b128 v[40:43], v8 offset:3072
  ds_read_b128 v[44:47], v9 offset:3072
  s_waitcnt lgkmcnt(0)
  v_mfma_f32_16x16x32_bf16 v[56:59], v[32:35], v[40:43], v[56:59]
  v_mfma_f32_16x16x32_bf16 v[60:63], v[36:39], v[40:43], v[60:63]
  v_mfma_f32_16x16x32_bf16 v[120:123], v[44:47], v[40:43], v[120:123]
  s_nop 7
  v_mfma_i32_16x16x4_4b_i8 v[32:47], v0, v0, 0
  v_max3_f32 v16, v56, v57, v58
  v_max3_f32 v17, v59, v60, v61
  v_max3_f32 v16, v16, v62, v63
  v_max3_f32 v17, v17, v120, v121
  v_max_f32 v18, v16, v17
  v_max_f32 v19, v16, v17
  s_nop 1
  v_permlane32_swap_b32 v18, v19
  v_max_f32 v16, v18, v19
  v_max_f32 v17, v18, v19
  s_nop 1
  v_permlane16_swap_b32 v16, v17
  v_max_f32 v16, v16, v17
  v_mul_f32 v13, 0xbe0293ee, v16
  v_fma_f32 v56, v56, s52, v13
  v_fma_f32 v57, v57, s52, v13
  v_exp_f32 v56, v56
  v_fma_f32 v58, v58, s52, v13
  v_exp_f32 v57, v57
  v_fma_f32 v59, v59, s52, v13
  v_exp_f32 v58, v58
  v_cvt_pk_bf16_f32 v56, v56, v57
  v_exp_f32 v59, v59
  v_fma_f32 v60, v60, s52, v13
  v_cvt_pk_bf16_f32 v57, v58, v59
  v_fma_f32 v61, v61, s52, v13
  v_exp_f32 v60, v60
  v_fma_f32 v62, v62, s52, v13
  v_exp_f32 v61, v61
  v_fma_f32 v63, v63, s52, v13
  v_exp_f32 v62, v62
  v_exp_f32 v63, v63
  v_cvt_pk_bf16_f32 v58, v60, v61
  v_cvt_pk_bf16_f32 v59, v62, v63
  v_fma_f32 v120, v120, s52, v13
  v_fma_f32 v121, v121, s52, v13
  v_exp_f32 v18, v120
  v_exp_f32 v19, v121
  v_mfma_f32_16x16x32_bf16 v[104:107], v[124:127], v[56:59], 0
  v_mfma_f32_16x16x32_bf16 v[96:99], v[80:83], v[56:59], 0
  v_mfma_f32_16x16x32_bf16 v[100:103], v[84:87], v[56:59], 0
  v_cvt_pk_bf16_f32 v14, v18, v19
  v_lshlrev_b64 v[16:17], v12, v[14:15]
  s_nop 1
  v_mfma_f32_16x16x16_bf16 v[108:111], v[124:125], v[16:17], v[104:107]
  s_nop 2
  v_cndmask_b32 v96, v96, v100, s[70:71]
  v_cndmask_b32 v97, v97, v101, s[70:71]
  v_cndmask_b32 v98, v98, v102, s[70:71]
  v_cndmask_b32 v99, v99, v103, s[70:71]
  s_nop 1
  v_mfma_f32_16x16x16_bf16 v[60:63], v[22:23], v[16:17], v[96:99]
  v_rcp_f32 v18, v108
  s_nop 7
  s_barrier
  s_branch L_R4_sy
.p2align 7
L_R5:
  ds_read_b128 v[88:91], v1 offset:20480
  ds_read_b128 v[92:95], v1 offset:21504
  ds_read_b128 v[96:99], v5 offset:20480
  ds_read_b128 v[100:103], v5 offset:21504
  ds_read_b128 v[104:107], v1 offset:36864
  ds_read_b128 v[108:111], v1 offset:37888
  ds_read_b128 v[112:115], v1 offset:53248
  ds_read_b128 v[116:119], v1 offset:54272
  ds_read_b128 v[120:123], v1 offset:4096
  ds_read_b128 v[124:127], v1 offset:5120
  v_mov_b32 v19, -1
  v_lshlrev_b32 v10, 3, v1
  global_load_dwordx4 v[80:83], v1, s[62:63]
  global_load_dwordx4 v[84:87], v1, s[62:63] offset:1024
  s_waitcnt vmcnt(2) lgkmcnt(0)
  s_branch L_R5_p2
.p2align 5
L_R5_fe:
  s_mov_b64 exec, vcc
  global_load_dwordx4 v[24:27], v1, s[54:55] offset:-2048 sc1
  s_mov_b64 exec, -1
  v_mov_b32 v19, -1
  v_mov_b32 v19, -1
  v_mov_b32 v19, -1
  v_mov_b32 v19, -1
  v_mfma_f32_16x16x1_4b_f32 v[56:71], v0, v0, 0
  s_waitcnt vmcnt(4)
  v_max3_u32 v16, v24, v25, v26
  v_max_u32 v16, v16, v27
  v_cmp_eq_u32 vcc, -1, v16
  s_cbranch_vccz L_R5_p2a
  s_mov_b64 exec, vcc
  global_load_dwordx4 v[24:27], v1, s[54:55] offset:-2048 sc1
  s_mov_b64 exec, -1
  s_waitcnt vmcnt(3)
  v_max3_u32 v16, v24, v25, v26
  v_max_u32 v16, v16, v27
  v_cmp_eq_u32 vcc, -1, v16
  s_cbranch_vccz L_R5_p2a
  s_mov_b64 exec, vcc
  global_load_dwordx4 v[24:27], v1, s[54:55] offset:-2048 sc1
  s_mov_b64 exec, -1
  s_waitcnt vmcnt(2)
  v_max3_u32 v16, v24, v25, v26
  v_max_u32 v16, v16, v27
  v_cmp_eq_u32 vcc, -1, v16
  s_cbranch_vccz L_R5_p2a
L_R5_fe2:
  s_mov_b64 exec, vcc
  global_load_dwordx4 v[24:27], v1, s[54:55] offset:-2048 sc1
  s_mov_b64 exec, -1
  s_waitcnt vmcnt(2)
  v_max3_u32 v16, v24, v25, v26
  v_max_u32 v16, v16, v27
  v_cmp_eq_u32 vcc, -1, v16
  s_cbranch_vccz L_R5_p2a
  s_sub_u32 s7, s7, 1
  s_cbranch_scc0 L_R5_fe2
  s_mov_b32 s7, 0
  v_mov_b32 v16, 0
  s_branch L_R5_p2a
.p2align 5
L_R5_fl:
  s_mov_b64 exec, vcc
  global_load_dwordx4 v[28:31], v1, s[54:55] offset:2048 sc1
  s_mov_b64 exec, -1
  s_waitcnt vmcnt(2)
  v_max3_u32 v16, v28, v29, v30
  v_max_u32 v16, v16, v31
  v_cmp_eq_u32 vcc, -1, v16
  ds_write_b128 v6, v[28:31] offset:21504
  s_cbranch_vccz L_R5_cl
L_R5_fl2:
  s_mov_b64 exec, vcc
  global_load_dwordx4 v[28:31], v1, s[54:55] offset:2048 sc1
  s_mov_b64 exec, -1
  s_waitcnt vmcnt(2)
  v_max3_u32 v16, v28, v29, v30
  v_max_u32 v16, v16, v31
  v_cmp_eq_u32 vcc, -1, v16
  ds_write_b128 v6, v[28:31] offset:21504
  s_cbranch_vccz L_R5_cl
  s_sub_u32 s7, s7, 1
  s_cbranch_scc0 L_R5_fl2
  s_mov_b32 s7, 0
  s_branch L_R5_cl
.p2align 6
L_R5_p2:
  s_waitcnt vmcnt(4)
  v_max3_u32 v16, v24, v25, v26
  v_max_u32 v16, v16, v27
L_R5_p2a:
  v_smfmac_f32_16x16x64_bf16 v[56:59], v[24:27], v[88:95], v2
  ds_write_b128 v6, v[24:27] offset:17408
  v_cmp_eq_u32 vcc, -1, v16
  v_smfmac_f32_16x16x64_bf16 v[60:63], v[24:27], a[136:143], v2
  v_smfmac_f32_16x16x64_bf16 v[64:67], v[24:27], a[16:23], v2
  s_cbranch_vccnz L_R5_fe
  v_smfmac_f32_16x16x64_bf16 v[68:71], v[24:27], a[24:31], v2
  global_load_dwordx4 v[28:31], v1, s[54:55] offset:2048 sc1
  ds_read_b128 v[88:91], v5 offset:36864
  v_smfmac_f32_16x16x64_bf16 v[72:75], v[24:27], v[144:151], v2
  s_waitcnt lgkmcnt(1)
  s_barrier
  s_waitcnt vmcnt(3)
  v_max3_u32 v16, v28, v29, v30
  v_max_u32 v16, v16, v31
  v_cmp_eq_u32 vcc, -1, v16
  v_smfmac_f32_16x16x64_bf16 v[76:79], v[24:27], v[152:159], v2
  ds_write_b128 v6, v[28:31] offset:21504
  s_cbranch_vccnz L_R5_fl
L_R5_cl:
  v_smfmac_f32_16x16x64_bf16 v[56:59], v[28:31], v[96:103], v2
  ds_read_b128 v[32:35], v6 offset:18432
  global_load_dwordx4 v[80:83], v1, s[62:63]
  v_smfmac_f32_16x16x64_bf16 v[60:63], v[28:31], a[168:175], v2
  ds_read_b128 v[36:39], v6 offset:19456
  global_load_dwordx4 v[84:87], v1, s[62:63] offset:1024
  v_smfmac_f32_16x16x64_bf16 v[64:67], v[28:31], a[80:87], v2
  s_waitcnt lgkmcnt(2)
  s_barrier
  ds_read_b128 v[40:43], v6 offset:16384
  v_smfmac_f32_16x16x64_bf16 v[68:71], v[28:31], a[88:95], v2
  ds_read_b128 v[44:47], v6 offset:22528
  v_smfmac_f32_16x16x64_bf16 v[72:75], v[28:31], v[208:215], v2
  ds_read_b128 v[48:51], v6 offset:23552
  v_smfmac_f32_16x16x64_bf16 v[76:79], v[28:31], v[216:223], v2
  ds_read_b128 v[52:55], v6 offset:20480
  s_waitcnt lgkmcnt(5)
  v_smfmac_f32_16x16x64_bf16 v[56:59], v[32:35], v[104:111], v2
  ds_read_b128 v[92:95], v5 offset:37888
  v_smfmac_f32_16x16x64_bf16 v[60:63], v[32:35], a[144:151], v2
  global_store_dwordx4 v1, v[20:23], s[64:65] sc1
  ds_read_b128 v[96:99], v5 offset:53248
  s_waitcnt lgkmcnt(6)
  v_smfmac_f32_16x16x64_bf16 v[56:59], v[36:39], v[112:119], v2
  ds_read_b128 v[100:103], v5 offset:54272
  v_smfmac_f32_16x16x64_bf16 v[60:63], v[36:39], a[152:159], v2
  ds_read_b128 v[104:107], v5 offset:4096
  s_waitcnt lgkmcnt(7)
  v_smfmac_f32_16x16x64_bf16 v[56:59], v[40:43], v[120:127], v2
  ds_read_b128 v[108:111], v5 offset:5120
  v_smfmac_f32_16x16x64_bf16 v[60:63], v[40:43], a[128:135], v2
  ds_read_b128 v[112:115], v6 offset:0
  s_waitcnt lgkmcnt(5)
  v_smfmac_f32_16x16x64_bf16 v[56:59], v[44:47], v[88:95], v2
  ds_read_b128 v[116:119], v6 offset:2048
  v_smfmac_f32_16x16x64_bf16 v[60:63], v[44:47], a[176:183], v2
  ds_read_b128 v[120:123], v6 offset:4096
  s_waitcnt lgkmcnt(5)
  v_smfmac_f32_16x16x64_bf16 v[56:59], v[48:51], v[96:103], v2
  global_load_dword v10, v0, s[66:67] sc1
  ds_read_b128 v[124:127], v6 offset:6144
  v_smfmac_f32_16x16x64_bf16 v[60:63], v[48:51], a[184:191], v2
  ds_write_b32 v11, v19 offset:4612
  s_waitcnt lgkmcnt(5)
  v_smfmac_f32_16x16x64_bf16 v[56:59], v[52:55], v[104:111], v2
  v_smfmac_f32_16x16x64_bf16 v[60:63], v[52:55], a[160:167], v2
  s_waitcnt vmcnt(4)
  ds_read_b128 v[24:27], v6 offset:1024
  v_smfmac_f32_16x16x64_bf16 v[64:67], v[32:35], a[32:39], v2
  ds_read_b128 v[28:31], v6 offset:3072
  v_add_f32 v56, v56, v57
  v_add_f32 v58, v58, v59
  v_smfmac_f32_16x16x64_bf16 v[68:71], v[32:35], a[40:47], v2
  v_add_f32 v60, v60, v61
  v_add_f32 v62, v62, v63
  v_smfmac_f32_16x16x64_bf16 v[64:67], v[36:39], a[48:55], v2
  v_cvt_pk_bf16_f32 v16, v56, v60
  v_cvt_pk_bf16_f32 v17, v58, v62
  v_smfmac_f32_16x16x64_bf16 v[68:71], v[36:39], a[56:63], v2
  ds_write2_b32 v7, v16, v17 offset0:0 offset1:16
  v_smfmac_f32_16x16x64_bf16 v[64:67], v[40:43], a[0:7], v2
  v_smfmac_f32_16x16x64_bf16 v[68:71], v[40:43], a[8:15], v2
  v_smfmac_f32_16x16x64_bf16 v[64:67], v[44:47], a[96:103], v2
  v_smfmac_f32_16x16x64_bf16 v[68:71], v[44:47], a[104:111], v2
  s_waitcnt lgkmcnt(0)
  s_barrier
  v_smfmac_f32_16x16x64_bf16 v[64:67], v[48:51], a[112:119], v2
  ds_read_b128 v[96:99], v8 offset:0
  v_smfmac_f32_16x16x64_bf16 v[68:71], v[48:51], a[120:127], v2
  ds_read_b128 v[100:103], v8 offset:1024
  v_smfmac_f32_16x16x64_bf16 v[64:67], v[52:55], a[64:71], v2
  ds_read_b128 v[104:107], v8 offset:2048
  v_smfmac_f32_16x16x64_bf16 v[68:71], v[52:55], a[72:79], v2
  ds_read_b128 v[108:111], v8 offset:3072
  v_smfmac_f32_16x16x64_bf16 v[72:75], v[32:35], v[160:167], v2
  ds_read_b128 v[88:91], v6 offset:5120
  v_add_f32 v64, v64, v65
  v_smfmac_f32_16x16x64_bf16 v[76:79], v[32:35], v[168:175], v2
  ds_read_b128 v[92:95], v6 offset:7168
  v_add_f32 v66, v66, v67
  s_waitcnt lgkmcnt(5)
  v_mfma_f32_16x16x32_bf16 v[56:59], v[112:115], v[96:99], 0
  v_add_f32 v68, v68, v69
  v_add_f32 v70, v70, v71
  s_waitcnt lgkmcnt(4)
  v_mfma_f32_16x16x32_bf16 v[56:59], v[116:119], v[100:103], v[56:59]
  v_cvt_pk_bf16_f32 v20, v64, v68
  v_cvt_pk_bf16_f32 v21, v66, v70
  s_waitcnt lgkmcnt(3)
  v_mfma_f32_16x16x32_bf16 v[56:59], v[120:123], v[104:107], v[56:59]
  ds_write2_b32 v7, v20, v21 offset0:128 offset1:144
  s_waitcnt lgkmcnt(3)
  v_mfma_f32_16x16x32_bf16 v[56:59], v[124:127], v[108:111], v[56:59]
  ds_read_b128 v[124:127], v6 offset:31744
  v_mfma_f32_16x16x32_bf16 v[60:63], v[24:27], v[96:99], 0
  v_mfma_f32_16x16x32_bf16 v[60:63], v[28:31], v[100:103], v[60:63]
  s_waitcnt lgkmcnt(3)
  v_max3_f32 v16, v56, v57, v58
  v_max_f32 v18, v16, v59
  v_max_f32 v19, v16, v59
  v_mfma_f32_16x16x32_bf16 v[60:63], v[88:91], v[104:107], v[60:63]
  s_waitcnt lgkmcnt(1)
  s_barrier
  v_permlane32_swap_b32 v18, v19
  v_max_f32 v16, v18, v19
  v_max_f32 v17, v18, v19
  v_mfma_f32_16x16x32_bf16 v[60:63], v[92:95], v[108:111], v[60:63]
  ds_read_b128 v[64:67], v9 offset:0
  v_permlane16_swap_b32 v16, v17
  v_max_f32 v16, v16, v17
  v_mul_f32 v13, 0xbe0293ee, v16
  v_smfmac_f32_16x16x64_bf16 v[72:75], v[36:39], v[176:183], v2
  ds_read_b128 v[68:71], v9 offset:1024
  v_fma_f32 v56, v56, s52, v13
  v_fma_f32 v57, v57, s52, v13
  v_smfmac_f32_16x16x64_bf16 v[76:79], v[36:39], v[184:191], v2
  ds_read_b128 v[112:115], v9 offset:2048
  v_exp_f32 v56, v56
  v_smfmac_f32_16x16x64_bf16 v[72:75], v[40:43], v[128:135], v2
  ds_read_b128 v[116:119], v9 offset:3072
  v_fma_f32 v58, v58, s52, v13
  v_exp_f32 v57, v57
  v_smfmac_f32_16x16x64_bf16 v[76:79], v[40:43], v[136:143], v2
  ds_read_b128 v[24:27], v1 offset:22528
  s_waitcnt lgkmcnt(4)
  v_fma_f32 v59, v59, s52, v13
  v_mfma_f32_16x16x32_bf16 v[120:123], v[64:67], v[96:99], 0
  v_exp_f32 v58, v58
  v_cvt_pk_bf16_f32 v56, v56, v57
  s_waitcnt lgkmcnt(3)
  v_mfma_f32_16x16x32_bf16 v[120:123], v[68:71], v[100:103], v[120:123]
  v_exp_f32 v59, v59
  v_fma_f32 v60, v60, s52, v13
  s_waitcnt lgkmcnt(2)
  v_mfma_f32_16x16x32_bf16 v[120:123], v[112:115], v[104:107], v[120:123]
  s_waitcnt lgkmcnt(1)
  v_cvt_pk_bf16_f32 v57, v58, v59
  v_fma_f32 v61, v61, s52, v13
  v_exp_f32 v60, v60
  v_mfma_f32_16x16x32_bf16 v[120:123], v[116:119], v[108:111], v[120:123]
  v_fma_f32 v62, v62, s52, v13
  v_exp_f32 v61, v61
  v_smfmac_f32_16x16x64_bf16 v[72:75], v[44:47], v[224:231], v2
  ds_read_b128 v[28:31], v1 offset:23552
  v_fma_f32 v63, v63, s52, v13
  v_smfmac_f32_16x16x64_bf16 v[76:79], v[44:47], v[232:239], v2
  ds_read_b128 v[88:91], v5 offset:22528
  v_exp_f32 v62, v62
  v_smfmac_f32_16x16x64_bf16 v[72:75], v[48:51], v[240:247], v2
  ds_read_b128 v[92:95], v5 offset:23552
  v_exp_f32 v63, v63
  v_smfmac_f32_16x16x64_bf16 v[76:79], v[48:51], v[248:255], v2
  ds_read_b128 v[112:115], v1 offset:38912
  v_cvt_pk_bf16_f32 v58, v60, v61
  v_cvt_pk_bf16_f32 v59, v62, v63
  s_nop 1
  v_mfma_f32_16x16x32_bf16 v[104:107], v[124:127], v[56:59], 0
  s_waitcnt vmcnt(2)
  v_fma_f32 v120, v120, s52, v13
  v_fma_f32 v121, v121, s52, v13
  v_mfma_f32_16x16x32_bf16 v[96:99], v[80:83], v[56:59], 0
  v_exp_f32 v18, v120
  v_mfma_f32_16x16x32_bf16 v[100:103], v[84:87], v[56:59], 0
  v_exp_f32 v19, v121
  v_smfmac_f32_16x16x64_bf16 v[72:75], v[52:55], v[192:199], v2
  ds_read_b128 v[116:119], v1 offset:39936
  v_cvt_pk_bf16_f32 v14, v18, v19
  v_lshlrev_b64 v[16:17], v12, v[14:15]
  v_smfmac_f32_16x16x64_bf16 v[76:79], v[52:55], v[200:207], v2
  v_cndmask_b32 v96, v96, v100, s[70:71]
  v_mfma_f32_16x16x16_bf16 v[108:111], v[124:125], v[16:17], v[104:107]
  v_cndmask_b32 v97, v97, v101, s[70:71]
  v_cndmask_b32 v98, v98, v102, s[70:71]
  v_cndmask_b32 v99, v99, v103, s[70:71]
  v_add_f32 v72, v72, v73
  v_add_f32 v74, v74, v75
  v_add_f32 v76, v76, v77
  v_add_f32 v78, v78, v79
  v_cvt_pk_bf16_f32 v22, v72, v74
  v_cvt_pk_bf16_f32 v23, v76, v78
  s_cmp_eq_u32 s44, 63
  v_mov_b32_e64 v19, -1
  v_mfma_f32_16x16x16_bf16 v[60:63], v[22:23], v[16:17], v[96:99]
  v_cmp_nge_f32_e64 vcc, s53, v108
  v_rcp_f32_e64 v18, v108
  v_mov_b32_e64 v19, -1
  v_mov_b32_e64 v19, -1
  v_mov_b32_e64 v19, -1
  v_mfma_i32_16x16x4_4b_i8 v[32:47], v0, v0, 0
  v_mov_b32_e64 v19, -1
  s_cbranch_vccnz L_R5_slow
L_R5_sy:
  v_mul_f32 v60, v60, v18
  v_mul_f32 v61, v61, v18
  v_cvt_pk_bf16_f32 v16, v60, v61
  v_mul_f32 v62, v62, v18
  v_mul_f32 v63, v63, v18
  v_cvt_pk_bf16_f32 v17, v62, v63
  ds_write_b64 v11, v[16:17] offset:4608
  v_mov_b32_dpp v72, v16 quad_perm:[0,0,2,2] row_mask:0xf bank_mask:0xf
  v_mov_b32_dpp v74, v16 quad_perm:[1,1,3,3] row_mask:0xf bank_mask:0xf
  v_mov_b32_dpp v73, v17 quad_perm:[0,0,2,2] row_mask:0xf bank_mask:0xf
  v_mov_b32_dpp v75, v17 quad_perm:[1,1,3,3] row_mask:0xf bank_mask:0xf
  ds_read_b128 v[48:51], v8 offset:5120
  s_nop 0
  v_smfmac_f32_16x16x64_bf16 v[32:35], v[72:75], a[200:207], v2
  ds_read_b128 v[52:55], v8 offset:5632
  v_smfmac_f32_16x16x64_bf16 v[36:39], v[72:75], a[232:239], v2
  ds_read_b128 v[76:79], v8 offset:4096
  global_load_lds_dwordx4 v1, s[60:61]
  s_waitcnt lgkmcnt(4)
  v_smfmac_f32_16x16x64_bf16 v[40:43], v[72:75], v[24:31], v2
  global_load_lds_dwordx4 v1, s[60:61] offset:1024
  ds_read_b128 v[64:67], v1 offset:55296
  v_smfmac_f32_16x16x64_bf16 v[44:47], v[72:75], v[88:95], v2
  ds_read_b128 v[68:71], v1 offset:56320
L_R5_ok:
  s_waitcnt lgkmcnt(4)
  v_smfmac_f32_16x16x64_bf16 v[32:35], v[48:51], a[208:215], v2
  ds_read_b128 v[120:123], v1 offset:6144
  v_max_u32 v18, v49, v51
  s_waitcnt lgkmcnt(4)
  v_smfmac_f32_16x16x64_bf16 v[32:35], v[52:55], a[216:223], v2
  ds_read_b128 v[124:127], v1 offset:7168
  v_max3_u32 v18, v18, v53, v55
  s_waitcnt lgkmcnt(4)
  v_smfmac_f32_16x16x64_bf16 v[32:35], v[76:79], a[192:199], v2
  ds_read_b128 v[96:99], v5 offset:38912
  v_max3_u32 v18, v18, v77, v79
  v_smfmac_f32_16x16x64_bf16 v[36:39], v[48:51], a[240:247], v2
  ds_read_b128 v[100:103], v5 offset:39936
  v_smfmac_f32_16x16x64_bf16 v[36:39], v[52:55], a[248:255], v2
  ds_read_b128 v[104:107], v5 offset:55296
  v_cmp_eq_u32 vcc, -1, v18
  v_cvt_pk_bf16_f32 v33, v33, v35
  v_cvt_pk_bf16_f32 v32, v32, v34
  v_and_or_b32 v33, v33, -2, s12
  v_smfmac_f32_16x16x64_bf16 v[36:39], v[76:79], a[224:231], v2
  s_cbranch_vccnz L_R5_of
  global_store_dwordx2 v3, v[32:33], s[46:47] offset:0 sc1
  ds_read_b128 v[108:111], v5 offset:56320
  v_smfmac_f32_16x16x64_bf16 v[40:43], v[48:51], v[112:119], v2
  ds_read_b128 v[56:59], v5 offset:6144
  s_waitcnt lgkmcnt(7)
  v_smfmac_f32_16x16x64_bf16 v[40:43], v[52:55], v[64:71], v2
  ds_read_b128 v[60:63], v5 offset:7168
  s_waitcnt lgkmcnt(6)
  v_cvt_pk_bf16_f32 v37, v37, v39
  v_cvt_pk_bf16_f32 v36, v36, v38
  v_and_or_b32 v37, v37, -2, s12
  v_smfmac_f32_16x16x64_bf16 v[40:43], v[76:79], v[120:127], v2
  global_store_dwordx2 v3, v[36:37], s[46:47] offset:2048 sc1
  s_waitcnt lgkmcnt(4)
  v_smfmac_f32_16x16x64_bf16 v[44:47], v[48:51], v[96:103], v2
  s_waitcnt lgkmcnt(2)
  v_smfmac_f32_16x16x64_bf16 v[44:47], v[52:55], v[104:111], v2
  ds_read_b128 v[48:51], v6 offset:30720
  v_cvt_pk_bf16_f32 v41, v41, v43
  v_cvt_pk_bf16_f32 v40, v40, v42
  v_and_or_b32 v41, v41, -2, s12
  s_waitcnt lgkmcnt(1)
  v_smfmac_f32_16x16x64_bf16 v[44:47], v[76:79], v[56:63], v2
  global_store_dwordx2 v3, v[40:41], s[48:49] offset:0 sc1
  v_mov_b32 v72, 0
  v_mov_b32 v73, 0
  v_mov_b32 v74, 0
  v_mov_b32 v75, 0
  s_nop 2
  v_cvt_pk_bf16_f32 v45, v45, v47
  v_cvt_pk_bf16_f32 v44, v44, v46
  v_and_or_b32 v45, v45, -2, s12
  global_store_dwordx2 v3, v[44:45], s[48:49] offset:2048 sc1
  s_add_u32 s54, s54, 0x2000
  s_bitset0_b32 s54, 15
  v_mov_b32 v76, 0
  ds_read_b128 v[88:91], v1 offset:20480
  v_mov_b32 v77, 0
  ds_read_b128 v[92:95], v1 offset:21504
  v_mov_b32 v78, 0
  ds_read_b128 v[96:99], v5 offset:20480
  v_mov_b32 v79, 0
  ds_read_b128 v[100:103], v5 offset:21504
  v_mov_b32 v19, -1
  ds_read_b128 v[104:107], v1 offset:36864
  v_mov_b32 v19, -1
  ds_read_b128 v[108:111], v1 offset:37888
  v_mov_b32 v19, -1
  ds_read_b128 v[112:115], v1 offset:53248
  v_mov_b32 v19, -1
  ds_read_b128 v[116:119], v1 offset:54272
  v_mov_b32 v19, -1
  ds_read_b128 v[120:123], v1 offset:4096
  v_mov_b32 v19, -1
  ds_read_b128 v[124:127], v1 offset:5120
  global_load_dwordx4 v[80:83], v1, s[50:51] sc1
  global_load_dwordx4 v[84:87], v1, s[50:51] offset:1024 sc1
  v_mov_b32 v19, -1
  s_add_u32 s60, s60, 262144
  s_addc_u32 s61, s61, 0
  v_mov_b32 v19, -1
  s_add_u32 s68, s68, 262144
  s_addc_u32 s69, s69, 0
  v_mov_b32 v19, -1
  s_add_u32 s62, s62, 262144
  s_addc_u32 s63, s63, 0
  v_mov_b32 v19, -1
  s_add_u32 s64, s64, 262144
  s_addc_u32 s65, s65, 0
  v_mov_b32 v19, -1
  v_mov_b32 v19, -1
  v_mov_b32 v19, -1
  v_mov_b32 v19, -1
  v_mov_b32 v19, -1
  v_mov_b32 v19, -1
  v_mov_b32 v19, -1
  v_mov_b32 v19, -1
  v_mov_b32 v19, -1
  v_mov_b32 v19, -1
  v_mov_b32 v19, -1
  v_mov_b32 v19, -1
  v_mov_b32 v19, -1
  v_mov_b32 v19, -1
  v_mov_b32 v19, -1
  v_mov_b32 v19, -1
  v_mov_b32 v19, -1
  v_mov_b32 v19, -1
  v_mov_b32 v19, -1
  v_mov_b32 v19, -1
  v_mov_b32 v19, -1
  v_mov_b32 v19, -1
  global_load_dwordx4 v[80:83], v1, s[50:51] sc1
  global_load_dwordx4 v[84:87], v1, s[50:51] offset:1024 sc1
  v_mov_b32 v19, -1
  v_mov_b32 v19, -1
  v_mov_b32 v19, -1
  v_mov_b32 v19, -1
  v_mov_b32 v19, -1
  s_waitcnt lgkmcnt(10)
  v_mfma_f32_16x16x1_4b_f32 v[56:71], v0, v0, 0
  s_waitcnt vmcnt(3)
  v_bitop3_b32 v16, v81, v83, s12 bitop3:0x7e
  v_mfma_f32_16x16x32_bf16 v[52:55], v[48:51], v[80:83], 0
  s_waitcnt vmcnt(2)
  v_bitop3_b32 v17, v85, v87, s12 bitop3:0x7e
  v_mfma_f32_16x16x32_bf16 v[52:55], v[48:51], v[84:87], v[52:55]
  v_bitop3_b32 v16, v16, v17, 1 bitop3:0xa8
  v_cmp_ne_u32 vcc, 0, v16
  v_readfirstlane_b32 s79, v10
  v_mov_b32 v19, -1
  v_mov_b32 v19, -1
  v_mov_b32 v19, -1
  v_mov_b32 v19, -1
  v_mov_b32_e64 v19, -1
L_R5_c1:
  v_add_f32_dpp v52, v52, v52 row_ror:4 row_mask:0xf bank_mask:0xf
  v_add_f32_dpp v53, v53, v53 row_ror:4 row_mask:0xf bank_mask:0xf
  s_cbranch_vccnz L_R5_pf
  v_add_f32_dpp v52, v52, v52 row_ror:8 row_mask:0xf bank_mask:0xf
  v_add_f32_dpp v53, v53, v53 row_ror:8 row_mask:0xf bank_mask:0xf
  v_cvt_pk_bf16_f32 v16, v52, v53
  global_store_dword v4, v16, s[56:57] sc1
  s_cmp_eq_u32 s79, 0
  s_cbranch_scc1 L_R5_fw
L_R5_fok:
  v_mov_b32 v19, -1
  global_store_dword v4, v19, s[58:59] sc1
  s_add_u32 s58, s58, 0x2000
  s_bitset0_b32 s58, 15
  v_mov_b32 v19, -1
  s_cmp_lt_u32 s44, 61
  s_cselect_b32 s74, 2048, 0
  v_mov_b32 v19, -1
  s_add_u32 s66, s66, s74
  s_addc_u32 s67, s67, 0
  v_mov_b32 v19, -1
  s_add_u32 s56, s56, 0x2000
  s_bitset0_b32 s56, 15
  v_mov_b32 v19, -1
  s_xor_b32 s12, s12, 1
  s_add_u32 s44, s44, 1
  v_lshlrev_b32 v10, 3, v1
  s_cmp_eq_u32 s44, 63
  s_cselect_b32 s53, -1, s53
  v_mov_b32 v19, -1
  v_mov_b32 v19, -1
  v_mov_b32 v19, -1
  v_mov_b32 v19, -1
  v_mov_b32 v19, -1
  v_mov_b32 v19, -1
  v_mov_b32 v19, -1
  v_mov_b32 v19, -1
  v_mov_b32 v19, -1
  v_mov_b32 v19, -1
  v_mov_b32 v19, -1
  v_mov_b32 v19, -1
  v_mov_b32 v19, -1
  v_mov_b32 v19, -1
  v_mov_b32 v19, -1
  v_mov_b32 v19, -1
  v_mov_b32 v19, -1
  v_mov_b32 v19, -1
  v_mov_b32 v19, -1
  v_mov_b32 v19, -1
  v_mov_b32 v19, -1
  v_mov_b32 v19, -1
  v_mov_b32 v19, -1
  global_load_dwordx4 v[24:27], v1, s[54:55] offset:-2048 sc1
  v_mov_b32 v19, -1
  v_mov_b32 v19, -1
  v_mov_b32 v19, -1
  v_mov_b32 v19, -1
  v_mov_b32 v19, -1
  v_mov_b32 v19, -1
  v_mov_b32 v19, -1
  v_mov_b32 v19, -1
  v_mov_b32 v19, -1
  v_mov_b32 v19, -1
  v_mov_b32 v19, -1
  v_mov_b32 v19, -1
  global_load_dwordx4 v[24:27], v1, s[54:55] offset:-2048 sc1
  v_mov_b32 v19, -1
  v_mov_b32 v19, -1
  v_mov_b32 v19, -1
  v_mov_b32 v19, -1
  v_mov_b32 v19, -1
  v_mov_b32 v19, -1
  global_load_dwordx4 v[28:31], v1, s[54:55] offset:2048 sc1
  v_mov_b32 v19, -1
  v_mov_b32 v19, -1
  v_mov_b32 v19, -1
  v_mov_b32 v19, -1
  v_mov_b32 v19, -1
  v_mov_b32 v19, -1
  v_mov_b32 v19, -1
  v_mov_b32 v19, -1
  v_mov_b32 v19, -1
  v_mov_b32 v19, -1
  v_mov_b32 v19, -1
  v_mov_b32 v19, -1
  global_load_dwordx4 v[24:27], v1, s[54:55] offset:-2048 sc1
  v_mov_b32 v19, -1
  v_mov_b32 v19, -1
  v_mov_b32 v19, -1
  v_mov_b32 v19, -1
  v_mov_b32_e64 v19, -1
  v_mov_b32_e64 v19, -1
  global_load_dwordx4 v[28:31], v1, s[54:55] offset:2048 sc1
  v_mov_b32_e64 v19, -1
  v_mov_b32_e64 v19, -1
  s_waitcnt lgkmcnt(0)
  v_mfma_f32_16x16x1_4b_f32 v[56:71], v0, v0, 0
  s_branch L_R5_p2
L_R5_slow:
  s_cbranch_scc0 L_R5_slow2
L_R5_fin:
  s_add_u32 s64, s64, 262144
  s_addc_u32 s65, s65, 0
  global_store_dwordx4 v1, v[20:23], s[64:65] sc1
  s_endpgm
.p2align 5
L_R5_pf:
  s_mov_b64 exec, vcc
  global_load_dwordx4 v[80:83], v1, s[50:51] sc1
  global_load_dwordx4 v[84:87], v1, s[50:51] offset:1024 sc1
  s_mov_b64 exec, -1
  s_waitcnt vmcnt(3)
  v_bitop3_b32 v16, v81, v83, s12 bitop3:0x7e
  v_mfma_f32_16x16x32_bf16 v[52:55], v[48:51], v[80:83], 0
  s_waitcnt vmcnt(2)
  v_bitop3_b32 v17, v85, v87, s12 bitop3:0x7e
  v_mfma_f32_16x16x32_bf16 v[52:55], v[48:51], v[84:87], v[52:55]
  v_bitop3_b32 v16, v16, v17, 1 bitop3:0xa8
  v_cmp_ne_u32 vcc, 0, v16
  s_nop 2
  s_cbranch_vccz L_R5_c1
L_R5_pf2:
  s_mov_b64 exec, vcc
  global_load_dwordx4 v[80:83], v1, s[50:51] sc1
  global_load_dwordx4 v[84:87], v1, s[50:51] offset:1024 sc1
  s_mov_b64 exec, -1
  s_waitcnt vmcnt(3)
  v_bitop3_b32 v16, v81, v83, s12 bitop3:0x7e
  v_mfma_f32_16x16x32_bf16 v[52:55], v[48:51], v[80:83], 0
  s_waitcnt vmcnt(2)
  v_bitop3_b32 v17, v85, v87, s12 bitop3:0x7e
  v_mfma_f32_16x16x32_bf16 v[52:55], v[48:51], v[84:87], v[52:55]
  v_bitop3_b32 v16, v16, v17, 1 bitop3:0xa8
  v_cmp_ne_u32 vcc, 0, v16
  s_nop 2
  s_cbranch_vccz L_R5_c1
  s_sub_u32 s7, s7, 1
  s_cbranch_scc0 L_R5_pf2
  s_mov_b32 s7, 0
  s_mov_b64 vcc, 0
  s_branch L_R5_c1
L_R5_of:
  s_nop 7
  ds_read_b128 v[48:51], v8 offset:5120
  ds_read_b128 v[52:55], v8 offset:5632
  ds_read_b128 v[76:79], v8 offset:4096
  s_waitcnt lgkmcnt(0)
  v_max_u32 v18, v49, v51
  v_max3_u32 v18, v18, v53, v55
  v_max3_u32 v18, v18, v77, v79
  v_cmp_eq_u32 vcc, -1, v18
  s_cbranch_vccz L_R5_og
  s_sub_u32 s7, s7, 1
  s_cbranch_scc0 L_R5_of
  s_mov_b32 s7, 0
  v_min_u32 v49, -2, v49
  v_min_u32 v51, -2, v51
  v_min_u32 v53, -2, v53
  v_min_u32 v55, -2, v55
  v_min_u32 v77, -2, v77
  v_min_u32 v79, -2, v79
L_R5_og:
  v_mfma_i32_16x16x4_4b_i8 v[32:47], v0, v0, 0
  s_nop 11
  v_smfmac_f32_16x16x64_bf16 v[32:35], v[72:75], a[200:207], v2
  v_smfmac_f32_16x16x64_bf16 v[36:39], v[72:75], a[232:239], v2
  v_smfmac_f32_16x16x64_bf16 v[40:43], v[72:75], v[24:31], v2
  v_smfmac_f32_16x16x64_bf16 v[44:47], v[72:75], v[88:95], v2
  s_branch L_R5_ok
L_R5_fw:
Lww_39:
  global_load_dword v19, v0, s[66:67] offset:0 sc1
  s_waitcnt vmcnt(0)
  v_cmp_gt_u32 vcc, 1, v19
  s_cbranch_vccz Lwd_40
  s_sub_u32 s7, s7, 1
  s_cbranch_scc0 Lww_39
  s_mov_b32 s7, 0
Lwd_40:
  s_branch L_R5_fok
.p2align 2
L_R5_slow2:
  s_nop 7
  s_nop 7
  ds_read_b128 v[32:35], v6 offset:0
  ds_read_b128 v[36:39], v6 offset:1024
  ds_read_b128 v[40:43], v8 offset:0
  ds_read_b128 v[44:47], v9 offset:0
  s_waitcnt lgkmcnt(0)
  v_mfma_f32_16x16x32_bf16 v[56:59], v[32:35], v[40:43], 0
  v_mfma_f32_16x16x32_bf16 v[60:63], v[36:39], v[40:43], 0
  v_mfma_f32_16x16x32_bf16 v[120:123], v[44:47], v[40:43], 0
  s_nop 7
  ds_read_b128 v[32:35], v6 offset:2048
  ds_read_b128 v[36:39], v6 offset:3072
  ds_read_b128 v[40:43], v8 offset:1024
  ds_read_b128 v[44:47], v9 offset:1024
  s_waitcnt lgkmcnt(0)
  v_mfma_f32_16x16x32_bf16 v[56:59], v[32:35], v[40:43], v[56:59]
  v_mfma_f32_16x16x32_bf16 v[60:63], v[36:39], v[40:43], v[60:63]
  v_mfma_f32_16x16x32_bf16 v[120:123], v[44:47], v[40:43], v[120:123]
  s_nop 7
  ds_read_b128 v[32:35], v6 offset:4096
  ds_read_b128 v[36:39], v6 offset:5120
  ds_read_b128 v[40:43], v8 offset:2048
  ds_read_b128 v[44:47], v9 offset:2048
  s_waitcnt lgkmcnt(0)
  v_mfma_f32_16x16x32_bf16 v[56:59], v[32:35], v[40:43], v[56:59]
  v_mfma_f32_16x16x32_bf16 v[60:63], v[36:39], v[40:43], v[60:63]
  v_mfma_f32_16x16x32_bf16 v[120:123], v[44:47], v[40:43], v[120:123]
  s_nop 7
  ds_read_b128 v[32:35], v6 offset:6144
  ds_read_b128 v[36:39], v6 offset:7168
  ds_read_b128 v[40:43], v8 offset:3072
  ds_read_b128 v[44:47], v9 offset:3072
  s_waitcnt lgkmcnt(0)
  v_mfma_f32_16x16x32_bf16 v[56:59], v[32:35], v[40:43], v[56:59]
  v_mfma_f32_16x16x32_bf16 v[60:63], v[36:39], v[40:43], v[60:63]
  v_mfma_f32_16x16x32_bf16 v[120:123], v[44:47], v[40:43], v[120:123]
  s_nop 7
  v_mfma_i32_16x16x4_4b_i8 v[32:47], v0, v0, 0
  v_max3_f32 v16, v56, v57, v58
  v_max3_f32 v17, v59, v60, v61
  v_max3_f32 v16, v16, v62, v63
  v_max3_f32 v17, v17, v120, v121
  v_max_f32 v18, v16, v17
  v_max_f32 v19, v16, v17
  s_nop 1
  v_permlane32_swap_b32 v18, v19
  v_max_f32 v16, v18, v19
  v_max_f32 v17, v18, v19
  s_nop 1
  v_permlane16_swap_b32 v16, v17
  v_max_f32 v16, v16, v17
  v_mul_f32 v13, 0xbe0293ee, v16
  v_fma_f32 v56, v56, s52, v13
  v_fma_f32 v57, v57, s52, v13
  v_exp_f32 v56, v56
  v_fma_f32 v58, v58, s52, v13
  v_exp_f32 v57, v57
  v_fma_f32 v59, v59, s52, v13
  v_exp_f32 v58, v58
  v_cvt_pk_bf16_f32 v56, v56, v57
  v_exp_f32 v59, v59
  v_fma_f32 v60, v60, s52, v13
  v_cvt_pk_bf16_f32 v57, v58, v59
  v_fma_f32 v61, v61, s52, v13
  v_exp_f32 v60, v60
  v_fma_f32 v62, v62, s52, v13
  v_exp_f32 v61, v61
  v_fma_f32 v63, v63, s52, v13
  v_exp_f32 v62, v62
  v_exp_f32 v63, v63
  v_cvt_pk_bf16_f32 v58, v60, v61
  v_cvt_pk_bf16_f32 v59, v62, v63
  v_fma_f32 v120, v120, s52, v13
  v_fma_f32 v121, v121, s52, v13
  v_exp_f32 v18, v120
  v_exp_f32 v19, v121
  v_mfma_f32_16x16x32_bf16 v[104:107], v[124:127], v[56:59], 0
  v_mfma_f32_16x16x32_bf16 v[96:99], v[80:83], v[56:59], 0
  v_mfma_f32_16x16x32_bf16 v[100:103], v[84:87], v[56:59], 0
  v_cvt_pk_bf16_f32 v14, v18, v19
  v_lshlrev_b64 v[16:17], v12, v[14:15]
  s_nop 1
  v_mfma_f32_16x16x16_bf16 v[108:111], v[124:125], v[16:17], v[104:107]
  s_nop 2
  v_cndmask_b32 v96, v96, v100, s[70:71]
  v_cndmask_b32 v97, v97, v101, s[70:71]
  v_cndmask_b32 v98, v98, v102, s[70:71]
  v_cndmask_b32 v99, v99, v103, s[70:71]
  s_nop 1
  v_mfma_f32_16x16x16_bf16 v[60:63], v[22:23], v[16:17], v[96:99]
  v_rcp_f32 v18, v108
  s_nop 7
  s_barrier
  s_branch L_R5_sy
.p2align 7
L_R6:
  ds_read_b128 v[88:91], v1 offset:40960
  ds_read_b128 v[92:95], v1 offset:41984
  ds_read_b128 v[96:99], v5 offset:40960
  ds_read_b128 v[100:103], v5 offset:41984
  ds_read_b128 v[104:107], v1 offset:57344
  ds_read_b128 v[108:111], v1 offset:58368
  ds_read_b128 v[112:115], v1 offset:8192
  ds_read_b128 v[116:119], v1 offset:9216
  ds_read_b128 v[120:123], v1 offset:24576
  ds_read_b128 v[124:127], v1 offset:25600
  v_mov_b32 v19, -1
  v_lshlrev_b32 v10, 3, v1
  global_load_dwordx4 v[80:83], v1, s[62:63]
  global_load_dwordx4 v[84:87], v1, s[62:63] offset:1024
  s_waitcnt vmcnt(2) lgkmcnt(0)
  s_branch L_R6_p2
.p2align 5
L_R6_fe:
  s_mov_b64 exec, vcc
  global_load_dwordx4 v[24:27], v1, s[54:55] offset:-2048 sc1
  s_mov_b64 exec, -1
  v_mov_b32 v19, -1
  v_mov_b32 v19, -1
  v_mov_b32 v19, -1
  v_mov_b32 v19, -1
  v_mfma_f32_16x16x1_4b_f32 v[56:71], v0, v0, 0
  s_waitcnt vmcnt(4)
  v_max3_u32 v16, v24, v25, v26
  v_max_u32 v16, v16, v27
  v_cmp_eq_u32 vcc, -1, v16
  s_cbranch_vccz L_R6_p2a
  s_mov_b64 exec, vcc
  global_load_dwordx4 v[24:27], v1, s[54:55] offset:-2048 sc1
  s_mov_b64 exec, -1
  s_waitcnt vmcnt(3)
  v_max3_u32 v16, v24, v25, v26
  v_max_u32 v16, v16, v27
  v_cmp_eq_u32 vcc, -1, v16
  s_cbranch_vccz L_R6_p2a
  s_mov_b64 exec, vcc
  global_load_dwordx4 v[24:27], v1, s[54:55] offset:-2048 sc1
  s_mov_b64 exec, -1
  s_waitcnt vmcnt(2)
  v_max3_u32 v16, v24, v25, v26
  v_max_u32 v16, v16, v27
  v_cmp_eq_u32 vcc, -1, v16
  s_cbranch_vccz L_R6_p2a
L_R6_fe2:
  s_mov_b64 exec, vcc
  global_load_dwordx4 v[24:27], v1, s[54:55] offset:-2048 sc1
  s_mov_b64 exec, -1
  s_waitcnt vmcnt(2)
  v_max3_u32 v16, v24, v25, v26
  v_max_u32 v16, v16, v27
  v_cmp_eq_u32 vcc, -1, v16
  s_cbranch_vccz L_R6_p2a
  s_sub_u32 s7, s7, 1
  s_cbranch_scc0 L_R6_fe2
  s_mov_b32 s7, 0
  v_mov_b32 v16, 0
  s_branch L_R6_p2a
.p2align 5
L_R6_fl:
  s_mov_b64 exec, vcc
  global_load_dwordx4 v[28:31], v1, s[54:55] offset:2048 sc1
  s_mov_b64 exec, -1
  s_waitcnt vmcnt(2)
  v_max3_u32 v16, v28, v29, v30
  v_max_u32 v16, v16, v31
  v_cmp_eq_u32 vcc, -1, v16
  ds_write_b128 v6, v[28:31] offset:22528
  s_cbranch_vccz L_R6_cl
L_R6_fl2:
  s_mov_b64 exec, vcc
  global_load_dwordx4 v[28:31], v1, s[54:55] offset:2048 sc1
  s_mov_b64 exec, -1
  s_waitcnt vmcnt(2)
  v_max3_u32 v16, v28, v29, v30
  v_max_u32 v16, v16, v31
  v_cmp_eq_u32 vcc, -1, v16
  ds_write_b128 v6, v[28:31] offset:22528
  s_cbranch_vccz L_R6_cl
  s_sub_u32 s7, s7, 1
  s_cbranch_scc0 L_R6_fl2
  s_mov_b32 s7, 0
  s_branch L_R6_cl
.p2align 6
L_R6_p2:
  s_waitcnt vmcnt(4)
  v_max3_u32 v16, v24, v25, v26
  v_max_u32 v16, v16, v27
L_R6_p2a:
  v_smfmac_f32_16x16x64_bf16 v[56:59], v[24:27], v[88:95], v2
  ds_write_b128 v6, v[24:27] offset:18432
  v_cmp_eq_u32 vcc, -1, v16
  v_smfmac_f32_16x16x64_bf16 v[60:63], v[24:27], a[144:151], v2
  v_smfmac_f32_16x16x64_bf16 v[64:67], v[24:27], a[32:39], v2
  s_cbranch_vccnz L_R6_fe
  v_smfmac_f32_16x16x64_bf16 v[68:71], v[24:27], a[40:47], v2
  global_load_dwordx4 v[28:31], v1, s[54:55] offset:2048 sc1
  ds_read_b128 v[88:91], v5 offset:57344
  v_smfmac_f32_16x16x64_bf16 v[72:75], v[24:27], v[160:167], v2
  s_waitcnt lgkmcnt(1)
  s_barrier
  s_waitcnt vmcnt(3)
  v_max3_u32 v16, v28, v29, v30
  v_max_u32 v16, v16, v31
  v_cmp_eq_u32 vcc, -1, v16
  v_smfmac_f32_16x16x64_bf16 v[76:79], v[24:27], v[168:175], v2
  ds_write_b128 v6, v[28:31] offset:22528
  s_cbranch_vccnz L_R6_fl
L_R6_cl:
  v_smfmac_f32_16x16x64_bf16 v[56:59], v[28:31], v[96:103], v2
  ds_read_b128 v[32:35], v6 offset:19456
  global_load_dwordx4 v[80:83], v1, s[62:63]
  v_smfmac_f32_16x16x64_bf16 v[60:63], v[28:31], a[176:183], v2
  ds_read_b128 v[36:39], v6 offset:16384
  global_load_dwordx4 v[84:87], v1, s[62:63] offset:1024
  v_smfmac_f32_16x16x64_bf16 v[64:67], v[28:31], a[96:103], v2
  s_waitcnt lgkmcnt(2)
  s_barrier
  ds_read_b128 v[40:43], v6 offset:17408
  v_smfmac_f32_16x16x64_bf16 v[68:71], v[28:31], a[104:111], v2
  ds_read_b128 v[44:47], v6 offset:23552
  global_load_dword v10, v10, s[68:69]
  v_smfmac_f32_16x16x64_bf16 v[72:75], v[28:31], v[224:231], v2
  ds_read_b128 v[48:51], v6 offset:20480
  v_smfmac_f32_16x16x64_bf16 v[76:79], v[28:31], v[232:239], v2
  ds_read_b128 v[52:55], v6 offset:21504
  s_waitcnt lgkmcnt(5)
  v_smfmac_f32_16x16x64_bf16 v[56:59], v[32:35], v[104:111], v2
  ds_read_b128 v[92:95], v5 offset:58368
  v_smfmac_f32_16x16x64_bf16 v[60:63], v[32:35], a[152:159], v2
  ds_read_b128 v[96:99], v5 offset:8192
  s_waitcnt lgkmcnt(6)
  v_smfmac_f32_16x16x64_bf16 v[56:59], v[36:39], v[112:119], v2
  ds_read_b128 v[100:103], v5 offset:9216
  v_smfmac_f32_16x16x64_bf16 v[60:63], v[36:39], a[128:135], v2
  global_store_dwordx4 v1, v[20:23], s[64:65] sc1
  ds_read_b128 v[104:107], v5 offset:24576
  s_waitcnt lgkmcnt(7)
  v_smfmac_f32_16x16x64_bf16 v[56:59], v[40:43], v[120:127], v2
  ds_read_b128 v[108:111], v5 offset:25600
  v_smfmac_f32_16x16x64_bf16 v[60:63], v[40:43], a[136:143], v2
  ds_read_b128 v[112:115], v6 offset:0
  s_waitcnt lgkmcnt(5)
  v_smfmac_f32_16x16x64_bf16 v[56:59], v[44:47], v[88:95], v2
  ds_read_b128 v[116:119], v6 offset:2048
  v_smfmac_f32_16x16x64_bf16 v[60:63], v[44:47], a[184:191], v2
  ds_read_b128 v[120:123], v6 offset:4096
  s_waitcnt lgkmcnt(5)
  v_smfmac_f32_16x16x64_bf16 v[56:59], v[48:51], v[96:103], v2
  global_load_dword v10, v0, s[66:67] sc1
  ds_read_b128 v[124:127], v6 offset:6144
  v_smfmac_f32_16x16x64_bf16 v[60:63], v[48:51], a[160:167], v2
  ds_write_b32 v11, v19 offset:5124
  s_waitcnt lgkmcnt(5)
  v_smfmac_f32_16x16x64_bf16 v[56:59], v[52:55], v[104:111], v2
  v_smfmac_f32_16x16x64_bf16 v[60:63], v[52:55], a[168:175], v2
  s_waitcnt vmcnt(5)
  ds_read_b128 v[24:27], v6 offset:1024
  v_smfmac_f32_16x16x64_bf16 v[64:67], v[32:35], a[48:55], v2
  ds_read_b128 v[28:31], v6 offset:3072
  v_add_f32 v56, v56, v57
  v_add_f32 v58, v58, v59
  v_smfmac_f32_16x16x64_bf16 v[68:71], v[32:35], a[56:63], v2
  v_add_f32 v60, v60, v61
  v_add_f32 v62, v62, v63
  v_smfmac_f32_16x16x64_bf16 v[64:67], v[36:39], a[0:7], v2
  v_cvt_pk_bf16_f32 v16, v56, v60
  v_cvt_pk_bf16_f32 v17, v58, v62
  v_smfmac_f32_16x16x64_bf16 v[68:71], v[36:39], a[8:15], v2
  ds_write2_b32 v7, v16, v17 offset0:0 offset1:16
  v_smfmac_f32_16x16x64_bf16 v[64:67], v[40:43], a[16:23], v2
  v_smfmac_f32_16x16x64_bf16 v[68:71], v[40:43], a[24:31], v2
  v_smfmac_f32_16x16x64_bf16 v[64:67], v[44:47], a[112:119], v2
  v_smfmac_f32_16x16x64_bf16 v[68:71], v[44:47], a[120:127], v2
  s_waitcnt lgkmcnt(0)
  s_barrier
  v_smfmac_f32_16x16x64_bf16 v[64:67], v[48:51], a[64:71], v2
  ds_read_b128 v[96:99], v8 offset:0
  v_smfmac_f32_16x16x64_bf16 v[68:71], v[48:51], a[72:79], v2
  ds_read_b128 v[100:103], v8 offset:1024
  v_smfmac_f32_16x16x64_bf16 v[64:67], v[52:55], a[80:87], v2
  ds_read_b128 v[104:107], v8 offset:2048
  v_smfmac_f32_16x16x64_bf16 v[68:71], v[52:55], a[88:95], v2
  ds_read_b128 v[108:111], v8 offset:3072
  v_smfmac_f32_16x16x64_bf16 v[72:75], v[32:35], v[176:183], v2
  ds_read_b128 v[88:91], v6 offset:5120
  v_add_f32 v64, v64, v65
  v_smfmac_f32_16x16x64_bf16 v[76:79], v[32:35], v[184:191], v2
  ds_read_b128 v[92:95], v6 offset:7168
  v_add_f32 v66, v66, v67
  s_waitcnt lgkmcnt(5)
  v_mfma_f32_16x16x32_bf16 v[56:59], v[112:115], v[96:99], 0
  v_add_f32 v68, v68, v69
  v_add_f32 v70, v70, v71
  s_waitcnt lgkmcnt(4)
  v_mfma_f32_16x16x32_bf16 v[56:59], v[116:119], v[100:103], v[56:59]
  v_cvt_pk_bf16_f32 v20, v64, v68
  v_cvt_pk_bf16_f32 v21, v66, v70
  s_waitcnt lgkmcnt(3)
  v_mfma_f32_16x16x32_bf16 v[56:59], v[120:123], v[104:107], v[56:59]
  ds_write2_b32 v7, v20, v21 offset0:128 offset1:144
  s_waitcnt lgkmcnt(3)
  v_mfma_f32_16x16x32_bf16 v[56:59], v[124:127], v[108:111], v[56:59]
  ds_read_b128 v[124:127], v6 offset:31744
  v_mfma_f32_16x16x32_bf16 v[60:63], v[24:27], v[96:99], 0
  v_mfma_f32_16x16x32_bf16 v[60:63], v[28:31], v[100:103], v[60:63]
  s_waitcnt lgkmcnt(3)
  v_max3_f32 v16, v56, v57, v58
  v_max_f32 v18, v16, v59
  v_max_f32 v19, v16, v59
  v_mfma_f32_16x16x32_bf16 v[60:63], v[88:91], v[104:107], v[60:63]
  s_waitcnt lgkmcnt(1)
  s_barrier
  v_permlane32_swap_b32 v18, v19
  v_max_f32 v16, v18, v19
  v_max_f32 v17, v18, v19
  v_mfma_f32_16x16x32_bf16 v[60:63], v[92:95], v[108:111], v[60:63]
  ds_read_b128 v[64:67], v9 offset:0
  v_permlane16_swap_b32 v16, v17
  v_max_f32 v16, v16, v17
  v_mul_f32 v13, 0xbe0293ee, v16
  v_smfmac_f32_16x16x64_bf16 v[72:75], v[36:39], v[128:135], v2
  ds_read_b128 v[68:71], v9 offset:1024
  v_fma_f32 v56, v56, s52, v13
  v_fma_f32 v57, v57, s52, v13
  v_smfmac_f32_16x16x64_bf16 v[76:79], v[36:39], v[136:143], v2
  ds_read_b128 v[112:115], v9 offset:2048
  v_exp_f32 v56, v56
  v_smfmac_f32_16x16x64_bf16 v[72:75], v[40:43], v[144:151], v2
  ds_read_b128 v[116:119], v9 offset:3072
  v_fma_f32 v58, v58, s52, v13
  v_exp_f32 v57, v57
  v_smfmac_f32_16x16x64_bf16 v[76:79], v[40:43], v[152:159], v2
  ds_read_b128 v[24:27], v1 offset:43008
  s_waitcnt lgkmcnt(4)
  v_fma_f32 v59, v59, s52, v13
  v_mfma_f32_16x16x32_bf16 v[120:123], v[64:67], v[96:99], 0
  v_exp_f32 v58, v58
  v_cvt_pk_bf16_f32 v56, v56, v57
  s_waitcnt lgkmcnt(3)
  v_mfma_f32_16x16x32_bf16 v[120:123], v[68:71], v[100:103], v[120:123]
  v_exp_f32 v59, v59
  v_fma_f32 v60, v60, s52, v13
  s_waitcnt lgkmcnt(2)
  v_mfma_f32_16x16x32_bf16 v[120:123], v[112:115], v[104:107], v[120:123]
  s_waitcnt lgkmcnt(1)
  v_cvt_pk_bf16_f32 v57, v58, v59
  v_fma_f32 v61, v61, s52, v13
  v_exp_f32 v60, v60
  v_mfma_f32_16x16x32_bf16 v[120:123], v[116:119], v[108:111], v[120:123]
  v_fma_f32 v62, v62, s52, v13
  v_exp_f32 v61, v61
  v_smfmac_f32_16x16x64_bf16 v[72:75], v[44:47], v[240:247], v2
  ds_read_b128 v[28:31], v1 offset:44032
  v_fma_f32 v63, v63, s52, v13
  v_smfmac_f32_16x16x64_bf16 v[76:79], v[44:47], v[248:255], v2
  ds_read_b128 v[88:91], v5 offset:43008
  v_exp_f32 v62, v62
  v_smfmac_f32_16x16x64_bf16 v[72:75], v[48:51], v[192:199], v2
  ds_read_b128 v[92:95], v5 offset:44032
  v_exp_f32 v63, v63
  v_smfmac_f32_16x16x64_bf16 v[76:79], v[48:51], v[200:207], v2
  ds_read_b128 v[112:115], v1 offset:59392
  v_cvt_pk_bf16_f32 v58, v60, v61
  v_cvt_pk_bf16_f32 v59, v62, v63
  s_nop 1
  v_mfma_f32_16x16x32_bf16 v[104:107], v[124:127], v[56:59], 0
  s_waitcnt vmcnt(3)
  v_fma_f32 v120, v120, s52, v13
  v_fma_f32 v121, v121, s52, v13
  v_mfma_f32_16x16x32_bf16 v[96:99], v[80:83], v[56:59], 0
  v_exp_f32 v18, v120
  v_mfma_f32_16x16x32_bf16 v[100:103], v[84:87], v[56:59], 0
  v_exp_f32 v19, v121
  v_smfmac_f32_16x16x64_bf16 v[72:75], v[52:55], v[208:215], v2
  ds_read_b128 v[116:119], v1 offset:60416
  v_cvt_pk_bf16_f32 v14, v18, v19
  v_lshlrev_b64 v[16:17], v12, v[14:15]
  v_smfmac_f32_16x16x64_bf16 v[76:79], v[52:55], v[216:223], v2
  v_cndmask_b32 v96, v96, v100, s[70:71]
  v_mfma_f32_16x16x16_bf16 v[108:111], v[124:125], v[16:17], v[104:107]
  v_cndmask_b32 v97, v97, v101, s[70:71]
  v_cndmask_b32 v98, v98, v102, s[70:71]
  v_cndmask_b32 v99, v99, v103, s[70:71]
  v_add_f32 v72, v72, v73
  v_add_f32 v74, v74, v75
  v_add_f32 v76, v76, v77
  v_add_f32 v78, v78, v79
  v_cvt_pk_bf16_f32 v22, v72, v74
  v_cvt_pk_bf16_f32 v23, v76, v78
  s_cmp_eq_u32 s44, 63
  v_mov_b32 v19, -1
  v_mfma_f32_16x16x16_bf16 v[60:63], v[22:23], v[16:17], v[96:99]
  v_cmp_nge_f32 vcc, s53, v108
  v_rcp_f32_e64 v18, v108
  v_mov_b32_e64 v19, -1
  v_mov_b32_e64 v19, -1
  v_mov_b32_e64 v19, -1
  v_mfma_i32_16x16x4_4b_i8 v[32:47], v0, v0, 0
  v_mov_b32_e64 v19, -1
  s_cbranch_vccnz L_R6_slow
L_R6_sy:
  v_mul_f32 v60, v60, v18
  v_mul_f32 v61, v61, v18
  v_cvt_pk_bf16_f32 v16, v60, v61
  v_mul_f32 v62, v62, v18
  v_mul_f32 v63, v63, v18
  v_cvt_pk_bf16_f32 v17, v62, v63
  ds_write_b64 v11, v[16:17] offset:5120
  v_mov_b32_dpp v72, v16 quad_perm:[0,0,2,2] row_mask:0xf bank_mask:0xf
  v_mov_b32_dpp v74, v16 quad_perm:[1,1,3,3] row_mask:0xf bank_mask:0xf
  v_mov_b32_dpp v73, v17 quad_perm:[0,0,2,2] row_mask:0xf bank_mask:0xf
  v_mov_b32_dpp v75, v17 quad_perm:[1,1,3,3] row_mask:0xf bank_mask:0xf
  ds_read_b128 v[48:51], v8 offset:5632
  s_nop 0
  v_smfmac_f32_16x16x64_bf16 v[32:35], v[72:75], a[208:215], v2
  ds_read_b128 v[52:55], v8 offset:4096
  v_smfmac_f32_16x16x64_bf16 v[36:39], v[72:75], a[240:247], v2
  ds_read_b128 v[76:79], v8 offset:4608
  global_load_lds_dwordx4 v1, s[60:61]
  s_waitcnt lgkmcnt(4)
  v_smfmac_f32_16x16x64_bf16 v[40:43], v[72:75], v[24:31], v2
  global_load_lds_dwordx4 v1, s[60:61] offset:1024
  ds_read_b128 v[64:67], v1 offset:10240
  v_smfmac_f32_16x16x64_bf16 v[44:47], v[72:75], v[88:95], v2
  ds_read_b128 v[68:71], v1 offset:11264
L_R6_ok:
  s_waitcnt lgkmcnt(4)
  v_smfmac_f32_16x16x64_bf16 v[32:35], v[48:51], a[216:223], v2
  ds_read_b128 v[120:123], v1 offset:26624
  v_max_u32 v18, v49, v51
  s_waitcnt lgkmcnt(4)
  v_smfmac_f32_16x16x64_bf16 v[32:35], v[52:55], a[192:199], v2
  ds_read_b128 v[124:127], v1 offset:27648
  v_max3_u32 v18, v18, v53, v55
  s_waitcnt lgkmcnt(4)
  v_smfmac_f32_16x16x64_bf16 v[32:35], v[76:79], a[200:207], v2
  ds_read_b128 v[96:99], v5 offset:59392
  v_max3_u32 v18, v18, v77, v79
  v_smfmac_f32_16x16x64_bf16 v[36:39], v[48:51], a[248:255], v2
  ds_read_b128 v[100:103], v5 offset:60416
  v_smfmac_f32_16x16x64_bf16 v[36:39], v[52:55], a[224:231], v2
  ds_read_b128 v[104:107], v5 offset:10240
  v_cmp_eq_u32 vcc, -1, v18
  v_cvt_pk_bf16_f32 v33, v33, v35
  v_cvt_pk_bf16_f32 v32, v32, v34
  v_and_or_b32 v33, v33, -2, s12
  v_smfmac_f32_16x16x64_bf16 v[36:39], v[76:79], a[232:239], v2
  s_cbranch_vccnz L_R6_of
  global_store_dwordx2 v3, v[32:33], s[46:47] offset:0 sc1
  ds_read_b128 v[108:111], v5 offset:11264
  v_smfmac_f32_16x16x64_bf16 v[40:43], v[48:51], v[112:119], v2
  ds_read_b128 v[56:59], v5 offset:26624
  s_waitcnt lgkmcnt(7)
  v_smfmac_f32_16x16x64_bf16 v[40:43], v[52:55], v[64:71], v2
  ds_read_b128 v[60:63], v5 offset:27648
  s_waitcnt lgkmcnt(6)
  v_cvt_pk_bf16_f32 v37, v37, v39
  v_cvt_pk_bf16_f32 v36, v36, v38
  v_and_or_b32 v37, v37, -2, s12
  v_smfmac_f32_16x16x64_bf16 v[40:43], v[76:79], v[120:127], v2
  global_store_dwordx2 v3, v[36:37], s[46:47] offset:2048 sc1
  s_waitcnt lgkmcnt(4)
  v_smfmac_f32_16x16x64_bf16 v[44:47], v[48:51], v[96:103], v2
  s_waitcnt lgkmcnt(2)
  v_smfmac_f32_16x16x64_bf16 v[44:47], v[52:55], v[104:111], v2
  ds_read_b128 v[48:51], v6 offset:30720
  v_cvt_pk_bf16_f32 v41, v41, v43
  v_cvt_pk_bf16_f32 v40, v40, v42
  v_and_or_b32 v41, v41, -2, s12
  s_waitcnt lgkmcnt(1)
  v_smfmac_f32_16x16x64_bf16 v[44:47], v[76:79], v[56:63], v2
  global_store_dwordx2 v3, v[40:41], s[48:49] offset:0 sc1
  v_mov_b32 v72, 0
  v_mov_b32 v73, 0
  v_mov_b32 v74, 0
  v_mov_b32 v75, 0
  s_nop 2
  v_cvt_pk_bf16_f32 v45, v45, v47
  v_cvt_pk_bf16_f32 v44, v44, v46
  v_and_or_b32 v45, v45, -2, s12
  global_store_dwordx2 v3, v[44:45], s[48:49] offset:2048 sc1
  s_add_u32 s54, s54, 0x2000
  s_bitset0_b32 s54, 15
  v_mov_b32 v76, 0
  ds_read_b128 v[88:91], v1 offset:40960
  v_mov_b32 v77, 0
  ds_read_b128 v[92:95], v1 offset:41984
  v_mov_b32 v78, 0
  ds_read_b128 v[96:99], v5 offset:40960
  v_mov_b32 v79, 0
  ds_read_b128 v[100:103], v5 offset:41984
  v_mov_b32 v19, -1
  ds_read_b128 v[104:107], v1 offset:57344
  v_mov_b32 v19, -1
  ds_read_b128 v[108:111], v1 offset:58368
  v_mov_b32 v19, -1
  ds_read_b128 v[112:115], v1 offset:8192
  v_mov_b32 v19, -1
  ds_read_b128 v[116:119], v1 offset:9216
  v_mov_b32 v19, -1
  ds_read_b128 v[120:123], v1 offset:24576
  v_mov_b32 v19, -1
  ds_read_b128 v[124:127], v1 offset:25600
  v_mov_b32 v19, -1
  s_add_u32 s60, s60, 262144
  s_addc_u32 s61, s61, 0
  v_mov_b32 v19, -1
  s_add_u32 s68, s68, 262144
  s_addc_u32 s69, s69, 0
  v_mov_b32 v19, -1
  s_add_u32 s62, s62, 262144
  s_addc_u32 s63, s63, 0
  v_mov_b32 v19, -1
  s_add_u32 s64, s64, 262144
  s_addc_u32 s65, s65, 0
  v_mov_b32 v19, -1
  v_mov_b32 v19, -1
  v_mov_b32 v19, -1
  v_mov_b32 v19, -1
  global_load_dwordx4 v[80:83], v1, s[50:51] sc1
  global_load_dwordx4 v[84:87], v1, s[50:51] offset:1024 sc1
  v_mov_b32 v19, -1
  v_mov_b32 v19, -1
  v_mov_b32 v19, -1
  v_mov_b32 v19, -1
  v_mov_b32 v19, -1
  v_mov_b32 v19, -1
  v_mov_b32 v19, -1
  v_mov_b32 v19, -1
  v_mov_b32 v19, -1
  v_mov_b32 v19, -1
  v_mov_b32 v19, -1
  v_mov_b32 v19, -1
  v_mov_b32 v19, -1
  v_mov_b32 v19, -1
  v_mov_b32 v19, -1
  v_mov_b32 v19, -1
  v_mov_b32 v19, -1
  v_mov_b32 v19, -1
  v_mov_b32 v19, -1
  v_mov_b32 v19, -1
  v_mov_b32 v19, -1
  v_mov_b32 v19, -1
  v_mov_b32 v19, -1
  v_mov_b32 v19, -1
  v_mov_b32 v19, -1
  v_mov_b32 v19, -1
  v_mov_b32 v19, -1
  v_mov_b32 v19, -1
  v_mov_b32 v19, -1
  v_mov_b32 v19, -1
  v_mov_b32 v19, -1
  v_mov_b32 v19, -1
  v_mov_b32 v19, -1
  v_mov_b32 v19, -1
  v_mov_b32 v19, -1
  global_load_dwordx4 v[80:83], v1, s[50:51] sc1
  global_load_dwordx4 v[84:87], v1, s[50:51] offset:1024 sc1
  v_mov_b32 v19, -1
  v_mov_b32 v19, -1
  v_mov_b32 v19, -1
  v_mov_b32 v19, -1
  v_mov_b32 v19, -1
  v_mov_b32_e64 v19, -1
  s_waitcnt lgkmcnt(10)
  v_mfma_f32_16x16x1_4b_f32 v[56:71], v0, v0, 0
  s_waitcnt vmcnt(3)
  v_bitop3_b32 v16, v81, v83, s12 bitop3:0x7e
  v_mfma_f32_16x16x32_bf16 v[52:55], v[48:51], v[80:83], 0
  s_waitcnt vmcnt(2)
  v_bitop3_b32 v17, v85, v87, s12 bitop3:0x7e
  v_mfma_f32_16x16x32_bf16 v[52:55], v[48:51], v[84:87], v[52:55]
  v_bitop3_b32 v16, v16, v17, 1 bitop3:0xa8
  v_cmp_ne_u32_e64 vcc, 0, v16
  v_readfirstlane_b32 s79, v10
  v_mov_b32_e64 v19, -1
  v_mov_b32_e64 v19, -1
  v_mov_b32_e64 v19, -1
  v_mov_b32_e64 v19, -1
  v_mov_b32_e64 v19, -1
L_R6_c1:
  v_add_f32_dpp v52, v52, v52 row_ror:4 row_mask:0xf bank_mask:0xf
  v_add_f32_dpp v53, v53, v53 row_ror:4 row_mask:0xf bank_mask:0xf
  s_cbranch_vccnz L_R6_pf
  v_add_f32_dpp v52, v52, v52 row_ror:8 row_mask:0xf bank_mask:0xf
  v_add_f32_dpp v53, v53, v53 row_ror:8 row_mask:0xf bank_mask:0xf
  v_cvt_pk_bf16_f32 v16, v52, v53
  global_store_dword v4, v16, s[56:57] sc1
  s_cmp_eq_u32 s79, 0
  s_cbranch_scc1 L_R6_fw
L_R6_fok:
  v_mov_b32 v19, -1
  global_store_dword v4, v19, s[58:59] sc1
  s_add_u32 s58, s58, 0x2000
  s_bitset0_b32 s58, 15
  v_mov_b32 v19, -1
  s_cmp_lt_u32 s44, 61
  s_cselect_b32 s74, 2048, 0
  v_mov_b32 v19, -1
  s_add_u32 s66, s66, s74
  s_addc_u32 s67, s67, 0
  v_mov_b32 v19, -1
  s_add_u32 s56, s56, 0x2000
  s_bitset0_b32 s56, 15
  v_mov_b32 v19, -1
  s_xor_b32 s12, s12, 1
  s_add_u32 s44, s44, 1
  v_lshlrev_b32 v10, 3, v1
  s_cmp_eq_u32 s44, 63
  s_cselect_b32 s53, -1, s53
  v_mov_b32 v19, -1
  v_mov_b32 v19, -1
  v_mov_b32 v19, -1
  v_mov_b32 v19, -1
  v_mov_b32 v19, -1
  v_mov_b32 v19, -1
  v_mov_b32 v19, -1
  v_mov_b32 v19, -1
  v_mov_b32 v19, -1
  v_mov_b32 v19, -1
  v_mov_b32 v19, -1
  v_mov_b32 v19, -1
  v_mov_b32 v19, -1
  global_load_dwordx4 v[24:27], v1, s[54:55] offset:-2048 sc1
  v_mov_b32 v19, -1
  v_mov_b32 v19, -1
  v_mov_b32 v19, -1
  v_mov_b32 v19, -1
  v_mov_b32 v19, -1
  v_mov_b32 v19, -1
  v_mov_b32 v19, -1
  v_mov_b32 v19, -1
  v_mov_b32 v19, -1
  v_mov_b32 v19, -1
  v_mov_b32 v19, -1
  v_mov_b32 v19, -1
  global_load_dwordx4 v[24:27], v1, s[54:55] offset:-2048 sc1
  v_mov_b32 v19, -1
  v_mov_b32 v19, -1
  v_mov_b32 v19, -1
  v_mov_b32 v19, -1
  v_mov_b32 v19, -1
  v_mov_b32 v19, -1
  global_load_dwordx4 v[28:31], v1, s[54:55] offset:2048 sc1
  v_mov_b32 v19, -1
  v_mov_b32 v19, -1
  v_mov_b32 v19, -1
  v_mov_b32 v19, -1
  v_mov_b32 v19, -1
  v_mov_b32 v19, -1
  v_mov_b32 v19, -1
  v_mov_b32 v19, -1
  v_mov_b32 v19, -1
  v_mov_b32 v19, -1
  v_mov_b32 v19, -1
  v_mov_b32 v19, -1
  global_load_dwordx4 v[24:27], v1, s[54:55] offset:-2048 sc1
  v_mov_b32 v19, -1
  v_mov_b32 v19, -1
  v_mov_b32_e64 v19, -1
  v_mov_b32_e64 v19, -1
  v_mov_b32_e64 v19, -1
  v_mov_b32_e64 v19, -1
  global_load_dwordx4 v[28:31], v1, s[54:55] offset:2048 sc1
  v_mov_b32_e64 v19, -1
  v_mov_b32_e64 v19, -1
  s_waitcnt lgkmcnt(0)
  v_mfma_f32_16x16x1_4b_f32 v[56:71], v0, v0, 0
  s_branch L_R6_p2
L_R6_slow:
  s_cbranch_scc0 L_R6_slow2
L_R6_fin:
  s_add_u32 s64, s64, 262144
  s_addc_u32 s65, s65, 0
  global_store_dwordx4 v1, v[20:23], s[64:65] sc1
  s_endpgm
.p2align 5
L_R6_pf:
  s_mov_b64 exec, vcc
  global_load_dwordx4 v[80:83], v1, s[50:51] sc1
  global_load_dwordx4 v[84:87], v1, s[50:51] offset:1024 sc1
  s_mov_b64 exec, -1
  s_waitcnt vmcnt(3)
  v_bitop3_b32 v16, v81, v83, s12 bitop3:0x7e
  v_mfma_f32_16x16x32_bf16 v[52:55], v[48:51], v[80:83], 0
  s_waitcnt vmcnt(2)
  v_bitop3_b32 v17, v85, v87, s12 bitop3:0x7e
  v_mfma_f32_16x16x32_bf16 v[52:55], v[48:51], v[84:87], v[52:55]
  v_bitop3_b32 v16, v16, v17, 1 bitop3:0xa8
  v_cmp_ne_u32 vcc, 0, v16
  s_nop 2
  s_cbranch_vccz L_R6_c1
L_R6_pf2:
  s_mov_b64 exec, vcc
  global_load_dwordx4 v[80:83], v1, s[50:51] sc1
  global_load_dwordx4 v[84:87], v1, s[50:51] offset:1024 sc1
  s_mov_b64 exec, -1
  s_waitcnt vmcnt(3)
  v_bitop3_b32 v16, v81, v83, s12 bitop3:0x7e
  v_mfma_f32_16x16x32_bf16 v[52:55], v[48:51], v[80:83], 0
  s_waitcnt vmcnt(2)
  v_bitop3_b32 v17, v85, v87, s12 bitop3:0x7e
  v_mfma_f32_16x16x32_bf16 v[52:55], v[48:51], v[84:87], v[52:55]
  v_bitop3_b32 v16, v16, v17, 1 bitop3:0xa8
  v_cmp_ne_u32 vcc, 0, v16
  s_nop 2
  s_cbranch_vccz L_R6_c1
  s_sub_u32 s7, s7, 1
  s_cbranch_scc0 L_R6_pf2
  s_mov_b32 s7, 0
  s_mov_b64 vcc, 0
  s_branch L_R6_c1
L_R6_of:
  s_nop 7
  ds_read_b128 v[48:51], v8 offset:5632
  ds_read_b128 v[52:55], v8 offset:4096
  ds_read_b128 v[76:79], v8 offset:4608
  s_waitcnt lgkmcnt(0)
  v_max_u32 v18, v49, v51
  v_max3_u32 v18, v18, v53, v55
  v_max3_u32 v18, v18, v77, v79
  v_cmp_eq_u32 vcc, -1, v18
  s_cbranch_vccz L_R6_og
  s_sub_u32 s7, s7, 1
  s_cbranch_scc0 L_R6_of
  s_mov_b32 s7, 0
  v_min_u32 v49, -2, v49
  v_min_u32 v51, -2, v51
  v_min_u32 v53, -2, v53
  v_min_u32 v55, -2, v55
  v_min_u32 v77, -2, v77
  v_min_u32 v79, -2, v79
L_R6_og:
  v_mfma_i32_16x16x4_4b_i8 v[32:47], v0, v0, 0
  s_nop 11
  v_smfmac_f32_16x16x64_bf16 v[32:35], v[72:75], a[208:215], v2
  v_smfmac_f32_16x16x64_bf16 v[36:39], v[72:75], a[240:247], v2
  v_smfmac_f32_16x16x64_bf16 v[40:43], v[72:75], v[24:31], v2
  v_smfmac_f32_16x16x64_bf16 v[44:47], v[72:75], v[88:95], v2
  s_branch L_R6_ok
L_R6_fw:
Lww_41:
  global_load_dword v19, v0, s[66:67] offset:0 sc1
  s_waitcnt vmcnt(0)
  v_cmp_gt_u32 vcc, 1, v19
  s_cbranch_vccz Lwd_42
  s_sub_u32 s7, s7, 1
  s_cbranch_scc0 Lww_41
  s_mov_b32 s7, 0
Lwd_42:
  s_branch L_R6_fok
.p2align 2
L_R6_slow2:
  s_nop 7
  s_nop 7
  ds_read_b128 v[32:35], v6 offset:0
  ds_read_b128 v[36:39], v6 offset:1024
  ds_read_b128 v[40:43], v8 offset:0
  ds_read_b128 v[44:47], v9 offset:0
  s_waitcnt lgkmcnt(0)
  v_mfma_f32_16x16x32_bf16 v[56:59], v[32:35], v[40:43], 0
  v_mfma_f32_16x16x32_bf16 v[60:63], v[36:39], v[40:43], 0
  v_mfma_f32_16x16x32_bf16 v[120:123], v[44:47], v[40:43], 0
  s_nop 7
  ds_read_b128 v[32:35], v6 offset:2048
  ds_read_b128 v[36:39], v6 offset:3072
  ds_read_b128 v[40:43], v8 offset:1024
  ds_read_b128 v[44:47], v9 offset:1024
  s_waitcnt lgkmcnt(0)
  v_mfma_f32_16x16x32_bf16 v[56:59], v[32:35], v[40:43], v[56:59]
  v_mfma_f32_16x16x32_bf16 v[60:63], v[36:39], v[40:43], v[60:63]
  v_mfma_f32_16x16x32_bf16 v[120:123], v[44:47], v[40:43], v[120:123]
  s_nop 7
  ds_read_b128 v[32:35], v6 offset:4096
  ds_read_b128 v[36:39], v6 offset:5120
  ds_read_b128 v[40:43], v8 offset:2048
  ds_read_b128 v[44:47], v9 offset:2048
  s_waitcnt lgkmcnt(0)
  v_mfma_f32_16x16x32_bf16 v[56:59], v[32:35], v[40:43], v[56:59]
  v_mfma_f32_16x16x32_bf16 v[60:63], v[36:39], v[40:43], v[60:63]
  v_mfma_f32_16x16x32_bf16 v[120:123], v[44:47], v[40:43], v[120:123]
  s_nop 7
  ds_read_b128 v[32:35], v6 offset:6144
  ds_read_b128 v[36:39], v6 offset:7168
  ds_read_b128 v[40:43], v8 offset:3072
  ds_read_b128 v[44:47], v9 offset:3072
  s_waitcnt lgkmcnt(0)
  v_mfma_f32_16x16x32_bf16 v[56:59], v[32:35], v[40:43], v[56:59]
  v_mfma_f32_16x16x32_bf16 v[60:63], v[36:39], v[40:43], v[60:63]
  v_mfma_f32_16x16x32_bf16 v[120:123], v[44:47], v[40:43], v[120:123]
  s_nop 7
  v_mfma_i32_16x16x4_4b_i8 v[32:47], v0, v0, 0
  v_max3_f32 v16, v56, v57, v58
  v_max3_f32 v17, v59, v60, v61
  v_max3_f32 v16, v16, v62, v63
  v_max3_f32 v17, v17, v120, v121
  v_max_f32 v18, v16, v17
  v_max_f32 v19, v16, v17
  s_nop 1
  v_permlane32_swap_b32 v18, v19
  v_max_f32 v16, v18, v19
  v_max_f32 v17, v18, v19
  s_nop 1
  v_permlane16_swap_b32 v16, v17
  v_max_f32 v16, v16, v17
  v_mul_f32 v13, 0xbe0293ee, v16
  v_fma_f32 v56, v56, s52, v13
  v_fma_f32 v57, v57, s52, v13
  v_exp_f32 v56, v56
  v_fma_f32 v58, v58, s52, v13
  v_exp_f32 v57, v57
  v_fma_f32 v59, v59, s52, v13
  v_exp_f32 v58, v58
  v_cvt_pk_bf16_f32 v56, v56, v57
  v_exp_f32 v59, v59
  v_fma_f32 v60, v60, s52, v13
  v_cvt_pk_bf16_f32 v57, v58, v59
  v_fma_f32 v61, v61, s52, v13
  v_exp_f32 v60, v60
  v_fma_f32 v62, v62, s52, v13
  v_exp_f32 v61, v61
  v_fma_f32 v63, v63, s52, v13
  v_exp_f32 v62, v62
  v_exp_f32 v63, v63
  v_cvt_pk_bf16_f32 v58, v60, v61
  v_cvt_pk_bf16_f32 v59, v62, v63
  v_fma_f32 v120, v120, s52, v13
  v_fma_f32 v121, v121, s52, v13
  v_exp_f32 v18, v120
  v_exp_f32 v19, v121
  v_mfma_f32_16x16x32_bf16 v[104:107], v[124:127], v[56:59], 0
  v_mfma_f32_16x16x32_bf16 v[96:99], v[80:83], v[56:59], 0
  v_mfma_f32_16x16x32_bf16 v[100:103], v[84:87], v[56:59], 0
  v_cvt_pk_bf16_f32 v14, v18, v19
  v_lshlrev_b64 v[16:17], v12, v[14:15]
  s_nop 1
  v_mfma_f32_16x16x16_bf16 v[108:111], v[124:125], v[16:17], v[104:107]
  s_nop 2
  v_cndmask_b32 v96, v96, v100, s[70:71]
  v_cndmask_b32 v97, v97, v101, s[70:71]
  v_cndmask_b32 v98, v98, v102, s[70:71]
  v_cndmask_b32 v99, v99, v103, s[70:71]
  s_nop 1
  v_mfma_f32_16x16x16_bf16 v[60:63], v[22:23], v[16:17], v[96:99]
  v_rcp_f32 v18, v108
  s_nop 7
  s_barrier
  s_branch L_R6_sy
.p2align 7
L_R7:
  ds_read_b128 v[88:91], v1 offset:61440
  ds_read_b128 v[92:95], v1 offset:62464
  ds_read_b128 v[96:99], v5 offset:61440
  ds_read_b128 v[100:103], v5 offset:62464
  ds_read_b128 v[104:107], v1 offset:12288
  ds_read_b128 v[108:111], v1 offset:13312
  ds_read_b128 v[112:115], v1 offset:28672
  ds_read_b128 v[116:119], v1 offset:29696
  ds_read_b128 v[120:123], v1 offset:45056
  ds_read_b128 v[124:127], v1 offset:46080
  v_mov_b32 v19, -1
  v_lshlrev_b32 v10, 3, v1
  global_load_dwordx4 v[80:83], v1, s[62:63]
  global_load_dwordx4 v[84:87], v1, s[62:63] offset:1024
  s_waitcnt vmcnt(2) lgkmcnt(0)
  s_branch L_R7_p2
.p2align 5
L_R7_fe:
  s_mov_b64 exec, vcc
  global_load_dwordx4 v[24:27], v1, s[54:55] offset:-2048 sc1
  s_mov_b64 exec, -1
  v_mov_b32 v19, -1
  v_mov_b32 v19, -1
  v_mov_b32 v19, -1
  v_mov_b32 v19, -1
  v_mfma_f32_16x16x1_4b_f32 v[56:71], v0, v0, 0
  s_waitcnt vmcnt(4)
  v_max3_u32 v16, v24, v25, v26
  v_max_u32 v16, v16, v27
  v_cmp_eq_u32 vcc, -1, v16
  s_cbranch_vccz L_R7_p2a
  s_mov_b64 exec, vcc
  global_load_dwordx4 v[24:27], v1, s[54:55] offset:-2048 sc1
  s_mov_b64 exec, -1
  s_waitcnt vmcnt(3)
  v_max3_u32 v16, v24, v25, v26
  v_max_u32 v16, v16, v27
  v_cmp_eq_u32 vcc, -1, v16
  s_cbranch_vccz L_R7_p2a
  s_mov_b64 exec, vcc
  global_load_dwordx4 v[24:27], v1, s[54:55] offset:-2048 sc1
  s_mov_b64 exec, -1
  s_waitcnt vmcnt(2)
  v_max3_u32 v16, v24, v25, v26
  v_max_u32 v16, v16, v27
  v_cmp_eq_u32 vcc, -1, v16
  s_cbranch_vccz L_R7_p2a
L_R7_fe2:
  s_mov_b64 exec, vcc
  global_load_dwordx4 v[24:27], v1, s[54:55] offset:-2048 sc1
  s_mov_b64 exec, -1
  s_waitcnt vmcnt(2)
  v_max3_u32 v16, v24, v25, v26
  v_max_u32 v16, v16, v27
  v_cmp_eq_u32 vcc, -1, v16
  s_cbranch_vccz L_R7_p2a
  s_sub_u32 s7, s7, 1
  s_cbranch_scc0 L_R7_fe2
  s_mov_b32 s7, 0
  v_mov_b32 v16, 0
  s_branch L_R7_p2a
.p2align 5
L_R7_fl:
  s_mov_b64 exec, vcc
  global_load_dwordx4 v[28:31], v1, s[54:55] offset:2048 sc1
  s_mov_b64 exec, -1
  s_waitcnt vmcnt(2)
  v_max3_u32 v16, v28, v29, v30
  v_max_u32 v16, v16, v31
  v_cmp_eq_u32 vcc, -1, v16
  ds_write_b128 v6, v[28:31] offset:23552
  s_cbranch_vccz L_R7_cl
L_R7_fl2:
  s_mov_b64 exec, vcc
  global_load_dwordx4 v[28:31], v1, s[54:55] offset:2048 sc1
  s_mov_b64 exec, -1
  s_waitcnt vmcnt(2)
  v_max3_u32 v16, v28, v29, v30
  v_max_u32 v16, v16, v31
  v_cmp_eq_u32 vcc, -1, v16
  ds_write_b128 v6, v[28:31] offset:23552
  s_cbranch_vccz L_R7_cl
  s_sub_u32 s7, s7, 1
  s_cbranch_scc0 L_R7_fl2
  s_mov_b32 s7, 0
  s_branch L_R7_cl
.p2align 6
L_R7_p2:
  s_waitcnt vmcnt(4)
  v_max3_u32 v16, v24, v25, v26
  v_max_u32 v16, v16, v27
L_R7_p2a:
  v_smfmac_f32_16x16x64_bf16 v[56:59], v[24:27], v[88:95], v2
  ds_write_b128 v6, v[24:27] offset:19456
  v_cmp_eq_u32 vcc, -1, v16
  v_smfmac_f32_16x16x64_bf16 v[60:63], v[24:27], a[152:159], v2
  v_smfmac_f32_16x16x64_bf16 v[64:67], v[24:27], a[48:55], v2
  s_cbranch_vccnz L_R7_fe
  v_smfmac_f32_16x16x64_bf16 v[68:71], v[24:27], a[56:63], v2
  global_load_dwordx4 v[28:31], v1, s[54:55] offset:2048 sc1
  ds_read_b128 v[88:91], v5 offset:12288
  v_smfmac_f32_16x16x64_bf16 v[72:75], v[24:27], v[176:183], v2
  s_waitcnt lgkmcnt(1)
  s_barrier
  s_waitcnt vmcnt(3)
  v_max3_u32 v16, v28, v29, v30
  v_max_u32 v16, v16, v31
  v_cmp_eq_u32 vcc, -1, v16
  v_smfmac_f32_16x16x64_bf16 v[76:79], v[24:27], v[184:191], v2
  ds_write_b128 v6, v[28:31] offset:23552
  s_cbranch_vccnz L_R7_fl
L_R7_cl:
  v_smfmac_f32_16x16x64_bf16 v[56:59], v[28:31], v[96:103], v2
  ds_read_b128 v[32:35], v6 offset:16384
  global_load_dwordx4 v[80:83], v1, s[62:63]
  v_smfmac_f32_16x16x64_bf16 v[60:63], v[28:31], a[184:191], v2
  ds_read_b128 v[36:39], v6 offset:17408
  global_load_dwordx4 v[84:87], v1, s[62:63] offset:1024
  v_smfmac_f32_16x16x64_bf16 v[64:67], v[28:31], a[112:119], v2
  s_waitcnt lgkmcnt(2)
  s_barrier
  ds_read_b128 v[40:43], v6 offset:18432
  v_smfmac_f32_16x16x64_bf16 v[68:71], v[28:31], a[120:127], v2
  ds_read_b128 v[44:47], v6 offset:20480
  v_smfmac_f32_16x16x64_bf16 v[72:75], v[28:31], v[240:247], v2
  ds_read_b128 v[48:51], v6 offset:21504
  v_smfmac_f32_16x16x64_bf16 v[76:79], v[28:31], v[248:255], v2
  ds_read_b128 v[52:55], v6 offset:22528
  s_waitcnt lgkmcnt(5)
  v_smfmac_f32_16x16x64_bf16 v[56:59], v[32:35], v[104:111], v2
  ds_read_b128 v[92:95], v5 offset:13312
  v_smfmac_f32_16x16x64_bf16 v[60:63], v[32:35], a[128:135], v2
  ds_read_b128 v[96:99], v5 offset:28672
  s_waitcnt lgkmcnt(6)
  v_smfmac_f32_16x16x64_bf16 v[56:59], v[36:39], v[112:119], v2
  ds_read_b128 v[100:103], v5 offset:29696
  v_smfmac_f32_16x16x64_bf16 v[60:63], v[36:39], a[136:143], v2
  ds_read_b128 v[104:107], v5 offset:45056
  s_waitcnt lgkmcnt(7)
  v_smfmac_f32_16x16x64_bf16 v[56:59], v[40:43], v[120:127], v2
  ds_read_b128 v[108:111], v5 offset:46080
  v_smfmac_f32_16x16x64_bf16 v[60:63], v[40:43], a[144:151], v2
  global_store_dwordx4 v1, v[20:23], s[64:65] sc1
  ds_read_b128 v[112:115], v6 offset:0
  s_waitcnt lgkmcnt(5)
  v_smfmac_f32_16x16x64_bf16 v[56:59], v[44:47], v[88:95], v2
  ds_read_b128 v[116:119], v6 offset:2048
  v_smfmac_f32_16x16x64_bf16 v[60:63], v[44:47], a[160:167], v2
  ds_read_b128 v[120:123], v6 offset:4096
  s_waitcnt lgkmcnt(5)
  v_smfmac_f32_16x16x64_bf16 v[56:59], v[48:51], v[96:103], v2
  global_load_dword v10, v0, s[66:67] sc1
  ds_read_b128 v[124:127], v6 offset:6144
  v_smfmac_f32_16x16x64_bf16 v[60:63], v[48:51], a[168:175], v2
  ds_write_b32 v11, v19 offset:5636
  s_waitcnt lgkmcnt(5)
  v_smfmac_f32_16x16x64_bf16 v[56:59], v[52:55], v[104:111], v2
  v_smfmac_f32_16x16x64_bf16 v[60:63], v[52:55], a[176:183], v2
  s_waitcnt vmcnt(4)
  ds_read_b128 v[24:27], v6 offset:1024
  v_smfmac_f32_16x16x64_bf16 v[64:67], v[32:35], a[0:7], v2
  ds_read_b128 v[28:31], v6 offset:3072
  v_add_f32 v56, v56, v57
  v_add_f32 v58, v58, v59
  v_smfmac_f32_16x16x64_bf16 v[68:71], v[32:35], a[8:15], v2
  v_add_f32 v60, v60, v61
  v_add_f32 v62, v62, v63
  v_smfmac_f32_16x16x64_bf16 v[64:67], v[36:39], a[16:23], v2
  v_cvt_pk_bf16_f32 v16, v56, v60
  v_cvt_pk_bf16_f32 v17, v58, v62
  v_smfmac_f32_16x16x64_bf16 v[68:71], v[36:39], a[24:31], v2
  ds_write2_b32 v7, v16, v17 offset0:0 offset1:16
  v_smfmac_f32_16x16x64_bf16 v[64:67], v[40:43], a[32:39], v2
  v_smfmac_f32_16x16x64_bf16 v[68:71], v[40:43], a[40:47], v2
  v_smfmac_f32_16x16x64_bf16 v[64:67], v[44:47], a[64:71], v2
  v_smfmac_f32_16x16x64_bf16 v[68:71], v[44:47], a[72:79], v2
  s_waitcnt lgkmcnt(0)
  s_barrier
  v_smfmac_f32_16x16x64_bf16 v[64:67], v[48:51], a[80:87], v2
  ds_read_b128 v[96:99], v8 offset:0
  v_smfmac_f32_16x16x64_bf16 v[68:71], v[48:51], a[88:95], v2
  ds_read_b128 v[100:103], v8 offset:1024
  v_smfmac_f32_16x16x64_bf16 v[64:67], v[52:55], a[96:103], v2
  ds_read_b128 v[104:107], v8 offset:2048
  v_smfmac_f32_16x16x64_bf16 v[68:71], v[52:55], a[104:111], v2
  ds_read_b128 v[108:111], v8 offset:3072
  v_smfmac_f32_16x16x64_bf16 v[72:75], v[32:35], v[128:135], v2
  ds_read_b128 v[88:91], v6 offset:5120
  v_add_f32 v64, v64, v65
  v_smfmac_f32_16x16x64_bf16 v[76:79], v[32:35], v[136:143], v2
  ds_read_b128 v[92:95], v6 offset:7168
  v_add_f32 v66, v66, v67
  s_waitcnt lgkmcnt(5)
  v_mfma_f32_16x16x32_bf16 v[56:59], v[112:115], v[96:99], 0
  v_add_f32 v68, v68, v69
  v_add_f32 v70, v70, v71
  s_waitcnt lgkmcnt(4)
  v_mfma_f32_16x16x32_bf16 v[56:59], v[116:119], v[100:103], v[56:59]
  v_cvt_pk_bf16_f32 v20, v64, v68
  v_cvt_pk_bf16_f32 v21, v66, v70
  s_waitcnt lgkmcnt(3)
  v_mfma_f32_16x16x32_bf16 v[56:59], v[120:123], v[104:107], v[56:59]
  ds_write2_b32 v7, v20, v21 offset0:128 offset1:144
  s_waitcnt lgkmcnt(3)
  v_mfma_f32_16x16x32_bf16 v[56:59], v[124:127], v[108:111], v[56:59]
  ds_read_b128 v[124:127], v6 offset:31744
  v_mfma_f32_16x16x32_bf16 v[60:63], v[24:27], v[96:99], 0
  v_mfma_f32_16x16x32_bf16 v[60:63], v[28:31], v[100:103], v[60:63]
  s_waitcnt lgkmcnt(3)
  v_max3_f32 v16, v56, v57, v58
  v_max_f32 v18, v16, v59
  v_max_f32 v19, v16, v59
  v_mfma_f32_16x16x32_bf16 v[60:63], v[88:91], v[104:107], v[60:63]
  s_waitcnt lgkmcnt(1)
  s_barrier
  v_permlane32_swap_b32 v18, v19
  v_max_f32 v16, v18, v19
  v_max_f32 v17, v18, v19
  v_mfma_f32_16x16x32_bf16 v[60:63], v[92:95], v[108:111], v[60:63]
  ds_read_b128 v[64:67], v9 offset:0
  v_permlane16_swap_b32 v16, v17
  v_max_f32 v16, v16, v17
  v_mul_f32 v13, 0xbe0293ee, v16
  v_smfmac_f32_16x16x64_bf16 v[72:75], v[36:39], v[144:151], v2
  ds_read_b128 v[68:71], v9 offset:1024
  v_fma_f32 v56, v56, s52, v13
  v_fma_f32 v57, v57, s52, v13
  v_smfmac_f32_16x16x64_bf16 v[76:79], v[36:39], v[152:159], v2
  ds_read_b128 v[112:115], v9 offset:2048
  v_exp_f32 v56, v56
  v_smfmac_f32_16x16x64_bf16 v[72:75], v[40:43], v[160:167], v2
  ds_read_b128 v[116:119], v9 offset:3072
  v_fma_f32 v58, v58, s52, v13
  v_exp_f32 v57, v57
  v_smfmac_f32_16x16x64_bf16 v[76:79], v[40:43], v[168:175], v2
  ds_read_b128 v[24:27], v1 offset:63488
  s_waitcnt lgkmcnt(4)
  v_fma_f32 v59, v59, s52, v13
  v_mfma_f32_16x16x32_bf16 v[120:123], v[64:67], v[96:99], 0
  v_exp_f32 v58, v58
  v_cvt_pk_bf16_f32 v56, v56, v57
  s_waitcnt lgkmcnt(3)
  v_mfma_f32_16x16x32_bf16 v[120:123], v[68:71], v[100:103], v[120:123]
  v_exp_f32 v59, v59
  v_fma_f32 v60, v60, s52, v13
  s_waitcnt lgkmcnt(2)
  v_mfma_f32_16x16x32_bf16 v[120:123], v[112:115], v[104:107], v[120:123]
  s_waitcnt lgkmcnt(1)
  v_cvt_pk_bf16_f32 v57, v58, v59
  v_fma_f32 v61, v61, s52, v13
  v_exp_f32 v60, v60
  v_mfma_f32_16x16x32_bf16 v[120:123], v[116:119], v[108:111], v[120:123]
  v_fma_f32 v62, v62, s52, v13
  v_exp_f32 v61, v61
  v_smfmac_f32_16x16x64_bf16 v[72:75], v[44:47], v[192:199], v2
  ds_read_b128 v[28:31], v1 offset:64512
  v_fma_f32 v63, v63, s52, v13
  v_smfmac_f32_16x16x64_bf16 v[76:79], v[44:47], v[200:207], v2
  ds_read_b128 v[88:91], v5 offset:63488
  v_exp_f32 v62, v62
  v_smfmac_f32_16x16x64_bf16 v[72:75], v[48:51], v[208:215], v2
  ds_read_b128 v[92:95], v5 offset:64512
  v_exp_f32 v63, v63
  v_smfmac_f32_16x16x64_bf16 v[76:79], v[48:51], v[216:223], v2
  ds_read_b128 v[112:115], v1 offset:14336
  v_cvt_pk_bf16_f32 v58, v60, v61
  v_cvt_pk_bf16_f32 v59, v62, v63
  s_nop 1
  v_mfma_f32_16x16x32_bf16 v[104:107], v[124:127], v[56:59], 0
  s_waitcnt vmcnt(2)
  v_fma_f32 v120, v120, s52, v13
  v_fma_f32 v121, v121, s52, v13
  v_mfma_f32_16x16x32_bf16 v[96:99], v[80:83], v[56:59], 0
  v_exp_f32 v18, v120
  v_mfma_f32_16x16x32_bf16 v[100:103], v[84:87], v[56:59], 0
  v_exp_f32 v19, v121
  v_smfmac_f32_16x16x64_bf16 v[72:75], v[52:55], v[224:231], v2
  ds_read_b128 v[116:119], v1 offset:15360
  v_cvt_pk_bf16_f32 v14, v18, v19
  v_lshlrev_b64 v[16:17], v12, v[14:15]
  v_smfmac_f32_16x16x64_bf16 v[76:79], v[52:55], v[232:239], v2
  v_cndmask_b32 v96, v96, v100, s[70:71]
  v_mfma_f32_16x16x16_bf16 v[108:111], v[124:125], v[16:17], v[104:107]
  v_cndmask_b32 v97, v97, v101, s[70:71]
  v_cndmask_b32 v98, v98, v102, s[70:71]
  v_cndmask_b32 v99, v99, v103, s[70:71]
  v_add_f32 v72, v72, v73
  v_add_f32 v74, v74, v75
  v_add_f32 v76, v76, v77
  v_add_f32 v78, v78, v79
  v_cvt_pk_bf16_f32 v22, v72, v74
  v_cvt_pk_bf16_f32 v23, v76, v78
  s_cmp_eq_u32 s44, 63
  v_mov_b32_e64 v19, -1
  v_mfma_f32_16x16x16_bf16 v[60:63], v[22:23], v[16:17], v[96:99]
  v_cmp_nge_f32_e64 vcc, s53, v108
  v_rcp_f32_e64 v18, v108
  v_mov_b32_e64 v19, -1
  v_mov_b32_e64 v19, -1
  v_mov_b32_e64 v19, -1
  v_mfma_i32_16x16x4_4b_i8 v[32:47], v0, v0, 0
  v_mov_b32_e64 v19, -1
  s_cbranch_vccnz L_R7_slow
L_R7_sy:
  v_mul_f32 v60, v60, v18
  v_mul_f32 v61, v61, v18
  v_cvt_pk_bf16_f32 v16, v60, v61
  v_mul_f32 v62, v62, v18
  v_mul_f32 v63, v63, v18
  v_cvt_pk_bf16_f32 v17, v62, v63
  ds_write_b64 v11, v[16:17] offset:5632
  v_mov_b32_dpp v72, v16 quad_perm:[0,0,2,2] row_mask:0xf bank_mask:0xf
  v_mov_b32_dpp v74, v16 quad_perm:[1,1,3,3] row_mask:0xf bank_mask:0xf
  v_mov_b32_dpp v73, v17 quad_perm:[0,0,2,2] row_mask:0xf bank_mask:0xf
  v_mov_b32_dpp v75, v17 quad_perm:[1,1,3,3] row_mask:0xf bank_mask:0xf
  ds_read_b128 v[48:51], v8 offset:4096
  s_nop 0
  v_smfmac_f32_16x16x64_bf16 v[32:35], v[72:75], a[216:223], v2
  ds_read_b128 v[52:55], v8 offset:4608
  v_smfmac_f32_16x16x64_bf16 v[36:39], v[72:75], a[248:255], v2
  ds_read_b128 v[76:79], v8 offset:5120
  global_load_lds_dwordx4 v1, s[60:61]
  s_waitcnt lgkmcnt(4)
  v_smfmac_f32_16x16x64_bf16 v[40:43], v[72:75], v[24:31], v2
  global_load_lds_dwordx4 v1, s[60:61] offset:1024
  ds_read_b128 v[64:67], v1 offset:30720
  v_smfmac_f32_16x16x64_bf16 v[44:47], v[72:75], v[88:95], v2
  ds_read_b128 v[68:71], v1 offset:31744
L_R7_ok:
  s_waitcnt lgkmcnt(4)
  v_smfmac_f32_16x16x64_bf16 v[32:35], v[48:51], a[192:199], v2
  ds_read_b128 v[120:123], v1 offset:47104
  v_max_u32 v18, v49, v51
  s_waitcnt lgkmcnt(4)
  v_smfmac_f32_16x16x64_bf16 v[32:35], v[52:55], a[200:207], v2
  ds_read_b128 v[124:127], v1 offset:48128
  v_max3_u32 v18, v18, v53, v55
  s_waitcnt lgkmcnt(4)
  v_smfmac_f32_16x16x64_bf16 v[32:35], v[76:79], a[208:215], v2
  ds_read_b128 v[96:99], v5 offset:14336
  v_max3_u32 v18, v18, v77, v79
  v_smfmac_f32_16x16x64_bf16 v[36:39], v[48:51], a[224:231], v2
  ds_read_b128 v[100:103], v5 offset:15360
  v_smfmac_f32_16x16x64_bf16 v[36:39], v[52:55], a[232:239], v2
  ds_read_b128 v[104:107], v5 offset:30720
  v_cmp_eq_u32 vcc, -1, v18
  v_cvt_pk_bf16_f32 v33, v33, v35
  v_cvt_pk_bf16_f32 v32, v32, v34
  v_and_or_b32 v33, v33, -2, s12
  v_smfmac_f32_16x16x64_bf16 v[36:39], v[76:79], a[240:247], v2
  s_cbranch_vccnz L_R7_of
  global_store_dwordx2 v3, v[32:33], s[46:47] offset:0 sc1
  ds_read_b128 v[108:111], v5 offset:31744
  v_smfmac_f32_16x16x64_bf16 v[40:43], v[48:51], v[112:119], v2
  ds_read_b128 v[56:59], v5 offset:47104
  s_waitcnt lgkmcnt(7)
  v_smfmac_f32_16x16x64_bf16 v[40:43], v[52:55], v[64:71], v2
  ds_read_b128 v[60:63], v5 offset:48128
  s_waitcnt lgkmcnt(6)
  v_cvt_pk_bf16_f32 v37, v37, v39
  v_cvt_pk_bf16_f32 v36, v36, v38
  v_and_or_b32 v37, v37, -2, s12
  v_smfmac_f32_16x16x64_bf16 v[40:43], v[76:79], v[120:127], v2
  global_store_dwordx2 v3, v[36:37], s[46:47] offset:2048 sc1
  s_waitcnt lgkmcnt(4)
  v_smfmac_f32_16x16x64_bf16 v[44:47], v[48:51], v[96:103], v2
  s_waitcnt lgkmcnt(2)
  v_smfmac_f32_16x16x64_bf16 v[44:47], v[52:55], v[104:111], v2
  ds_read_b128 v[48:51], v6 offset:30720
  v_cvt_pk_bf16_f32 v41, v41, v43
  v_cvt_pk_bf16_f32 v40, v40, v42
  v_and_or_b32 v41, v41, -2, s12
  s_waitcnt lgkmcnt(1)
  v_smfmac_f32_16x16x64_bf16 v[44:47], v[76:79], v[56:63], v2
  global_store_dwordx2 v3, v[40:41], s[48:49] offset:0 sc1
  v_mov_b32 v72, 0
  v_mov_b32 v73, 0
  v_mov_b32 v74, 0
  v_mov_b32 v75, 0
  s_nop 2
  v_cvt_pk_bf16_f32 v45, v45, v47
  v_cvt_pk_bf16_f32 v44, v44, v46
  v_and_or_b32 v45, v45, -2, s12
  global_store_dwordx2 v3, v[44:45], s[48:49] offset:2048 sc1
  s_add_u32 s54, s54, 0x2000
  s_bitset0_b32 s54, 15
  v_mov_b32 v76, 0
  ds_read_b128 v[88:91], v1 offset:61440
  v_mov_b32 v77, 0
  ds_read_b128 v[92:95], v1 offset:62464
  v_mov_b32 v78, 0
  ds_read_b128 v[96:99], v5 offset:61440
  v_mov_b32 v79, 0
  ds_read_b128 v[100:103], v5 offset:62464
  v_mov_b32 v19, -1
  ds_read_b128 v[104:107], v1 offset:12288
  v_mov_b32 v19, -1
  ds_read_b128 v[108:111], v1 offset:13312
  v_mov_b32 v19, -1
  ds_read_b128 v[112:115], v1 offset:28672
  v_mov_b32 v19, -1
  ds_read_b128 v[116:119], v1 offset:29696
  v_mov_b32 v19, -1
  ds_read_b128 v[120:123], v1 offset:45056
  v_mov_b32 v19, -1
  ds_read_b128 v[124:127], v1 offset:46080
  v_mov_b32 v19, -1
  s_add_u32 s60, s60, 262144
  s_addc_u32 s61, s61, 0
  v_mov_b32 v19, -1
  s_add_u32 s68, s68, 262144
  s_addc_u32 s69, s69, 0
  v_mov_b32 v19, -1
  s_add_u32 s62, s62, 262144
  s_addc_u32 s63, s63, 0
  v_mov_b32 v19, -1
  s_add_u32 s64, s64, 262144
  s_addc_u32 s65, s65, 0
  v_mov_b32 v19, -1
  v_mov_b32 v19, -1
  v_mov_b32 v19, -1
  v_mov_b32 v19, -1
  v_mov_b32 v19, -1
  v_mov_b32 v19, -1
  v_mov_b32 v19, -1
  v_mov_b32 v19, -1
  v_mov_b32 v19, -1
  v_mov_b32 v19, -1
  v_mov_b32 v19, -1
  v_mov_b32 v19, -1
  v_mov_b32 v19, -1
  v_mov_b32 v19, -1
  global_load_dwordx4 v[80:83], v1, s[50:51] sc1
  global_load_dwordx4 v[84:87], v1, s[50:51] offset:1024 sc1
  v_mov_b32 v19, -1
  v_mov_b32 v19, -1
  v_mov_b32 v19, -1
  v_mov_b32 v19, -1
  v_mov_b32 v19, -1
  v_mov_b32 v19, -1
  v_mov_b32 v19, -1
  v_mov_b32 v19, -1
  v_mov_b32 v19, -1
  v_mov_b32 v19, -1
  v_mov_b32 v19, -1
  v_mov_b32 v19, -1
  v_mov_b32 v19, -1
  v_mov_b32 v19, -1
  v_mov_b32 v19, -1
  v_mov_b32 v19, -1
  v_mov_b32 v19, -1
  v_mov_b32 v19, -1
  v_mov_b32 v19, -1
  v_mov_b32 v19, -1
  v_mov_b32 v19, -1
  v_mov_b32 v19, -1
  v_mov_b32 v19, -1
  v_mov_b32 v19, -1
  v_mov_b32 v19, -1
  v_mov_b32 v19, -1
  v_mov_b32 v19, -1
  v_mov_b32 v19, -1
  v_mov_b32 v19, -1
  v_mov_b32 v19, -1
  v_mov_b32 v19, -1
  v_mov_b32 v19, -1
  v_mov_b32 v19, -1
  v_mov_b32 v19, -1
  v_mov_b32 v19, -1
  global_load_dwordx4 v[80:83], v1, s[50:51] sc1
  global_load_dwordx4 v[84:87], v1, s[50:51] offset:1024 sc1
  v_mov_b32 v19, -1
  v_mov_b32 v19, -1
  v_mov_b32 v19, -1
  v_mov_b32 v19, -1
  v_mov_b32 v19, -1
  v_mov_b32 v19, -1
  s_waitcnt lgkmcnt(10)
  v_mfma_f32_16x16x1_4b_f32 v[56:71], v0, v0, 0
  s_waitcnt vmcnt(3)
  v_bitop3_b32 v16, v81, v83, s12 bitop3:0x7e
  v_mfma_f32_16x16x32_bf16 v[52:55], v[48:51], v[80:83], 0
  s_waitcnt vmcnt(2)
  v_bitop3_b32 v17, v85, v87, s12 bitop3:0x7e
  v_mfma_f32_16x16x32_bf16 v[52:55], v[48:51], v[84:87], v[52:55]
  v_bitop3_b32 v16, v16, v17, 1 bitop3:0xa8
  v_cmp_ne_u32 vcc, 0, v16
  v_readfirstlane_b32 s79, v10
  v_mov_b32_e64 v19, -1
  v_mov_b32_e64 v19, -1
  v_mov_b32_e64 v19, -1
  v_mov_b32_e64 v19, -1
  v_mov_b32_e64 v19, -1
L_R7_c1:
  v_add_f32_dpp v52, v52, v52 row_ror:4 row_mask:0xf bank_mask:0xf
  v_add_f32_dpp v53, v53, v53 row_ror:4 row_mask:0xf bank_mask:0xf
  s_cbranch_vccnz L_R7_pf
  v_add_f32_dpp v52, v52, v52 row_ror:8 row_mask:0xf bank_mask:0xf
  v_add_f32_dpp v53, v53, v53 row_ror:8 row_mask:0xf bank_mask:0xf
  v_cvt_pk_bf16_f32 v16, v52, v53
  global_store_dword v4, v16, s[56:57] sc1
  s_cmp_eq_u32 s79, 0
  s_cbranch_scc1 L_R7_fw
L_R7_fok:
  v_mov_b32 v19, -1
  global_store_dword v4, v19, s[58:59] sc1
  s_add_u32 s58, s58, 0x2000
  s_bitset0_b32 s58, 15
  v_mov_b32 v19, -1
  s_cmp_lt_u32 s44, 61
  s_cselect_b32 s74, 2048, 0
  v_mov_b32 v19, -1
  s_add_u32 s66, s66, s74
  s_addc_u32 s67, s67, 0
  v_mov_b32 v19, -1
  s_add_u32 s56, s56, 0x2000
  s_bitset0_b32 s56, 15
  v_mov_b32 v19, -1
  s_xor_b32 s12, s12, 1
  s_add_u32 s44, s44, 1
  v_lshlrev_b32 v10, 3, v1
  s_cmp_eq_u32 s44, 63
  s_cselect_b32 s53, -1, s53
  v_mov_b32 v19, -1
  v_mov_b32 v19, -1
  v_mov_b32 v19, -1
  global_load_dwordx4 v[24:27], v1, s[54:55] offset:-2048 sc1
  v_mov_b32 v19, -1
  v_mov_b32 v19, -1
  v_mov_b32 v19, -1
  v_mov_b32 v19, -1
  v_mov_b32 v19, -1
  v_mov_b32 v19, -1
  v_mov_b32 v19, -1
  v_mov_b32 v19, -1
  v_mov_b32 v19, -1
  v_mov_b32 v19, -1
  v_mov_b32 v19, -1
  v_mov_b32 v19, -1
  global_load_dwordx4 v[24:27], v1, s[54:55] offset:-2048 sc1
  v_mov_b32 v19, -1
  v_mov_b32 v19, -1
  v_mov_b32 v19, -1
  v_mov_b32 v19, -1
  v_mov_b32 v19, -1
  v_mov_b32 v19, -1
  global_load_dwordx4 v[28:31], v1, s[54:55] offset:2048 sc1
  v_mov_b32 v19, -1
  v_mov_b32 v19, -1
  v_mov_b32 v19, -1
  v_mov_b32 v19, -1
  v_mov_b32 v19, -1
  v_mov_b32 v19, -1
  v_mov_b32 v19, -1
  v_mov_b32 v19, -1
  v_mov_b32 v19, -1
  v_mov_b32 v19, -1
  v_mov_b32 v19, -1
  v_mov_b32 v19, -1
  global_load_dwordx4 v[24:27], v1, s[54:55] offset:-2048 sc1
  v_mov_b32_e64 v19, -1
  v_mov_b32_e64 v19, -1
  v_mov_b32_e64 v19, -1
  v_mov_b32_e64 v19, -1
  v_mov_b32_e64 v19, -1
  v_mov_b32_e64 v19, -1
  global_load_dwordx4 v[28:31], v1, s[54:55] offset:2048 sc1
  v_mov_b32_e64 v19, -1
  v_mov_b32_e64 v19, -1
  s_waitcnt lgkmcnt(0)
  v_mfma_f32_16x16x1_4b_f32 v[56:71], v0, v0, 0
  s_branch L_R7_p2
L_R7_slow:
  s_cbranch_scc0 L_R7_slow2
L_R7_fin:
  s_add_u32 s64, s64, 262144
  s_addc_u32 s65, s65, 0
  global_store_dwordx4 v1, v[20:23], s[64:65] sc1
  s_endpgm
.p2align 5
L_R7_pf:
  s_mov_b64 exec, vcc
  global_load_dwordx4 v[80:83], v1, s[50:51] sc1
  global_load_dwordx4 v[84:87], v1, s[50:51] offset:1024 sc1
  s_mov_b64 exec, -1
  s_waitcnt vmcnt(3)
  v_bitop3_b32 v16, v81, v83, s12 bitop3:0x7e
  v_mfma_f32_16x16x32_bf16 v[52:55], v[48:51], v[80:83], 0
  s_waitcnt vmcnt(2)
  v_bitop3_b32 v17, v85, v87, s12 bitop3:0x7e
  v_mfma_f32_16x16x32_bf16 v[52:55], v[48:51], v[84:87], v[52:55]
  v_bitop3_b32 v16, v16, v17, 1 bitop3:0xa8
  v_cmp_ne_u32 vcc, 0, v16
  s_nop 2
  s_cbranch_vccz L_R7_c1
L_R7_pf2:
  s_mov_b64 exec, vcc
  global_load_dwordx4 v[80:83], v1, s[50:51] sc1
  global_load_dwordx4 v[84:87], v1, s[50:51] offset:1024 sc1
  s_mov_b64 exec, -1
  s_waitcnt vmcnt(3)
  v_bitop3_b32 v16, v81, v83, s12 bitop3:0x7e
  v_mfma_f32_16x16x32_bf16 v[52:55], v[48:51], v[80:83], 0
  s_waitcnt vmcnt(2)
  v_bitop3_b32 v17, v85, v87, s12 bitop3:0x7e
  v_mfma_f32_16x16x32_bf16 v[52:55], v[48:51], v[84:87], v[52:55]
  v_bitop3_b32 v16, v16, v17, 1 bitop3:0xa8
  v_cmp_ne_u32 vcc, 0, v16
  s_nop 2
  s_cbranch_vccz L_R7_c1
  s_sub_u32 s7, s7, 1
  s_cbranch_scc0 L_R7_pf2
  s_mov_b32 s7, 0
  s_mov_b64 vcc, 0
  s_branch L_R7_c1
L_R7_of:
  s_nop 7
  ds_read_b128 v[48:51], v8 offset:4096
  ds_read_b128 v[52:55], v8 offset:4608
  ds_read_b128 v[76:79], v8 offset:5120
  s_waitcnt lgkmcnt(0)
  v_max_u32 v18, v49, v51
  v_max3_u32 v18, v18, v53, v55
  v_max3_u32 v18, v18, v77, v79
  v_cmp_eq_u32 vcc, -1, v18
  s_cbranch_vccz L_R7_og
  s_sub_u32 s7, s7, 1
  s_cbranch_scc0 L_R7_of
  s_mov_b32 s7, 0
  v_min_u32 v49, -2, v49
  v_min_u32 v51, -2, v51
  v_min_u32 v53, -2, v53
  v_min_u32 v55, -2, v55
  v_min_u32 v77, -2, v77
  v_min_u32 v79, -2, v79
L_R7_og:
  v_mfma_i32_16x16x4_4b_i8 v[32:47], v0, v0, 0
  s_nop 11
  v_smfmac_f32_16x16x64_bf16 v[32:35], v[72:75], a[216:223], v2
  v_smfmac_f32_16x16x64_bf16 v[36:39], v[72:75], a[248:255], v2
  v_smfmac_f32_16x16x64_bf16 v[40:43], v[72:75], v[24:31], v2
  v_smfmac_f32_16x16x64_bf16 v[44:47], v[72:75], v[88:95], v2
  s_branch L_R7_ok
L_R7_fw:
Lww_43:
  global_load_dword v19, v0, s[66:67] offset:0 sc1
  s_waitcnt vmcnt(0)
  v_cmp_gt_u32 vcc, 1, v19
  s_cbranch_vccz Lwd_44
  s_sub_u32 s7, s7, 1
  s_cbranch_scc0 Lww_43
  s_mov_b32 s7, 0
Lwd_44:
  s_branch L_R7_fok
.p2align 2
L_R7_slow2:
  s_nop 7
  s_nop 7
  ds_read_b128 v[32:35], v6 offset:0
  ds_read_b128 v[36:39], v6 offset:1024
  ds_read_b128 v[40:43], v8 offset:0
  ds_read_b128 v[44:47], v9 offset:0
  s_waitcnt lgkmcnt(0)
  v_mfma_f32_16x16x32_bf16 v[56:59], v[32:35], v[40:43], 0
  v_mfma_f32_16x16x32_bf16 v[60:63], v[36:39], v[40:43], 0
  v_mfma_f32_16x16x32_bf16 v[120:123], v[44:47], v[40:43], 0
  s_nop 7
  ds_read_b128 v[32:35], v6 offset:2048
  ds_read_b128 v[36:39], v6 offset:3072
  ds_read_b128 v[40:43], v8 offset:1024
  ds_read_b128 v[44:47], v9 offset:1024
  s_waitcnt lgkmcnt(0)
  v_mfma_f32_16x16x32_bf16 v[56:59], v[32:35], v[40:43], v[56:59]
  v_mfma_f32_16x16x32_bf16 v[60:63], v[36:39], v[40:43], v[60:63]
  v_mfma_f32_16x16x32_bf16 v[120:123], v[44:47], v[40:43], v[120:123]
  s_nop 7
  ds_read_b128 v[32:35], v6 offset:4096
  ds_read_b128 v[36:39], v6 offset:5120
  ds_read_b128 v[40:43], v8 offset:2048
  ds_read_b128 v[44:47], v9 offset:2048
  s_waitcnt lgkmcnt(0)
  v_mfma_f32_16x16x32_bf16 v[56:59], v[32:35], v[40:43], v[56:59]
  v_mfma_f32_16x16x32_bf16 v[60:63], v[36:39], v[40:43], v[60:63]
  v_mfma_f32_16x16x32_bf16 v[120:123], v[44:47], v[40:43], v[120:123]
  s_nop 7
  ds_read_b128 v[32:35], v6 offset:6144
  ds_read_b128 v[36:39], v6 offset:7168
  ds_read_b128 v[40:43], v8 offset:3072
  ds_read_b128 v[44:47], v9 offset:3072
  s_waitcnt lgkmcnt(0)
  v_mfma_f32_16x16x32_bf16 v[56:59], v[32:35], v[40:43], v[56:59]
  v_mfma_f32_16x16x32_bf16 v[60:63], v[36:39], v[40:43], v[60:63]
  v_mfma_f32_16x16x32_bf16 v[120:123], v[44:47], v[40:43], v[120:123]
  s_nop 7
  v_mfma_i32_16x16x4_4b_i8 v[32:47], v0, v0, 0
  v_max3_f32 v16, v56, v57, v58
  v_max3_f32 v17, v59, v60, v61
  v_max3_f32 v16, v16, v62, v63
  v_max3_f32 v17, v17, v120, v121
  v_max_f32 v18, v16, v17
  v_max_f32 v19, v16, v17
  s_nop 1
  v_permlane32_swap_b32 v18, v19
  v_max_f32 v16, v18, v19
  v_max_f32 v17, v18, v19
  s_nop 1
  v_permlane16_swap_b32 v16, v17
  v_max_f32 v16, v16, v17
  v_mul_f32 v13, 0xbe0293ee, v16
  v_fma_f32 v56, v56, s52, v13
  v_fma_f32 v57, v57, s52, v13
  v_exp_f32 v56, v56
  v_fma_f32 v58, v58, s52, v13
  v_exp_f32 v57, v57
  v_fma_f32 v59, v59, s52, v13
  v_exp_f32 v58, v58
  v_cvt_pk_bf16_f32 v56, v56, v57
  v_exp_f32 v59, v59
  v_fma_f32 v60, v60, s52, v13
  v_cvt_pk_bf16_f32 v57, v58, v59
  v_fma_f32 v61, v61, s52, v13
  v_exp_f32 v60, v60
  v_fma_f32 v62, v62, s52, v13
  v_exp_f32 v61, v61
  v_fma_f32 v63, v63, s52, v13
  v_exp_f32 v62, v62
  v_exp_f32 v63, v63
  v_cvt_pk_bf16_f32 v58, v60, v61
  v_cvt_pk_bf16_f32 v59, v62, v63
  v_fma_f32 v120, v120, s52, v13
  v_fma_f32 v121, v121, s52, v13
  v_exp_f32 v18, v120
  v_exp_f32 v19, v121
  v_mfma_f32_16x16x32_bf16 v[104:107], v[124:127], v[56:59], 0
  v_mfma_f32_16x16x32_bf16 v[96:99], v[80:83], v[56:59], 0
  v_mfma_f32_16x16x32_bf16 v[100:103], v[84:87], v[56:59], 0
  v_cvt_pk_bf16_f32 v14, v18, v19
  v_lshlrev_b64 v[16:17], v12, v[14:15]
  s_nop 1
  v_mfma_f32_16x16x16_bf16 v[108:111], v[124:125], v[16:17], v[104:107]
  s_nop 2
  v_cndmask_b32 v96, v96, v100, s[70:71]
  v_cndmask_b32 v97, v97, v101, s[70:71]
  v_cndmask_b32 v98, v98, v102, s[70:71]
  v_cndmask_b32 v99, v99, v103, s[70:71]
  s_nop 1
  v_mfma_f32_16x16x16_bf16 v[60:63], v[22:23], v[16:17], v[96:99]
  v_rcp_f32 v18, v108
  s_nop 7
  s_barrier
  s_branch L_R7_sy
.p2align 2
.section .rodata,"a"
.p2align 6
.amdhsa_kernel parallel_sum__memory_aug_recurrent_mem_tr__swiglu_ffn__prompt_kernel
  .amdhsa_next_free_vgpr 512
  .amdhsa_next_free_sgpr 102
  .amdhsa_accum_offset 256
  .amdhsa_group_segment_fixed_size 0
  .amdhsa_kernarg_size 112
  .amdhsa_user_sgpr_count 2
  .amdhsa_user_sgpr_kernarg_segment_ptr 1
  .amdhsa_system_sgpr_workgroup_id_x 1
.end_amdhsa_kernel
```
